```python
import torch

def _softmax(x, axis=-1):
    return torch.softmax(x, dim=axis)
def _gelu(x):
    return torch.nn.functional.gelu(x, approximate="tanh")
def _silu(x):
    return torch.nn.functional.silu(x)
def _sigmoid(x):
    return torch.sigmoid(x)
def _layernorm(x, axis=-1, eps=1e-5):
    m = x.mean(dim=axis, keepdim=True)
    v = x.var(dim=axis, keepdim=True, unbiased=False)
    return (x - m) / torch.sqrt(v + eps)
def _scatter_add(tgt, idx, src, axis=0):
    return tgt.clone().index_add_(axis, idx, src)
def _segment_sum(src, seg, n):
    out = torch.zeros((n,) + src.shape[1:], dtype=src.dtype)
    return out.index_add_(0, seg, src)
def _pad(x, pw):
    flat = tuple(v for pair in reversed(pw) for v in pair)
    return torch.nn.functional.pad(x, flat)

kernel_name = 'interleave_layers__spectral_gfnet__dense_activation_silu__prompt'

def setup_inputs():

    _w = (lambda a: (lambda t: t.to(torch.bfloat16) if t.is_floating_point() else t)(torch.as_tensor(a)))
    def _A_setup():
        B, S, D = 1, 2048, 1024
        Df = D // 2 + 1
        return {
            "x": _w((lambda *s: torch.randn(*s, dtype=torch.bfloat16) * 0.05)(B, S, D)),
            "w_r": _w((lambda *s: torch.randn(*s, dtype=torch.bfloat16) * 0.4)(S, Df) * 0.02),
            "w_i": _w((lambda *s: torch.randn(*s, dtype=torch.bfloat16) * 0.4)(S, Df) * 0.02),
        }
    _A_in = _A_setup()

    def _B_setup():
        B, S, D, F = 1, 2048, 1024, 3584
        return {
            "x": _w((lambda *s: torch.randn(*s, dtype=torch.bfloat16) * 0.05)(B, S, D)),
            "w1": _w((lambda *s: torch.randn(*s, dtype=torch.bfloat16) * 0.4)(D, F) * (D ** -0.5)),
            "w2": _w((lambda *s: torch.randn(*s, dtype=torch.bfloat16) * 0.1)(F, D) * (F ** -0.5)),
        }
    _B_in = _B_setup()

    return {
        "A_x": _A_in["x"],
        "A_w_r": _A_in["w_r"],
        "A_w_i": _A_in["w_i"],
        "B_x": _B_in["x"],
        "B_w1": _B_in["w1"],
        "B_w2": _B_in["w2"],
    }

def reference(A_x, A_w_r, A_w_i, B_x, B_w1, B_w2):
    def _A_ref(x, w_r, w_i):
        B, S, D = x.shape
        X = (lambda x, axes=(-2,-1): torch.fft.rfft2(x.float(), dim=axes))(x, axes=(-2, -1))
        W = w_r + 1j * w_i
        X = X * W
        y = (lambda x, s, axes=(-2,-1): torch.fft.irfft2(x, s=s, dim=axes).to(torch.bfloat16))(X, (S, D), axes=(-2, -1))
        return y

    def _B_ref(x, w1, w2):
        h = torch.einsum("bsd,df->bsf", x, w1)
        h = _silu(h)
        out = torch.einsum("bsf,fd->bsd", h, w2)
        return out

    x = A_x
    x = x + _A_ref(_layernorm(x, axis=-1), A_w_r, A_w_i)
    x = x + _B_ref(_layernorm(x, axis=-1), B_w1, B_w2)
    x = x + _A_ref(_layernorm(x, axis=-1), A_w_r, A_w_i)
    x = x + _B_ref(_layernorm(x, axis=-1), B_w1, B_w2)
    return x
```

```asm
; @launch kernel=k1_kernel grid=(256,1,1) block=(256,1,1) lds=70656
; @launch kernel=k2_kernel grid=(256,1,1) block=(512,1,1) lds=98304
; @launch kernel=ff_kernel grid=(256,1,1) block=(256,1,1) lds=131072
; @launch kernel=k2b_kernel grid=(256,1,1) block=(512,1,1) lds=98304
; @launch kernel=ffb_kernel grid=(256,1,1) block=(256,1,1) lds=163840
.amdgcn_target "amdgcn-amd-amdhsa--gfx950"
.text
.globl k1_kernel
.p2align 8
.type k1_kernel,@function
k1_kernel:
    s_cmp_ge_u32 s2, 256
    s_cbranch_scc1 END_k1_kernel
    s_load_dwordx16 s[32:47], s[0:1], 0
    s_load_dwordx2 s[4:5], s[0:1], 64
    s_getpc_b64 s[60:61]
PF_k1_kernel_1:
    v_lshlrev_b32 v2, 7, v0
    v_min_u32 v2, END_k1_kernel-PF_k1_kernel_1-4, v2
    v_mov_b32 v3, 0
    v_lshl_add_u64 v[2:3], v[2:3], 0, s[60:61]
    global_load_dword a40, v[2:3], off
    v_lshrrev_b32 v1, 6, v0
    v_and_b32 v5, 63, v0
    v_readfirstlane_b32 s24, v1
    s_cmp_lt_u32 s2, 64
    s_cbranch_scc1 K1_Rx
    s_cmp_lt_u32 s2, 128
    s_cbranch_scc1 K1_Rt
    s_cmp_lt_u32 s2, 240
    s_cbranch_scc1 K1_Rw
    s_branch K1_N3
K1_Rt:
    s_sub_u32 s3, s2, 64
    s_lshr_b32 s16, s24, 1
    s_lshl_b32 s16, s16, 8
    s_add_u32 s16, s16, s3
    s_mul_i32 s16, s16, 1026
    s_add_u32 s16, s16, 2
    s_bfe_u32 s19, s16, 0x30001
    s_and_b32 s16, s16, -16
    v_lshlrev_b32 v1, 4, v5
    v_and_b32 v2, 12, v5
    v_add_u32 v2, v2, v5
    v_mul_u32_u24 v2, 65664, v2
    v_lshrrev_b32 v3, 4, v5
    v_lshl_add_u32 v2, v3, 28, v2
    s_waitcnt lgkmcnt(0)
    s_mov_b32 s12, s4
    s_mov_b32 s13, s5
    s_mov_b32 s14, 268435456
    s_mov_b32 s15, 0x00020000
    s_mov_b32 s64, s40
    s_mov_b32 s65, s41
    s_mov_b32 s66, 7340032
    s_mov_b32 s67, 0x00020000
    s_mov_b32 s8, s34
    s_mov_b32 s9, s35
    s_mov_b32 s10, 2101248
    s_mov_b32 s11, 0x00020000
    s_mov_b32 s20, s36
    s_mov_b32 s21, s37
    s_mov_b32 s22, 2101248
    s_mov_b32 s23, 0x00020000
    s_bitcmp1_b32 s24, 0
    s_cselect_b32 s8, s20, s8
    s_cselect_b32 s9, s21, s9
    buffer_load_dwordx4 v[152:155], v2, s[8:11], s16 offen offset:1024 nt
    buffer_load_dwordx4 v[16:19], v1, s[8:11], s16 offen nt
    s_add_u32 s16, s16, 65664
    buffer_load_dwordx4 v[20:23], v1, s[8:11], s16 offen nt
    s_add_u32 s16, s16, 65664
    buffer_load_dwordx4 v[24:27], v1, s[8:11], s16 offen nt
    s_add_u32 s16, s16, 65664
    buffer_load_dwordx4 v[28:31], v1, s[8:11], s16 offen nt
    s_add_u32 s16, s16, 328320
    buffer_load_dwordx4 v[32:35], v1, s[8:11], s16 offen nt
    s_add_u32 s16, s16, 65664
    buffer_load_dwordx4 v[36:39], v1, s[8:11], s16 offen nt
    s_add_u32 s16, s16, 65664
    buffer_load_dwordx4 v[40:43], v1, s[8:11], s16 offen nt
    s_add_u32 s16, s16, 65664
    buffer_load_dwordx4 v[44:47], v1, s[8:11], s16 offen nt
    s_add_u32 s16, s16, 328320
    buffer_load_dwordx4 v[48:51], v1, s[8:11], s16 offen nt
    s_add_u32 s16, s16, 65664
    buffer_load_dwordx4 v[52:55], v1, s[8:11], s16 offen nt
    s_add_u32 s16, s16, 65664
    buffer_load_dwordx4 v[56:59], v1, s[8:11], s16 offen nt
    s_add_u32 s16, s16, 65664
    buffer_load_dwordx4 v[60:63], v1, s[8:11], s16 offen nt
    s_add_u32 s16, s16, 328320
    buffer_load_dwordx4 v[64:67], v1, s[8:11], s16 offen nt
    s_add_u32 s16, s16, 65664
    buffer_load_dwordx4 v[68:71], v1, s[8:11], s16 offen nt
    s_add_u32 s16, s16, 65664
    buffer_load_dwordx4 v[72:75], v1, s[8:11], s16 offen nt
    s_add_u32 s16, s16, 65664
    buffer_load_dwordx4 v[76:79], v1, s[8:11], s16 offen nt
    s_mov_b32 s30, 0x05040100
    s_mov_b32 s31, 0x07060302
    s_lshl_b32 s17, s24, 1
    v_and_b32 v6, 7, v5
    v_xor_b32 v9, s17, v6
    v_lshlrev_b32 v9, 4, v9
    v_lshl_add_u32 v9, v5, 10, v9
    v_xor_b32 v10, 16, v9
    s_lshl_b32 s17, s24, 5
    s_add_u32 s17, s17, 0x10000
    v_lshl_add_u32 v11, v5, 1, s17
    v_lshl_add_u32 v11, v3, 10, v11
    s_lshl_b32 s17, s24, 14
    v_lshrrev_b32 v7, 3, v5
    v_add_u32 v7, s19, v7
    v_lshrrev_b32 v8, 3, v7
    v_lshl_add_u32 v7, v7, 7, s17
    s_mul_i32 s18, s3, 65536
    s_add_u32 s18, s18, s17
    s_add_u32 s18, s18, 58720256
    v_add_u32 v144, 0, v8
    v_and_b32 v144, 7, v144
    v_xor_b32 v144, v144, v6
    v_lshl_add_u32 v144, v144, 4, v7
    v_add_u32 v145, 1, v8
    v_and_b32 v145, 7, v145
    v_xor_b32 v145, v145, v6
    v_lshl_add_u32 v145, v145, 4, v7
    v_add_u32 v146, 2, v8
    v_and_b32 v146, 7, v146
    v_xor_b32 v146, v146, v6
    v_lshl_add_u32 v146, v146, 4, v7
    v_add_u32 v147, 3, v8
    v_and_b32 v147, 7, v147
    v_xor_b32 v147, v147, v6
    v_lshl_add_u32 v147, v147, 4, v7
    v_add_u32 v148, 4, v8
    v_and_b32 v148, 7, v148
    v_xor_b32 v148, v148, v6
    v_lshl_add_u32 v148, v148, 4, v7
    v_add_u32 v149, 5, v8
    v_and_b32 v149, 7, v149
    v_xor_b32 v149, v149, v6
    v_lshl_add_u32 v149, v149, 4, v7
    v_add_u32 v150, 6, v8
    v_and_b32 v150, 7, v150
    v_xor_b32 v150, v150, v6
    v_lshl_add_u32 v150, v150, 4, v7
    v_add_u32 v151, 7, v8
    v_and_b32 v151, 7, v151
    v_xor_b32 v151, v151, v6
    v_lshl_add_u32 v151, v151, 4, v7
    s_waitcnt vmcnt(16)
    ds_write_b16 v11, v152 offset:0
    ds_write_b16_d16_hi v11, v152 offset:128
    ds_write_b16 v11, v153 offset:256
    ds_write_b16_d16_hi v11, v153 offset:384
    ds_write_b16 v11, v154 offset:512
    ds_write_b16_d16_hi v11, v154 offset:640
    ds_write_b16 v11, v155 offset:768
    ds_write_b16_d16_hi v11, v155 offset:896
    s_waitcnt vmcnt(8)
    v_perm_b32 v80, v20, v16, s30
    v_perm_b32 v81, v28, v24, s30
    v_perm_b32 v82, v36, v32, s30
    v_perm_b32 v83, v44, v40, s30
    ds_write_b128 v9, v[80:83] offset:0
    v_perm_b32 v84, v20, v16, s31
    v_perm_b32 v85, v28, v24, s31
    v_perm_b32 v86, v36, v32, s31
    v_perm_b32 v87, v44, v40, s31
    ds_write_b128 v9, v[84:87] offset:128
    v_perm_b32 v88, v21, v17, s30
    v_perm_b32 v89, v29, v25, s30
    v_perm_b32 v90, v37, v33, s30
    v_perm_b32 v91, v45, v41, s30
    ds_write_b128 v9, v[88:91] offset:256
    v_perm_b32 v92, v21, v17, s31
    v_perm_b32 v93, v29, v25, s31
    v_perm_b32 v94, v37, v33, s31
    v_perm_b32 v95, v45, v41, s31
    ds_write_b128 v9, v[92:95] offset:384
    v_perm_b32 v96, v22, v18, s30
    v_perm_b32 v97, v30, v26, s30
    v_perm_b32 v98, v38, v34, s30
    v_perm_b32 v99, v46, v42, s30
    ds_write_b128 v9, v[96:99] offset:512
    v_perm_b32 v100, v22, v18, s31
    v_perm_b32 v101, v30, v26, s31
    v_perm_b32 v102, v38, v34, s31
    v_perm_b32 v103, v46, v42, s31
    ds_write_b128 v9, v[100:103] offset:640
    v_perm_b32 v104, v23, v19, s30
    v_perm_b32 v105, v31, v27, s30
    v_perm_b32 v106, v39, v35, s30
    v_perm_b32 v107, v47, v43, s30
    ds_write_b128 v9, v[104:107] offset:768
    v_perm_b32 v108, v23, v19, s31
    v_perm_b32 v109, v31, v27, s31
    v_perm_b32 v110, v39, v35, s31
    v_perm_b32 v111, v47, v43, s31
    ds_write_b128 v9, v[108:111] offset:896
    s_waitcnt vmcnt(0)
    v_perm_b32 v112, v52, v48, s30
    v_perm_b32 v113, v60, v56, s30
    v_perm_b32 v114, v68, v64, s30
    v_perm_b32 v115, v76, v72, s30
    ds_write_b128 v10, v[112:115] offset:0
    v_perm_b32 v116, v52, v48, s31
    v_perm_b32 v117, v60, v56, s31
    v_perm_b32 v118, v68, v64, s31
    v_perm_b32 v119, v76, v72, s31
    ds_write_b128 v10, v[116:119] offset:128
    v_perm_b32 v120, v53, v49, s30
    v_perm_b32 v121, v61, v57, s30
    v_perm_b32 v122, v69, v65, s30
    v_perm_b32 v123, v77, v73, s30
    ds_write_b128 v10, v[120:123] offset:256
    v_perm_b32 v124, v53, v49, s31
    v_perm_b32 v125, v61, v57, s31
    v_perm_b32 v126, v69, v65, s31
    v_perm_b32 v127, v77, v73, s31
    ds_write_b128 v10, v[124:127] offset:384
    v_perm_b32 v128, v54, v50, s30
    v_perm_b32 v129, v62, v58, s30
    v_perm_b32 v130, v70, v66, s30
    v_perm_b32 v131, v78, v74, s30
    ds_write_b128 v10, v[128:131] offset:512
    v_perm_b32 v132, v54, v50, s31
    v_perm_b32 v133, v62, v58, s31
    v_perm_b32 v134, v70, v66, s31
    v_perm_b32 v135, v78, v74, s31
    ds_write_b128 v10, v[132:135] offset:640
    v_perm_b32 v136, v55, v51, s30
    v_perm_b32 v137, v63, v59, s30
    v_perm_b32 v138, v71, v67, s30
    v_perm_b32 v139, v79, v75, s30
    ds_write_b128 v10, v[136:139] offset:768
    v_perm_b32 v140, v55, v51, s31
    v_perm_b32 v141, v63, v59, s31
    v_perm_b32 v142, v71, v67, s31
    v_perm_b32 v143, v79, v75, s31
    ds_write_b128 v10, v[140:143] offset:896
    s_waitcnt lgkmcnt(0)
    s_barrier
    ds_read_b128 v[16:19], v144 offset:0
    ds_read_b128 v[20:23], v145 offset:1024
    ds_read_b128 v[24:27], v146 offset:2048
    ds_read_b128 v[28:31], v147 offset:3072
    ds_read_b128 v[32:35], v148 offset:4096
    ds_read_b128 v[36:39], v149 offset:5120
    ds_read_b128 v[40:43], v150 offset:6144
    ds_read_b128 v[44:47], v151 offset:7168
    ds_read_b128 v[48:51], v144 offset:8192
    ds_read_b128 v[52:55], v145 offset:9216
    ds_read_b128 v[56:59], v146 offset:10240
    ds_read_b128 v[60:63], v147 offset:11264
    ds_read_b128 v[64:67], v148 offset:12288
    ds_read_b128 v[68:71], v149 offset:13312
    ds_read_b128 v[72:75], v150 offset:14336
    ds_read_b128 v[76:79], v151 offset:15360
    s_waitcnt lgkmcnt(15)
    buffer_store_dwordx4 v[16:19], v1, s[12:15], s18 offen offset:0 sc1
    s_waitcnt lgkmcnt(14)
    buffer_store_dwordx4 v[20:23], v1, s[12:15], s18 offen offset:1024 sc1
    s_waitcnt lgkmcnt(13)
    buffer_store_dwordx4 v[24:27], v1, s[12:15], s18 offen offset:2048 sc1
    s_waitcnt lgkmcnt(12)
    buffer_store_dwordx4 v[28:31], v1, s[12:15], s18 offen offset:3072 sc1
    s_add_u32 s18, s18, 4096
    s_waitcnt lgkmcnt(11)
    buffer_store_dwordx4 v[32:35], v1, s[12:15], s18 offen offset:0 sc1
    s_waitcnt lgkmcnt(10)
    buffer_store_dwordx4 v[36:39], v1, s[12:15], s18 offen offset:1024 sc1
    s_waitcnt lgkmcnt(9)
    buffer_store_dwordx4 v[40:43], v1, s[12:15], s18 offen offset:2048 sc1
    s_waitcnt lgkmcnt(8)
    buffer_store_dwordx4 v[44:47], v1, s[12:15], s18 offen offset:3072 sc1
    s_add_u32 s18, s18, 4096
    s_waitcnt lgkmcnt(7)
    buffer_store_dwordx4 v[48:51], v1, s[12:15], s18 offen offset:0 sc1
    s_waitcnt lgkmcnt(6)
    buffer_store_dwordx4 v[52:55], v1, s[12:15], s18 offen offset:1024 sc1
    s_waitcnt lgkmcnt(5)
    buffer_store_dwordx4 v[56:59], v1, s[12:15], s18 offen offset:2048 sc1
    s_waitcnt lgkmcnt(4)
    buffer_store_dwordx4 v[60:63], v1, s[12:15], s18 offen offset:3072 sc1
    s_add_u32 s18, s18, 4096
    s_waitcnt lgkmcnt(3)
    buffer_store_dwordx4 v[64:67], v1, s[12:15], s18 offen offset:0 sc1
    s_waitcnt lgkmcnt(2)
    buffer_store_dwordx4 v[68:71], v1, s[12:15], s18 offen offset:1024 sc1
    s_waitcnt lgkmcnt(1)
    buffer_store_dwordx4 v[72:75], v1, s[12:15], s18 offen offset:2048 sc1
    s_waitcnt lgkmcnt(0)
    buffer_store_dwordx4 v[76:79], v1, s[12:15], s18 offen offset:3072 sc1
    s_branch K1_DONE
K1_Rx:
    s_sub_u32 s3, s2, 0
    s_lshr_b32 s25, s3, 3
    s_add_u32 s25, s25, 0
    s_mov_b32 s68, s25
    s_lshl2_add_u32 s3, s3, s24
    v_bfe_u32 v1, v5, 1, 1
    v_bfe_u32 v2, v5, 3, 2
    v_lshl_add_u32 v1, v2, 1, v1
    v_and_b32 v2, 4, v1
    v_add_u32 v1, v1, v2
    v_lshlrev_b32 v1, 16, v1
    v_lshrrev_b32 v2, 5, v5
    v_lshl_add_u32 v1, v2, 6, v1
    v_bfe_u32 v2, v5, 2, 1
    v_lshl_add_u32 v1, v2, 5, v1
    v_and_b32 v2, 1, v5
    v_lshl_add_u32 v1, v2, 4, v1
    s_lshr_b32 s16, s3, 6
    s_lshl_b32 s16, s16, 9
    s_and_b32 s17, s3, 32
    s_lshl2_add_u32 s16, s17, s16
    s_and_b32 s17, s3, 31
    s_add_u32 s16, s16, s17
    s_lshl_b32 s16, s16, 11
    v_and_b32 v6, 31, v5
    v_lshrrev_b32 v7, 5, v5
    v_cvt_f32_u32 v6, v6
    v_cvt_f32_u32 v7, v7
    v_mul_f32 v8, 0xbd000000, v6
    v_mul_f32 v9, v8, v7
    v_mul_f32 v11, 0x41000000, v8
    v_fmamk_f32 v240, v8, 0x00000000, v9
    v_fmamk_f32 v241, v8, 0x40000000, v9
    v_fmamk_f32 v242, v8, 0x40800000, v9
    s_waitcnt lgkmcnt(0)
    s_mov_b32 s12, s4
    s_mov_b32 s13, s5
    s_mov_b32 s14, 268435456
    s_mov_b32 s15, 0x00020000
    s_mov_b32 s64, s40
    s_mov_b32 s65, s41
    s_mov_b32 s66, 7340032
    s_mov_b32 s67, 0x00020000
    s_mov_b32 s8, s32
    s_mov_b32 s9, s33
    s_mov_b32 s10, 4194304
    s_mov_b32 s11, 0x00020000
    buffer_load_dwordx4 v[16:19], v1, s[8:11], s16 offen offset:0 nt
    buffer_load_dwordx4 v[20:23], v1, s[8:11], s16 offen offset:128 nt
    buffer_load_dwordx4 v[24:27], v1, s[8:11], s16 offen offset:256 nt
    buffer_load_dwordx4 v[28:31], v1, s[8:11], s16 offen offset:384 nt
    buffer_load_dwordx4 v[32:35], v1, s[8:11], s16 offen offset:512 nt
    buffer_load_dwordx4 v[36:39], v1, s[8:11], s16 offen offset:640 nt
    buffer_load_dwordx4 v[40:43], v1, s[8:11], s16 offen offset:768 nt
    buffer_load_dwordx4 v[44:47], v1, s[8:11], s16 offen offset:896 nt
    buffer_load_dwordx4 v[48:51], v1, s[8:11], s16 offen offset:1024 nt
    buffer_load_dwordx4 v[52:55], v1, s[8:11], s16 offen offset:1152 nt
    buffer_load_dwordx4 v[56:59], v1, s[8:11], s16 offen offset:1280 nt
    buffer_load_dwordx4 v[60:63], v1, s[8:11], s16 offen offset:1408 nt
    buffer_load_dwordx4 v[64:67], v1, s[8:11], s16 offen offset:1536 nt
    buffer_load_dwordx4 v[68:71], v1, s[8:11], s16 offen offset:1664 nt
    buffer_load_dwordx4 v[72:75], v1, s[8:11], s16 offen offset:1792 nt
    buffer_load_dwordx4 v[76:79], v1, s[8:11], s16 offen offset:1920 nt
    v_fmamk_f32 v243, v8, 0x40c00000, v9
    v_cos_f32 v10, v11
    v_sin_f32 v11, v11
    v_cos_f32 v224, v240
    v_cos_f32 v225, v241
    v_cos_f32 v226, v242
    v_cos_f32 v227, v243
    v_sin_f32 v240, v240
    v_sin_f32 v241, v241
    v_sin_f32 v242, v242
    v_sin_f32 v243, v243
    v_pk_mul_f32 v[228:229], v[224:225], v[10:11] op_sel:[0,0] op_sel_hi:[1,0]
    v_pk_mul_f32 v[244:245], v[240:241], v[10:11] op_sel:[0,0] op_sel_hi:[1,0]
    v_pk_mul_f32 v[230:231], v[226:227], v[10:11] op_sel:[0,0] op_sel_hi:[1,0]
    v_pk_mul_f32 v[246:247], v[242:243], v[10:11] op_sel:[0,0] op_sel_hi:[1,0]
    v_pk_fma_f32 v[228:229], v[240:241], v[10:11], v[228:229] op_sel:[0,1,0] op_sel_hi:[1,1,1] neg_lo:[1,0,0] neg_hi:[1,0,0]
    v_pk_fma_f32 v[244:245], v[224:225], v[10:11], v[244:245] op_sel:[0,1,0] op_sel_hi:[1,1,1]
    v_pk_fma_f32 v[230:231], v[242:243], v[10:11], v[230:231] op_sel:[0,1,0] op_sel_hi:[1,1,1] neg_lo:[1,0,0] neg_hi:[1,0,0]
    v_pk_fma_f32 v[246:247], v[226:227], v[10:11], v[246:247] op_sel:[0,1,0] op_sel_hi:[1,1,1]
    v_pk_mul_f32 v[232:233], v[228:229], v[10:11] op_sel:[0,0] op_sel_hi:[1,0]
    v_pk_mul_f32 v[248:249], v[244:245], v[10:11] op_sel:[0,0] op_sel_hi:[1,0]
    v_pk_mul_f32 v[234:235], v[230:231], v[10:11] op_sel:[0,0] op_sel_hi:[1,0]
    v_pk_mul_f32 v[250:251], v[246:247], v[10:11] op_sel:[0,0] op_sel_hi:[1,0]
    v_pk_fma_f32 v[232:233], v[244:245], v[10:11], v[232:233] op_sel:[0,1,0] op_sel_hi:[1,1,1] neg_lo:[1,0,0] neg_hi:[1,0,0]
    v_pk_fma_f32 v[248:249], v[228:229], v[10:11], v[248:249] op_sel:[0,1,0] op_sel_hi:[1,1,1]
    v_pk_fma_f32 v[234:235], v[246:247], v[10:11], v[234:235] op_sel:[0,1,0] op_sel_hi:[1,1,1] neg_lo:[1,0,0] neg_hi:[1,0,0]
    v_pk_fma_f32 v[250:251], v[230:231], v[10:11], v[250:251] op_sel:[0,1,0] op_sel_hi:[1,1,1]
    v_pk_mul_f32 v[236:237], v[232:233], v[10:11] op_sel:[0,0] op_sel_hi:[1,0]
    v_pk_mul_f32 v[252:253], v[248:249], v[10:11] op_sel:[0,0] op_sel_hi:[1,0]
    v_pk_mul_f32 v[238:239], v[234:235], v[10:11] op_sel:[0,0] op_sel_hi:[1,0]
    v_pk_mul_f32 v[254:255], v[250:251], v[10:11] op_sel:[0,0] op_sel_hi:[1,0]
    v_pk_fma_f32 v[236:237], v[248:249], v[10:11], v[236:237] op_sel:[0,1,0] op_sel_hi:[1,1,1] neg_lo:[1,0,0] neg_hi:[1,0,0]
    v_pk_fma_f32 v[252:253], v[232:233], v[10:11], v[252:253] op_sel:[0,1,0] op_sel_hi:[1,1,1]
    v_pk_fma_f32 v[238:239], v[250:251], v[10:11], v[238:239] op_sel:[0,1,0] op_sel_hi:[1,1,1] neg_lo:[1,0,0] neg_hi:[1,0,0]
    v_pk_fma_f32 v[254:255], v[234:235], v[10:11], v[254:255] op_sel:[0,1,0] op_sel_hi:[1,1,1]
    v_cvt_pk_bf16_f32 v224, v224, v225
    v_cvt_pk_bf16_f32 v226, v226, v227
    v_cvt_pk_bf16_f32 v228, v228, v229
    v_cvt_pk_bf16_f32 v230, v230, v231
    v_cvt_pk_bf16_f32 v232, v232, v233
    v_cvt_pk_bf16_f32 v234, v234, v235
    v_cvt_pk_bf16_f32 v236, v236, v237
    v_cvt_pk_bf16_f32 v238, v238, v239
    v_cvt_pk_bf16_f32 v240, v240, v241
    v_cvt_pk_bf16_f32 v242, v242, v243
    v_cvt_pk_bf16_f32 v244, v244, v245
    v_cvt_pk_bf16_f32 v246, v246, v247
    v_cvt_pk_bf16_f32 v248, v248, v249
    v_cvt_pk_bf16_f32 v250, v250, v251
    v_cvt_pk_bf16_f32 v252, v252, v253
    v_cvt_pk_bf16_f32 v254, v254, v255
    v_accvgpr_write_b32 a0, v224
    v_accvgpr_write_b32 a1, v226
    v_accvgpr_write_b32 a2, v228
    v_accvgpr_write_b32 a3, v230
    v_accvgpr_write_b32 a4, v232
    v_accvgpr_write_b32 a5, v234
    v_accvgpr_write_b32 a6, v236
    v_accvgpr_write_b32 a7, v238
    v_accvgpr_write_b32 a8, v240
    v_accvgpr_write_b32 a9, v242
    v_accvgpr_write_b32 a10, v244
    v_accvgpr_write_b32 a11, v246
    v_accvgpr_write_b32 a12, v248
    v_accvgpr_write_b32 a13, v250
    v_accvgpr_write_b32 a14, v252
    v_accvgpr_write_b32 a15, v254
    v_bfe_u32 v8, v5, 1, 4
    v_cvt_f32_u32 v8, v8
    v_and_b32 v12, 1, v5
    v_cvt_f32_u32 v9, v12
    v_mul_f32 v8, 0x3d000000, v8
    v_mul_f32 v9, 0x3e800000, v9
    v_mul_f32 v7, 0x41800000, v7
    v_fmac_f32 v9, v8, v7
    v_mul_f32 v11, 0x40000000, v8
    v_fmamk_f32 v240, v8, 0x00000000, v9
    v_fmamk_f32 v241, v8, 0x41000000, v9
    v_fmamk_f32 v242, v8, 0x3f800000, v9
    v_fmamk_f32 v243, v8, 0x41100000, v9
    v_cos_f32 v10, v11
    v_sin_f32 v11, v11
    v_cos_f32 v224, v240
    v_cos_f32 v225, v241
    v_cos_f32 v226, v242
    v_cos_f32 v227, v243
    v_sin_f32 v240, v240
    v_sin_f32 v241, v241
    v_sin_f32 v242, v242
    v_sin_f32 v243, v243
    v_pk_mul_f32 v[228:229], v[224:225], v[10:11] op_sel:[0,0] op_sel_hi:[1,0]
    v_pk_mul_f32 v[244:245], v[240:241], v[10:11] op_sel:[0,0] op_sel_hi:[1,0]
    v_pk_mul_f32 v[230:231], v[226:227], v[10:11] op_sel:[0,0] op_sel_hi:[1,0]
    v_pk_mul_f32 v[246:247], v[242:243], v[10:11] op_sel:[0,0] op_sel_hi:[1,0]
    v_pk_fma_f32 v[228:229], v[240:241], v[10:11], v[228:229] op_sel:[0,1,0] op_sel_hi:[1,1,1] neg_lo:[1,0,0] neg_hi:[1,0,0]
    v_pk_fma_f32 v[244:245], v[224:225], v[10:11], v[244:245] op_sel:[0,1,0] op_sel_hi:[1,1,1]
    v_pk_fma_f32 v[230:231], v[242:243], v[10:11], v[230:231] op_sel:[0,1,0] op_sel_hi:[1,1,1] neg_lo:[1,0,0] neg_hi:[1,0,0]
    v_pk_fma_f32 v[246:247], v[226:227], v[10:11], v[246:247] op_sel:[0,1,0] op_sel_hi:[1,1,1]
    v_pk_mul_f32 v[232:233], v[228:229], v[10:11] op_sel:[0,0] op_sel_hi:[1,0]
    v_pk_mul_f32 v[248:249], v[244:245], v[10:11] op_sel:[0,0] op_sel_hi:[1,0]
    v_pk_mul_f32 v[234:235], v[230:231], v[10:11] op_sel:[0,0] op_sel_hi:[1,0]
    v_pk_mul_f32 v[250:251], v[246:247], v[10:11] op_sel:[0,0] op_sel_hi:[1,0]
    v_pk_fma_f32 v[232:233], v[244:245], v[10:11], v[232:233] op_sel:[0,1,0] op_sel_hi:[1,1,1] neg_lo:[1,0,0] neg_hi:[1,0,0]
    v_pk_fma_f32 v[248:249], v[228:229], v[10:11], v[248:249] op_sel:[0,1,0] op_sel_hi:[1,1,1]
    v_pk_fma_f32 v[234:235], v[246:247], v[10:11], v[234:235] op_sel:[0,1,0] op_sel_hi:[1,1,1] neg_lo:[1,0,0] neg_hi:[1,0,0]
    v_pk_fma_f32 v[250:251], v[230:231], v[10:11], v[250:251] op_sel:[0,1,0] op_sel_hi:[1,1,1]
    v_pk_mul_f32 v[236:237], v[232:233], v[10:11] op_sel:[0,0] op_sel_hi:[1,0]
    v_pk_mul_f32 v[252:253], v[248:249], v[10:11] op_sel:[0,0] op_sel_hi:[1,0]
    v_pk_mul_f32 v[238:239], v[234:235], v[10:11] op_sel:[0,0] op_sel_hi:[1,0]
    v_pk_mul_f32 v[254:255], v[250:251], v[10:11] op_sel:[0,0] op_sel_hi:[1,0]
    v_pk_fma_f32 v[236:237], v[248:249], v[10:11], v[236:237] op_sel:[0,1,0] op_sel_hi:[1,1,1] neg_lo:[1,0,0] neg_hi:[1,0,0]
    v_pk_fma_f32 v[252:253], v[232:233], v[10:11], v[252:253] op_sel:[0,1,0] op_sel_hi:[1,1,1]
    v_pk_fma_f32 v[238:239], v[250:251], v[10:11], v[238:239] op_sel:[0,1,0] op_sel_hi:[1,1,1] neg_lo:[1,0,0] neg_hi:[1,0,0]
    v_pk_fma_f32 v[254:255], v[234:235], v[10:11], v[254:255] op_sel:[0,1,0] op_sel_hi:[1,1,1]
    v_cvt_pk_bf16_f32 v224, v224, v225
    v_cvt_pk_bf16_f32 v226, v226, v227
    v_cvt_pk_bf16_f32 v228, v228, v229
    v_cvt_pk_bf16_f32 v230, v230, v231
    v_cvt_pk_bf16_f32 v232, v232, v233
    v_cvt_pk_bf16_f32 v234, v234, v235
    v_cvt_pk_bf16_f32 v236, v236, v237
    v_cvt_pk_bf16_f32 v238, v238, v239
    v_cvt_pk_bf16_f32 v240, v240, v241
    v_cvt_pk_bf16_f32 v242, v242, v243
    v_cvt_pk_bf16_f32 v244, v244, v245
    v_cvt_pk_bf16_f32 v246, v246, v247
    v_cvt_pk_bf16_f32 v248, v248, v249
    v_cvt_pk_bf16_f32 v250, v250, v251
    v_cvt_pk_bf16_f32 v252, v252, v253
    v_cvt_pk_bf16_f32 v254, v254, v255
    v_accvgpr_write_b32 a16, v224
    v_accvgpr_write_b32 a17, v226
    v_accvgpr_write_b32 a18, v228
    v_accvgpr_write_b32 a19, v230
    v_accvgpr_write_b32 a20, v232
    v_accvgpr_write_b32 a21, v234
    v_accvgpr_write_b32 a22, v236
    v_accvgpr_write_b32 a23, v238
    v_accvgpr_write_b32 a24, v240
    v_accvgpr_write_b32 a25, v242
    v_accvgpr_write_b32 a26, v244
    v_accvgpr_write_b32 a27, v246
    v_accvgpr_write_b32 a28, v248
    v_accvgpr_write_b32 a29, v250
    v_accvgpr_write_b32 a30, v252
    v_accvgpr_write_b32 a31, v254
    v_mul_f32 v8, 0xba800000, v6
    v_mul_f32 v9, v8, v7
    s_mov_b32 s28, 0x3d3504f3
    v_mul_f32 v11, 0x40000000, v8
    v_fmamk_f32 v240, v8, 0x00000000, v9
    v_fmamk_f32 v241, v8, 0x41000000, v9
    v_fmamk_f32 v242, v8, 0x3f800000, v9
    v_fmamk_f32 v243, v8, 0x41100000, v9
    v_cos_f32 v10, v11
    v_sin_f32 v11, v11
    v_cos_f32 v224, v240
    v_cos_f32 v225, v241
    v_cos_f32 v226, v242
    v_cos_f32 v227, v243
    v_sin_f32 v240, v240
    v_sin_f32 v241, v241
    v_sin_f32 v242, v242
    v_sin_f32 v243, v243
    v_pk_mul_f32 v[224:225], v[224:225], s[28:29] op_sel_hi:[1,0]
    v_pk_mul_f32 v[226:227], v[226:227], s[28:29] op_sel_hi:[1,0]
    v_pk_mul_f32 v[240:241], v[240:241], s[28:29] op_sel_hi:[1,0]
    v_pk_mul_f32 v[242:243], v[242:243], s[28:29] op_sel_hi:[1,0]
    v_pk_mul_f32 v[228:229], v[224:225], v[10:11] op_sel:[0,0] op_sel_hi:[1,0]
    v_pk_mul_f32 v[244:245], v[240:241], v[10:11] op_sel:[0,0] op_sel_hi:[1,0]
    v_pk_mul_f32 v[230:231], v[226:227], v[10:11] op_sel:[0,0] op_sel_hi:[1,0]
    v_pk_mul_f32 v[246:247], v[242:243], v[10:11] op_sel:[0,0] op_sel_hi:[1,0]
    v_pk_fma_f32 v[228:229], v[240:241], v[10:11], v[228:229] op_sel:[0,1,0] op_sel_hi:[1,1,1] neg_lo:[1,0,0] neg_hi:[1,0,0]
    v_pk_fma_f32 v[244:245], v[224:225], v[10:11], v[244:245] op_sel:[0,1,0] op_sel_hi:[1,1,1]
    v_pk_fma_f32 v[230:231], v[242:243], v[10:11], v[230:231] op_sel:[0,1,0] op_sel_hi:[1,1,1] neg_lo:[1,0,0] neg_hi:[1,0,0]
    v_pk_fma_f32 v[246:247], v[226:227], v[10:11], v[246:247] op_sel:[0,1,0] op_sel_hi:[1,1,1]
    v_pk_mul_f32 v[232:233], v[228:229], v[10:11] op_sel:[0,0] op_sel_hi:[1,0]
    v_pk_mul_f32 v[248:249], v[244:245], v[10:11] op_sel:[0,0] op_sel_hi:[1,0]
    v_pk_mul_f32 v[234:235], v[230:231], v[10:11] op_sel:[0,0] op_sel_hi:[1,0]
    v_pk_mul_f32 v[250:251], v[246:247], v[10:11] op_sel:[0,0] op_sel_hi:[1,0]
    v_pk_fma_f32 v[232:233], v[244:245], v[10:11], v[232:233] op_sel:[0,1,0] op_sel_hi:[1,1,1] neg_lo:[1,0,0] neg_hi:[1,0,0]
    v_pk_fma_f32 v[248:249], v[228:229], v[10:11], v[248:249] op_sel:[0,1,0] op_sel_hi:[1,1,1]
    v_pk_fma_f32 v[234:235], v[246:247], v[10:11], v[234:235] op_sel:[0,1,0] op_sel_hi:[1,1,1] neg_lo:[1,0,0] neg_hi:[1,0,0]
    v_pk_fma_f32 v[250:251], v[230:231], v[10:11], v[250:251] op_sel:[0,1,0] op_sel_hi:[1,1,1]
    v_pk_mul_f32 v[236:237], v[232:233], v[10:11] op_sel:[0,0] op_sel_hi:[1,0]
    v_pk_mul_f32 v[252:253], v[248:249], v[10:11] op_sel:[0,0] op_sel_hi:[1,0]
    v_pk_mul_f32 v[238:239], v[234:235], v[10:11] op_sel:[0,0] op_sel_hi:[1,0]
    v_pk_mul_f32 v[254:255], v[250:251], v[10:11] op_sel:[0,0] op_sel_hi:[1,0]
    v_pk_fma_f32 v[236:237], v[248:249], v[10:11], v[236:237] op_sel:[0,1,0] op_sel_hi:[1,1,1] neg_lo:[1,0,0] neg_hi:[1,0,0]
    v_pk_fma_f32 v[252:253], v[232:233], v[10:11], v[252:253] op_sel:[0,1,0] op_sel_hi:[1,1,1]
    v_pk_fma_f32 v[238:239], v[250:251], v[10:11], v[238:239] op_sel:[0,1,0] op_sel_hi:[1,1,1] neg_lo:[1,0,0] neg_hi:[1,0,0]
    v_pk_fma_f32 v[254:255], v[234:235], v[10:11], v[254:255] op_sel:[0,1,0] op_sel_hi:[1,1,1]
    v_mov_b32 v10, 0x3f803f80
    v_lshlrev_b32 v11, 31, v12
    v_lshrrev_b32 v12, 16, v11
    v_or_b32 v11, v11, v12
    v_xor_b32 v11, v10, v11
    v_accvgpr_write_b32 a32, v10
    v_accvgpr_write_b32 a33, v11
    v_accvgpr_write_b32 a34, v10
    v_accvgpr_write_b32 a35, v11
    s_mov_b32 s30, 0x05040100
    s_mov_b32 s31, 0x07060302
    s_waitcnt vmcnt(0)
    v_perm_b32 v208, v20, v16, s30
    v_perm_b32 v209, v28, v24, s30
    v_perm_b32 v210, v36, v32, s30
    v_perm_b32 v211, v44, v40, s30
    v_perm_b32 v212, v52, v48, s30
    v_perm_b32 v213, v60, v56, s30
    v_perm_b32 v214, v68, v64, s30
    v_perm_b32 v215, v76, v72, s30
    s_nop 1
    v_mfma_f32_32x32x16_bf16 v[144:159], v[208:211], a[0:3], 0
    v_perm_b32 v216, v20, v16, s31
    v_perm_b32 v217, v28, v24, s31
    v_perm_b32 v218, v36, v32, s31
    v_perm_b32 v219, v44, v40, s31
    v_perm_b32 v220, v52, v48, s31
    v_mfma_f32_32x32x16_bf16 v[160:175], v[208:211], a[8:11], 0
    v_perm_b32 v221, v60, v56, s31
    v_perm_b32 v222, v68, v64, s31
    v_perm_b32 v223, v76, v72, s31
    v_mfma_f32_32x32x16_bf16 v[144:159], v[212:215], a[4:7], v[144:159]
    v_mfma_f32_32x32x16_bf16 v[160:175], v[212:215], a[12:15], v[160:175]
    s_nop 11
    v_pk_mul_f32 v[8:9], v[160:161], v[240:241]
    v_pk_mul_f32 v[10:11], v[162:163], v[240:241]
    v_pk_mul_f32 v[12:13], v[164:165], v[240:241]
    v_pk_mul_f32 v[14:15], v[166:167], v[240:241]
    v_pk_mul_f32 v[160:161], v[160:161], v[224:225]
    v_pk_mul_f32 v[162:163], v[162:163], v[224:225]
    v_pk_mul_f32 v[164:165], v[164:165], v[224:225]
    v_pk_mul_f32 v[166:167], v[166:167], v[224:225]
    v_pk_fma_f32 v[160:161], v[144:145], v[240:241], v[160:161]
    v_pk_fma_f32 v[162:163], v[146:147], v[240:241], v[162:163]
    v_pk_fma_f32 v[164:165], v[148:149], v[240:241], v[164:165]
    v_pk_fma_f32 v[166:167], v[150:151], v[240:241], v[166:167]
    v_pk_fma_f32 v[144:145], v[144:145], v[224:225], v[8:9] neg_lo:[0,0,1] neg_hi:[0,0,1]
    v_pk_fma_f32 v[146:147], v[146:147], v[224:225], v[10:11] neg_lo:[0,0,1] neg_hi:[0,0,1]
    v_pk_fma_f32 v[148:149], v[148:149], v[224:225], v[12:13] neg_lo:[0,0,1] neg_hi:[0,0,1]
    v_pk_fma_f32 v[150:151], v[150:151], v[224:225], v[14:15] neg_lo:[0,0,1] neg_hi:[0,0,1]
    v_pk_mul_f32 v[8:9], v[168:169], v[240:241]
    v_pk_mul_f32 v[10:11], v[170:171], v[240:241]
    v_pk_mul_f32 v[12:13], v[172:173], v[240:241]
    v_pk_mul_f32 v[14:15], v[174:175], v[240:241]
    v_pk_mul_f32 v[168:169], v[168:169], v[224:225]
    v_pk_mul_f32 v[170:171], v[170:171], v[224:225]
    v_pk_mul_f32 v[172:173], v[172:173], v[224:225]
    v_pk_mul_f32 v[174:175], v[174:175], v[224:225]
    v_pk_fma_f32 v[168:169], v[152:153], v[240:241], v[168:169]
    v_pk_fma_f32 v[170:171], v[154:155], v[240:241], v[170:171]
    v_pk_fma_f32 v[172:173], v[156:157], v[240:241], v[172:173]
    v_pk_fma_f32 v[174:175], v[158:159], v[240:241], v[174:175]
    v_pk_fma_f32 v[152:153], v[152:153], v[224:225], v[8:9] neg_lo:[0,0,1] neg_hi:[0,0,1]
    v_pk_fma_f32 v[154:155], v[154:155], v[224:225], v[10:11] neg_lo:[0,0,1] neg_hi:[0,0,1]
    v_pk_fma_f32 v[156:157], v[156:157], v[224:225], v[12:13] neg_lo:[0,0,1] neg_hi:[0,0,1]
    v_pk_fma_f32 v[158:159], v[158:159], v[224:225], v[14:15] neg_lo:[0,0,1] neg_hi:[0,0,1]
    v_mfma_f32_32x32x16_bf16 v[176:191], v[216:219], a[0:3], 0
    v_perm_b32 v208, v21, v17, s30
    v_perm_b32 v209, v29, v25, s30
    v_perm_b32 v210, v37, v33, s30
    v_perm_b32 v211, v45, v41, s30
    v_perm_b32 v212, v53, v49, s30
    v_mfma_f32_32x32x16_bf16 v[192:207], v[216:219], a[8:11], 0
    v_perm_b32 v213, v61, v57, s30
    v_perm_b32 v214, v69, v65, s30
    v_perm_b32 v215, v77, v73, s30
    v_cvt_pk_bf16_f32 v80, v144, v145
    v_cvt_pk_bf16_f32 v84, v160, v161
    v_mfma_f32_32x32x16_bf16 v[176:191], v[220:223], a[4:7], v[176:191]
    v_cvt_pk_bf16_f32 v88, v146, v147
    v_cvt_pk_bf16_f32 v92, v162, v163
    v_cvt_pk_bf16_f32 v96, v148, v149
    v_cvt_pk_bf16_f32 v100, v164, v165
    v_cvt_pk_bf16_f32 v104, v150, v151
    v_mfma_f32_32x32x16_bf16 v[192:207], v[220:223], a[12:15], v[192:207]
    v_cvt_pk_bf16_f32 v108, v166, v167
    v_cvt_pk_bf16_f32 v112, v152, v153
    v_cvt_pk_bf16_f32 v116, v168, v169
    v_cvt_pk_bf16_f32 v120, v154, v155
    v_cvt_pk_bf16_f32 v124, v170, v171
    v_cvt_pk_bf16_f32 v128, v156, v157
    v_cvt_pk_bf16_f32 v132, v172, v173
    v_cvt_pk_bf16_f32 v136, v158, v159
    v_cvt_pk_bf16_f32 v140, v174, v175
    s_nop 2
    v_pk_mul_f32 v[8:9], v[192:193], v[242:243]
    v_pk_mul_f32 v[10:11], v[194:195], v[242:243]
    v_pk_mul_f32 v[12:13], v[196:197], v[242:243]
    v_pk_mul_f32 v[14:15], v[198:199], v[242:243]
    v_pk_mul_f32 v[192:193], v[192:193], v[226:227]
    v_pk_mul_f32 v[194:195], v[194:195], v[226:227]
    v_pk_mul_f32 v[196:197], v[196:197], v[226:227]
    v_pk_mul_f32 v[198:199], v[198:199], v[226:227]
    v_pk_fma_f32 v[192:193], v[176:177], v[242:243], v[192:193]
    v_pk_fma_f32 v[194:195], v[178:179], v[242:243], v[194:195]
    v_pk_fma_f32 v[196:197], v[180:181], v[242:243], v[196:197]
    v_pk_fma_f32 v[198:199], v[182:183], v[242:243], v[198:199]
    v_pk_fma_f32 v[176:177], v[176:177], v[226:227], v[8:9] neg_lo:[0,0,1] neg_hi:[0,0,1]
    v_pk_fma_f32 v[178:179], v[178:179], v[226:227], v[10:11] neg_lo:[0,0,1] neg_hi:[0,0,1]
    v_pk_fma_f32 v[180:181], v[180:181], v[226:227], v[12:13] neg_lo:[0,0,1] neg_hi:[0,0,1]
    v_pk_fma_f32 v[182:183], v[182:183], v[226:227], v[14:15] neg_lo:[0,0,1] neg_hi:[0,0,1]
    v_pk_mul_f32 v[8:9], v[200:201], v[242:243]
    v_pk_mul_f32 v[10:11], v[202:203], v[242:243]
    v_pk_mul_f32 v[12:13], v[204:205], v[242:243]
    v_pk_mul_f32 v[14:15], v[206:207], v[242:243]
    v_pk_mul_f32 v[200:201], v[200:201], v[226:227]
    v_pk_mul_f32 v[202:203], v[202:203], v[226:227]
    v_pk_mul_f32 v[204:205], v[204:205], v[226:227]
    v_pk_mul_f32 v[206:207], v[206:207], v[226:227]
    v_pk_fma_f32 v[200:201], v[184:185], v[242:243], v[200:201]
    v_pk_fma_f32 v[202:203], v[186:187], v[242:243], v[202:203]
    v_pk_fma_f32 v[204:205], v[188:189], v[242:243], v[204:205]
    v_pk_fma_f32 v[206:207], v[190:191], v[242:243], v[206:207]
    v_pk_fma_f32 v[184:185], v[184:185], v[226:227], v[8:9] neg_lo:[0,0,1] neg_hi:[0,0,1]
    v_pk_fma_f32 v[186:187], v[186:187], v[226:227], v[10:11] neg_lo:[0,0,1] neg_hi:[0,0,1]
    v_pk_fma_f32 v[188:189], v[188:189], v[226:227], v[12:13] neg_lo:[0,0,1] neg_hi:[0,0,1]
    v_pk_fma_f32 v[190:191], v[190:191], v[226:227], v[14:15] neg_lo:[0,0,1] neg_hi:[0,0,1]
    v_mfma_f32_32x32x16_bf16 v[144:159], v[208:211], a[0:3], 0
    v_perm_b32 v216, v21, v17, s31
    v_perm_b32 v217, v29, v25, s31
    v_perm_b32 v218, v37, v33, s31
    v_perm_b32 v219, v45, v41, s31
    v_perm_b32 v220, v53, v49, s31
    v_mfma_f32_32x32x16_bf16 v[160:175], v[208:211], a[8:11], 0
    v_perm_b32 v221, v61, v57, s31
    v_perm_b32 v222, v69, v65, s31
    v_perm_b32 v223, v77, v73, s31
    v_cvt_pk_bf16_f32 v81, v176, v177
    v_cvt_pk_bf16_f32 v85, v192, v193
    v_mfma_f32_32x32x16_bf16 v[144:159], v[212:215], a[4:7], v[144:159]
    v_cvt_pk_bf16_f32 v89, v178, v179
    v_cvt_pk_bf16_f32 v93, v194, v195
    v_cvt_pk_bf16_f32 v97, v180, v181
    v_cvt_pk_bf16_f32 v101, v196, v197
    v_cvt_pk_bf16_f32 v105, v182, v183
    v_mfma_f32_32x32x16_bf16 v[160:175], v[212:215], a[12:15], v[160:175]
    v_cvt_pk_bf16_f32 v109, v198, v199
    v_cvt_pk_bf16_f32 v113, v184, v185
    v_cvt_pk_bf16_f32 v117, v200, v201
    v_cvt_pk_bf16_f32 v121, v186, v187
    v_cvt_pk_bf16_f32 v125, v202, v203
    v_cvt_pk_bf16_f32 v129, v188, v189
    v_cvt_pk_bf16_f32 v133, v204, v205
    v_cvt_pk_bf16_f32 v137, v190, v191
    v_cvt_pk_bf16_f32 v141, v206, v207
    s_nop 2
    v_pk_mul_f32 v[8:9], v[160:161], v[244:245]
    v_pk_mul_f32 v[10:11], v[162:163], v[244:245]
    v_pk_mul_f32 v[12:13], v[164:165], v[244:245]
    v_pk_mul_f32 v[14:15], v[166:167], v[244:245]
    v_pk_mul_f32 v[160:161], v[160:161], v[228:229]
    v_pk_mul_f32 v[162:163], v[162:163], v[228:229]
    v_pk_mul_f32 v[164:165], v[164:165], v[228:229]
    v_pk_mul_f32 v[166:167], v[166:167], v[228:229]
    v_pk_fma_f32 v[160:161], v[144:145], v[244:245], v[160:161]
    v_pk_fma_f32 v[162:163], v[146:147], v[244:245], v[162:163]
    v_pk_fma_f32 v[164:165], v[148:149], v[244:245], v[164:165]
    v_pk_fma_f32 v[166:167], v[150:151], v[244:245], v[166:167]
    v_pk_fma_f32 v[144:145], v[144:145], v[228:229], v[8:9] neg_lo:[0,0,1] neg_hi:[0,0,1]
    v_pk_fma_f32 v[146:147], v[146:147], v[228:229], v[10:11] neg_lo:[0,0,1] neg_hi:[0,0,1]
    v_pk_fma_f32 v[148:149], v[148:149], v[228:229], v[12:13] neg_lo:[0,0,1] neg_hi:[0,0,1]
    v_pk_fma_f32 v[150:151], v[150:151], v[228:229], v[14:15] neg_lo:[0,0,1] neg_hi:[0,0,1]
    v_pk_mul_f32 v[8:9], v[168:169], v[244:245]
    v_pk_mul_f32 v[10:11], v[170:171], v[244:245]
    v_pk_mul_f32 v[12:13], v[172:173], v[244:245]
    v_pk_mul_f32 v[14:15], v[174:175], v[244:245]
    v_pk_mul_f32 v[168:169], v[168:169], v[228:229]
    v_pk_mul_f32 v[170:171], v[170:171], v[228:229]
    v_pk_mul_f32 v[172:173], v[172:173], v[228:229]
    v_pk_mul_f32 v[174:175], v[174:175], v[228:229]
    v_pk_fma_f32 v[168:169], v[152:153], v[244:245], v[168:169]
    v_pk_fma_f32 v[170:171], v[154:155], v[244:245], v[170:171]
    v_pk_fma_f32 v[172:173], v[156:157], v[244:245], v[172:173]
    v_pk_fma_f32 v[174:175], v[158:159], v[244:245], v[174:175]
    v_pk_fma_f32 v[152:153], v[152:153], v[228:229], v[8:9] neg_lo:[0,0,1] neg_hi:[0,0,1]
    v_pk_fma_f32 v[154:155], v[154:155], v[228:229], v[10:11] neg_lo:[0,0,1] neg_hi:[0,0,1]
    v_pk_fma_f32 v[156:157], v[156:157], v[228:229], v[12:13] neg_lo:[0,0,1] neg_hi:[0,0,1]
    v_pk_fma_f32 v[158:159], v[158:159], v[228:229], v[14:15] neg_lo:[0,0,1] neg_hi:[0,0,1]
    v_mfma_f32_32x32x16_bf16 v[176:191], v[216:219], a[0:3], 0
    v_perm_b32 v208, v22, v18, s30
    v_perm_b32 v209, v30, v26, s30
    v_perm_b32 v210, v38, v34, s30
    v_perm_b32 v211, v46, v42, s30
    v_perm_b32 v212, v54, v50, s30
    v_mfma_f32_32x32x16_bf16 v[192:207], v[216:219], a[8:11], 0
    v_perm_b32 v213, v62, v58, s30
    v_perm_b32 v214, v70, v66, s30
    v_perm_b32 v215, v78, v74, s30
    v_cvt_pk_bf16_f32 v82, v144, v145
    v_cvt_pk_bf16_f32 v86, v160, v161
    v_mfma_f32_32x32x16_bf16 v[176:191], v[220:223], a[4:7], v[176:191]
    v_cvt_pk_bf16_f32 v90, v146, v147
    v_cvt_pk_bf16_f32 v94, v162, v163
    v_cvt_pk_bf16_f32 v98, v148, v149
    v_cvt_pk_bf16_f32 v102, v164, v165
    v_cvt_pk_bf16_f32 v106, v150, v151
    v_mfma_f32_32x32x16_bf16 v[192:207], v[220:223], a[12:15], v[192:207]
    v_cvt_pk_bf16_f32 v110, v166, v167
    v_cvt_pk_bf16_f32 v114, v152, v153
    v_cvt_pk_bf16_f32 v118, v168, v169
    v_cvt_pk_bf16_f32 v122, v154, v155
    v_cvt_pk_bf16_f32 v126, v170, v171
    v_cvt_pk_bf16_f32 v130, v156, v157
    v_cvt_pk_bf16_f32 v134, v172, v173
    v_cvt_pk_bf16_f32 v138, v158, v159
    v_cvt_pk_bf16_f32 v142, v174, v175
    s_nop 2
    v_pk_mul_f32 v[8:9], v[192:193], v[246:247]
    v_pk_mul_f32 v[10:11], v[194:195], v[246:247]
    v_pk_mul_f32 v[12:13], v[196:197], v[246:247]
    v_pk_mul_f32 v[14:15], v[198:199], v[246:247]
    v_pk_mul_f32 v[192:193], v[192:193], v[230:231]
    v_pk_mul_f32 v[194:195], v[194:195], v[230:231]
    v_pk_mul_f32 v[196:197], v[196:197], v[230:231]
    v_pk_mul_f32 v[198:199], v[198:199], v[230:231]
    v_pk_fma_f32 v[192:193], v[176:177], v[246:247], v[192:193]
    v_pk_fma_f32 v[194:195], v[178:179], v[246:247], v[194:195]
    v_pk_fma_f32 v[196:197], v[180:181], v[246:247], v[196:197]
    v_pk_fma_f32 v[198:199], v[182:183], v[246:247], v[198:199]
    v_pk_fma_f32 v[176:177], v[176:177], v[230:231], v[8:9] neg_lo:[0,0,1] neg_hi:[0,0,1]
    v_pk_fma_f32 v[178:179], v[178:179], v[230:231], v[10:11] neg_lo:[0,0,1] neg_hi:[0,0,1]
    v_pk_fma_f32 v[180:181], v[180:181], v[230:231], v[12:13] neg_lo:[0,0,1] neg_hi:[0,0,1]
    v_pk_fma_f32 v[182:183], v[182:183], v[230:231], v[14:15] neg_lo:[0,0,1] neg_hi:[0,0,1]
    v_pk_mul_f32 v[8:9], v[200:201], v[246:247]
    v_pk_mul_f32 v[10:11], v[202:203], v[246:247]
    v_pk_mul_f32 v[12:13], v[204:205], v[246:247]
    v_pk_mul_f32 v[14:15], v[206:207], v[246:247]
    v_pk_mul_f32 v[200:201], v[200:201], v[230:231]
    v_pk_mul_f32 v[202:203], v[202:203], v[230:231]
    v_pk_mul_f32 v[204:205], v[204:205], v[230:231]
    v_pk_mul_f32 v[206:207], v[206:207], v[230:231]
    v_pk_fma_f32 v[200:201], v[184:185], v[246:247], v[200:201]
    v_pk_fma_f32 v[202:203], v[186:187], v[246:247], v[202:203]
    v_pk_fma_f32 v[204:205], v[188:189], v[246:247], v[204:205]
    v_pk_fma_f32 v[206:207], v[190:191], v[246:247], v[206:207]
    v_pk_fma_f32 v[184:185], v[184:185], v[230:231], v[8:9] neg_lo:[0,0,1] neg_hi:[0,0,1]
    v_pk_fma_f32 v[186:187], v[186:187], v[230:231], v[10:11] neg_lo:[0,0,1] neg_hi:[0,0,1]
    v_pk_fma_f32 v[188:189], v[188:189], v[230:231], v[12:13] neg_lo:[0,0,1] neg_hi:[0,0,1]
    v_pk_fma_f32 v[190:191], v[190:191], v[230:231], v[14:15] neg_lo:[0,0,1] neg_hi:[0,0,1]
    v_mfma_f32_32x32x16_bf16 v[144:159], v[208:211], a[0:3], 0
    v_perm_b32 v216, v22, v18, s31
    v_perm_b32 v217, v30, v26, s31
    v_perm_b32 v218, v38, v34, s31
    v_perm_b32 v219, v46, v42, s31
    v_perm_b32 v220, v54, v50, s31
    v_mfma_f32_32x32x16_bf16 v[160:175], v[208:211], a[8:11], 0
    v_perm_b32 v221, v62, v58, s31
    v_perm_b32 v222, v70, v66, s31
    v_perm_b32 v223, v78, v74, s31
    v_cvt_pk_bf16_f32 v83, v176, v177
    v_cvt_pk_bf16_f32 v87, v192, v193
    v_mfma_f32_32x32x16_bf16 v[144:159], v[212:215], a[4:7], v[144:159]
    v_cvt_pk_bf16_f32 v91, v178, v179
    v_cvt_pk_bf16_f32 v95, v194, v195
    v_cvt_pk_bf16_f32 v99, v180, v181
    v_cvt_pk_bf16_f32 v103, v196, v197
    v_cvt_pk_bf16_f32 v107, v182, v183
    v_mfma_f32_32x32x16_bf16 v[160:175], v[212:215], a[12:15], v[160:175]
    v_cvt_pk_bf16_f32 v111, v198, v199
    v_cvt_pk_bf16_f32 v115, v184, v185
    v_cvt_pk_bf16_f32 v119, v200, v201
    v_cvt_pk_bf16_f32 v123, v186, v187
    v_cvt_pk_bf16_f32 v127, v202, v203
    v_cvt_pk_bf16_f32 v131, v188, v189
    v_cvt_pk_bf16_f32 v135, v204, v205
    v_cvt_pk_bf16_f32 v139, v190, v191
    v_cvt_pk_bf16_f32 v143, v206, v207
    s_nop 2
    v_pk_mul_f32 v[8:9], v[160:161], v[248:249]
    v_pk_mul_f32 v[10:11], v[162:163], v[248:249]
    v_pk_mul_f32 v[12:13], v[164:165], v[248:249]
    v_pk_mul_f32 v[14:15], v[166:167], v[248:249]
    v_pk_mul_f32 v[160:161], v[160:161], v[232:233]
    v_pk_mul_f32 v[162:163], v[162:163], v[232:233]
    v_pk_mul_f32 v[164:165], v[164:165], v[232:233]
    v_pk_mul_f32 v[166:167], v[166:167], v[232:233]
    v_pk_fma_f32 v[160:161], v[144:145], v[248:249], v[160:161]
    v_pk_fma_f32 v[162:163], v[146:147], v[248:249], v[162:163]
    v_pk_fma_f32 v[164:165], v[148:149], v[248:249], v[164:165]
    v_pk_fma_f32 v[166:167], v[150:151], v[248:249], v[166:167]
    v_pk_fma_f32 v[144:145], v[144:145], v[232:233], v[8:9] neg_lo:[0,0,1] neg_hi:[0,0,1]
    v_pk_fma_f32 v[146:147], v[146:147], v[232:233], v[10:11] neg_lo:[0,0,1] neg_hi:[0,0,1]
    v_pk_fma_f32 v[148:149], v[148:149], v[232:233], v[12:13] neg_lo:[0,0,1] neg_hi:[0,0,1]
    v_pk_fma_f32 v[150:151], v[150:151], v[232:233], v[14:15] neg_lo:[0,0,1] neg_hi:[0,0,1]
    v_pk_mul_f32 v[8:9], v[168:169], v[248:249]
    v_pk_mul_f32 v[10:11], v[170:171], v[248:249]
    v_pk_mul_f32 v[12:13], v[172:173], v[248:249]
    v_pk_mul_f32 v[14:15], v[174:175], v[248:249]
    v_pk_mul_f32 v[168:169], v[168:169], v[232:233]
    v_pk_mul_f32 v[170:171], v[170:171], v[232:233]
    v_pk_mul_f32 v[172:173], v[172:173], v[232:233]
    v_pk_mul_f32 v[174:175], v[174:175], v[232:233]
    v_pk_fma_f32 v[168:169], v[152:153], v[248:249], v[168:169]
    v_pk_fma_f32 v[170:171], v[154:155], v[248:249], v[170:171]
    v_pk_fma_f32 v[172:173], v[156:157], v[248:249], v[172:173]
    v_pk_fma_f32 v[174:175], v[158:159], v[248:249], v[174:175]
    v_pk_fma_f32 v[152:153], v[152:153], v[232:233], v[8:9] neg_lo:[0,0,1] neg_hi:[0,0,1]
    v_pk_fma_f32 v[154:155], v[154:155], v[232:233], v[10:11] neg_lo:[0,0,1] neg_hi:[0,0,1]
    v_pk_fma_f32 v[156:157], v[156:157], v[232:233], v[12:13] neg_lo:[0,0,1] neg_hi:[0,0,1]
    v_pk_fma_f32 v[158:159], v[158:159], v[232:233], v[14:15] neg_lo:[0,0,1] neg_hi:[0,0,1]
    v_mfma_f32_32x32x16_bf16 v[176:191], v[216:219], a[0:3], 0
    v_perm_b32 v208, v23, v19, s30
    v_perm_b32 v209, v31, v27, s30
    v_perm_b32 v210, v39, v35, s30
    v_perm_b32 v211, v47, v43, s30
    v_perm_b32 v212, v55, v51, s30
    v_mfma_f32_32x32x16_bf16 v[192:207], v[216:219], a[8:11], 0
    v_perm_b32 v213, v63, v59, s30
    v_perm_b32 v214, v71, v67, s30
    v_perm_b32 v215, v79, v75, s30
    v_cvt_pk_bf16_f32 v16, v144, v145
    v_cvt_pk_bf16_f32 v20, v160, v161
    v_mfma_f32_32x32x16_bf16 v[176:191], v[220:223], a[4:7], v[176:191]
    v_cvt_pk_bf16_f32 v24, v146, v147
    v_cvt_pk_bf16_f32 v28, v162, v163
    v_cvt_pk_bf16_f32 v32, v148, v149
    v_cvt_pk_bf16_f32 v36, v164, v165
    v_cvt_pk_bf16_f32 v40, v150, v151
    v_mfma_f32_32x32x16_bf16 v[192:207], v[220:223], a[12:15], v[192:207]
    v_cvt_pk_bf16_f32 v44, v166, v167
    v_cvt_pk_bf16_f32 v48, v152, v153
    v_cvt_pk_bf16_f32 v52, v168, v169
    v_cvt_pk_bf16_f32 v56, v154, v155
    v_cvt_pk_bf16_f32 v60, v170, v171
    v_cvt_pk_bf16_f32 v64, v156, v157
    v_cvt_pk_bf16_f32 v68, v172, v173
    v_cvt_pk_bf16_f32 v72, v158, v159
    v_cvt_pk_bf16_f32 v76, v174, v175
    s_nop 2
    v_pk_mul_f32 v[8:9], v[192:193], v[250:251]
    v_pk_mul_f32 v[10:11], v[194:195], v[250:251]
    v_pk_mul_f32 v[12:13], v[196:197], v[250:251]
    v_pk_mul_f32 v[14:15], v[198:199], v[250:251]
    v_pk_mul_f32 v[192:193], v[192:193], v[234:235]
    v_pk_mul_f32 v[194:195], v[194:195], v[234:235]
    v_pk_mul_f32 v[196:197], v[196:197], v[234:235]
    v_pk_mul_f32 v[198:199], v[198:199], v[234:235]
    v_pk_fma_f32 v[192:193], v[176:177], v[250:251], v[192:193]
    v_pk_fma_f32 v[194:195], v[178:179], v[250:251], v[194:195]
    v_pk_fma_f32 v[196:197], v[180:181], v[250:251], v[196:197]
    v_pk_fma_f32 v[198:199], v[182:183], v[250:251], v[198:199]
    v_pk_fma_f32 v[176:177], v[176:177], v[234:235], v[8:9] neg_lo:[0,0,1] neg_hi:[0,0,1]
    v_pk_fma_f32 v[178:179], v[178:179], v[234:235], v[10:11] neg_lo:[0,0,1] neg_hi:[0,0,1]
    v_pk_fma_f32 v[180:181], v[180:181], v[234:235], v[12:13] neg_lo:[0,0,1] neg_hi:[0,0,1]
    v_pk_fma_f32 v[182:183], v[182:183], v[234:235], v[14:15] neg_lo:[0,0,1] neg_hi:[0,0,1]
    v_pk_mul_f32 v[8:9], v[200:201], v[250:251]
    v_pk_mul_f32 v[10:11], v[202:203], v[250:251]
    v_pk_mul_f32 v[12:13], v[204:205], v[250:251]
    v_pk_mul_f32 v[14:15], v[206:207], v[250:251]
    v_pk_mul_f32 v[200:201], v[200:201], v[234:235]
    v_pk_mul_f32 v[202:203], v[202:203], v[234:235]
    v_pk_mul_f32 v[204:205], v[204:205], v[234:235]
    v_pk_mul_f32 v[206:207], v[206:207], v[234:235]
    v_pk_fma_f32 v[200:201], v[184:185], v[250:251], v[200:201]
    v_pk_fma_f32 v[202:203], v[186:187], v[250:251], v[202:203]
    v_pk_fma_f32 v[204:205], v[188:189], v[250:251], v[204:205]
    v_pk_fma_f32 v[206:207], v[190:191], v[250:251], v[206:207]
    v_pk_fma_f32 v[184:185], v[184:185], v[234:235], v[8:9] neg_lo:[0,0,1] neg_hi:[0,0,1]
    v_pk_fma_f32 v[186:187], v[186:187], v[234:235], v[10:11] neg_lo:[0,0,1] neg_hi:[0,0,1]
    v_pk_fma_f32 v[188:189], v[188:189], v[234:235], v[12:13] neg_lo:[0,0,1] neg_hi:[0,0,1]
    v_pk_fma_f32 v[190:191], v[190:191], v[234:235], v[14:15] neg_lo:[0,0,1] neg_hi:[0,0,1]
    v_mfma_f32_32x32x16_bf16 v[144:159], v[208:211], a[0:3], 0
    v_perm_b32 v216, v23, v19, s31
    v_perm_b32 v217, v31, v27, s31
    v_perm_b32 v218, v39, v35, s31
    v_perm_b32 v219, v47, v43, s31
    v_perm_b32 v220, v55, v51, s31
    v_mfma_f32_32x32x16_bf16 v[160:175], v[208:211], a[8:11], 0
    v_perm_b32 v221, v63, v59, s31
    v_perm_b32 v222, v71, v67, s31
    v_perm_b32 v223, v79, v75, s31
    v_cvt_pk_bf16_f32 v17, v176, v177
    v_cvt_pk_bf16_f32 v21, v192, v193
    v_mfma_f32_32x32x16_bf16 v[144:159], v[212:215], a[4:7], v[144:159]
    v_cvt_pk_bf16_f32 v25, v178, v179
    v_cvt_pk_bf16_f32 v29, v194, v195
    v_cvt_pk_bf16_f32 v33, v180, v181
    v_cvt_pk_bf16_f32 v37, v196, v197
    v_cvt_pk_bf16_f32 v41, v182, v183
    v_mfma_f32_32x32x16_bf16 v[160:175], v[212:215], a[12:15], v[160:175]
    v_cvt_pk_bf16_f32 v45, v198, v199
    v_cvt_pk_bf16_f32 v49, v184, v185
    v_cvt_pk_bf16_f32 v53, v200, v201
    v_cvt_pk_bf16_f32 v57, v186, v187
    v_cvt_pk_bf16_f32 v61, v202, v203
    v_cvt_pk_bf16_f32 v65, v188, v189
    v_cvt_pk_bf16_f32 v69, v204, v205
    v_cvt_pk_bf16_f32 v73, v190, v191
    v_cvt_pk_bf16_f32 v77, v206, v207
    s_nop 2
    v_pk_mul_f32 v[8:9], v[160:161], v[252:253]
    v_pk_mul_f32 v[10:11], v[162:163], v[252:253]
    v_pk_mul_f32 v[12:13], v[164:165], v[252:253]
    v_pk_mul_f32 v[14:15], v[166:167], v[252:253]
    v_pk_mul_f32 v[160:161], v[160:161], v[236:237]
    v_pk_mul_f32 v[162:163], v[162:163], v[236:237]
    v_pk_mul_f32 v[164:165], v[164:165], v[236:237]
    v_pk_mul_f32 v[166:167], v[166:167], v[236:237]
    v_pk_fma_f32 v[160:161], v[144:145], v[252:253], v[160:161]
    v_pk_fma_f32 v[162:163], v[146:147], v[252:253], v[162:163]
    v_pk_fma_f32 v[164:165], v[148:149], v[252:253], v[164:165]
    v_pk_fma_f32 v[166:167], v[150:151], v[252:253], v[166:167]
    v_pk_fma_f32 v[144:145], v[144:145], v[236:237], v[8:9] neg_lo:[0,0,1] neg_hi:[0,0,1]
    v_pk_fma_f32 v[146:147], v[146:147], v[236:237], v[10:11] neg_lo:[0,0,1] neg_hi:[0,0,1]
    v_pk_fma_f32 v[148:149], v[148:149], v[236:237], v[12:13] neg_lo:[0,0,1] neg_hi:[0,0,1]
    v_pk_fma_f32 v[150:151], v[150:151], v[236:237], v[14:15] neg_lo:[0,0,1] neg_hi:[0,0,1]
    v_pk_mul_f32 v[8:9], v[168:169], v[252:253]
    v_pk_mul_f32 v[10:11], v[170:171], v[252:253]
    v_pk_mul_f32 v[12:13], v[172:173], v[252:253]
    v_pk_mul_f32 v[14:15], v[174:175], v[252:253]
    v_pk_mul_f32 v[168:169], v[168:169], v[236:237]
    v_pk_mul_f32 v[170:171], v[170:171], v[236:237]
    v_pk_mul_f32 v[172:173], v[172:173], v[236:237]
    v_pk_mul_f32 v[174:175], v[174:175], v[236:237]
    v_pk_fma_f32 v[168:169], v[152:153], v[252:253], v[168:169]
    v_pk_fma_f32 v[170:171], v[154:155], v[252:253], v[170:171]
    v_pk_fma_f32 v[172:173], v[156:157], v[252:253], v[172:173]
    v_pk_fma_f32 v[174:175], v[158:159], v[252:253], v[174:175]
    v_pk_fma_f32 v[152:153], v[152:153], v[236:237], v[8:9] neg_lo:[0,0,1] neg_hi:[0,0,1]
    v_pk_fma_f32 v[154:155], v[154:155], v[236:237], v[10:11] neg_lo:[0,0,1] neg_hi:[0,0,1]
    v_pk_fma_f32 v[156:157], v[156:157], v[236:237], v[12:13] neg_lo:[0,0,1] neg_hi:[0,0,1]
    v_pk_fma_f32 v[158:159], v[158:159], v[236:237], v[14:15] neg_lo:[0,0,1] neg_hi:[0,0,1]
    v_mfma_f32_32x32x16_bf16 v[176:191], v[216:219], a[0:3], 0
    v_cvt_pk_bf16_f32 v18, v144, v145
    v_cvt_pk_bf16_f32 v22, v160, v161
    v_cvt_pk_bf16_f32 v26, v146, v147
    v_cvt_pk_bf16_f32 v30, v162, v163
    v_cvt_pk_bf16_f32 v34, v148, v149
    v_mfma_f32_32x32x16_bf16 v[192:207], v[216:219], a[8:11], 0
    v_cvt_pk_bf16_f32 v38, v164, v165
    v_cvt_pk_bf16_f32 v42, v150, v151
    v_cvt_pk_bf16_f32 v46, v166, v167
    v_cvt_pk_bf16_f32 v50, v152, v153
    v_cvt_pk_bf16_f32 v54, v168, v169
    v_mfma_f32_32x32x16_bf16 v[176:191], v[220:223], a[4:7], v[176:191]
    v_cvt_pk_bf16_f32 v58, v154, v155
    v_cvt_pk_bf16_f32 v62, v170, v171
    v_cvt_pk_bf16_f32 v66, v156, v157
    v_cvt_pk_bf16_f32 v70, v172, v173
    v_cvt_pk_bf16_f32 v74, v158, v159
    v_mfma_f32_32x32x16_bf16 v[192:207], v[220:223], a[12:15], v[192:207]
    v_cvt_pk_bf16_f32 v78, v174, v175
    s_nop 10
    v_pk_mul_f32 v[8:9], v[192:193], v[254:255]
    v_pk_mul_f32 v[10:11], v[194:195], v[254:255]
    v_pk_mul_f32 v[12:13], v[196:197], v[254:255]
    v_pk_mul_f32 v[14:15], v[198:199], v[254:255]
    v_pk_mul_f32 v[192:193], v[192:193], v[238:239]
    v_pk_mul_f32 v[194:195], v[194:195], v[238:239]
    v_pk_mul_f32 v[196:197], v[196:197], v[238:239]
    v_pk_mul_f32 v[198:199], v[198:199], v[238:239]
    v_pk_fma_f32 v[192:193], v[176:177], v[254:255], v[192:193]
    v_pk_fma_f32 v[194:195], v[178:179], v[254:255], v[194:195]
    v_pk_fma_f32 v[196:197], v[180:181], v[254:255], v[196:197]
    v_pk_fma_f32 v[198:199], v[182:183], v[254:255], v[198:199]
    v_pk_fma_f32 v[176:177], v[176:177], v[238:239], v[8:9] neg_lo:[0,0,1] neg_hi:[0,0,1]
    v_pk_fma_f32 v[178:179], v[178:179], v[238:239], v[10:11] neg_lo:[0,0,1] neg_hi:[0,0,1]
    v_pk_fma_f32 v[180:181], v[180:181], v[238:239], v[12:13] neg_lo:[0,0,1] neg_hi:[0,0,1]
    v_pk_fma_f32 v[182:183], v[182:183], v[238:239], v[14:15] neg_lo:[0,0,1] neg_hi:[0,0,1]
    v_pk_mul_f32 v[8:9], v[200:201], v[254:255]
    v_pk_mul_f32 v[10:11], v[202:203], v[254:255]
    v_pk_mul_f32 v[12:13], v[204:205], v[254:255]
    v_pk_mul_f32 v[14:15], v[206:207], v[254:255]
    v_pk_mul_f32 v[200:201], v[200:201], v[238:239]
    v_pk_mul_f32 v[202:203], v[202:203], v[238:239]
    v_pk_mul_f32 v[204:205], v[204:205], v[238:239]
    v_pk_mul_f32 v[206:207], v[206:207], v[238:239]
    v_pk_fma_f32 v[200:201], v[184:185], v[254:255], v[200:201]
    v_pk_fma_f32 v[202:203], v[186:187], v[254:255], v[202:203]
    v_pk_fma_f32 v[204:205], v[188:189], v[254:255], v[204:205]
    v_pk_fma_f32 v[206:207], v[190:191], v[254:255], v[206:207]
    v_pk_fma_f32 v[184:185], v[184:185], v[238:239], v[8:9] neg_lo:[0,0,1] neg_hi:[0,0,1]
    v_pk_fma_f32 v[186:187], v[186:187], v[238:239], v[10:11] neg_lo:[0,0,1] neg_hi:[0,0,1]
    v_pk_fma_f32 v[188:189], v[188:189], v[238:239], v[12:13] neg_lo:[0,0,1] neg_hi:[0,0,1]
    v_pk_fma_f32 v[190:191], v[190:191], v[238:239], v[14:15] neg_lo:[0,0,1] neg_hi:[0,0,1]
    v_cvt_pk_bf16_f32 v19, v176, v177
    v_cvt_pk_bf16_f32 v23, v192, v193
    v_cvt_pk_bf16_f32 v27, v178, v179
    v_cvt_pk_bf16_f32 v31, v194, v195
    v_cvt_pk_bf16_f32 v35, v180, v181
    v_cvt_pk_bf16_f32 v39, v196, v197
    v_cvt_pk_bf16_f32 v43, v182, v183
    v_cvt_pk_bf16_f32 v47, v198, v199
    v_cvt_pk_bf16_f32 v51, v184, v185
    v_cvt_pk_bf16_f32 v55, v200, v201
    v_cvt_pk_bf16_f32 v59, v186, v187
    v_cvt_pk_bf16_f32 v63, v202, v203
    v_cvt_pk_bf16_f32 v67, v188, v189
    v_cvt_pk_bf16_f32 v71, v204, v205
    v_cvt_pk_bf16_f32 v75, v190, v191
    v_cvt_pk_bf16_f32 v79, v206, v207
    v_cmp_gt_u32 vcc, 2, v5
    v_mov_b32 v6, 1.0
    v_mov_b32 v7, 0
    v_cndmask_b32 v6, v6, v7, vcc
    v_cmp_eq_u32 vcc, 1, v5
    v_mov_b32 v8, 0x3f3504f3
    s_nop 0
    v_cndmask_b32 v7, v7, v8, vcc
    v_mov_b32 v4, 0
    s_nop 1
    v_mfma_f32_32x32x16_bf16 v[144:159], v[80:83], a[16:19], 0
    v_mov_b32 v240, v80
    v_mov_b32 v241, v81
    v_mov_b32 v242, v82
    v_mov_b32 v243, v83
    v_mov_b32 v244, v16
    v_mov_b32 v245, v17
    v_mfma_f32_32x32x16_bf16 v[144:159], v[16:19], a[20:23], v[144:159]
    v_mov_b32 v246, v18
    v_mov_b32 v247, v19
    v_mov_b32_dpp v240, v88 row_shr:1 row_mask:0x5 bank_mask:0xf
    v_mov_b32_dpp v241, v89 row_shr:1 row_mask:0x5 bank_mask:0xf
    v_mov_b32_dpp v242, v90 row_shr:1 row_mask:0x5 bank_mask:0xf
    v_mov_b32_dpp v243, v91 row_shr:1 row_mask:0x5 bank_mask:0xf
    v_mfma_f32_32x32x16_bf16 v[144:159], v[84:87], a[24:27], v[144:159]
    v_mov_b32_dpp v244, v24 row_shr:1 row_mask:0x5 bank_mask:0xf
    v_mov_b32_dpp v245, v25 row_shr:1 row_mask:0x5 bank_mask:0xf
    v_mov_b32_dpp v246, v26 row_shr:1 row_mask:0x5 bank_mask:0xf
    v_mov_b32_dpp v247, v27 row_shr:1 row_mask:0x5 bank_mask:0xf
    v_mov_b32_dpp v240, v96 row_shr:2 row_mask:0x5 bank_mask:0xf
    v_mov_b32_dpp v241, v97 row_shr:2 row_mask:0x5 bank_mask:0xf
    v_mfma_f32_32x32x16_bf16 v[144:159], v[20:23], a[28:31], v[144:159]
    v_mov_b32_dpp v242, v98 row_shr:2 row_mask:0x5 bank_mask:0xf
    v_mov_b32_dpp v243, v99 row_shr:2 row_mask:0x5 bank_mask:0xf
    v_mov_b32_dpp v244, v32 row_shr:2 row_mask:0x5 bank_mask:0xf
    v_mov_b32_dpp v245, v33 row_shr:2 row_mask:0x5 bank_mask:0xf
    v_mov_b32_dpp v246, v34 row_shr:2 row_mask:0x5 bank_mask:0xf
    v_mov_b32_dpp v247, v35 row_shr:2 row_mask:0x5 bank_mask:0xf
    v_mfma_f32_32x32x16_bf16 v[160:175], v[88:91], a[16:19], 0
    v_mov_b32_dpp v240, v104 row_shr:3 row_mask:0x5 bank_mask:0xf
    v_mov_b32_dpp v241, v105 row_shr:3 row_mask:0x5 bank_mask:0xf
    v_mov_b32_dpp v242, v106 row_shr:3 row_mask:0x5 bank_mask:0xf
    v_mov_b32_dpp v243, v107 row_shr:3 row_mask:0x5 bank_mask:0xf
    v_mov_b32_dpp v244, v40 row_shr:3 row_mask:0x5 bank_mask:0xf
    v_mov_b32_dpp v245, v41 row_shr:3 row_mask:0x5 bank_mask:0xf
    v_mfma_f32_32x32x16_bf16 v[160:175], v[24:27], a[20:23], v[160:175]
    v_mov_b32_dpp v246, v42 row_shr:3 row_mask:0x5 bank_mask:0xf
    v_mov_b32_dpp v247, v43 row_shr:3 row_mask:0x5 bank_mask:0xf
    v_mov_b32_dpp v240, v112 row_shr:8 row_mask:0x5 bank_mask:0xf
    v_mov_b32_dpp v241, v113 row_shr:8 row_mask:0x5 bank_mask:0xf
    v_mov_b32_dpp v242, v114 row_shr:8 row_mask:0x5 bank_mask:0xf
    v_mov_b32_dpp v243, v115 row_shr:8 row_mask:0x5 bank_mask:0xf
    v_mfma_f32_32x32x16_bf16 v[160:175], v[92:95], a[24:27], v[160:175]
    v_mov_b32_dpp v244, v48 row_shr:8 row_mask:0x5 bank_mask:0xf
    v_mov_b32_dpp v245, v49 row_shr:8 row_mask:0x5 bank_mask:0xf
    v_mov_b32_dpp v246, v50 row_shr:8 row_mask:0x5 bank_mask:0xf
    v_mov_b32_dpp v247, v51 row_shr:8 row_mask:0x5 bank_mask:0xf
    v_mov_b32_dpp v240, v120 row_shr:9 row_mask:0x5 bank_mask:0xf
    v_mov_b32_dpp v241, v121 row_shr:9 row_mask:0x5 bank_mask:0xf
    v_mfma_f32_32x32x16_bf16 v[160:175], v[28:31], a[28:31], v[160:175]
    v_mov_b32_dpp v242, v122 row_shr:9 row_mask:0x5 bank_mask:0xf
    v_mov_b32_dpp v243, v123 row_shr:9 row_mask:0x5 bank_mask:0xf
    v_mov_b32_dpp v244, v56 row_shr:9 row_mask:0x5 bank_mask:0xf
    v_mov_b32_dpp v245, v57 row_shr:9 row_mask:0x5 bank_mask:0xf
    v_mov_b32_dpp v246, v58 row_shr:9 row_mask:0x5 bank_mask:0xf
    v_mov_b32_dpp v247, v59 row_shr:9 row_mask:0x5 bank_mask:0xf
    v_mfma_f32_32x32x16_bf16 v[176:191], v[96:99], a[16:19], 0
    v_mov_b32_dpp v240, v128 row_shr:10 row_mask:0x5 bank_mask:0xf
    v_mov_b32_dpp v241, v129 row_shr:10 row_mask:0x5 bank_mask:0xf
    v_mov_b32_dpp v242, v130 row_shr:10 row_mask:0x5 bank_mask:0xf
    v_mov_b32_dpp v243, v131 row_shr:10 row_mask:0x5 bank_mask:0xf
    v_mov_b32_dpp v244, v64 row_shr:10 row_mask:0x5 bank_mask:0xf
    v_mov_b32_dpp v245, v65 row_shr:10 row_mask:0x5 bank_mask:0xf
    v_mfma_f32_32x32x16_bf16 v[176:191], v[32:35], a[20:23], v[176:191]
    v_mov_b32_dpp v246, v66 row_shr:10 row_mask:0x5 bank_mask:0xf
    v_mov_b32_dpp v247, v67 row_shr:10 row_mask:0x5 bank_mask:0xf
    v_mov_b32_dpp v240, v136 row_shr:11 row_mask:0x5 bank_mask:0xf
    v_mov_b32_dpp v241, v137 row_shr:11 row_mask:0x5 bank_mask:0xf
    v_mov_b32_dpp v242, v138 row_shr:11 row_mask:0x5 bank_mask:0xf
    v_mov_b32_dpp v243, v139 row_shr:11 row_mask:0x5 bank_mask:0xf
    v_mfma_f32_32x32x16_bf16 v[176:191], v[100:103], a[24:27], v[176:191]
    v_mov_b32_dpp v244, v72 row_shr:11 row_mask:0x5 bank_mask:0xf
    v_mov_b32_dpp v245, v73 row_shr:11 row_mask:0x5 bank_mask:0xf
    v_mov_b32_dpp v246, v74 row_shr:11 row_mask:0x5 bank_mask:0xf
    v_mov_b32_dpp v247, v75 row_shr:11 row_mask:0x5 bank_mask:0xf
    v_mul_f32 v8, v145, v145
    v_fmac_f32 v8, v146, v146
    v_mfma_f32_32x32x16_bf16 v[176:191], v[36:39], a[28:31], v[176:191]
    v_fmac_f32 v8, v147, v147
    v_fmac_f32 v8, v148, v148
    v_fmac_f32 v8, v149, v149
    v_fmac_f32 v8, v150, v150
    v_fmac_f32 v8, v151, v151
    v_fmac_f32 v8, v152, v152
    s_nop 1
    v_mfma_f32_32x32x16_bf16 a[48:63], v[240:243], a[32:35], 0
    v_fmac_f32 v8, v153, v153
    v_fmac_f32 v8, v154, v154
    v_fmac_f32 v8, v155, v155
    v_fmac_f32 v8, v156, v156
    v_fmac_f32 v8, v157, v157
    v_fmac_f32 v8, v158, v158
    v_mfma_f32_32x32x16_bf16 a[48:63], v[244:247], a[32:35], a[48:63]
    v_fmac_f32 v8, v159, v159
    v_mul_f32 v9, v161, v161
    v_fmac_f32 v9, v162, v162
    v_fmac_f32 v9, v163, v163
    v_fmac_f32 v9, v164, v164
    v_fmac_f32 v9, v165, v165
    v_mfma_f32_32x32x16_bf16 v[192:207], v[104:107], a[16:19], 0
    v_fmac_f32 v9, v166, v166
    v_fmac_f32 v9, v167, v167
    v_fmac_f32 v9, v168, v168
    v_fmac_f32 v9, v169, v169
    v_fmac_f32 v9, v170, v170
    v_fmac_f32 v9, v171, v171
    v_mfma_f32_32x32x16_bf16 v[192:207], v[40:43], a[20:23], v[192:207]
    v_accvgpr_read_b32 v2, a48
    v_mul_f32 v144, v144, v6
    v_fmac_f32 v144, v2, v7
    v_readlane_b32 s41, v2, 0
    v_accvgpr_read_b32 v3, a49
    v_mul_f32 v160, v160, v6
    v_mfma_f32_32x32x16_bf16 v[192:207], v[108:111], a[24:27], v[192:207]
    v_fmac_f32 v160, v3, v7
    v_readlane_b32 s43, v3, 0
    v_accvgpr_read_b32 v2, a50
    v_mul_f32 v176, v176, v6
    v_fmac_f32 v176, v2, v7
    v_readlane_b32 s45, v2, 0
    v_mfma_f32_32x32x16_bf16 v[192:207], v[44:47], a[28:31], v[192:207]
    v_fmac_f32 v9, v172, v172
    v_fmac_f32 v9, v173, v173
    v_fmac_f32 v9, v174, v174
    v_fmac_f32 v9, v175, v175
    v_mul_f32 v10, v177, v177
    v_fmac_f32 v10, v178, v178
    v_mfma_f32_32x32x16_bf16 v[208:223], v[112:115], a[16:19], 0
    v_fmac_f32 v10, v179, v179
    v_fmac_f32 v10, v180, v180
    v_fmac_f32 v10, v181, v181
    v_fmac_f32 v10, v182, v182
    v_fmac_f32 v10, v183, v183
    v_fmac_f32 v10, v184, v184
    v_mfma_f32_32x32x16_bf16 v[208:223], v[48:51], a[20:23], v[208:223]
    v_accvgpr_read_b32 v3, a51
    v_mul_f32 v192, v192, v6
    v_fmac_f32 v192, v3, v7
    v_readlane_b32 s47, v3, 0
    v_fmac_f32 v10, v185, v185
    v_fmac_f32 v10, v186, v186
    v_mfma_f32_32x32x16_bf16 v[208:223], v[116:119], a[24:27], v[208:223]
    v_fmac_f32 v10, v187, v187
    v_fmac_f32 v10, v188, v188
    v_fmac_f32 v10, v189, v189
    v_fmac_f32 v10, v190, v190
    v_fmac_f32 v10, v191, v191
    v_fmac_f32 v8, v144, v144
    v_mfma_f32_32x32x16_bf16 v[208:223], v[52:55], a[28:31], v[208:223]
    v_fmac_f32 v9, v160, v160
    v_fmac_f32 v10, v176, v176
    v_mul_f32 v11, v193, v193
    v_fmac_f32 v11, v194, v194
    v_fmac_f32 v11, v195, v195
    v_fmac_f32 v11, v196, v196
    v_mfma_f32_32x32x16_bf16 v[224:239], v[120:123], a[16:19], 0
    v_fmac_f32 v11, v197, v197
    v_fmac_f32 v11, v198, v198
    v_fmac_f32 v11, v199, v199
    v_fmac_f32 v11, v200, v200
    v_fmac_f32 v11, v201, v201
    v_fmac_f32 v11, v202, v202
    v_mfma_f32_32x32x16_bf16 v[224:239], v[56:59], a[20:23], v[224:239]
    v_accvgpr_read_b32 v2, a52
    v_mul_f32 v208, v208, v6
    v_fmac_f32 v208, v2, v7
    v_readlane_b32 s49, v2, 0
    v_fmac_f32 v11, v203, v203
    v_fmac_f32 v11, v204, v204
    v_mfma_f32_32x32x16_bf16 v[224:239], v[124:127], a[24:27], v[224:239]
    v_fmac_f32 v11, v205, v205
    v_fmac_f32 v11, v206, v206
    v_fmac_f32 v11, v207, v207
    v_fmac_f32 v11, v192, v192
    v_mul_f32 v12, v209, v209
    v_fmac_f32 v12, v210, v210
    v_mfma_f32_32x32x16_bf16 v[224:239], v[60:63], a[28:31], v[224:239]
    v_fmac_f32 v12, v211, v211
    v_fmac_f32 v12, v212, v212
    v_fmac_f32 v12, v213, v213
    v_fmac_f32 v12, v214, v214
    v_fmac_f32 v12, v215, v215
    v_fmac_f32 v12, v216, v216
    v_mfma_f32_32x32x16_bf16 v[240:255], v[128:131], a[16:19], 0
    v_fmac_f32 v12, v217, v217
    v_fmac_f32 v12, v218, v218
    v_fmac_f32 v12, v219, v219
    v_fmac_f32 v12, v220, v220
    v_fmac_f32 v12, v221, v221
    v_fmac_f32 v12, v222, v222
    v_mfma_f32_32x32x16_bf16 v[240:255], v[64:67], a[20:23], v[240:255]
    v_accvgpr_read_b32 v3, a53
    v_mul_f32 v224, v224, v6
    v_fmac_f32 v224, v3, v7
    v_readlane_b32 s51, v3, 0
    v_fmac_f32 v12, v223, v223
    v_fmac_f32 v12, v208, v208
    v_mfma_f32_32x32x16_bf16 v[240:255], v[132:135], a[24:27], v[240:255]
    v_mul_f32 v13, v225, v225
    v_fmac_f32 v13, v226, v226
    v_fmac_f32 v13, v227, v227
    v_fmac_f32 v13, v228, v228
    v_fmac_f32 v13, v229, v229
    v_fmac_f32 v13, v230, v230
    v_mfma_f32_32x32x16_bf16 v[240:255], v[68:71], a[28:31], v[240:255]
    v_fmac_f32 v13, v231, v231
    v_fmac_f32 v13, v232, v232
    v_fmac_f32 v13, v233, v233
    v_fmac_f32 v13, v234, v234
    v_fmac_f32 v13, v235, v235
    v_fmac_f32 v13, v236, v236
    v_mfma_f32_32x32x16_bf16 v[80:95], v[136:139], a[16:19], 0
    v_fmac_f32 v13, v237, v237
    v_fmac_f32 v13, v238, v238
    v_fmac_f32 v13, v239, v239
    v_fmac_f32 v13, v224, v224
    v_mfma_f32_32x32x16_bf16 v[80:95], v[72:75], a[20:23], v[80:95]
    v_mfma_f32_32x32x16_bf16 v[80:95], v[140:143], a[24:27], v[80:95]
    v_accvgpr_read_b32 v2, a54
    v_mul_f32 v240, v240, v6
    v_fmac_f32 v240, v2, v7
    v_readlane_b32 s53, v2, 0
    v_mul_f32 v14, v241, v241
    v_fmac_f32 v14, v242, v242
    v_mfma_f32_32x32x16_bf16 v[80:95], v[76:79], a[28:31], v[80:95]
    v_fmac_f32 v14, v243, v243
    v_fmac_f32 v14, v244, v244
    v_fmac_f32 v14, v245, v245
    v_fmac_f32 v14, v246, v246
    v_fmac_f32 v14, v247, v247
    v_fmac_f32 v14, v248, v248
    v_fmac_f32 v14, v249, v249
    v_fmac_f32 v14, v250, v250
    v_fmac_f32 v14, v251, v251
    v_fmac_f32 v14, v252, v252
    v_fmac_f32 v14, v253, v253
    v_fmac_f32 v14, v254, v254
    v_fmac_f32 v14, v255, v255
    v_accvgpr_read_b32 v3, a55
    v_mul_f32 v80, v80, v6
    v_fmac_f32 v80, v3, v7
    v_readlane_b32 s55, v3, 0
    v_bfe_u32 v1, v5, 3, 2
    v_lshlrev_b32 v1, 12, v1
    v_lshrrev_b32 v2, 5, v5
    v_lshl_add_u32 v1, v2, 9, v1
    v_and_b32 v2, 7, v5
    v_lshl_add_u32 v1, v2, 4, v1
    s_mul_i32 s16, s3, 16384
    s_add_u32 s16, s16, 36700160
    v_cvt_pk_bf16_f32 v16, v144, v160
    v_cvt_pk_bf16_f32 v17, v176, v192
    v_cvt_pk_bf16_f32 v18, v208, v224
    v_cvt_pk_bf16_f32 v19, v240, v80
    buffer_store_dwordx4 v[16:19], v1, s[12:15], s16 offen offset:0 sc1
    v_fmac_f32 v14, v240, v240
    v_mul_f32 v15, v81, v81
    v_fmac_f32 v15, v82, v82
    v_fmac_f32 v15, v83, v83
    v_cvt_pk_bf16_f32 v20, v145, v161
    v_cvt_pk_bf16_f32 v21, v177, v193
    v_cvt_pk_bf16_f32 v22, v209, v225
    v_cvt_pk_bf16_f32 v23, v241, v81
    buffer_store_dwordx4 v[20:23], v1, s[12:15], s16 offen offset:128 sc1
    v_fmac_f32 v15, v84, v84
    v_fmac_f32 v15, v85, v85
    v_fmac_f32 v15, v86, v86
    v_fmac_f32 v15, v87, v87
    v_cvt_pk_bf16_f32 v24, v146, v162
    v_cvt_pk_bf16_f32 v25, v178, v194
    v_cvt_pk_bf16_f32 v26, v210, v226
    v_cvt_pk_bf16_f32 v27, v242, v82
    buffer_store_dwordx4 v[24:27], v1, s[12:15], s16 offen offset:256 sc1
    v_fmac_f32 v15, v88, v88
    v_fmac_f32 v15, v89, v89
    v_fmac_f32 v15, v90, v90
    v_fmac_f32 v15, v91, v91
    v_cvt_pk_bf16_f32 v28, v147, v163
    v_cvt_pk_bf16_f32 v29, v179, v195
    v_cvt_pk_bf16_f32 v30, v211, v227
    v_cvt_pk_bf16_f32 v31, v243, v83
    buffer_store_dwordx4 v[28:31], v1, s[12:15], s16 offen offset:384 sc1
    v_fmac_f32 v15, v92, v92
    v_fmac_f32 v15, v93, v93
    v_fmac_f32 v15, v94, v94
    v_fmac_f32 v15, v95, v95
    v_cvt_pk_bf16_f32 v32, v148, v164
    v_cvt_pk_bf16_f32 v33, v180, v196
    v_cvt_pk_bf16_f32 v34, v212, v228
    v_cvt_pk_bf16_f32 v35, v244, v84
    buffer_store_dwordx4 v[32:35], v1, s[12:15], s16 offen offset:1024 sc1
    v_fmac_f32 v15, v80, v80
    v_cvt_pk_bf16_f32 v36, v149, v165
    v_cvt_pk_bf16_f32 v37, v181, v197
    v_cvt_pk_bf16_f32 v38, v213, v229
    v_cvt_pk_bf16_f32 v39, v245, v85
    buffer_store_dwordx4 v[36:39], v1, s[12:15], s16 offen offset:1152 sc1
    v_cvt_pk_bf16_f32 v40, v150, v166
    v_cvt_pk_bf16_f32 v41, v182, v198
    v_cvt_pk_bf16_f32 v42, v214, v230
    v_cvt_pk_bf16_f32 v43, v246, v86
    buffer_store_dwordx4 v[40:43], v1, s[12:15], s16 offen offset:1280 sc1
    v_cvt_pk_bf16_f32 v44, v151, v167
    v_cvt_pk_bf16_f32 v45, v183, v199
    v_cvt_pk_bf16_f32 v46, v215, v231
    v_cvt_pk_bf16_f32 v47, v247, v87
    buffer_store_dwordx4 v[44:47], v1, s[12:15], s16 offen offset:1408 sc1
    v_cvt_pk_bf16_f32 v48, v152, v168
    v_cvt_pk_bf16_f32 v49, v184, v200
    v_cvt_pk_bf16_f32 v50, v216, v232
    v_cvt_pk_bf16_f32 v51, v248, v88
    buffer_store_dwordx4 v[48:51], v1, s[12:15], s16 offen offset:2048 sc1
    v_cvt_pk_bf16_f32 v52, v153, v169
    v_cvt_pk_bf16_f32 v53, v185, v201
    v_cvt_pk_bf16_f32 v54, v217, v233
    v_cvt_pk_bf16_f32 v55, v249, v89
    buffer_store_dwordx4 v[52:55], v1, s[12:15], s16 offen offset:2176 sc1
    v_cvt_pk_bf16_f32 v56, v154, v170
    v_cvt_pk_bf16_f32 v57, v186, v202
    v_cvt_pk_bf16_f32 v58, v218, v234
    v_cvt_pk_bf16_f32 v59, v250, v90
    buffer_store_dwordx4 v[56:59], v1, s[12:15], s16 offen offset:2304 sc1
    v_cvt_pk_bf16_f32 v60, v155, v171
    v_cvt_pk_bf16_f32 v61, v187, v203
    v_cvt_pk_bf16_f32 v62, v219, v235
    v_cvt_pk_bf16_f32 v63, v251, v91
    buffer_store_dwordx4 v[60:63], v1, s[12:15], s16 offen offset:2432 sc1
    v_cvt_pk_bf16_f32 v64, v156, v172
    v_cvt_pk_bf16_f32 v65, v188, v204
    v_cvt_pk_bf16_f32 v66, v220, v236
    v_cvt_pk_bf16_f32 v67, v252, v92
    buffer_store_dwordx4 v[64:67], v1, s[12:15], s16 offen offset:3072 sc1
    v_cvt_pk_bf16_f32 v68, v157, v173
    v_cvt_pk_bf16_f32 v69, v189, v205
    v_cvt_pk_bf16_f32 v70, v221, v237
    v_cvt_pk_bf16_f32 v71, v253, v93
    buffer_store_dwordx4 v[68:71], v1, s[12:15], s16 offen offset:3200 sc1
    v_cvt_pk_bf16_f32 v72, v158, v174
    v_cvt_pk_bf16_f32 v73, v190, v206
    v_cvt_pk_bf16_f32 v74, v222, v238
    v_cvt_pk_bf16_f32 v75, v254, v94
    buffer_store_dwordx4 v[72:75], v1, s[12:15], s16 offen offset:3328 sc1
    v_cvt_pk_bf16_f32 v76, v159, v175
    v_cvt_pk_bf16_f32 v77, v191, v207
    v_cvt_pk_bf16_f32 v78, v223, v239
    v_cvt_pk_bf16_f32 v79, v255, v95
    buffer_store_dwordx4 v[76:79], v1, s[12:15], s16 offen offset:3456 sc1
    s_nop 1
    v_permlane32_swap_b32 v8, v9
    v_permlane32_swap_b32 v10, v11
    v_permlane32_swap_b32 v12, v13
    v_permlane32_swap_b32 v14, v15
    v_add_f32 v8, v8, v9
    v_add_f32 v10, v10, v11
    v_add_f32 v12, v12, v13
    v_add_f32 v14, v14, v15
    s_nop 1
    v_permlane16_swap_b32 v8, v10
    v_permlane16_swap_b32 v12, v14
    v_add_f32 v8, v8, v10
    v_add_f32 v12, v12, v14
    v_writelane_b32 v4, s41, 8
    v_writelane_b32 v4, s43, 9
    v_add_f32_dpp v8, v8, v8 row_ror:8 row_mask:0xf bank_mask:0xf
    v_add_f32_dpp v12, v12, v12 row_ror:8 row_mask:0xf bank_mask:0xf
    v_writelane_b32 v4, s45, 10
    v_writelane_b32 v4, s47, 11
    v_add_f32_dpp v8, v8, v8 row_ror:4 row_mask:0xf bank_mask:0xf
    v_add_f32_dpp v12, v12, v12 row_ror:4 row_mask:0xf bank_mask:0xf
    v_writelane_b32 v4, s49, 12
    v_writelane_b32 v4, s51, 13
    v_add_f32_dpp v8, v8, v8 row_ror:2 row_mask:0xf bank_mask:0xf
    v_add_f32_dpp v12, v12, v12 row_ror:2 row_mask:0xf bank_mask:0xf
    v_writelane_b32 v4, s53, 14
    v_writelane_b32 v4, s55, 15
    v_add_f32_dpp v8, v8, v8 row_ror:1 row_mask:0xf bank_mask:0xf
    v_add_f32_dpp v12, v12, v12 row_ror:1 row_mask:0xf bank_mask:0xf
    v_mul_f32 v4, 0x3cb504f3, v4
    s_nop 0
    v_readlane_b32 s40, v8, 0
    v_readlane_b32 s42, v8, 32
    v_readlane_b32 s44, v8, 16
    v_readlane_b32 s46, v8, 48
    v_readlane_b32 s48, v12, 0
    v_readlane_b32 s50, v12, 32
    v_readlane_b32 s52, v12, 16
    v_readlane_b32 s54, v12, 48
    v_lshrrev_b32 v3, 5, v5
    v_and_b32 v6, 7, v5
    v_lshlrev_b32 v6, 2, v6
    v_lshl_add_u32 v6, v3, 26, v6
    v_bfe_u32 v3, v5, 3, 1
    v_lshl_add_u32 v6, v3, 13, v6
    v_bfe_u32 v3, v5, 4, 1
    v_lshl_add_u32 v6, v3, 30, v6
    s_lshl_b32 s19, s3, 5
    s_add_u32 s19, s19, 63963136
    v_writelane_b32 v4, s40, 0
    v_writelane_b32 v4, s42, 1
    v_writelane_b32 v4, s44, 2
    v_writelane_b32 v4, s46, 3
    v_writelane_b32 v4, s48, 4
    v_writelane_b32 v4, s50, 5
    v_writelane_b32 v4, s52, 6
    v_writelane_b32 v4, s54, 7
    buffer_store_dword v4, v6, s[12:15], s19 offen sc1
    s_mov_b32 s26, s68
    s_lshl2_add_u32 s26, s26, s24
    s_lshl_b32 s26, s26, 6
    v_add_u32 v2, s26, v5
    v_mul_u32_u24 v3, 9363, v2
    v_lshrrev_b32 v3, 16, v3
    v_lshlrev_b32 v2, 7, v2
    v_mul_u32_u24 v3, 6272, v3
    v_add_u32 v2, v2, v3
    s_and_b32 s26, s2, 7
    s_mul_i32 s26, s26, 896
    buffer_load_dword a41, v2, s[64:67], s26 offen
    s_branch K1_DONE
K1_Rw:
    s_sub_u32 s3, s2, 128
    s_lshr_b32 s25, s3, 3
    s_add_u32 s25, s25, 8
    s_mov_b32 s68, s25
    s_lshl2_add_u32 s3, s3, s24
    v_bfe_u32 v1, v5, 1, 1
    v_bfe_u32 v2, v5, 3, 2
    v_lshl_add_u32 v1, v2, 1, v1
    v_lshlrev_b32 v1, 11, v1
    v_lshrrev_b32 v2, 5, v5
    v_lshl_add_u32 v1, v2, 6, v1
    v_bfe_u32 v2, v5, 2, 1
    v_lshl_add_u32 v1, v2, 5, v1
    v_and_b32 v2, 1, v5
    v_lshl_add_u32 v1, v2, 4, v1
    s_lshl_b32 s16, s3, 14
    v_and_b32 v6, 31, v5
    v_lshrrev_b32 v7, 5, v5
    v_cvt_f32_u32 v6, v6
    v_cvt_f32_u32 v7, v7
    v_mul_f32 v8, 0xbd000000, v6
    v_mul_f32 v9, v8, v7
    v_mul_f32 v11, 0x41000000, v8
    v_fmamk_f32 v240, v8, 0x00000000, v9
    v_fmamk_f32 v241, v8, 0x40000000, v9
    v_fmamk_f32 v242, v8, 0x40800000, v9
    s_waitcnt lgkmcnt(0)
    s_mov_b32 s12, s4
    s_mov_b32 s13, s5
    s_mov_b32 s14, 268435456
    s_mov_b32 s15, 0x00020000
    s_mov_b32 s64, s40
    s_mov_b32 s65, s41
    s_mov_b32 s66, 7340032
    s_mov_b32 s67, 0x00020000
    s_mov_b32 s8, s42
    s_mov_b32 s9, s43
    s_mov_b32 s10, 7340032
    s_mov_b32 s11, 0x00020000
    buffer_load_dwordx4 v[16:19], v1, s[8:11], s16 offen offset:0
    buffer_load_dwordx4 v[20:23], v1, s[8:11], s16 offen offset:128
    buffer_load_dwordx4 v[24:27], v1, s[8:11], s16 offen offset:256
    buffer_load_dwordx4 v[28:31], v1, s[8:11], s16 offen offset:384
    buffer_load_dwordx4 v[32:35], v1, s[8:11], s16 offen offset:512
    buffer_load_dwordx4 v[36:39], v1, s[8:11], s16 offen offset:640
    buffer_load_dwordx4 v[40:43], v1, s[8:11], s16 offen offset:768
    buffer_load_dwordx4 v[44:47], v1, s[8:11], s16 offen offset:896
    buffer_load_dwordx4 v[48:51], v1, s[8:11], s16 offen offset:1024
    buffer_load_dwordx4 v[52:55], v1, s[8:11], s16 offen offset:1152
    buffer_load_dwordx4 v[56:59], v1, s[8:11], s16 offen offset:1280
    buffer_load_dwordx4 v[60:63], v1, s[8:11], s16 offen offset:1408
    buffer_load_dwordx4 v[64:67], v1, s[8:11], s16 offen offset:1536
    buffer_load_dwordx4 v[68:71], v1, s[8:11], s16 offen offset:1664
    buffer_load_dwordx4 v[72:75], v1, s[8:11], s16 offen offset:1792
    buffer_load_dwordx4 v[76:79], v1, s[8:11], s16 offen offset:1920
    v_fmamk_f32 v243, v8, 0x40c00000, v9
    v_cos_f32 v10, v11
    v_sin_f32 v11, v11
    v_cos_f32 v224, v240
    v_cos_f32 v225, v241
    v_cos_f32 v226, v242
    v_cos_f32 v227, v243
    v_sin_f32 v240, v240
    v_sin_f32 v241, v241
    v_sin_f32 v242, v242
    v_sin_f32 v243, v243
    v_pk_mul_f32 v[228:229], v[224:225], v[10:11] op_sel:[0,0] op_sel_hi:[1,0]
    v_pk_mul_f32 v[244:245], v[240:241], v[10:11] op_sel:[0,0] op_sel_hi:[1,0]
    v_pk_mul_f32 v[230:231], v[226:227], v[10:11] op_sel:[0,0] op_sel_hi:[1,0]
    v_pk_mul_f32 v[246:247], v[242:243], v[10:11] op_sel:[0,0] op_sel_hi:[1,0]
    v_pk_fma_f32 v[228:229], v[240:241], v[10:11], v[228:229] op_sel:[0,1,0] op_sel_hi:[1,1,1] neg_lo:[1,0,0] neg_hi:[1,0,0]
    v_pk_fma_f32 v[244:245], v[224:225], v[10:11], v[244:245] op_sel:[0,1,0] op_sel_hi:[1,1,1]
    v_pk_fma_f32 v[230:231], v[242:243], v[10:11], v[230:231] op_sel:[0,1,0] op_sel_hi:[1,1,1] neg_lo:[1,0,0] neg_hi:[1,0,0]
    v_pk_fma_f32 v[246:247], v[226:227], v[10:11], v[246:247] op_sel:[0,1,0] op_sel_hi:[1,1,1]
    v_pk_mul_f32 v[232:233], v[228:229], v[10:11] op_sel:[0,0] op_sel_hi:[1,0]
    v_pk_mul_f32 v[248:249], v[244:245], v[10:11] op_sel:[0,0] op_sel_hi:[1,0]
    v_pk_mul_f32 v[234:235], v[230:231], v[10:11] op_sel:[0,0] op_sel_hi:[1,0]
    v_pk_mul_f32 v[250:251], v[246:247], v[10:11] op_sel:[0,0] op_sel_hi:[1,0]
    v_pk_fma_f32 v[232:233], v[244:245], v[10:11], v[232:233] op_sel:[0,1,0] op_sel_hi:[1,1,1] neg_lo:[1,0,0] neg_hi:[1,0,0]
    v_pk_fma_f32 v[248:249], v[228:229], v[10:11], v[248:249] op_sel:[0,1,0] op_sel_hi:[1,1,1]
    v_pk_fma_f32 v[234:235], v[246:247], v[10:11], v[234:235] op_sel:[0,1,0] op_sel_hi:[1,1,1] neg_lo:[1,0,0] neg_hi:[1,0,0]
    v_pk_fma_f32 v[250:251], v[230:231], v[10:11], v[250:251] op_sel:[0,1,0] op_sel_hi:[1,1,1]
    v_pk_mul_f32 v[236:237], v[232:233], v[10:11] op_sel:[0,0] op_sel_hi:[1,0]
    v_pk_mul_f32 v[252:253], v[248:249], v[10:11] op_sel:[0,0] op_sel_hi:[1,0]
    v_pk_mul_f32 v[238:239], v[234:235], v[10:11] op_sel:[0,0] op_sel_hi:[1,0]
    v_pk_mul_f32 v[254:255], v[250:251], v[10:11] op_sel:[0,0] op_sel_hi:[1,0]
    v_pk_fma_f32 v[236:237], v[248:249], v[10:11], v[236:237] op_sel:[0,1,0] op_sel_hi:[1,1,1] neg_lo:[1,0,0] neg_hi:[1,0,0]
    v_pk_fma_f32 v[252:253], v[232:233], v[10:11], v[252:253] op_sel:[0,1,0] op_sel_hi:[1,1,1]
    v_pk_fma_f32 v[238:239], v[250:251], v[10:11], v[238:239] op_sel:[0,1,0] op_sel_hi:[1,1,1] neg_lo:[1,0,0] neg_hi:[1,0,0]
    v_pk_fma_f32 v[254:255], v[234:235], v[10:11], v[254:255] op_sel:[0,1,0] op_sel_hi:[1,1,1]
    v_cvt_pk_bf16_f32 v224, v224, v225
    v_cvt_pk_bf16_f32 v226, v226, v227
    v_cvt_pk_bf16_f32 v228, v228, v229
    v_cvt_pk_bf16_f32 v230, v230, v231
    v_cvt_pk_bf16_f32 v232, v232, v233
    v_cvt_pk_bf16_f32 v234, v234, v235
    v_cvt_pk_bf16_f32 v236, v236, v237
    v_cvt_pk_bf16_f32 v238, v238, v239
    v_cvt_pk_bf16_f32 v240, v240, v241
    v_cvt_pk_bf16_f32 v242, v242, v243
    v_cvt_pk_bf16_f32 v244, v244, v245
    v_cvt_pk_bf16_f32 v246, v246, v247
    v_cvt_pk_bf16_f32 v248, v248, v249
    v_cvt_pk_bf16_f32 v250, v250, v251
    v_cvt_pk_bf16_f32 v252, v252, v253
    v_cvt_pk_bf16_f32 v254, v254, v255
    v_accvgpr_write_b32 a0, v224
    v_accvgpr_write_b32 a1, v226
    v_accvgpr_write_b32 a2, v228
    v_accvgpr_write_b32 a3, v230
    v_accvgpr_write_b32 a4, v232
    v_accvgpr_write_b32 a5, v234
    v_accvgpr_write_b32 a6, v236
    v_accvgpr_write_b32 a7, v238
    v_accvgpr_write_b32 a8, v240
    v_accvgpr_write_b32 a9, v242
    v_accvgpr_write_b32 a10, v244
    v_accvgpr_write_b32 a11, v246
    v_accvgpr_write_b32 a12, v248
    v_accvgpr_write_b32 a13, v250
    v_accvgpr_write_b32 a14, v252
    v_accvgpr_write_b32 a15, v254
    v_bfe_u32 v8, v5, 1, 4
    v_cvt_f32_u32 v8, v8
    v_and_b32 v12, 1, v5
    v_cvt_f32_u32 v9, v12
    v_mul_f32 v8, 0x3d000000, v8
    v_mul_f32 v9, 0x3e800000, v9
    v_mul_f32 v7, 0x41800000, v7
    v_fmac_f32 v9, v8, v7
    v_mul_f32 v11, 0x40000000, v8
    v_fmamk_f32 v240, v8, 0x00000000, v9
    v_fmamk_f32 v241, v8, 0x41000000, v9
    v_fmamk_f32 v242, v8, 0x3f800000, v9
    v_fmamk_f32 v243, v8, 0x41100000, v9
    v_cos_f32 v10, v11
    v_sin_f32 v11, v11
    v_cos_f32 v224, v240
    v_cos_f32 v225, v241
    v_cos_f32 v226, v242
    v_cos_f32 v227, v243
    v_sin_f32 v240, v240
    v_sin_f32 v241, v241
    v_sin_f32 v242, v242
    v_sin_f32 v243, v243
    v_pk_mul_f32 v[228:229], v[224:225], v[10:11] op_sel:[0,0] op_sel_hi:[1,0]
    v_pk_mul_f32 v[244:245], v[240:241], v[10:11] op_sel:[0,0] op_sel_hi:[1,0]
    v_pk_mul_f32 v[230:231], v[226:227], v[10:11] op_sel:[0,0] op_sel_hi:[1,0]
    v_pk_mul_f32 v[246:247], v[242:243], v[10:11] op_sel:[0,0] op_sel_hi:[1,0]
    v_pk_fma_f32 v[228:229], v[240:241], v[10:11], v[228:229] op_sel:[0,1,0] op_sel_hi:[1,1,1] neg_lo:[1,0,0] neg_hi:[1,0,0]
    v_pk_fma_f32 v[244:245], v[224:225], v[10:11], v[244:245] op_sel:[0,1,0] op_sel_hi:[1,1,1]
    v_pk_fma_f32 v[230:231], v[242:243], v[10:11], v[230:231] op_sel:[0,1,0] op_sel_hi:[1,1,1] neg_lo:[1,0,0] neg_hi:[1,0,0]
    v_pk_fma_f32 v[246:247], v[226:227], v[10:11], v[246:247] op_sel:[0,1,0] op_sel_hi:[1,1,1]
    v_pk_mul_f32 v[232:233], v[228:229], v[10:11] op_sel:[0,0] op_sel_hi:[1,0]
    v_pk_mul_f32 v[248:249], v[244:245], v[10:11] op_sel:[0,0] op_sel_hi:[1,0]
    v_pk_mul_f32 v[234:235], v[230:231], v[10:11] op_sel:[0,0] op_sel_hi:[1,0]
    v_pk_mul_f32 v[250:251], v[246:247], v[10:11] op_sel:[0,0] op_sel_hi:[1,0]
    v_pk_fma_f32 v[232:233], v[244:245], v[10:11], v[232:233] op_sel:[0,1,0] op_sel_hi:[1,1,1] neg_lo:[1,0,0] neg_hi:[1,0,0]
    v_pk_fma_f32 v[248:249], v[228:229], v[10:11], v[248:249] op_sel:[0,1,0] op_sel_hi:[1,1,1]
    v_pk_fma_f32 v[234:235], v[246:247], v[10:11], v[234:235] op_sel:[0,1,0] op_sel_hi:[1,1,1] neg_lo:[1,0,0] neg_hi:[1,0,0]
    v_pk_fma_f32 v[250:251], v[230:231], v[10:11], v[250:251] op_sel:[0,1,0] op_sel_hi:[1,1,1]
    v_pk_mul_f32 v[236:237], v[232:233], v[10:11] op_sel:[0,0] op_sel_hi:[1,0]
    v_pk_mul_f32 v[252:253], v[248:249], v[10:11] op_sel:[0,0] op_sel_hi:[1,0]
    v_pk_mul_f32 v[238:239], v[234:235], v[10:11] op_sel:[0,0] op_sel_hi:[1,0]
    v_pk_mul_f32 v[254:255], v[250:251], v[10:11] op_sel:[0,0] op_sel_hi:[1,0]
    v_pk_fma_f32 v[236:237], v[248:249], v[10:11], v[236:237] op_sel:[0,1,0] op_sel_hi:[1,1,1] neg_lo:[1,0,0] neg_hi:[1,0,0]
    v_pk_fma_f32 v[252:253], v[232:233], v[10:11], v[252:253] op_sel:[0,1,0] op_sel_hi:[1,1,1]
    v_pk_fma_f32 v[238:239], v[250:251], v[10:11], v[238:239] op_sel:[0,1,0] op_sel_hi:[1,1,1] neg_lo:[1,0,0] neg_hi:[1,0,0]
    v_pk_fma_f32 v[254:255], v[234:235], v[10:11], v[254:255] op_sel:[0,1,0] op_sel_hi:[1,1,1]
    v_cvt_pk_bf16_f32 v224, v224, v225
    v_cvt_pk_bf16_f32 v226, v226, v227
    v_cvt_pk_bf16_f32 v228, v228, v229
    v_cvt_pk_bf16_f32 v230, v230, v231
    v_cvt_pk_bf16_f32 v232, v232, v233
    v_cvt_pk_bf16_f32 v234, v234, v235
    v_cvt_pk_bf16_f32 v236, v236, v237
    v_cvt_pk_bf16_f32 v238, v238, v239
    v_cvt_pk_bf16_f32 v240, v240, v241
    v_cvt_pk_bf16_f32 v242, v242, v243
    v_cvt_pk_bf16_f32 v244, v244, v245
    v_cvt_pk_bf16_f32 v246, v246, v247
    v_cvt_pk_bf16_f32 v248, v248, v249
    v_cvt_pk_bf16_f32 v250, v250, v251
    v_cvt_pk_bf16_f32 v252, v252, v253
    v_cvt_pk_bf16_f32 v254, v254, v255
    v_accvgpr_write_b32 a16, v224
    v_accvgpr_write_b32 a17, v226
    v_accvgpr_write_b32 a18, v228
    v_accvgpr_write_b32 a19, v230
    v_accvgpr_write_b32 a20, v232
    v_accvgpr_write_b32 a21, v234
    v_accvgpr_write_b32 a22, v236
    v_accvgpr_write_b32 a23, v238
    v_accvgpr_write_b32 a24, v240
    v_accvgpr_write_b32 a25, v242
    v_accvgpr_write_b32 a26, v244
    v_accvgpr_write_b32 a27, v246
    v_accvgpr_write_b32 a28, v248
    v_accvgpr_write_b32 a29, v250
    v_accvgpr_write_b32 a30, v252
    v_accvgpr_write_b32 a31, v254
    v_mul_f32 v8, 0xba800000, v6
    v_mul_f32 v9, v8, v7
    s_mov_b32 s28, 0x3d3504f3
    v_mul_f32 v11, 0x40000000, v8
    v_fmamk_f32 v240, v8, 0x00000000, v9
    v_fmamk_f32 v241, v8, 0x41000000, v9
    v_fmamk_f32 v242, v8, 0x3f800000, v9
    v_fmamk_f32 v243, v8, 0x41100000, v9
    v_cos_f32 v10, v11
    v_sin_f32 v11, v11
    v_cos_f32 v224, v240
    v_cos_f32 v225, v241
    v_cos_f32 v226, v242
    v_cos_f32 v227, v243
    v_sin_f32 v240, v240
    v_sin_f32 v241, v241
    v_sin_f32 v242, v242
    v_sin_f32 v243, v243
    v_pk_mul_f32 v[224:225], v[224:225], s[28:29] op_sel_hi:[1,0]
    v_pk_mul_f32 v[226:227], v[226:227], s[28:29] op_sel_hi:[1,0]
    v_pk_mul_f32 v[240:241], v[240:241], s[28:29] op_sel_hi:[1,0]
    v_pk_mul_f32 v[242:243], v[242:243], s[28:29] op_sel_hi:[1,0]
    v_pk_mul_f32 v[228:229], v[224:225], v[10:11] op_sel:[0,0] op_sel_hi:[1,0]
    v_pk_mul_f32 v[244:245], v[240:241], v[10:11] op_sel:[0,0] op_sel_hi:[1,0]
    v_pk_mul_f32 v[230:231], v[226:227], v[10:11] op_sel:[0,0] op_sel_hi:[1,0]
    v_pk_mul_f32 v[246:247], v[242:243], v[10:11] op_sel:[0,0] op_sel_hi:[1,0]
    v_pk_fma_f32 v[228:229], v[240:241], v[10:11], v[228:229] op_sel:[0,1,0] op_sel_hi:[1,1,1] neg_lo:[1,0,0] neg_hi:[1,0,0]
    v_pk_fma_f32 v[244:245], v[224:225], v[10:11], v[244:245] op_sel:[0,1,0] op_sel_hi:[1,1,1]
    v_pk_fma_f32 v[230:231], v[242:243], v[10:11], v[230:231] op_sel:[0,1,0] op_sel_hi:[1,1,1] neg_lo:[1,0,0] neg_hi:[1,0,0]
    v_pk_fma_f32 v[246:247], v[226:227], v[10:11], v[246:247] op_sel:[0,1,0] op_sel_hi:[1,1,1]
    v_pk_mul_f32 v[232:233], v[228:229], v[10:11] op_sel:[0,0] op_sel_hi:[1,0]
    v_pk_mul_f32 v[248:249], v[244:245], v[10:11] op_sel:[0,0] op_sel_hi:[1,0]
    v_pk_mul_f32 v[234:235], v[230:231], v[10:11] op_sel:[0,0] op_sel_hi:[1,0]
    v_pk_mul_f32 v[250:251], v[246:247], v[10:11] op_sel:[0,0] op_sel_hi:[1,0]
    v_pk_fma_f32 v[232:233], v[244:245], v[10:11], v[232:233] op_sel:[0,1,0] op_sel_hi:[1,1,1] neg_lo:[1,0,0] neg_hi:[1,0,0]
    v_pk_fma_f32 v[248:249], v[228:229], v[10:11], v[248:249] op_sel:[0,1,0] op_sel_hi:[1,1,1]
    v_pk_fma_f32 v[234:235], v[246:247], v[10:11], v[234:235] op_sel:[0,1,0] op_sel_hi:[1,1,1] neg_lo:[1,0,0] neg_hi:[1,0,0]
    v_pk_fma_f32 v[250:251], v[230:231], v[10:11], v[250:251] op_sel:[0,1,0] op_sel_hi:[1,1,1]
    v_pk_mul_f32 v[236:237], v[232:233], v[10:11] op_sel:[0,0] op_sel_hi:[1,0]
    v_pk_mul_f32 v[252:253], v[248:249], v[10:11] op_sel:[0,0] op_sel_hi:[1,0]
    v_pk_mul_f32 v[238:239], v[234:235], v[10:11] op_sel:[0,0] op_sel_hi:[1,0]
    v_pk_mul_f32 v[254:255], v[250:251], v[10:11] op_sel:[0,0] op_sel_hi:[1,0]
    v_pk_fma_f32 v[236:237], v[248:249], v[10:11], v[236:237] op_sel:[0,1,0] op_sel_hi:[1,1,1] neg_lo:[1,0,0] neg_hi:[1,0,0]
    v_pk_fma_f32 v[252:253], v[232:233], v[10:11], v[252:253] op_sel:[0,1,0] op_sel_hi:[1,1,1]
    v_pk_fma_f32 v[238:239], v[250:251], v[10:11], v[238:239] op_sel:[0,1,0] op_sel_hi:[1,1,1] neg_lo:[1,0,0] neg_hi:[1,0,0]
    v_pk_fma_f32 v[254:255], v[234:235], v[10:11], v[254:255] op_sel:[0,1,0] op_sel_hi:[1,1,1]
    v_mov_b32 v10, 0x3f803f80
    v_lshlrev_b32 v11, 31, v12
    v_lshrrev_b32 v12, 16, v11
    v_or_b32 v11, v11, v12
    v_xor_b32 v11, v10, v11
    v_accvgpr_write_b32 a32, v10
    v_accvgpr_write_b32 a33, v11
    v_accvgpr_write_b32 a34, v10
    v_accvgpr_write_b32 a35, v11
    s_mov_b32 s30, 0x05040100
    s_mov_b32 s31, 0x07060302
    s_mul_i32 s25, s3, 586
    s_lshr_b32 s25, s25, 16
    s_mul_i32 s17, s25, 112
    s_sub_u32 s17, s3, s17
    s_lshr_b32 s18, s17, 2
    s_and_b32 s17, s17, 3
    s_mul_i32 s27, s25, 1835008
    s_lshl_b32 s17, s17, 9
    s_add_u32 s27, s27, s17
    s_add_u32 s27, s27, 50331648
    s_mul_i32 s17, s18, 37
    s_lshr_b32 s17, s17, 8
    s_mul_i32 s19, s17, 7
    s_sub_u32 s18, s18, s19
    s_mul_i32 s18, s18, 5
    s_mov_b32 s20, 2627930144
    s_mov_b32 s21, 4
    s_lshr_b64 s[20:21], s[20:21], s18
    s_and_b32 s20, s20, 31
    s_mov_b32 s22, 723986626
    s_mov_b32 s23, 6
    s_lshr_b64 s[22:23], s[22:23], s18
    s_and_b32 s22, s22, 31
    v_bfe_u32 v4, v5, 3, 2
    v_sub_u32 v2, s17, v4
    v_and_b32 v2, 3, v2
    v_cmp_eq_u32 vcc, 0, v2
    v_add_u32 v2, s22, v2
    v_mov_b32 v3, s20
    s_mov_b32 s17, 458752
    v_cndmask_b32 v2, v2, v3, vcc
    v_mul_lo_u32 v4, v4, s17
    v_and_b32 v3, 7, v5
    v_lshl_add_u32 v4, v3, 4, v4
    v_and_b32 v3, 1, v2
    v_lshl_add_u32 v4, v3, 11, v4
    v_lshrrev_b32 v2, 1, v2
    v_lshrrev_b32 v3, 5, v5
    s_lshl_b32 s25, s25, 1
    v_subrev_u32 v3, s25, v3
    v_cmp_gt_u32 s[20:21], 10, v2
    v_add_u32 v9, 50, v2
    v_add_u32 v6, 6, v3
    v_and_b32 v6, 7, v6
    v_cmp_gt_u32 vcc, 6, v6
    v_mad_u32_u24 v7, v2, 6, v6
    v_mad_u32_u24 v8, v6, 4, v9
    v_cndmask_b32 v7, v8, v7, s[20:21]
    v_mad_u32_u24 v8, v6, 14, v2
    v_cndmask_b32 v7, v8, v7, vcc
    v_lshl_add_u32 v7, v7, 12, v4
    v_accvgpr_write_b32 a42, v7
    v_add_u32 v6, 8, v3
    v_and_b32 v6, 7, v6
    v_cmp_gt_u32 vcc, 6, v6
    v_mad_u32_u24 v7, v2, 6, v6
    v_mad_u32_u24 v8, v6, 4, v9
    v_cndmask_b32 v7, v8, v7, s[20:21]
    v_mad_u32_u24 v8, v6, 14, v2
    v_cndmask_b32 v7, v8, v7, vcc
    v_lshl_add_u32 v7, v7, 12, v4
    v_accvgpr_write_b32 a43, v7
    v_add_u32 v6, 10, v3
    v_and_b32 v6, 7, v6
    v_cmp_gt_u32 vcc, 6, v6
    v_mad_u32_u24 v7, v2, 6, v6
    v_mad_u32_u24 v8, v6, 4, v9
    v_cndmask_b32 v7, v8, v7, s[20:21]
    v_mad_u32_u24 v8, v6, 14, v2
    v_cndmask_b32 v7, v8, v7, vcc
    v_lshl_add_u32 v7, v7, 12, v4
    v_accvgpr_write_b32 a44, v7
    v_add_u32 v6, 12, v3
    v_and_b32 v6, 7, v6
    v_cmp_gt_u32 vcc, 6, v6
    v_mad_u32_u24 v7, v2, 6, v6
    v_mad_u32_u24 v8, v6, 4, v9
    v_cndmask_b32 v7, v8, v7, s[20:21]
    v_mad_u32_u24 v8, v6, 14, v2
    v_cndmask_b32 v7, v8, v7, vcc
    v_lshl_add_u32 v7, v7, 12, v4
    v_accvgpr_write_b32 a45, v7
    s_waitcnt vmcnt(0)
    v_perm_b32 v208, v20, v16, s30
    v_perm_b32 v209, v28, v24, s30
    v_perm_b32 v210, v36, v32, s30
    v_perm_b32 v211, v44, v40, s30
    v_perm_b32 v212, v52, v48, s30
    v_perm_b32 v213, v60, v56, s30
    v_perm_b32 v214, v68, v64, s30
    v_perm_b32 v215, v76, v72, s30
    s_nop 1
    v_mfma_f32_32x32x16_bf16 v[144:159], v[208:211], a[0:3], 0
    v_perm_b32 v216, v20, v16, s31
    v_perm_b32 v217, v28, v24, s31
    v_perm_b32 v218, v36, v32, s31
    v_perm_b32 v219, v44, v40, s31
    v_perm_b32 v220, v52, v48, s31
    v_mfma_f32_32x32x16_bf16 v[160:175], v[208:211], a[8:11], 0
    v_perm_b32 v221, v60, v56, s31
    v_perm_b32 v222, v68, v64, s31
    v_perm_b32 v223, v76, v72, s31
    v_mfma_f32_32x32x16_bf16 v[144:159], v[212:215], a[4:7], v[144:159]
    v_mfma_f32_32x32x16_bf16 v[160:175], v[212:215], a[12:15], v[160:175]
    s_nop 11
    v_pk_mul_f32 v[8:9], v[160:161], v[240:241]
    v_pk_mul_f32 v[10:11], v[162:163], v[240:241]
    v_pk_mul_f32 v[12:13], v[164:165], v[240:241]
    v_pk_mul_f32 v[14:15], v[166:167], v[240:241]
    v_pk_mul_f32 v[160:161], v[160:161], v[224:225]
    v_pk_mul_f32 v[162:163], v[162:163], v[224:225]
    v_pk_mul_f32 v[164:165], v[164:165], v[224:225]
    v_pk_mul_f32 v[166:167], v[166:167], v[224:225]
    v_pk_fma_f32 v[160:161], v[144:145], v[240:241], v[160:161]
    v_pk_fma_f32 v[162:163], v[146:147], v[240:241], v[162:163]
    v_pk_fma_f32 v[164:165], v[148:149], v[240:241], v[164:165]
    v_pk_fma_f32 v[166:167], v[150:151], v[240:241], v[166:167]
    v_pk_fma_f32 v[144:145], v[144:145], v[224:225], v[8:9] neg_lo:[0,0,1] neg_hi:[0,0,1]
    v_pk_fma_f32 v[146:147], v[146:147], v[224:225], v[10:11] neg_lo:[0,0,1] neg_hi:[0,0,1]
    v_pk_fma_f32 v[148:149], v[148:149], v[224:225], v[12:13] neg_lo:[0,0,1] neg_hi:[0,0,1]
    v_pk_fma_f32 v[150:151], v[150:151], v[224:225], v[14:15] neg_lo:[0,0,1] neg_hi:[0,0,1]
    v_pk_mul_f32 v[8:9], v[168:169], v[240:241]
    v_pk_mul_f32 v[10:11], v[170:171], v[240:241]
    v_pk_mul_f32 v[12:13], v[172:173], v[240:241]
    v_pk_mul_f32 v[14:15], v[174:175], v[240:241]
    v_pk_mul_f32 v[168:169], v[168:169], v[224:225]
    v_pk_mul_f32 v[170:171], v[170:171], v[224:225]
    v_pk_mul_f32 v[172:173], v[172:173], v[224:225]
    v_pk_mul_f32 v[174:175], v[174:175], v[224:225]
    v_pk_fma_f32 v[168:169], v[152:153], v[240:241], v[168:169]
    v_pk_fma_f32 v[170:171], v[154:155], v[240:241], v[170:171]
    v_pk_fma_f32 v[172:173], v[156:157], v[240:241], v[172:173]
    v_pk_fma_f32 v[174:175], v[158:159], v[240:241], v[174:175]
    v_pk_fma_f32 v[152:153], v[152:153], v[224:225], v[8:9] neg_lo:[0,0,1] neg_hi:[0,0,1]
    v_pk_fma_f32 v[154:155], v[154:155], v[224:225], v[10:11] neg_lo:[0,0,1] neg_hi:[0,0,1]
    v_pk_fma_f32 v[156:157], v[156:157], v[224:225], v[12:13] neg_lo:[0,0,1] neg_hi:[0,0,1]
    v_pk_fma_f32 v[158:159], v[158:159], v[224:225], v[14:15] neg_lo:[0,0,1] neg_hi:[0,0,1]
    v_mfma_f32_32x32x16_bf16 v[176:191], v[216:219], a[0:3], 0
    v_perm_b32 v208, v21, v17, s30
    v_perm_b32 v209, v29, v25, s30
    v_perm_b32 v210, v37, v33, s30
    v_perm_b32 v211, v45, v41, s30
    v_perm_b32 v212, v53, v49, s30
    v_mfma_f32_32x32x16_bf16 v[192:207], v[216:219], a[8:11], 0
    v_perm_b32 v213, v61, v57, s30
    v_perm_b32 v214, v69, v65, s30
    v_perm_b32 v215, v77, v73, s30
    v_cvt_pk_bf16_f32 v80, v144, v145
    v_cvt_pk_bf16_f32 v84, v160, v161
    v_mfma_f32_32x32x16_bf16 v[176:191], v[220:223], a[4:7], v[176:191]
    v_cvt_pk_bf16_f32 v88, v146, v147
    v_cvt_pk_bf16_f32 v92, v162, v163
    v_cvt_pk_bf16_f32 v96, v148, v149
    v_cvt_pk_bf16_f32 v100, v164, v165
    v_cvt_pk_bf16_f32 v104, v150, v151
    v_mfma_f32_32x32x16_bf16 v[192:207], v[220:223], a[12:15], v[192:207]
    v_cvt_pk_bf16_f32 v108, v166, v167
    v_cvt_pk_bf16_f32 v112, v152, v153
    v_cvt_pk_bf16_f32 v116, v168, v169
    v_cvt_pk_bf16_f32 v120, v154, v155
    v_cvt_pk_bf16_f32 v124, v170, v171
    v_cvt_pk_bf16_f32 v128, v156, v157
    v_cvt_pk_bf16_f32 v132, v172, v173
    v_cvt_pk_bf16_f32 v136, v158, v159
    v_cvt_pk_bf16_f32 v140, v174, v175
    s_nop 2
    v_pk_mul_f32 v[8:9], v[192:193], v[242:243]
    v_pk_mul_f32 v[10:11], v[194:195], v[242:243]
    v_pk_mul_f32 v[12:13], v[196:197], v[242:243]
    v_pk_mul_f32 v[14:15], v[198:199], v[242:243]
    v_pk_mul_f32 v[192:193], v[192:193], v[226:227]
    v_pk_mul_f32 v[194:195], v[194:195], v[226:227]
    v_pk_mul_f32 v[196:197], v[196:197], v[226:227]
    v_pk_mul_f32 v[198:199], v[198:199], v[226:227]
    v_pk_fma_f32 v[192:193], v[176:177], v[242:243], v[192:193]
    v_pk_fma_f32 v[194:195], v[178:179], v[242:243], v[194:195]
    v_pk_fma_f32 v[196:197], v[180:181], v[242:243], v[196:197]
    v_pk_fma_f32 v[198:199], v[182:183], v[242:243], v[198:199]
    v_pk_fma_f32 v[176:177], v[176:177], v[226:227], v[8:9] neg_lo:[0,0,1] neg_hi:[0,0,1]
    v_pk_fma_f32 v[178:179], v[178:179], v[226:227], v[10:11] neg_lo:[0,0,1] neg_hi:[0,0,1]
    v_pk_fma_f32 v[180:181], v[180:181], v[226:227], v[12:13] neg_lo:[0,0,1] neg_hi:[0,0,1]
    v_pk_fma_f32 v[182:183], v[182:183], v[226:227], v[14:15] neg_lo:[0,0,1] neg_hi:[0,0,1]
    v_pk_mul_f32 v[8:9], v[200:201], v[242:243]
    v_pk_mul_f32 v[10:11], v[202:203], v[242:243]
    v_pk_mul_f32 v[12:13], v[204:205], v[242:243]
    v_pk_mul_f32 v[14:15], v[206:207], v[242:243]
    v_pk_mul_f32 v[200:201], v[200:201], v[226:227]
    v_pk_mul_f32 v[202:203], v[202:203], v[226:227]
    v_pk_mul_f32 v[204:205], v[204:205], v[226:227]
    v_pk_mul_f32 v[206:207], v[206:207], v[226:227]
    v_pk_fma_f32 v[200:201], v[184:185], v[242:243], v[200:201]
    v_pk_fma_f32 v[202:203], v[186:187], v[242:243], v[202:203]
    v_pk_fma_f32 v[204:205], v[188:189], v[242:243], v[204:205]
    v_pk_fma_f32 v[206:207], v[190:191], v[242:243], v[206:207]
    v_pk_fma_f32 v[184:185], v[184:185], v[226:227], v[8:9] neg_lo:[0,0,1] neg_hi:[0,0,1]
    v_pk_fma_f32 v[186:187], v[186:187], v[226:227], v[10:11] neg_lo:[0,0,1] neg_hi:[0,0,1]
    v_pk_fma_f32 v[188:189], v[188:189], v[226:227], v[12:13] neg_lo:[0,0,1] neg_hi:[0,0,1]
    v_pk_fma_f32 v[190:191], v[190:191], v[226:227], v[14:15] neg_lo:[0,0,1] neg_hi:[0,0,1]
    v_mfma_f32_32x32x16_bf16 v[144:159], v[208:211], a[0:3], 0
    v_perm_b32 v216, v21, v17, s31
    v_perm_b32 v217, v29, v25, s31
    v_perm_b32 v218, v37, v33, s31
    v_perm_b32 v219, v45, v41, s31
    v_perm_b32 v220, v53, v49, s31
    v_mfma_f32_32x32x16_bf16 v[160:175], v[208:211], a[8:11], 0
    v_perm_b32 v221, v61, v57, s31
    v_perm_b32 v222, v69, v65, s31
    v_perm_b32 v223, v77, v73, s31
    v_cvt_pk_bf16_f32 v81, v176, v177
    v_cvt_pk_bf16_f32 v85, v192, v193
    v_mfma_f32_32x32x16_bf16 v[144:159], v[212:215], a[4:7], v[144:159]
    v_cvt_pk_bf16_f32 v89, v178, v179
    v_cvt_pk_bf16_f32 v93, v194, v195
    v_cvt_pk_bf16_f32 v97, v180, v181
    v_cvt_pk_bf16_f32 v101, v196, v197
    v_cvt_pk_bf16_f32 v105, v182, v183
    v_mfma_f32_32x32x16_bf16 v[160:175], v[212:215], a[12:15], v[160:175]
    v_cvt_pk_bf16_f32 v109, v198, v199
    v_cvt_pk_bf16_f32 v113, v184, v185
    v_cvt_pk_bf16_f32 v117, v200, v201
    v_cvt_pk_bf16_f32 v121, v186, v187
    v_cvt_pk_bf16_f32 v125, v202, v203
    v_cvt_pk_bf16_f32 v129, v188, v189
    v_cvt_pk_bf16_f32 v133, v204, v205
    v_cvt_pk_bf16_f32 v137, v190, v191
    v_cvt_pk_bf16_f32 v141, v206, v207
    s_nop 2
    v_pk_mul_f32 v[8:9], v[160:161], v[244:245]
    v_pk_mul_f32 v[10:11], v[162:163], v[244:245]
    v_pk_mul_f32 v[12:13], v[164:165], v[244:245]
    v_pk_mul_f32 v[14:15], v[166:167], v[244:245]
    v_pk_mul_f32 v[160:161], v[160:161], v[228:229]
    v_pk_mul_f32 v[162:163], v[162:163], v[228:229]
    v_pk_mul_f32 v[164:165], v[164:165], v[228:229]
    v_pk_mul_f32 v[166:167], v[166:167], v[228:229]
    v_pk_fma_f32 v[160:161], v[144:145], v[244:245], v[160:161]
    v_pk_fma_f32 v[162:163], v[146:147], v[244:245], v[162:163]
    v_pk_fma_f32 v[164:165], v[148:149], v[244:245], v[164:165]
    v_pk_fma_f32 v[166:167], v[150:151], v[244:245], v[166:167]
    v_pk_fma_f32 v[144:145], v[144:145], v[228:229], v[8:9] neg_lo:[0,0,1] neg_hi:[0,0,1]
    v_pk_fma_f32 v[146:147], v[146:147], v[228:229], v[10:11] neg_lo:[0,0,1] neg_hi:[0,0,1]
    v_pk_fma_f32 v[148:149], v[148:149], v[228:229], v[12:13] neg_lo:[0,0,1] neg_hi:[0,0,1]
    v_pk_fma_f32 v[150:151], v[150:151], v[228:229], v[14:15] neg_lo:[0,0,1] neg_hi:[0,0,1]
    v_pk_mul_f32 v[8:9], v[168:169], v[244:245]
    v_pk_mul_f32 v[10:11], v[170:171], v[244:245]
    v_pk_mul_f32 v[12:13], v[172:173], v[244:245]
    v_pk_mul_f32 v[14:15], v[174:175], v[244:245]
    v_pk_mul_f32 v[168:169], v[168:169], v[228:229]
    v_pk_mul_f32 v[170:171], v[170:171], v[228:229]
    v_pk_mul_f32 v[172:173], v[172:173], v[228:229]
    v_pk_mul_f32 v[174:175], v[174:175], v[228:229]
    v_pk_fma_f32 v[168:169], v[152:153], v[244:245], v[168:169]
    v_pk_fma_f32 v[170:171], v[154:155], v[244:245], v[170:171]
    v_pk_fma_f32 v[172:173], v[156:157], v[244:245], v[172:173]
    v_pk_fma_f32 v[174:175], v[158:159], v[244:245], v[174:175]
    v_pk_fma_f32 v[152:153], v[152:153], v[228:229], v[8:9] neg_lo:[0,0,1] neg_hi:[0,0,1]
    v_pk_fma_f32 v[154:155], v[154:155], v[228:229], v[10:11] neg_lo:[0,0,1] neg_hi:[0,0,1]
    v_pk_fma_f32 v[156:157], v[156:157], v[228:229], v[12:13] neg_lo:[0,0,1] neg_hi:[0,0,1]
    v_pk_fma_f32 v[158:159], v[158:159], v[228:229], v[14:15] neg_lo:[0,0,1] neg_hi:[0,0,1]
    v_mfma_f32_32x32x16_bf16 v[176:191], v[216:219], a[0:3], 0
    v_perm_b32 v208, v22, v18, s30
    v_perm_b32 v209, v30, v26, s30
    v_perm_b32 v210, v38, v34, s30
    v_perm_b32 v211, v46, v42, s30
    v_perm_b32 v212, v54, v50, s30
    v_mfma_f32_32x32x16_bf16 v[192:207], v[216:219], a[8:11], 0
    v_perm_b32 v213, v62, v58, s30
    v_perm_b32 v214, v70, v66, s30
    v_perm_b32 v215, v78, v74, s30
    v_cvt_pk_bf16_f32 v82, v144, v145
    v_cvt_pk_bf16_f32 v86, v160, v161
    v_mfma_f32_32x32x16_bf16 v[176:191], v[220:223], a[4:7], v[176:191]
    v_cvt_pk_bf16_f32 v90, v146, v147
    v_cvt_pk_bf16_f32 v94, v162, v163
    v_cvt_pk_bf16_f32 v98, v148, v149
    v_cvt_pk_bf16_f32 v102, v164, v165
    v_cvt_pk_bf16_f32 v106, v150, v151
    v_mfma_f32_32x32x16_bf16 v[192:207], v[220:223], a[12:15], v[192:207]
    v_cvt_pk_bf16_f32 v110, v166, v167
    v_cvt_pk_bf16_f32 v114, v152, v153
    v_cvt_pk_bf16_f32 v118, v168, v169
    v_cvt_pk_bf16_f32 v122, v154, v155
    v_cvt_pk_bf16_f32 v126, v170, v171
    v_cvt_pk_bf16_f32 v130, v156, v157
    v_cvt_pk_bf16_f32 v134, v172, v173
    v_cvt_pk_bf16_f32 v138, v158, v159
    v_cvt_pk_bf16_f32 v142, v174, v175
    s_nop 2
    v_pk_mul_f32 v[8:9], v[192:193], v[246:247]
    v_pk_mul_f32 v[10:11], v[194:195], v[246:247]
    v_pk_mul_f32 v[12:13], v[196:197], v[246:247]
    v_pk_mul_f32 v[14:15], v[198:199], v[246:247]
    v_pk_mul_f32 v[192:193], v[192:193], v[230:231]
    v_pk_mul_f32 v[194:195], v[194:195], v[230:231]
    v_pk_mul_f32 v[196:197], v[196:197], v[230:231]
    v_pk_mul_f32 v[198:199], v[198:199], v[230:231]
    v_pk_fma_f32 v[192:193], v[176:177], v[246:247], v[192:193]
    v_pk_fma_f32 v[194:195], v[178:179], v[246:247], v[194:195]
    v_pk_fma_f32 v[196:197], v[180:181], v[246:247], v[196:197]
    v_pk_fma_f32 v[198:199], v[182:183], v[246:247], v[198:199]
    v_pk_fma_f32 v[176:177], v[176:177], v[230:231], v[8:9] neg_lo:[0,0,1] neg_hi:[0,0,1]
    v_pk_fma_f32 v[178:179], v[178:179], v[230:231], v[10:11] neg_lo:[0,0,1] neg_hi:[0,0,1]
    v_pk_fma_f32 v[180:181], v[180:181], v[230:231], v[12:13] neg_lo:[0,0,1] neg_hi:[0,0,1]
    v_pk_fma_f32 v[182:183], v[182:183], v[230:231], v[14:15] neg_lo:[0,0,1] neg_hi:[0,0,1]
    v_pk_mul_f32 v[8:9], v[200:201], v[246:247]
    v_pk_mul_f32 v[10:11], v[202:203], v[246:247]
    v_pk_mul_f32 v[12:13], v[204:205], v[246:247]
    v_pk_mul_f32 v[14:15], v[206:207], v[246:247]
    v_pk_mul_f32 v[200:201], v[200:201], v[230:231]
    v_pk_mul_f32 v[202:203], v[202:203], v[230:231]
    v_pk_mul_f32 v[204:205], v[204:205], v[230:231]
    v_pk_mul_f32 v[206:207], v[206:207], v[230:231]
    v_pk_fma_f32 v[200:201], v[184:185], v[246:247], v[200:201]
    v_pk_fma_f32 v[202:203], v[186:187], v[246:247], v[202:203]
    v_pk_fma_f32 v[204:205], v[188:189], v[246:247], v[204:205]
    v_pk_fma_f32 v[206:207], v[190:191], v[246:247], v[206:207]
    v_pk_fma_f32 v[184:185], v[184:185], v[230:231], v[8:9] neg_lo:[0,0,1] neg_hi:[0,0,1]
    v_pk_fma_f32 v[186:187], v[186:187], v[230:231], v[10:11] neg_lo:[0,0,1] neg_hi:[0,0,1]
    v_pk_fma_f32 v[188:189], v[188:189], v[230:231], v[12:13] neg_lo:[0,0,1] neg_hi:[0,0,1]
    v_pk_fma_f32 v[190:191], v[190:191], v[230:231], v[14:15] neg_lo:[0,0,1] neg_hi:[0,0,1]
    v_mfma_f32_32x32x16_bf16 v[144:159], v[208:211], a[0:3], 0
    v_perm_b32 v216, v22, v18, s31
    v_perm_b32 v217, v30, v26, s31
    v_perm_b32 v218, v38, v34, s31
    v_perm_b32 v219, v46, v42, s31
    v_perm_b32 v220, v54, v50, s31
    v_mfma_f32_32x32x16_bf16 v[160:175], v[208:211], a[8:11], 0
    v_perm_b32 v221, v62, v58, s31
    v_perm_b32 v222, v70, v66, s31
    v_perm_b32 v223, v78, v74, s31
    v_cvt_pk_bf16_f32 v83, v176, v177
    v_cvt_pk_bf16_f32 v87, v192, v193
    v_mfma_f32_32x32x16_bf16 v[144:159], v[212:215], a[4:7], v[144:159]
    v_cvt_pk_bf16_f32 v91, v178, v179
    v_cvt_pk_bf16_f32 v95, v194, v195
    v_cvt_pk_bf16_f32 v99, v180, v181
    v_cvt_pk_bf16_f32 v103, v196, v197
    v_cvt_pk_bf16_f32 v107, v182, v183
    v_mfma_f32_32x32x16_bf16 v[160:175], v[212:215], a[12:15], v[160:175]
    v_cvt_pk_bf16_f32 v111, v198, v199
    v_cvt_pk_bf16_f32 v115, v184, v185
    v_cvt_pk_bf16_f32 v119, v200, v201
    v_cvt_pk_bf16_f32 v123, v186, v187
    v_cvt_pk_bf16_f32 v127, v202, v203
    v_cvt_pk_bf16_f32 v131, v188, v189
    v_cvt_pk_bf16_f32 v135, v204, v205
    v_cvt_pk_bf16_f32 v139, v190, v191
    v_cvt_pk_bf16_f32 v143, v206, v207
    s_nop 2
    v_pk_mul_f32 v[8:9], v[160:161], v[248:249]
    v_pk_mul_f32 v[10:11], v[162:163], v[248:249]
    v_pk_mul_f32 v[12:13], v[164:165], v[248:249]
    v_pk_mul_f32 v[14:15], v[166:167], v[248:249]
    v_pk_mul_f32 v[160:161], v[160:161], v[232:233]
    v_pk_mul_f32 v[162:163], v[162:163], v[232:233]
    v_pk_mul_f32 v[164:165], v[164:165], v[232:233]
    v_pk_mul_f32 v[166:167], v[166:167], v[232:233]
    v_pk_fma_f32 v[160:161], v[144:145], v[248:249], v[160:161]
    v_pk_fma_f32 v[162:163], v[146:147], v[248:249], v[162:163]
    v_pk_fma_f32 v[164:165], v[148:149], v[248:249], v[164:165]
    v_pk_fma_f32 v[166:167], v[150:151], v[248:249], v[166:167]
    v_pk_fma_f32 v[144:145], v[144:145], v[232:233], v[8:9] neg_lo:[0,0,1] neg_hi:[0,0,1]
    v_pk_fma_f32 v[146:147], v[146:147], v[232:233], v[10:11] neg_lo:[0,0,1] neg_hi:[0,0,1]
    v_pk_fma_f32 v[148:149], v[148:149], v[232:233], v[12:13] neg_lo:[0,0,1] neg_hi:[0,0,1]
    v_pk_fma_f32 v[150:151], v[150:151], v[232:233], v[14:15] neg_lo:[0,0,1] neg_hi:[0,0,1]
    v_pk_mul_f32 v[8:9], v[168:169], v[248:249]
    v_pk_mul_f32 v[10:11], v[170:171], v[248:249]
    v_pk_mul_f32 v[12:13], v[172:173], v[248:249]
    v_pk_mul_f32 v[14:15], v[174:175], v[248:249]
    v_pk_mul_f32 v[168:169], v[168:169], v[232:233]
    v_pk_mul_f32 v[170:171], v[170:171], v[232:233]
    v_pk_mul_f32 v[172:173], v[172:173], v[232:233]
    v_pk_mul_f32 v[174:175], v[174:175], v[232:233]
    v_pk_fma_f32 v[168:169], v[152:153], v[248:249], v[168:169]
    v_pk_fma_f32 v[170:171], v[154:155], v[248:249], v[170:171]
    v_pk_fma_f32 v[172:173], v[156:157], v[248:249], v[172:173]
    v_pk_fma_f32 v[174:175], v[158:159], v[248:249], v[174:175]
    v_pk_fma_f32 v[152:153], v[152:153], v[232:233], v[8:9] neg_lo:[0,0,1] neg_hi:[0,0,1]
    v_pk_fma_f32 v[154:155], v[154:155], v[232:233], v[10:11] neg_lo:[0,0,1] neg_hi:[0,0,1]
    v_pk_fma_f32 v[156:157], v[156:157], v[232:233], v[12:13] neg_lo:[0,0,1] neg_hi:[0,0,1]
    v_pk_fma_f32 v[158:159], v[158:159], v[232:233], v[14:15] neg_lo:[0,0,1] neg_hi:[0,0,1]
    v_mfma_f32_32x32x16_bf16 v[176:191], v[216:219], a[0:3], 0
    v_perm_b32 v208, v23, v19, s30
    v_perm_b32 v209, v31, v27, s30
    v_perm_b32 v210, v39, v35, s30
    v_perm_b32 v211, v47, v43, s30
    v_perm_b32 v212, v55, v51, s30
    v_mfma_f32_32x32x16_bf16 v[192:207], v[216:219], a[8:11], 0
    v_perm_b32 v213, v63, v59, s30
    v_perm_b32 v214, v71, v67, s30
    v_perm_b32 v215, v79, v75, s30
    v_cvt_pk_bf16_f32 v16, v144, v145
    v_cvt_pk_bf16_f32 v20, v160, v161
    v_mfma_f32_32x32x16_bf16 v[176:191], v[220:223], a[4:7], v[176:191]
    v_cvt_pk_bf16_f32 v24, v146, v147
    v_cvt_pk_bf16_f32 v28, v162, v163
    v_cvt_pk_bf16_f32 v32, v148, v149
    v_cvt_pk_bf16_f32 v36, v164, v165
    v_cvt_pk_bf16_f32 v40, v150, v151
    v_mfma_f32_32x32x16_bf16 v[192:207], v[220:223], a[12:15], v[192:207]
    v_cvt_pk_bf16_f32 v44, v166, v167
    v_cvt_pk_bf16_f32 v48, v152, v153
    v_cvt_pk_bf16_f32 v52, v168, v169
    v_cvt_pk_bf16_f32 v56, v154, v155
    v_cvt_pk_bf16_f32 v60, v170, v171
    v_cvt_pk_bf16_f32 v64, v156, v157
    v_cvt_pk_bf16_f32 v68, v172, v173
    v_cvt_pk_bf16_f32 v72, v158, v159
    v_cvt_pk_bf16_f32 v76, v174, v175
    s_nop 2
    v_pk_mul_f32 v[8:9], v[192:193], v[250:251]
    v_pk_mul_f32 v[10:11], v[194:195], v[250:251]
    v_pk_mul_f32 v[12:13], v[196:197], v[250:251]
    v_pk_mul_f32 v[14:15], v[198:199], v[250:251]
    v_pk_mul_f32 v[192:193], v[192:193], v[234:235]
    v_pk_mul_f32 v[194:195], v[194:195], v[234:235]
    v_pk_mul_f32 v[196:197], v[196:197], v[234:235]
    v_pk_mul_f32 v[198:199], v[198:199], v[234:235]
    v_pk_fma_f32 v[192:193], v[176:177], v[250:251], v[192:193]
    v_pk_fma_f32 v[194:195], v[178:179], v[250:251], v[194:195]
    v_pk_fma_f32 v[196:197], v[180:181], v[250:251], v[196:197]
    v_pk_fma_f32 v[198:199], v[182:183], v[250:251], v[198:199]
    v_pk_fma_f32 v[176:177], v[176:177], v[234:235], v[8:9] neg_lo:[0,0,1] neg_hi:[0,0,1]
    v_pk_fma_f32 v[178:179], v[178:179], v[234:235], v[10:11] neg_lo:[0,0,1] neg_hi:[0,0,1]
    v_pk_fma_f32 v[180:181], v[180:181], v[234:235], v[12:13] neg_lo:[0,0,1] neg_hi:[0,0,1]
    v_pk_fma_f32 v[182:183], v[182:183], v[234:235], v[14:15] neg_lo:[0,0,1] neg_hi:[0,0,1]
    v_pk_mul_f32 v[8:9], v[200:201], v[250:251]
    v_pk_mul_f32 v[10:11], v[202:203], v[250:251]
    v_pk_mul_f32 v[12:13], v[204:205], v[250:251]
    v_pk_mul_f32 v[14:15], v[206:207], v[250:251]
    v_pk_mul_f32 v[200:201], v[200:201], v[234:235]
    v_pk_mul_f32 v[202:203], v[202:203], v[234:235]
    v_pk_mul_f32 v[204:205], v[204:205], v[234:235]
    v_pk_mul_f32 v[206:207], v[206:207], v[234:235]
    v_pk_fma_f32 v[200:201], v[184:185], v[250:251], v[200:201]
    v_pk_fma_f32 v[202:203], v[186:187], v[250:251], v[202:203]
    v_pk_fma_f32 v[204:205], v[188:189], v[250:251], v[204:205]
    v_pk_fma_f32 v[206:207], v[190:191], v[250:251], v[206:207]
    v_pk_fma_f32 v[184:185], v[184:185], v[234:235], v[8:9] neg_lo:[0,0,1] neg_hi:[0,0,1]
    v_pk_fma_f32 v[186:187], v[186:187], v[234:235], v[10:11] neg_lo:[0,0,1] neg_hi:[0,0,1]
    v_pk_fma_f32 v[188:189], v[188:189], v[234:235], v[12:13] neg_lo:[0,0,1] neg_hi:[0,0,1]
    v_pk_fma_f32 v[190:191], v[190:191], v[234:235], v[14:15] neg_lo:[0,0,1] neg_hi:[0,0,1]
    v_mfma_f32_32x32x16_bf16 v[144:159], v[208:211], a[0:3], 0
    v_perm_b32 v216, v23, v19, s31
    v_perm_b32 v217, v31, v27, s31
    v_perm_b32 v218, v39, v35, s31
    v_perm_b32 v219, v47, v43, s31
    v_perm_b32 v220, v55, v51, s31
    v_mfma_f32_32x32x16_bf16 v[160:175], v[208:211], a[8:11], 0
    v_perm_b32 v221, v63, v59, s31
    v_perm_b32 v222, v71, v67, s31
    v_perm_b32 v223, v79, v75, s31
    v_cvt_pk_bf16_f32 v17, v176, v177
    v_cvt_pk_bf16_f32 v21, v192, v193
    v_mfma_f32_32x32x16_bf16 v[144:159], v[212:215], a[4:7], v[144:159]
    v_cvt_pk_bf16_f32 v25, v178, v179
    v_cvt_pk_bf16_f32 v29, v194, v195
    v_cvt_pk_bf16_f32 v33, v180, v181
    v_cvt_pk_bf16_f32 v37, v196, v197
    v_cvt_pk_bf16_f32 v41, v182, v183
    v_mfma_f32_32x32x16_bf16 v[160:175], v[212:215], a[12:15], v[160:175]
    v_cvt_pk_bf16_f32 v45, v198, v199
    v_cvt_pk_bf16_f32 v49, v184, v185
    v_cvt_pk_bf16_f32 v53, v200, v201
    v_cvt_pk_bf16_f32 v57, v186, v187
    v_cvt_pk_bf16_f32 v61, v202, v203
    v_cvt_pk_bf16_f32 v65, v188, v189
    v_cvt_pk_bf16_f32 v69, v204, v205
    v_cvt_pk_bf16_f32 v73, v190, v191
    v_cvt_pk_bf16_f32 v77, v206, v207
    s_nop 2
    v_pk_mul_f32 v[8:9], v[160:161], v[252:253]
    v_pk_mul_f32 v[10:11], v[162:163], v[252:253]
    v_pk_mul_f32 v[12:13], v[164:165], v[252:253]
    v_pk_mul_f32 v[14:15], v[166:167], v[252:253]
    v_pk_mul_f32 v[160:161], v[160:161], v[236:237]
    v_pk_mul_f32 v[162:163], v[162:163], v[236:237]
    v_pk_mul_f32 v[164:165], v[164:165], v[236:237]
    v_pk_mul_f32 v[166:167], v[166:167], v[236:237]
    v_pk_fma_f32 v[160:161], v[144:145], v[252:253], v[160:161]
    v_pk_fma_f32 v[162:163], v[146:147], v[252:253], v[162:163]
    v_pk_fma_f32 v[164:165], v[148:149], v[252:253], v[164:165]
    v_pk_fma_f32 v[166:167], v[150:151], v[252:253], v[166:167]
    v_pk_fma_f32 v[144:145], v[144:145], v[236:237], v[8:9] neg_lo:[0,0,1] neg_hi:[0,0,1]
    v_pk_fma_f32 v[146:147], v[146:147], v[236:237], v[10:11] neg_lo:[0,0,1] neg_hi:[0,0,1]
    v_pk_fma_f32 v[148:149], v[148:149], v[236:237], v[12:13] neg_lo:[0,0,1] neg_hi:[0,0,1]
    v_pk_fma_f32 v[150:151], v[150:151], v[236:237], v[14:15] neg_lo:[0,0,1] neg_hi:[0,0,1]
    v_pk_mul_f32 v[8:9], v[168:169], v[252:253]
    v_pk_mul_f32 v[10:11], v[170:171], v[252:253]
    v_pk_mul_f32 v[12:13], v[172:173], v[252:253]
    v_pk_mul_f32 v[14:15], v[174:175], v[252:253]
    v_pk_mul_f32 v[168:169], v[168:169], v[236:237]
    v_pk_mul_f32 v[170:171], v[170:171], v[236:237]
    v_pk_mul_f32 v[172:173], v[172:173], v[236:237]
    v_pk_mul_f32 v[174:175], v[174:175], v[236:237]
    v_pk_fma_f32 v[168:169], v[152:153], v[252:253], v[168:169]
    v_pk_fma_f32 v[170:171], v[154:155], v[252:253], v[170:171]
    v_pk_fma_f32 v[172:173], v[156:157], v[252:253], v[172:173]
    v_pk_fma_f32 v[174:175], v[158:159], v[252:253], v[174:175]
    v_pk_fma_f32 v[152:153], v[152:153], v[236:237], v[8:9] neg_lo:[0,0,1] neg_hi:[0,0,1]
    v_pk_fma_f32 v[154:155], v[154:155], v[236:237], v[10:11] neg_lo:[0,0,1] neg_hi:[0,0,1]
    v_pk_fma_f32 v[156:157], v[156:157], v[236:237], v[12:13] neg_lo:[0,0,1] neg_hi:[0,0,1]
    v_pk_fma_f32 v[158:159], v[158:159], v[236:237], v[14:15] neg_lo:[0,0,1] neg_hi:[0,0,1]
    v_mfma_f32_32x32x16_bf16 v[176:191], v[216:219], a[0:3], 0
    v_cvt_pk_bf16_f32 v18, v144, v145
    v_cvt_pk_bf16_f32 v22, v160, v161
    v_cvt_pk_bf16_f32 v26, v146, v147
    v_cvt_pk_bf16_f32 v30, v162, v163
    v_cvt_pk_bf16_f32 v34, v148, v149
    v_mfma_f32_32x32x16_bf16 v[192:207], v[216:219], a[8:11], 0
    v_cvt_pk_bf16_f32 v38, v164, v165
    v_cvt_pk_bf16_f32 v42, v150, v151
    v_cvt_pk_bf16_f32 v46, v166, v167
    v_cvt_pk_bf16_f32 v50, v152, v153
    v_cvt_pk_bf16_f32 v54, v168, v169
    v_mfma_f32_32x32x16_bf16 v[176:191], v[220:223], a[4:7], v[176:191]
    v_cvt_pk_bf16_f32 v58, v154, v155
    v_cvt_pk_bf16_f32 v62, v170, v171
    v_cvt_pk_bf16_f32 v66, v156, v157
    v_cvt_pk_bf16_f32 v70, v172, v173
    v_cvt_pk_bf16_f32 v74, v158, v159
    v_mfma_f32_32x32x16_bf16 v[192:207], v[220:223], a[12:15], v[192:207]
    v_cvt_pk_bf16_f32 v78, v174, v175
    s_nop 10
    v_pk_mul_f32 v[8:9], v[192:193], v[254:255]
    v_pk_mul_f32 v[10:11], v[194:195], v[254:255]
    v_pk_mul_f32 v[12:13], v[196:197], v[254:255]
    v_pk_mul_f32 v[14:15], v[198:199], v[254:255]
    v_pk_mul_f32 v[192:193], v[192:193], v[238:239]
    v_pk_mul_f32 v[194:195], v[194:195], v[238:239]
    v_pk_mul_f32 v[196:197], v[196:197], v[238:239]
    v_pk_mul_f32 v[198:199], v[198:199], v[238:239]
    v_pk_fma_f32 v[192:193], v[176:177], v[254:255], v[192:193]
    v_pk_fma_f32 v[194:195], v[178:179], v[254:255], v[194:195]
    v_pk_fma_f32 v[196:197], v[180:181], v[254:255], v[196:197]
    v_pk_fma_f32 v[198:199], v[182:183], v[254:255], v[198:199]
    v_pk_fma_f32 v[176:177], v[176:177], v[238:239], v[8:9] neg_lo:[0,0,1] neg_hi:[0,0,1]
    v_pk_fma_f32 v[178:179], v[178:179], v[238:239], v[10:11] neg_lo:[0,0,1] neg_hi:[0,0,1]
    v_pk_fma_f32 v[180:181], v[180:181], v[238:239], v[12:13] neg_lo:[0,0,1] neg_hi:[0,0,1]
    v_pk_fma_f32 v[182:183], v[182:183], v[238:239], v[14:15] neg_lo:[0,0,1] neg_hi:[0,0,1]
    v_pk_mul_f32 v[8:9], v[200:201], v[254:255]
    v_pk_mul_f32 v[10:11], v[202:203], v[254:255]
    v_pk_mul_f32 v[12:13], v[204:205], v[254:255]
    v_pk_mul_f32 v[14:15], v[206:207], v[254:255]
    v_pk_mul_f32 v[200:201], v[200:201], v[238:239]
    v_pk_mul_f32 v[202:203], v[202:203], v[238:239]
    v_pk_mul_f32 v[204:205], v[204:205], v[238:239]
    v_pk_mul_f32 v[206:207], v[206:207], v[238:239]
    v_pk_fma_f32 v[200:201], v[184:185], v[254:255], v[200:201]
    v_pk_fma_f32 v[202:203], v[186:187], v[254:255], v[202:203]
    v_pk_fma_f32 v[204:205], v[188:189], v[254:255], v[204:205]
    v_pk_fma_f32 v[206:207], v[190:191], v[254:255], v[206:207]
    v_pk_fma_f32 v[184:185], v[184:185], v[238:239], v[8:9] neg_lo:[0,0,1] neg_hi:[0,0,1]
    v_pk_fma_f32 v[186:187], v[186:187], v[238:239], v[10:11] neg_lo:[0,0,1] neg_hi:[0,0,1]
    v_pk_fma_f32 v[188:189], v[188:189], v[238:239], v[12:13] neg_lo:[0,0,1] neg_hi:[0,0,1]
    v_pk_fma_f32 v[190:191], v[190:191], v[238:239], v[14:15] neg_lo:[0,0,1] neg_hi:[0,0,1]
    v_cvt_pk_bf16_f32 v19, v176, v177
    v_cvt_pk_bf16_f32 v23, v192, v193
    v_cvt_pk_bf16_f32 v27, v178, v179
    v_cvt_pk_bf16_f32 v31, v194, v195
    v_cvt_pk_bf16_f32 v35, v180, v181
    v_cvt_pk_bf16_f32 v39, v196, v197
    v_cvt_pk_bf16_f32 v43, v182, v183
    v_cvt_pk_bf16_f32 v47, v198, v199
    v_cvt_pk_bf16_f32 v51, v184, v185
    v_cvt_pk_bf16_f32 v55, v200, v201
    v_cvt_pk_bf16_f32 v59, v186, v187
    v_cvt_pk_bf16_f32 v63, v202, v203
    v_cvt_pk_bf16_f32 v67, v188, v189
    v_cvt_pk_bf16_f32 v71, v204, v205
    v_cvt_pk_bf16_f32 v75, v190, v191
    v_cvt_pk_bf16_f32 v79, v206, v207
    v_cmp_gt_u32 vcc, 2, v5
    v_mov_b32 v6, 1.0
    v_mov_b32 v7, 0
    v_cndmask_b32 v6, v6, v7, vcc
    v_cmp_eq_u32 vcc, 1, v5
    v_mov_b32 v8, 0x3f3504f3
    s_nop 0
    v_cndmask_b32 v7, v7, v8, vcc
    v_cmp_eq_u32 vcc, 0, v5
    v_mov_b32 v8, 0.5
    s_nop 0
    v_cndmask_b32 v7, v7, v8, vcc
    s_nop 1
    v_mfma_f32_32x32x16_bf16 v[144:159], v[80:83], a[16:19], 0
    v_mov_b32 v240, v80
    v_mov_b32 v241, v81
    v_mov_b32 v242, v82
    v_mov_b32 v243, v83
    v_mov_b32 v244, v16
    v_mov_b32 v245, v17
    v_mfma_f32_32x32x16_bf16 v[144:159], v[16:19], a[20:23], v[144:159]
    v_mov_b32 v246, v18
    v_mov_b32 v247, v19
    v_mov_b32_dpp v240, v88 row_shr:1 row_mask:0x5 bank_mask:0xf
    v_mov_b32_dpp v241, v89 row_shr:1 row_mask:0x5 bank_mask:0xf
    v_mov_b32_dpp v242, v90 row_shr:1 row_mask:0x5 bank_mask:0xf
    v_mov_b32_dpp v243, v91 row_shr:1 row_mask:0x5 bank_mask:0xf
    v_mfma_f32_32x32x16_bf16 v[144:159], v[84:87], a[24:27], v[144:159]
    v_mov_b32_dpp v244, v24 row_shr:1 row_mask:0x5 bank_mask:0xf
    v_mov_b32_dpp v245, v25 row_shr:1 row_mask:0x5 bank_mask:0xf
    v_mov_b32_dpp v246, v26 row_shr:1 row_mask:0x5 bank_mask:0xf
    v_mov_b32_dpp v247, v27 row_shr:1 row_mask:0x5 bank_mask:0xf
    v_mov_b32_dpp v240, v96 row_shr:2 row_mask:0x5 bank_mask:0xf
    v_mov_b32_dpp v241, v97 row_shr:2 row_mask:0x5 bank_mask:0xf
    v_mfma_f32_32x32x16_bf16 v[144:159], v[20:23], a[28:31], v[144:159]
    v_mov_b32_dpp v242, v98 row_shr:2 row_mask:0x5 bank_mask:0xf
    v_mov_b32_dpp v243, v99 row_shr:2 row_mask:0x5 bank_mask:0xf
    v_mov_b32_dpp v244, v32 row_shr:2 row_mask:0x5 bank_mask:0xf
    v_mov_b32_dpp v245, v33 row_shr:2 row_mask:0x5 bank_mask:0xf
    v_mov_b32_dpp v246, v34 row_shr:2 row_mask:0x5 bank_mask:0xf
    v_mov_b32_dpp v247, v35 row_shr:2 row_mask:0x5 bank_mask:0xf
    v_mfma_f32_32x32x16_bf16 v[160:175], v[88:91], a[16:19], 0
    v_mov_b32_dpp v240, v104 row_shr:3 row_mask:0x5 bank_mask:0xf
    v_mov_b32_dpp v241, v105 row_shr:3 row_mask:0x5 bank_mask:0xf
    v_mov_b32_dpp v242, v106 row_shr:3 row_mask:0x5 bank_mask:0xf
    v_mov_b32_dpp v243, v107 row_shr:3 row_mask:0x5 bank_mask:0xf
    v_mov_b32_dpp v244, v40 row_shr:3 row_mask:0x5 bank_mask:0xf
    v_mov_b32_dpp v245, v41 row_shr:3 row_mask:0x5 bank_mask:0xf
    v_mfma_f32_32x32x16_bf16 v[160:175], v[24:27], a[20:23], v[160:175]
    v_mov_b32_dpp v246, v42 row_shr:3 row_mask:0x5 bank_mask:0xf
    v_mov_b32_dpp v247, v43 row_shr:3 row_mask:0x5 bank_mask:0xf
    v_mov_b32_dpp v240, v112 row_shr:8 row_mask:0x5 bank_mask:0xf
    v_mov_b32_dpp v241, v113 row_shr:8 row_mask:0x5 bank_mask:0xf
    v_mov_b32_dpp v242, v114 row_shr:8 row_mask:0x5 bank_mask:0xf
    v_mov_b32_dpp v243, v115 row_shr:8 row_mask:0x5 bank_mask:0xf
    v_mfma_f32_32x32x16_bf16 v[160:175], v[92:95], a[24:27], v[160:175]
    v_mov_b32_dpp v244, v48 row_shr:8 row_mask:0x5 bank_mask:0xf
    v_mov_b32_dpp v245, v49 row_shr:8 row_mask:0x5 bank_mask:0xf
    v_mov_b32_dpp v246, v50 row_shr:8 row_mask:0x5 bank_mask:0xf
    v_mov_b32_dpp v247, v51 row_shr:8 row_mask:0x5 bank_mask:0xf
    v_mov_b32_dpp v240, v120 row_shr:9 row_mask:0x5 bank_mask:0xf
    v_mov_b32_dpp v241, v121 row_shr:9 row_mask:0x5 bank_mask:0xf
    v_mfma_f32_32x32x16_bf16 v[160:175], v[28:31], a[28:31], v[160:175]
    v_mov_b32_dpp v242, v122 row_shr:9 row_mask:0x5 bank_mask:0xf
    v_mov_b32_dpp v243, v123 row_shr:9 row_mask:0x5 bank_mask:0xf
    v_mov_b32_dpp v244, v56 row_shr:9 row_mask:0x5 bank_mask:0xf
    v_mov_b32_dpp v245, v57 row_shr:9 row_mask:0x5 bank_mask:0xf
    v_mov_b32_dpp v246, v58 row_shr:9 row_mask:0x5 bank_mask:0xf
    v_mov_b32_dpp v247, v59 row_shr:9 row_mask:0x5 bank_mask:0xf
    v_mfma_f32_32x32x16_bf16 v[176:191], v[96:99], a[16:19], 0
    v_mov_b32_dpp v240, v128 row_shr:10 row_mask:0x5 bank_mask:0xf
    v_mov_b32_dpp v241, v129 row_shr:10 row_mask:0x5 bank_mask:0xf
    v_mov_b32_dpp v242, v130 row_shr:10 row_mask:0x5 bank_mask:0xf
    v_mov_b32_dpp v243, v131 row_shr:10 row_mask:0x5 bank_mask:0xf
    v_mov_b32_dpp v244, v64 row_shr:10 row_mask:0x5 bank_mask:0xf
    v_mov_b32_dpp v245, v65 row_shr:10 row_mask:0x5 bank_mask:0xf
    v_mfma_f32_32x32x16_bf16 v[176:191], v[32:35], a[20:23], v[176:191]
    v_mov_b32_dpp v246, v66 row_shr:10 row_mask:0x5 bank_mask:0xf
    v_mov_b32_dpp v247, v67 row_shr:10 row_mask:0x5 bank_mask:0xf
    v_mov_b32_dpp v240, v136 row_shr:11 row_mask:0x5 bank_mask:0xf
    v_mov_b32_dpp v241, v137 row_shr:11 row_mask:0x5 bank_mask:0xf
    v_mov_b32_dpp v242, v138 row_shr:11 row_mask:0x5 bank_mask:0xf
    v_mov_b32_dpp v243, v139 row_shr:11 row_mask:0x5 bank_mask:0xf
    v_mfma_f32_32x32x16_bf16 v[176:191], v[100:103], a[24:27], v[176:191]
    v_mov_b32_dpp v244, v72 row_shr:11 row_mask:0x5 bank_mask:0xf
    v_mov_b32_dpp v245, v73 row_shr:11 row_mask:0x5 bank_mask:0xf
    v_mov_b32_dpp v246, v74 row_shr:11 row_mask:0x5 bank_mask:0xf
    v_mov_b32_dpp v247, v75 row_shr:11 row_mask:0x5 bank_mask:0xf
    v_mfma_f32_32x32x16_bf16 v[176:191], v[36:39], a[28:31], v[176:191]
    s_nop 1
    v_mfma_f32_32x32x16_bf16 a[48:63], v[240:243], a[32:35], 0
    v_mfma_f32_32x32x16_bf16 a[48:63], v[244:247], a[32:35], a[48:63]
    v_mfma_f32_32x32x16_bf16 v[192:207], v[104:107], a[16:19], 0
    v_mfma_f32_32x32x16_bf16 v[192:207], v[40:43], a[20:23], v[192:207]
    v_mfma_f32_32x32x16_bf16 v[192:207], v[108:111], a[24:27], v[192:207]
    v_mfma_f32_32x32x16_bf16 v[192:207], v[44:47], a[28:31], v[192:207]
    v_mfma_f32_32x32x16_bf16 v[208:223], v[112:115], a[16:19], 0
    v_mfma_f32_32x32x16_bf16 v[208:223], v[48:51], a[20:23], v[208:223]
    v_mfma_f32_32x32x16_bf16 v[208:223], v[116:119], a[24:27], v[208:223]
    v_mfma_f32_32x32x16_bf16 v[208:223], v[52:55], a[28:31], v[208:223]
    v_mfma_f32_32x32x16_bf16 v[224:239], v[120:123], a[16:19], 0
    v_mfma_f32_32x32x16_bf16 v[224:239], v[56:59], a[20:23], v[224:239]
    v_mfma_f32_32x32x16_bf16 v[224:239], v[124:127], a[24:27], v[224:239]
    v_mfma_f32_32x32x16_bf16 v[224:239], v[60:63], a[28:31], v[224:239]
    v_mfma_f32_32x32x16_bf16 v[240:255], v[128:131], a[16:19], 0
    v_accvgpr_read_b32 v2, a48
    v_mul_f32 v144, v144, v6
    v_fmac_f32 v144, v2, v7
    v_accvgpr_read_b32 v3, a49
    v_mul_f32 v160, v160, v6
    v_fmac_f32 v160, v3, v7
    v_mfma_f32_32x32x16_bf16 v[240:255], v[64:67], a[20:23], v[240:255]
    v_accvgpr_read_b32 v2, a50
    v_mul_f32 v176, v176, v6
    v_fmac_f32 v176, v2, v7
    v_accvgpr_read_b32 v3, a51
    v_mul_f32 v192, v192, v6
    v_fmac_f32 v192, v3, v7
    v_mfma_f32_32x32x16_bf16 v[240:255], v[132:135], a[24:27], v[240:255]
    v_accvgpr_read_b32 v2, a52
    v_mul_f32 v208, v208, v6
    v_fmac_f32 v208, v2, v7
    v_accvgpr_read_b32 v3, a53
    v_mul_f32 v224, v224, v6
    v_fmac_f32 v224, v3, v7
    v_mfma_f32_32x32x16_bf16 v[240:255], v[68:71], a[28:31], v[240:255]
    v_mfma_f32_32x32x16_bf16 v[80:95], v[136:139], a[16:19], 0
    v_mfma_f32_32x32x16_bf16 v[80:95], v[72:75], a[20:23], v[80:95]
    v_mfma_f32_32x32x16_bf16 v[80:95], v[140:143], a[24:27], v[80:95]
    v_mfma_f32_32x32x16_bf16 v[80:95], v[76:79], a[28:31], v[80:95]
    s_nop 0
    s_nop 0
    s_nop 0
    s_nop 0
    s_nop 0
    s_nop 0
    s_nop 0
    s_nop 0
    s_nop 0
    v_accvgpr_read_b32 v2, a54
    v_mul_f32 v240, v240, v6
    v_fmac_f32 v240, v2, v7
    s_nop 0
    v_accvgpr_read_b32 v3, a55
    v_mul_f32 v80, v80, v6
    v_fmac_f32 v80, v3, v7
    v_accvgpr_read_b32 v1, a42
    v_accvgpr_read_b32 v2, a43
    v_accvgpr_read_b32 v3, a44
    v_accvgpr_read_b32 v4, a45
    v_cvt_pk_bf16_f32 v16, v144, v160
    v_cvt_pk_bf16_f32 v17, v176, v192
    v_cvt_pk_bf16_f32 v18, v208, v224
    v_cvt_pk_bf16_f32 v19, v240, v80
    buffer_store_dwordx4 v[16:19], v1, s[12:15], s27 offen offset:0 sc1
    v_cvt_pk_bf16_f32 v20, v145, v161
    v_cvt_pk_bf16_f32 v21, v177, v193
    v_cvt_pk_bf16_f32 v22, v209, v225
    v_cvt_pk_bf16_f32 v23, v241, v81
    buffer_store_dwordx4 v[20:23], v1, s[12:15], s27 offen offset:128 sc1
    v_cvt_pk_bf16_f32 v24, v146, v162
    v_cvt_pk_bf16_f32 v25, v178, v194
    v_cvt_pk_bf16_f32 v26, v210, v226
    v_cvt_pk_bf16_f32 v27, v242, v82
    buffer_store_dwordx4 v[24:27], v1, s[12:15], s27 offen offset:256 sc1
    v_cvt_pk_bf16_f32 v28, v147, v163
    v_cvt_pk_bf16_f32 v29, v179, v195
    v_cvt_pk_bf16_f32 v30, v211, v227
    v_cvt_pk_bf16_f32 v31, v243, v83
    buffer_store_dwordx4 v[28:31], v1, s[12:15], s27 offen offset:384 sc1
    v_cvt_pk_bf16_f32 v32, v148, v164
    v_cvt_pk_bf16_f32 v33, v180, v196
    v_cvt_pk_bf16_f32 v34, v212, v228
    v_cvt_pk_bf16_f32 v35, v244, v84
    buffer_store_dwordx4 v[32:35], v2, s[12:15], s27 offen offset:0 sc1
    v_cvt_pk_bf16_f32 v36, v149, v165
    v_cvt_pk_bf16_f32 v37, v181, v197
    v_cvt_pk_bf16_f32 v38, v213, v229
    v_cvt_pk_bf16_f32 v39, v245, v85
    buffer_store_dwordx4 v[36:39], v2, s[12:15], s27 offen offset:128 sc1
    v_cvt_pk_bf16_f32 v40, v150, v166
    v_cvt_pk_bf16_f32 v41, v182, v198
    v_cvt_pk_bf16_f32 v42, v214, v230
    v_cvt_pk_bf16_f32 v43, v246, v86
    buffer_store_dwordx4 v[40:43], v2, s[12:15], s27 offen offset:256 sc1
    v_cvt_pk_bf16_f32 v44, v151, v167
    v_cvt_pk_bf16_f32 v45, v183, v199
    v_cvt_pk_bf16_f32 v46, v215, v231
    v_cvt_pk_bf16_f32 v47, v247, v87
    buffer_store_dwordx4 v[44:47], v2, s[12:15], s27 offen offset:384 sc1
    v_cvt_pk_bf16_f32 v48, v152, v168
    v_cvt_pk_bf16_f32 v49, v184, v200
    v_cvt_pk_bf16_f32 v50, v216, v232
    v_cvt_pk_bf16_f32 v51, v248, v88
    buffer_store_dwordx4 v[48:51], v3, s[12:15], s27 offen offset:0 sc1
    v_cvt_pk_bf16_f32 v52, v153, v169
    v_cvt_pk_bf16_f32 v53, v185, v201
    v_cvt_pk_bf16_f32 v54, v217, v233
    v_cvt_pk_bf16_f32 v55, v249, v89
    buffer_store_dwordx4 v[52:55], v3, s[12:15], s27 offen offset:128 sc1
    v_cvt_pk_bf16_f32 v56, v154, v170
    v_cvt_pk_bf16_f32 v57, v186, v202
    v_cvt_pk_bf16_f32 v58, v218, v234
    v_cvt_pk_bf16_f32 v59, v250, v90
    buffer_store_dwordx4 v[56:59], v3, s[12:15], s27 offen offset:256 sc1
    v_cvt_pk_bf16_f32 v60, v155, v171
    v_cvt_pk_bf16_f32 v61, v187, v203
    v_cvt_pk_bf16_f32 v62, v219, v235
    v_cvt_pk_bf16_f32 v63, v251, v91
    buffer_store_dwordx4 v[60:63], v3, s[12:15], s27 offen offset:384 sc1
    v_cvt_pk_bf16_f32 v64, v156, v172
    v_cvt_pk_bf16_f32 v65, v188, v204
    v_cvt_pk_bf16_f32 v66, v220, v236
    v_cvt_pk_bf16_f32 v67, v252, v92
    buffer_store_dwordx4 v[64:67], v4, s[12:15], s27 offen offset:0 sc1
    v_cvt_pk_bf16_f32 v68, v157, v173
    v_cvt_pk_bf16_f32 v69, v189, v205
    v_cvt_pk_bf16_f32 v70, v221, v237
    v_cvt_pk_bf16_f32 v71, v253, v93
    buffer_store_dwordx4 v[68:71], v4, s[12:15], s27 offen offset:128 sc1
    v_cvt_pk_bf16_f32 v72, v158, v174
    v_cvt_pk_bf16_f32 v73, v190, v206
    v_cvt_pk_bf16_f32 v74, v222, v238
    v_cvt_pk_bf16_f32 v75, v254, v94
    buffer_store_dwordx4 v[72:75], v4, s[12:15], s27 offen offset:256 sc1
    v_cvt_pk_bf16_f32 v76, v159, v175
    v_cvt_pk_bf16_f32 v77, v191, v207
    v_cvt_pk_bf16_f32 v78, v223, v239
    v_cvt_pk_bf16_f32 v79, v255, v95
    buffer_store_dwordx4 v[76:79], v4, s[12:15], s27 offen offset:384 sc1
    s_mov_b32 s26, s68
    s_lshl2_add_u32 s26, s26, s24
    s_lshl_b32 s26, s26, 6
    v_add_u32 v2, s26, v5
    v_mul_u32_u24 v3, 9363, v2
    v_lshrrev_b32 v3, 16, v3
    v_lshlrev_b32 v2, 7, v2
    v_mul_u32_u24 v3, 6272, v3
    v_add_u32 v2, v2, v3
    s_and_b32 s26, s2, 7
    s_mul_i32 s26, s26, 896
    buffer_load_dword a41, v2, s[64:67], s26 offen
    s_branch K1_DONE
K1_N3:
    s_getpc_b64 s[60:61]
PF_k1_kernel_2:
    v_lshlrev_b32 v6, 7, v0
    v_min_u32 v6, END_k2_kernel-k2_kernel-4, v6
    v_add_u32 v6, k2_kernel-PF_k1_kernel_2, v6
    v_ashrrev_i32 v7, 31, v6
    v_lshl_add_u64 v[6:7], v[6:7], 0, s[60:61]
    global_load_dword a40, v[6:7], off
    s_waitcnt lgkmcnt(0)
    s_mov_b32 s12, s4
    s_mov_b32 s13, s5
    s_mov_b32 s14, 268435456
    s_mov_b32 s15, 0x00020000
    s_mov_b32 s64, s40
    s_mov_b32 s65, s41
    s_mov_b32 s66, 7340032
    s_mov_b32 s67, 0x00020000
    s_lshr_b32 s26, s2, 3
    s_mul_i32 s26, s26, 3
    s_sub_u32 s26, s26, 68
    s_lshl2_add_u32 s26, s26, s24
    s_lshl_b32 s26, s26, 6
    v_add_u32 v2, s26, v5
    v_mul_u32_u24 v3, 9363, v2
    v_lshrrev_b32 v3, 16, v3
    v_lshlrev_b32 v2, 7, v2
    v_mul_u32_u24 v3, 6272, v3
    v_add_u32 v2, v2, v3
    s_and_b32 s26, s2, 7
    s_mul_i32 s26, s26, 896
    buffer_load_dword a41, v2, s[64:67], s26 offen
    s_waitcnt vmcnt(0)
    s_lshr_b32 s26, s2, 3
    s_mul_i32 s26, s26, 3
    s_sub_u32 s26, s26, 67
    s_lshl2_add_u32 s26, s26, s24
    s_lshl_b32 s26, s26, 6
    v_add_u32 v2, s26, v5
    v_mul_u32_u24 v3, 9363, v2
    v_lshrrev_b32 v3, 16, v3
    v_lshlrev_b32 v2, 7, v2
    v_mul_u32_u24 v3, 6272, v3
    v_add_u32 v2, v2, v3
    s_and_b32 s26, s2, 7
    s_mul_i32 s26, s26, 896
    buffer_load_dword a41, v2, s[64:67], s26 offen
    s_waitcnt vmcnt(0)
    s_lshr_b32 s26, s2, 3
    s_mul_i32 s26, s26, 3
    s_sub_u32 s26, s26, 66
    s_lshl2_add_u32 s26, s26, s24
    s_lshl_b32 s26, s26, 6
    v_add_u32 v2, s26, v5
    v_mul_u32_u24 v3, 9363, v2
    v_lshrrev_b32 v3, 16, v3
    v_lshlrev_b32 v2, 7, v2
    v_mul_u32_u24 v3, 6272, v3
    v_add_u32 v2, v2, v3
    s_and_b32 s26, s2, 7
    s_mul_i32 s26, s26, 896
    buffer_load_dword a41, v2, s[64:67], s26 offen
    s_waitcnt vmcnt(0)
K1_DONE:
END_k1_kernel:
    s_endpgm

.globl k2_kernel
.p2align 8
.type k2_kernel,@function
k2_kernel:
    s_mov_b32 s50, 0
    s_cmp_lt_u32 s2, 128
    s_cbranch_scc1 BODY2_k2_kernel
    s_cmp_ge_u32 s2, 240
    s_cbranch_scc1 NXPF_k2_kernel
    v_lshrrev_b32 v1, 6, v0
    v_and_b32 v5, 63, v0
    v_readfirstlane_b32 s24, v1
    s_load_dwordx2 s[4:5], s[0:1], 64
    s_load_dwordx2 s[6:7], s[0:1], 32
    s_getpc_b64 s[60:61]
PF_k2_kernel_1:
    v_lshlrev_b32 v2, 7, v0
    v_min_u32 v2, BODY_k2_kernel-PF_k2_kernel_1-4, v2
    v_mov_b32 v3, 0
    v_lshl_add_u64 v[2:3], v[2:3], 0, s[60:61]
    global_load_dword v140, v[2:3], off
    s_and_b32 s3, s2, 7
    s_mul_i32 s3, s3, 14
    s_sub_u32 s16, s2, 128
    s_lshr_b32 s16, s16, 3
    s_add_u32 s3, s3, s16
    s_and_b32 s25, s24, 3
    v_lshrrev_b32 v1, 2, v5
    v_mul_u32_u24 v1, 7168, v1
    v_lshrrev_b32 v2, 4, v5
    v_xor_b32 v2, v2, v5
    v_and_b32 v2, 3, v2
    v_lshl_add_u32 v1, v2, 4, v1
    s_mul_i32 s16, s24, 917504
    s_lshl_b32 s17, s3, 6
    s_add_u32 s16, s16, s17
    s_lshl_b32 s17, s24, 13
    v_and_b32 v6, 31, v5
    v_lshrrev_b32 v7, 5, v5
    v_cvt_f32_u32 v6, v6
    v_cvt_f32_u32 v7, v7
    v_mul_f32 v8, 0xbd000000, v6
    v_mul_f32 v9, v8, v7
    v_mul_f32 v11, 0x41000000, v8
    v_fmamk_f32 v240, v8, 0x00000000, v9
    v_fmamk_f32 v241, v8, 0x40000000, v9
    v_fmamk_f32 v242, v8, 0x40800000, v9
    s_waitcnt lgkmcnt(0)
    s_mov_b32 s12, s4
    s_mov_b32 s13, s5
    s_mov_b32 s14, 268435456
    s_mov_b32 s15, 0x00020000
    s_mov_b32 s8, s6
    s_mov_b32 s9, s7
    s_mov_b32 s10, 7340032
    s_mov_b32 s11, 0x00020000
    s_add_u32 m0, s17, 0
    s_nop 0
    buffer_load_dwordx4 v1, s[8:11], s16 offen  lds
    s_add_u32 m0, s17, 1024
    s_add_u32 s16, s16, 114688
    buffer_load_dwordx4 v1, s[8:11], s16 offen  lds
    s_add_u32 m0, s17, 2048
    s_add_u32 s16, s16, 114688
    buffer_load_dwordx4 v1, s[8:11], s16 offen  lds
    s_add_u32 m0, s17, 3072
    s_add_u32 s16, s16, 114688
    buffer_load_dwordx4 v1, s[8:11], s16 offen  lds
    s_add_u32 m0, s17, 4096
    s_add_u32 s16, s16, 114688
    buffer_load_dwordx4 v1, s[8:11], s16 offen  lds
    s_add_u32 m0, s17, 5120
    s_add_u32 s16, s16, 114688
    buffer_load_dwordx4 v1, s[8:11], s16 offen  lds
    s_add_u32 m0, s17, 6144
    s_add_u32 s16, s16, 114688
    buffer_load_dwordx4 v1, s[8:11], s16 offen  lds
    s_add_u32 m0, s17, 7168
    s_add_u32 s16, s16, 114688
    buffer_load_dwordx4 v1, s[8:11], s16 offen  lds
    v_fmamk_f32 v243, v8, 0x40c00000, v9
    v_cos_f32 v10, v11
    v_sin_f32 v11, v11
    v_cos_f32 v224, v240
    v_cos_f32 v225, v241
    v_cos_f32 v226, v242
    v_cos_f32 v227, v243
    v_sin_f32 v240, v240
    v_sin_f32 v241, v241
    v_sin_f32 v242, v242
    v_sin_f32 v243, v243
    v_pk_mul_f32 v[228:229], v[224:225], v[10:11] op_sel:[0,0] op_sel_hi:[1,0]
    v_pk_mul_f32 v[244:245], v[240:241], v[10:11] op_sel:[0,0] op_sel_hi:[1,0]
    v_pk_mul_f32 v[230:231], v[226:227], v[10:11] op_sel:[0,0] op_sel_hi:[1,0]
    v_pk_mul_f32 v[246:247], v[242:243], v[10:11] op_sel:[0,0] op_sel_hi:[1,0]
    v_pk_fma_f32 v[228:229], v[240:241], v[10:11], v[228:229] op_sel:[0,1,0] op_sel_hi:[1,1,1] neg_lo:[1,0,0] neg_hi:[1,0,0]
    v_pk_fma_f32 v[244:245], v[224:225], v[10:11], v[244:245] op_sel:[0,1,0] op_sel_hi:[1,1,1]
    v_pk_fma_f32 v[230:231], v[242:243], v[10:11], v[230:231] op_sel:[0,1,0] op_sel_hi:[1,1,1] neg_lo:[1,0,0] neg_hi:[1,0,0]
    v_pk_fma_f32 v[246:247], v[226:227], v[10:11], v[246:247] op_sel:[0,1,0] op_sel_hi:[1,1,1]
    v_pk_mul_f32 v[232:233], v[228:229], v[10:11] op_sel:[0,0] op_sel_hi:[1,0]
    v_pk_mul_f32 v[248:249], v[244:245], v[10:11] op_sel:[0,0] op_sel_hi:[1,0]
    v_pk_mul_f32 v[234:235], v[230:231], v[10:11] op_sel:[0,0] op_sel_hi:[1,0]
    v_pk_mul_f32 v[250:251], v[246:247], v[10:11] op_sel:[0,0] op_sel_hi:[1,0]
    v_pk_fma_f32 v[232:233], v[244:245], v[10:11], v[232:233] op_sel:[0,1,0] op_sel_hi:[1,1,1] neg_lo:[1,0,0] neg_hi:[1,0,0]
    v_pk_fma_f32 v[248:249], v[228:229], v[10:11], v[248:249] op_sel:[0,1,0] op_sel_hi:[1,1,1]
    v_pk_fma_f32 v[234:235], v[246:247], v[10:11], v[234:235] op_sel:[0,1,0] op_sel_hi:[1,1,1] neg_lo:[1,0,0] neg_hi:[1,0,0]
    v_pk_fma_f32 v[250:251], v[230:231], v[10:11], v[250:251] op_sel:[0,1,0] op_sel_hi:[1,1,1]
    v_pk_mul_f32 v[236:237], v[232:233], v[10:11] op_sel:[0,0] op_sel_hi:[1,0]
    v_pk_mul_f32 v[252:253], v[248:249], v[10:11] op_sel:[0,0] op_sel_hi:[1,0]
    v_pk_mul_f32 v[238:239], v[234:235], v[10:11] op_sel:[0,0] op_sel_hi:[1,0]
    v_pk_mul_f32 v[254:255], v[250:251], v[10:11] op_sel:[0,0] op_sel_hi:[1,0]
    v_pk_fma_f32 v[236:237], v[248:249], v[10:11], v[236:237] op_sel:[0,1,0] op_sel_hi:[1,1,1] neg_lo:[1,0,0] neg_hi:[1,0,0]
    v_pk_fma_f32 v[252:253], v[232:233], v[10:11], v[252:253] op_sel:[0,1,0] op_sel_hi:[1,1,1]
    v_pk_fma_f32 v[238:239], v[250:251], v[10:11], v[238:239] op_sel:[0,1,0] op_sel_hi:[1,1,1] neg_lo:[1,0,0] neg_hi:[1,0,0]
    v_pk_fma_f32 v[254:255], v[234:235], v[10:11], v[254:255] op_sel:[0,1,0] op_sel_hi:[1,1,1]
    v_cvt_pk_bf16_f32 v80, v224, v225
    v_cvt_pk_bf16_f32 v81, v226, v227
    v_cvt_pk_bf16_f32 v82, v228, v229
    v_cvt_pk_bf16_f32 v83, v230, v231
    v_cvt_pk_bf16_f32 v84, v232, v233
    v_cvt_pk_bf16_f32 v85, v234, v235
    v_cvt_pk_bf16_f32 v86, v236, v237
    v_cvt_pk_bf16_f32 v87, v238, v239
    v_cvt_pk_bf16_f32 v88, v240, v241
    v_cvt_pk_bf16_f32 v89, v242, v243
    v_cvt_pk_bf16_f32 v90, v244, v245
    v_cvt_pk_bf16_f32 v91, v246, v247
    v_cvt_pk_bf16_f32 v92, v248, v249
    v_cvt_pk_bf16_f32 v93, v250, v251
    v_cvt_pk_bf16_f32 v94, v252, v253
    v_cvt_pk_bf16_f32 v95, v254, v255
    v_and_b32 v8, 4, v5
    v_lshlrev_b32 v8, 1, v8
    v_bfe_u32 v9, v5, 3, 2
    v_lshl_add_u32 v8, v9, 1, v8
    v_bfe_u32 v9, v5, 1, 1
    v_add_u32 v8, v8, v9
    v_cvt_f32_u32 v8, v8
    v_and_b32 v12, 1, v5
    v_cvt_f32_u32 v9, v12
    v_mul_f32 v8, 0x3d000000, v8
    v_mul_f32 v9, 0x3e800000, v9
    v_mul_f32 v7, 0x40800000, v7
    v_fmac_f32 v9, v8, v7
    v_mul_f32 v11, 0x41000000, v8
    v_fmamk_f32 v240, v8, 0x00000000, v9
    v_fmamk_f32 v241, v8, 0x3f800000, v9
    v_fmamk_f32 v242, v8, 0x40000000, v9
    v_fmamk_f32 v243, v8, 0x40400000, v9
    v_cos_f32 v10, v11
    v_sin_f32 v11, v11
    v_cos_f32 v224, v240
    v_cos_f32 v225, v241
    v_cos_f32 v226, v242
    v_cos_f32 v227, v243
    v_sin_f32 v240, v240
    v_sin_f32 v241, v241
    v_sin_f32 v242, v242
    v_sin_f32 v243, v243
    v_pk_mul_f32 v[228:229], v[224:225], v[10:11] op_sel:[0,0] op_sel_hi:[1,0]
    v_pk_mul_f32 v[244:245], v[240:241], v[10:11] op_sel:[0,0] op_sel_hi:[1,0]
    v_pk_mul_f32 v[230:231], v[226:227], v[10:11] op_sel:[0,0] op_sel_hi:[1,0]
    v_pk_mul_f32 v[246:247], v[242:243], v[10:11] op_sel:[0,0] op_sel_hi:[1,0]
    v_pk_fma_f32 v[228:229], v[240:241], v[10:11], v[228:229] op_sel:[0,1,0] op_sel_hi:[1,1,1] neg_lo:[1,0,0] neg_hi:[1,0,0]
    v_pk_fma_f32 v[244:245], v[224:225], v[10:11], v[244:245] op_sel:[0,1,0] op_sel_hi:[1,1,1]
    v_pk_fma_f32 v[230:231], v[242:243], v[10:11], v[230:231] op_sel:[0,1,0] op_sel_hi:[1,1,1] neg_lo:[1,0,0] neg_hi:[1,0,0]
    v_pk_fma_f32 v[246:247], v[226:227], v[10:11], v[246:247] op_sel:[0,1,0] op_sel_hi:[1,1,1]
    v_pk_mul_f32 v[232:233], v[228:229], v[10:11] op_sel:[0,0] op_sel_hi:[1,0]
    v_pk_mul_f32 v[248:249], v[244:245], v[10:11] op_sel:[0,0] op_sel_hi:[1,0]
    v_pk_mul_f32 v[234:235], v[230:231], v[10:11] op_sel:[0,0] op_sel_hi:[1,0]
    v_pk_mul_f32 v[250:251], v[246:247], v[10:11] op_sel:[0,0] op_sel_hi:[1,0]
    v_pk_fma_f32 v[232:233], v[244:245], v[10:11], v[232:233] op_sel:[0,1,0] op_sel_hi:[1,1,1] neg_lo:[1,0,0] neg_hi:[1,0,0]
    v_pk_fma_f32 v[248:249], v[228:229], v[10:11], v[248:249] op_sel:[0,1,0] op_sel_hi:[1,1,1]
    v_pk_fma_f32 v[234:235], v[246:247], v[10:11], v[234:235] op_sel:[0,1,0] op_sel_hi:[1,1,1] neg_lo:[1,0,0] neg_hi:[1,0,0]
    v_pk_fma_f32 v[250:251], v[230:231], v[10:11], v[250:251] op_sel:[0,1,0] op_sel_hi:[1,1,1]
    v_pk_mul_f32 v[236:237], v[232:233], v[10:11] op_sel:[0,0] op_sel_hi:[1,0]
    v_pk_mul_f32 v[252:253], v[248:249], v[10:11] op_sel:[0,0] op_sel_hi:[1,0]
    v_pk_mul_f32 v[238:239], v[234:235], v[10:11] op_sel:[0,0] op_sel_hi:[1,0]
    v_pk_mul_f32 v[254:255], v[250:251], v[10:11] op_sel:[0,0] op_sel_hi:[1,0]
    v_pk_fma_f32 v[236:237], v[248:249], v[10:11], v[236:237] op_sel:[0,1,0] op_sel_hi:[1,1,1] neg_lo:[1,0,0] neg_hi:[1,0,0]
    v_pk_fma_f32 v[252:253], v[232:233], v[10:11], v[252:253] op_sel:[0,1,0] op_sel_hi:[1,1,1]
    v_pk_fma_f32 v[238:239], v[250:251], v[10:11], v[238:239] op_sel:[0,1,0] op_sel_hi:[1,1,1] neg_lo:[1,0,0] neg_hi:[1,0,0]
    v_pk_fma_f32 v[254:255], v[234:235], v[10:11], v[254:255] op_sel:[0,1,0] op_sel_hi:[1,1,1]
    v_cvt_pk_bf16_f32 v96, v224, v225
    v_cvt_pk_bf16_f32 v97, v226, v227
    v_cvt_pk_bf16_f32 v98, v228, v229
    v_cvt_pk_bf16_f32 v99, v230, v231
    v_cvt_pk_bf16_f32 v100, v232, v233
    v_cvt_pk_bf16_f32 v101, v234, v235
    v_cvt_pk_bf16_f32 v102, v236, v237
    v_cvt_pk_bf16_f32 v103, v238, v239
    v_cvt_pk_bf16_f32 v104, v240, v241
    v_cvt_pk_bf16_f32 v105, v242, v243
    v_cvt_pk_bf16_f32 v106, v244, v245
    v_cvt_pk_bf16_f32 v107, v246, v247
    v_cvt_pk_bf16_f32 v108, v248, v249
    v_cvt_pk_bf16_f32 v109, v250, v251
    v_cvt_pk_bf16_f32 v110, v252, v253
    v_cvt_pk_bf16_f32 v111, v254, v255
    v_mul_f32 v8, 0xba800000, v6
    v_mul_f32 v9, v8, v7
    s_mov_b32 s28, 0x3d3504f3
    v_mul_f32 v11, 0x41000000, v8
    v_fmamk_f32 v240, v8, 0x00000000, v9
    v_fmamk_f32 v241, v8, 0x3f800000, v9
    v_fmamk_f32 v242, v8, 0x40000000, v9
    v_fmamk_f32 v243, v8, 0x40400000, v9
    v_cos_f32 v10, v11
    v_sin_f32 v11, v11
    v_cos_f32 v224, v240
    v_cos_f32 v225, v241
    v_cos_f32 v226, v242
    v_cos_f32 v227, v243
    v_sin_f32 v240, v240
    v_sin_f32 v241, v241
    v_sin_f32 v242, v242
    v_sin_f32 v243, v243
    v_pk_mul_f32 v[224:225], v[224:225], s[28:29] op_sel_hi:[1,0]
    v_pk_mul_f32 v[226:227], v[226:227], s[28:29] op_sel_hi:[1,0]
    v_pk_mul_f32 v[240:241], v[240:241], s[28:29] op_sel_hi:[1,0]
    v_pk_mul_f32 v[242:243], v[242:243], s[28:29] op_sel_hi:[1,0]
    v_pk_mul_f32 v[228:229], v[224:225], v[10:11] op_sel:[0,0] op_sel_hi:[1,0]
    v_pk_mul_f32 v[244:245], v[240:241], v[10:11] op_sel:[0,0] op_sel_hi:[1,0]
    v_pk_mul_f32 v[230:231], v[226:227], v[10:11] op_sel:[0,0] op_sel_hi:[1,0]
    v_pk_mul_f32 v[246:247], v[242:243], v[10:11] op_sel:[0,0] op_sel_hi:[1,0]
    v_pk_fma_f32 v[228:229], v[240:241], v[10:11], v[228:229] op_sel:[0,1,0] op_sel_hi:[1,1,1] neg_lo:[1,0,0] neg_hi:[1,0,0]
    v_pk_fma_f32 v[244:245], v[224:225], v[10:11], v[244:245] op_sel:[0,1,0] op_sel_hi:[1,1,1]
    v_pk_fma_f32 v[230:231], v[242:243], v[10:11], v[230:231] op_sel:[0,1,0] op_sel_hi:[1,1,1] neg_lo:[1,0,0] neg_hi:[1,0,0]
    v_pk_fma_f32 v[246:247], v[226:227], v[10:11], v[246:247] op_sel:[0,1,0] op_sel_hi:[1,1,1]
    v_pk_mul_f32 v[232:233], v[228:229], v[10:11] op_sel:[0,0] op_sel_hi:[1,0]
    v_pk_mul_f32 v[248:249], v[244:245], v[10:11] op_sel:[0,0] op_sel_hi:[1,0]
    v_pk_mul_f32 v[234:235], v[230:231], v[10:11] op_sel:[0,0] op_sel_hi:[1,0]
    v_pk_mul_f32 v[250:251], v[246:247], v[10:11] op_sel:[0,0] op_sel_hi:[1,0]
    v_pk_fma_f32 v[232:233], v[244:245], v[10:11], v[232:233] op_sel:[0,1,0] op_sel_hi:[1,1,1] neg_lo:[1,0,0] neg_hi:[1,0,0]
    v_pk_fma_f32 v[248:249], v[228:229], v[10:11], v[248:249] op_sel:[0,1,0] op_sel_hi:[1,1,1]
    v_pk_fma_f32 v[234:235], v[246:247], v[10:11], v[234:235] op_sel:[0,1,0] op_sel_hi:[1,1,1] neg_lo:[1,0,0] neg_hi:[1,0,0]
    v_pk_fma_f32 v[250:251], v[230:231], v[10:11], v[250:251] op_sel:[0,1,0] op_sel_hi:[1,1,1]
    v_pk_mul_f32 v[236:237], v[232:233], v[10:11] op_sel:[0,0] op_sel_hi:[1,0]
    v_pk_mul_f32 v[252:253], v[248:249], v[10:11] op_sel:[0,0] op_sel_hi:[1,0]
    v_pk_mul_f32 v[238:239], v[234:235], v[10:11] op_sel:[0,0] op_sel_hi:[1,0]
    v_pk_mul_f32 v[254:255], v[250:251], v[10:11] op_sel:[0,0] op_sel_hi:[1,0]
    v_pk_fma_f32 v[236:237], v[248:249], v[10:11], v[236:237] op_sel:[0,1,0] op_sel_hi:[1,1,1] neg_lo:[1,0,0] neg_hi:[1,0,0]
    v_pk_fma_f32 v[252:253], v[232:233], v[10:11], v[252:253] op_sel:[0,1,0] op_sel_hi:[1,1,1]
    v_pk_fma_f32 v[238:239], v[250:251], v[10:11], v[238:239] op_sel:[0,1,0] op_sel_hi:[1,1,1] neg_lo:[1,0,0] neg_hi:[1,0,0]
    v_pk_fma_f32 v[254:255], v[234:235], v[10:11], v[254:255] op_sel:[0,1,0] op_sel_hi:[1,1,1]
    v_mov_b32 v10, 0x3f803f80
    v_lshlrev_b32 v11, 31, v12
    v_xor_b32 v11, v10, v11
    v_bfe_i32 v10, v5, 4, 1
    v_bfi_b32 v11, v10, 0, v11
    v_mov_b32 v112, v11
    v_mov_b32 v113, v11
    v_mov_b32 v114, v11
    v_mov_b32 v115, v11
    s_mov_b32 s30, 0x05040100
    s_mov_b32 s31, 0x07060302
    v_bfe_u32 v2, v5, 2, 2
    v_xor_b32 v2, s25, v2
    v_lshlrev_b32 v2, 4, v2
    v_lshl_add_u32 v2, v5, 6, v2
    s_lshr_b32 s26, s24, 2
    s_lshl_b32 s27, s26, 3
    v_add_u32 v2, s27, v2
    s_waitcnt vmcnt(0)
    s_barrier
    ds_read_b64 v[16:17], v2 offset:0
    ds_read_b64 v[18:19], v2 offset:4096
    ds_read_b64 v[20:21], v2 offset:8192
    ds_read_b64 v[22:23], v2 offset:12288
    ds_read_b64 v[24:25], v2 offset:16384
    ds_read_b64 v[26:27], v2 offset:20480
    ds_read_b64 v[28:29], v2 offset:24576
    ds_read_b64 v[30:31], v2 offset:28672
    ds_read_b64 v[32:33], v2 offset:32768
    ds_read_b64 v[34:35], v2 offset:36864
    ds_read_b64 v[36:37], v2 offset:40960
    ds_read_b64 v[38:39], v2 offset:45056
    ds_read_b64 v[40:41], v2 offset:49152
    ds_read_b64 v[42:43], v2 offset:53248
    ds_read_b64 v[44:45], v2 offset:57344
    ds_read_b64 v[46:47], v2 offset:61440
    s_mul_i32 s16, s3, 9363
    s_lshr_b32 s16, s16, 16
    s_and_b32 s20, s16, 0
    s_mul_i32 s17, s16, 7
    s_sub_u32 s17, s3, s17
    s_mul_i32 s16, s16, 458752
    s_add_u32 s16, s16, 41943040
    s_lshl2_add_u32 s18, s26, s25
    s_lshl_b32 s18, s18, 9
    s_add_u32 s16, s16, s18
    s_lshl_b32 s18, s17, 12
    s_lshl_b32 s19, s17, 16
    s_cmp_lt_u32 s17, 3
    s_cselect_b32 s18, s18, s19
    s_cselect_b32 s19, 3, 1
    s_lshl_b32 s19, s19, 12
    s_add_u32 s16, s16, s18
    s_lshl2_add_u32 s18, s19, s16
    s_bitcmp1_b32 s20, 0
    s_cselect_b32 s17, s16, s18
    s_cselect_b32 s16, s18, s16
    s_lshr_b32 s20, s20, 1
    v_lshrrev_b32 v1, 5, v5
    v_xor_b32 v1, s20, v1
    v_bfe_u32 v3, v5, 3, 2
    v_lshl_add_u32 v1, v1, 3, v3
    v_mul_lo_u32 v1, v1, s19
    s_lshl_b32 s18, s25, 1
    v_and_b32 v3, 7, v5
    v_xor_b32 v3, s18, v3
    v_lshl_add_u32 v1, v3, 4, v1
    v_xor_b32 v3, 16, v1
    v_cmp_eq_u32 vcc, 0, v5
    v_mov_b32 v6, 1.0
    v_mov_b32 v7, 0
    v_mov_b32 v4, 0x3f3504f3
    v_cndmask_b32 v6, v6, v7, vcc
    v_cndmask_b32 v7, v7, v4, vcc
    s_waitcnt lgkmcnt(0)
    v_perm_b32 v208, v18, v16, s30
    v_perm_b32 v209, v22, v20, s30
    v_perm_b32 v210, v26, v24, s30
    v_perm_b32 v211, v30, v28, s30
    v_perm_b32 v212, v34, v32, s30
    v_perm_b32 v213, v38, v36, s30
    v_perm_b32 v214, v42, v40, s30
    v_perm_b32 v215, v46, v44, s30
    s_nop 1
    v_mfma_f32_32x32x16_bf16 v[144:159], v[208:211], v[80:83], 0
    v_perm_b32 v216, v18, v16, s31
    v_perm_b32 v217, v22, v20, s31
    v_mfma_f32_32x32x16_bf16 v[160:175], v[208:211], v[88:91], 0
    v_perm_b32 v218, v26, v24, s31
    v_perm_b32 v219, v30, v28, s31
    v_mfma_f32_32x32x16_bf16 v[144:159], v[212:215], v[84:87], v[144:159]
    v_perm_b32 v220, v34, v32, s31
    v_perm_b32 v221, v38, v36, s31
    v_mfma_f32_32x32x16_bf16 v[160:175], v[212:215], v[92:95], v[160:175]
    v_perm_b32 v222, v42, v40, s31
    v_perm_b32 v223, v46, v44, s31
    s_nop 11
    v_pk_mul_f32 v[8:9], v[160:161], v[240:241]
    v_pk_mul_f32 v[10:11], v[162:163], v[242:243]
    v_pk_mul_f32 v[12:13], v[164:165], v[244:245]
    v_pk_mul_f32 v[14:15], v[166:167], v[246:247]
    v_pk_mul_f32 v[160:161], v[160:161], v[224:225]
    v_pk_mul_f32 v[162:163], v[162:163], v[226:227]
    v_pk_mul_f32 v[164:165], v[164:165], v[228:229]
    v_pk_mul_f32 v[166:167], v[166:167], v[230:231]
    v_pk_fma_f32 v[160:161], v[144:145], v[240:241], v[160:161]
    v_pk_fma_f32 v[162:163], v[146:147], v[242:243], v[162:163]
    v_pk_fma_f32 v[164:165], v[148:149], v[244:245], v[164:165]
    v_pk_fma_f32 v[166:167], v[150:151], v[246:247], v[166:167]
    v_pk_fma_f32 v[144:145], v[144:145], v[224:225], v[8:9] neg_lo:[0,0,1] neg_hi:[0,0,1]
    v_pk_fma_f32 v[146:147], v[146:147], v[226:227], v[10:11] neg_lo:[0,0,1] neg_hi:[0,0,1]
    v_pk_fma_f32 v[148:149], v[148:149], v[228:229], v[12:13] neg_lo:[0,0,1] neg_hi:[0,0,1]
    v_pk_fma_f32 v[150:151], v[150:151], v[230:231], v[14:15] neg_lo:[0,0,1] neg_hi:[0,0,1]
    v_pk_mul_f32 v[8:9], v[168:169], v[248:249]
    v_pk_mul_f32 v[10:11], v[170:171], v[250:251]
    v_pk_mul_f32 v[12:13], v[172:173], v[252:253]
    v_pk_mul_f32 v[14:15], v[174:175], v[254:255]
    v_pk_mul_f32 v[168:169], v[168:169], v[232:233]
    v_pk_mul_f32 v[170:171], v[170:171], v[234:235]
    v_pk_mul_f32 v[172:173], v[172:173], v[236:237]
    v_pk_mul_f32 v[174:175], v[174:175], v[238:239]
    v_pk_fma_f32 v[168:169], v[152:153], v[248:249], v[168:169]
    v_pk_fma_f32 v[170:171], v[154:155], v[250:251], v[170:171]
    v_pk_fma_f32 v[172:173], v[156:157], v[252:253], v[172:173]
    v_pk_fma_f32 v[174:175], v[158:159], v[254:255], v[174:175]
    v_pk_fma_f32 v[152:153], v[152:153], v[232:233], v[8:9] neg_lo:[0,0,1] neg_hi:[0,0,1]
    v_pk_fma_f32 v[154:155], v[154:155], v[234:235], v[10:11] neg_lo:[0,0,1] neg_hi:[0,0,1]
    v_pk_fma_f32 v[156:157], v[156:157], v[236:237], v[12:13] neg_lo:[0,0,1] neg_hi:[0,0,1]
    v_pk_fma_f32 v[158:159], v[158:159], v[238:239], v[14:15] neg_lo:[0,0,1] neg_hi:[0,0,1]
    v_mfma_f32_32x32x16_bf16 v[176:191], v[216:219], v[80:83], 0
    v_cvt_pk_bf16_f32 v116, v144, v145
    v_cvt_pk_bf16_f32 v117, v146, v147
    v_cvt_pk_bf16_f32 v118, v148, v149
    v_cvt_pk_bf16_f32 v119, v150, v151
    v_mfma_f32_32x32x16_bf16 v[192:207], v[216:219], v[88:91], 0
    v_cvt_pk_bf16_f32 v120, v152, v153
    v_cvt_pk_bf16_f32 v121, v154, v155
    v_cvt_pk_bf16_f32 v122, v156, v157
    v_cvt_pk_bf16_f32 v123, v158, v159
    v_mfma_f32_32x32x16_bf16 v[176:191], v[220:223], v[84:87], v[176:191]
    v_cvt_pk_bf16_f32 v124, v160, v161
    v_cvt_pk_bf16_f32 v125, v162, v163
    v_cvt_pk_bf16_f32 v126, v164, v165
    v_cvt_pk_bf16_f32 v127, v166, v167
    v_mfma_f32_32x32x16_bf16 v[192:207], v[220:223], v[92:95], v[192:207]
    v_cvt_pk_bf16_f32 v128, v168, v169
    v_cvt_pk_bf16_f32 v129, v170, v171
    v_cvt_pk_bf16_f32 v130, v172, v173
    v_cvt_pk_bf16_f32 v131, v174, v175
    s_nop 1
    v_mfma_f32_16x16x32_bf16 v[160:163], v[112:115], v[116:119], 0
    v_perm_b32 v208, v19, v17, s30
    v_perm_b32 v209, v23, v21, s30
    v_mfma_f32_32x32x16_bf16 v[144:159], v[96:99], v[116:119], 0
    v_perm_b32 v210, v27, v25, s30
    v_perm_b32 v211, v31, v29, s30
    v_mfma_f32_16x16x32_bf16 v[160:163], v[112:115], v[120:123], v[160:163]
    v_perm_b32 v212, v35, v33, s30
    v_perm_b32 v213, v39, v37, s30
    v_mfma_f32_32x32x16_bf16 v[144:159], v[100:103], v[120:123], v[144:159]
    v_perm_b32 v214, v43, v41, s30
    v_perm_b32 v215, v47, v45, s30
    v_mfma_f32_32x32x16_bf16 v[144:159], v[104:107], v[124:127], v[144:159]
    v_mfma_f32_32x32x16_bf16 v[144:159], v[108:111], v[128:131], v[144:159]
    s_nop 3
    v_pk_mul_f32 v[8:9], v[192:193], v[240:241]
    v_pk_mul_f32 v[10:11], v[194:195], v[242:243]
    v_pk_mul_f32 v[12:13], v[196:197], v[244:245]
    v_pk_mul_f32 v[14:15], v[198:199], v[246:247]
    v_pk_mul_f32 v[192:193], v[192:193], v[224:225]
    v_pk_mul_f32 v[194:195], v[194:195], v[226:227]
    v_pk_mul_f32 v[196:197], v[196:197], v[228:229]
    v_pk_mul_f32 v[198:199], v[198:199], v[230:231]
    v_pk_fma_f32 v[192:193], v[176:177], v[240:241], v[192:193]
    v_pk_fma_f32 v[194:195], v[178:179], v[242:243], v[194:195]
    v_pk_fma_f32 v[196:197], v[180:181], v[244:245], v[196:197]
    v_pk_fma_f32 v[198:199], v[182:183], v[246:247], v[198:199]
    v_pk_fma_f32 v[176:177], v[176:177], v[224:225], v[8:9] neg_lo:[0,0,1] neg_hi:[0,0,1]
    v_pk_fma_f32 v[178:179], v[178:179], v[226:227], v[10:11] neg_lo:[0,0,1] neg_hi:[0,0,1]
    v_pk_fma_f32 v[180:181], v[180:181], v[228:229], v[12:13] neg_lo:[0,0,1] neg_hi:[0,0,1]
    v_pk_fma_f32 v[182:183], v[182:183], v[230:231], v[14:15] neg_lo:[0,0,1] neg_hi:[0,0,1]
    v_pk_mul_f32 v[8:9], v[200:201], v[248:249]
    v_pk_mul_f32 v[10:11], v[202:203], v[250:251]
    v_pk_mul_f32 v[12:13], v[204:205], v[252:253]
    v_pk_mul_f32 v[14:15], v[206:207], v[254:255]
    v_pk_mul_f32 v[200:201], v[200:201], v[232:233]
    v_pk_mul_f32 v[202:203], v[202:203], v[234:235]
    v_pk_mul_f32 v[204:205], v[204:205], v[236:237]
    v_pk_mul_f32 v[206:207], v[206:207], v[238:239]
    v_pk_fma_f32 v[200:201], v[184:185], v[248:249], v[200:201]
    v_pk_fma_f32 v[202:203], v[186:187], v[250:251], v[202:203]
    v_pk_fma_f32 v[204:205], v[188:189], v[252:253], v[204:205]
    v_pk_fma_f32 v[206:207], v[190:191], v[254:255], v[206:207]
    v_pk_fma_f32 v[184:185], v[184:185], v[232:233], v[8:9] neg_lo:[0,0,1] neg_hi:[0,0,1]
    v_pk_fma_f32 v[186:187], v[186:187], v[234:235], v[10:11] neg_lo:[0,0,1] neg_hi:[0,0,1]
    v_pk_fma_f32 v[188:189], v[188:189], v[236:237], v[12:13] neg_lo:[0,0,1] neg_hi:[0,0,1]
    v_pk_fma_f32 v[190:191], v[190:191], v[238:239], v[14:15] neg_lo:[0,0,1] neg_hi:[0,0,1]
    v_mul_f32 v145, v145, v6
    v_fmac_f32 v145, v161, v7
    v_cvt_pk_bf16_f32 v136, v152, v153
    v_cvt_pk_bf16_f32 v137, v154, v155
    v_cvt_pk_bf16_f32 v138, v156, v157
    v_cvt_pk_bf16_f32 v139, v158, v159
    buffer_store_dwordx4 v[136:139], v1, s[12:15], s17 offen offset:0 sc1
    v_cvt_pk_bf16_f32 v132, v144, v145
    v_cvt_pk_bf16_f32 v133, v146, v147
    v_cvt_pk_bf16_f32 v134, v148, v149
    v_cvt_pk_bf16_f32 v135, v150, v151
    buffer_store_dwordx4 v[132:135], v1, s[12:15], s16 offen offset:0 sc1
    v_mfma_f32_32x32x16_bf16 v[144:159], v[208:211], v[80:83], 0
    v_cvt_pk_bf16_f32 v116, v176, v177
    v_cvt_pk_bf16_f32 v117, v178, v179
    v_cvt_pk_bf16_f32 v118, v180, v181
    v_cvt_pk_bf16_f32 v119, v182, v183
    v_mfma_f32_32x32x16_bf16 v[160:175], v[208:211], v[88:91], 0
    v_cvt_pk_bf16_f32 v120, v184, v185
    v_cvt_pk_bf16_f32 v121, v186, v187
    v_cvt_pk_bf16_f32 v122, v188, v189
    v_cvt_pk_bf16_f32 v123, v190, v191
    v_mfma_f32_32x32x16_bf16 v[144:159], v[212:215], v[84:87], v[144:159]
    v_cvt_pk_bf16_f32 v124, v192, v193
    v_cvt_pk_bf16_f32 v125, v194, v195
    v_cvt_pk_bf16_f32 v126, v196, v197
    v_cvt_pk_bf16_f32 v127, v198, v199
    v_mfma_f32_32x32x16_bf16 v[160:175], v[212:215], v[92:95], v[160:175]
    v_cvt_pk_bf16_f32 v128, v200, v201
    v_cvt_pk_bf16_f32 v129, v202, v203
    v_cvt_pk_bf16_f32 v130, v204, v205
    v_cvt_pk_bf16_f32 v131, v206, v207
    s_nop 1
    v_mfma_f32_16x16x32_bf16 v[192:195], v[112:115], v[116:119], 0
    v_perm_b32 v216, v19, v17, s31
    v_perm_b32 v217, v23, v21, s31
    v_mfma_f32_32x32x16_bf16 v[176:191], v[96:99], v[116:119], 0
    v_perm_b32 v218, v27, v25, s31
    v_perm_b32 v219, v31, v29, s31
    v_mfma_f32_16x16x32_bf16 v[192:195], v[112:115], v[120:123], v[192:195]
    v_perm_b32 v220, v35, v33, s31
    v_perm_b32 v221, v39, v37, s31
    v_mfma_f32_32x32x16_bf16 v[176:191], v[100:103], v[120:123], v[176:191]
    v_perm_b32 v222, v43, v41, s31
    v_perm_b32 v223, v47, v45, s31
    v_mfma_f32_32x32x16_bf16 v[176:191], v[104:107], v[124:127], v[176:191]
    v_mfma_f32_32x32x16_bf16 v[176:191], v[108:111], v[128:131], v[176:191]
    s_nop 3
    v_pk_mul_f32 v[8:9], v[160:161], v[240:241]
    v_pk_mul_f32 v[10:11], v[162:163], v[242:243]
    v_pk_mul_f32 v[12:13], v[164:165], v[244:245]
    v_pk_mul_f32 v[14:15], v[166:167], v[246:247]
    v_pk_mul_f32 v[160:161], v[160:161], v[224:225]
    v_pk_mul_f32 v[162:163], v[162:163], v[226:227]
    v_pk_mul_f32 v[164:165], v[164:165], v[228:229]
    v_pk_mul_f32 v[166:167], v[166:167], v[230:231]
    v_pk_fma_f32 v[160:161], v[144:145], v[240:241], v[160:161]
    v_pk_fma_f32 v[162:163], v[146:147], v[242:243], v[162:163]
    v_pk_fma_f32 v[164:165], v[148:149], v[244:245], v[164:165]
    v_pk_fma_f32 v[166:167], v[150:151], v[246:247], v[166:167]
    v_pk_fma_f32 v[144:145], v[144:145], v[224:225], v[8:9] neg_lo:[0,0,1] neg_hi:[0,0,1]
    v_pk_fma_f32 v[146:147], v[146:147], v[226:227], v[10:11] neg_lo:[0,0,1] neg_hi:[0,0,1]
    v_pk_fma_f32 v[148:149], v[148:149], v[228:229], v[12:13] neg_lo:[0,0,1] neg_hi:[0,0,1]
    v_pk_fma_f32 v[150:151], v[150:151], v[230:231], v[14:15] neg_lo:[0,0,1] neg_hi:[0,0,1]
    v_pk_mul_f32 v[8:9], v[168:169], v[248:249]
    v_pk_mul_f32 v[10:11], v[170:171], v[250:251]
    v_pk_mul_f32 v[12:13], v[172:173], v[252:253]
    v_pk_mul_f32 v[14:15], v[174:175], v[254:255]
    v_pk_mul_f32 v[168:169], v[168:169], v[232:233]
    v_pk_mul_f32 v[170:171], v[170:171], v[234:235]
    v_pk_mul_f32 v[172:173], v[172:173], v[236:237]
    v_pk_mul_f32 v[174:175], v[174:175], v[238:239]
    v_pk_fma_f32 v[168:169], v[152:153], v[248:249], v[168:169]
    v_pk_fma_f32 v[170:171], v[154:155], v[250:251], v[170:171]
    v_pk_fma_f32 v[172:173], v[156:157], v[252:253], v[172:173]
    v_pk_fma_f32 v[174:175], v[158:159], v[254:255], v[174:175]
    v_pk_fma_f32 v[152:153], v[152:153], v[232:233], v[8:9] neg_lo:[0,0,1] neg_hi:[0,0,1]
    v_pk_fma_f32 v[154:155], v[154:155], v[234:235], v[10:11] neg_lo:[0,0,1] neg_hi:[0,0,1]
    v_pk_fma_f32 v[156:157], v[156:157], v[236:237], v[12:13] neg_lo:[0,0,1] neg_hi:[0,0,1]
    v_pk_fma_f32 v[158:159], v[158:159], v[238:239], v[14:15] neg_lo:[0,0,1] neg_hi:[0,0,1]
    v_mul_f32 v177, v177, v6
    v_fmac_f32 v177, v193, v7
    v_cvt_pk_bf16_f32 v136, v184, v185
    v_cvt_pk_bf16_f32 v137, v186, v187
    v_cvt_pk_bf16_f32 v138, v188, v189
    v_cvt_pk_bf16_f32 v139, v190, v191
    buffer_store_dwordx4 v[136:139], v1, s[12:15], s17 offen offset:128 sc1
    v_cvt_pk_bf16_f32 v132, v176, v177
    v_cvt_pk_bf16_f32 v133, v178, v179
    v_cvt_pk_bf16_f32 v134, v180, v181
    v_cvt_pk_bf16_f32 v135, v182, v183
    buffer_store_dwordx4 v[132:135], v1, s[12:15], s16 offen offset:128 sc1
    v_mfma_f32_32x32x16_bf16 v[176:191], v[216:219], v[80:83], 0
    v_cvt_pk_bf16_f32 v116, v144, v145
    v_cvt_pk_bf16_f32 v117, v146, v147
    v_cvt_pk_bf16_f32 v118, v148, v149
    v_cvt_pk_bf16_f32 v119, v150, v151
    v_mfma_f32_32x32x16_bf16 v[192:207], v[216:219], v[88:91], 0
    v_cvt_pk_bf16_f32 v120, v152, v153
    v_cvt_pk_bf16_f32 v121, v154, v155
    v_cvt_pk_bf16_f32 v122, v156, v157
    v_cvt_pk_bf16_f32 v123, v158, v159
    v_mfma_f32_32x32x16_bf16 v[176:191], v[220:223], v[84:87], v[176:191]
    v_cvt_pk_bf16_f32 v124, v160, v161
    v_cvt_pk_bf16_f32 v125, v162, v163
    v_cvt_pk_bf16_f32 v126, v164, v165
    v_cvt_pk_bf16_f32 v127, v166, v167
    v_mfma_f32_32x32x16_bf16 v[192:207], v[220:223], v[92:95], v[192:207]
    v_cvt_pk_bf16_f32 v128, v168, v169
    v_cvt_pk_bf16_f32 v129, v170, v171
    v_cvt_pk_bf16_f32 v130, v172, v173
    v_cvt_pk_bf16_f32 v131, v174, v175
    s_nop 1
    v_mfma_f32_16x16x32_bf16 v[160:163], v[112:115], v[116:119], 0
    v_mfma_f32_32x32x16_bf16 v[144:159], v[96:99], v[116:119], 0
    v_mfma_f32_16x16x32_bf16 v[160:163], v[112:115], v[120:123], v[160:163]
    v_mfma_f32_32x32x16_bf16 v[144:159], v[100:103], v[120:123], v[144:159]
    v_mfma_f32_32x32x16_bf16 v[144:159], v[104:107], v[124:127], v[144:159]
    v_mfma_f32_32x32x16_bf16 v[144:159], v[108:111], v[128:131], v[144:159]
    s_nop 3
    v_pk_mul_f32 v[8:9], v[192:193], v[240:241]
    v_pk_mul_f32 v[10:11], v[194:195], v[242:243]
    v_pk_mul_f32 v[12:13], v[196:197], v[244:245]
    v_pk_mul_f32 v[14:15], v[198:199], v[246:247]
    v_pk_mul_f32 v[192:193], v[192:193], v[224:225]
    v_pk_mul_f32 v[194:195], v[194:195], v[226:227]
    v_pk_mul_f32 v[196:197], v[196:197], v[228:229]
    v_pk_mul_f32 v[198:199], v[198:199], v[230:231]
    v_pk_fma_f32 v[192:193], v[176:177], v[240:241], v[192:193]
    v_pk_fma_f32 v[194:195], v[178:179], v[242:243], v[194:195]
    v_pk_fma_f32 v[196:197], v[180:181], v[244:245], v[196:197]
    v_pk_fma_f32 v[198:199], v[182:183], v[246:247], v[198:199]
    v_pk_fma_f32 v[176:177], v[176:177], v[224:225], v[8:9] neg_lo:[0,0,1] neg_hi:[0,0,1]
    v_pk_fma_f32 v[178:179], v[178:179], v[226:227], v[10:11] neg_lo:[0,0,1] neg_hi:[0,0,1]
    v_pk_fma_f32 v[180:181], v[180:181], v[228:229], v[12:13] neg_lo:[0,0,1] neg_hi:[0,0,1]
    v_pk_fma_f32 v[182:183], v[182:183], v[230:231], v[14:15] neg_lo:[0,0,1] neg_hi:[0,0,1]
    v_pk_mul_f32 v[8:9], v[200:201], v[248:249]
    v_pk_mul_f32 v[10:11], v[202:203], v[250:251]
    v_pk_mul_f32 v[12:13], v[204:205], v[252:253]
    v_pk_mul_f32 v[14:15], v[206:207], v[254:255]
    v_pk_mul_f32 v[200:201], v[200:201], v[232:233]
    v_pk_mul_f32 v[202:203], v[202:203], v[234:235]
    v_pk_mul_f32 v[204:205], v[204:205], v[236:237]
    v_pk_mul_f32 v[206:207], v[206:207], v[238:239]
    v_pk_fma_f32 v[200:201], v[184:185], v[248:249], v[200:201]
    v_pk_fma_f32 v[202:203], v[186:187], v[250:251], v[202:203]
    v_pk_fma_f32 v[204:205], v[188:189], v[252:253], v[204:205]
    v_pk_fma_f32 v[206:207], v[190:191], v[254:255], v[206:207]
    v_pk_fma_f32 v[184:185], v[184:185], v[232:233], v[8:9] neg_lo:[0,0,1] neg_hi:[0,0,1]
    v_pk_fma_f32 v[186:187], v[186:187], v[234:235], v[10:11] neg_lo:[0,0,1] neg_hi:[0,0,1]
    v_pk_fma_f32 v[188:189], v[188:189], v[236:237], v[12:13] neg_lo:[0,0,1] neg_hi:[0,0,1]
    v_pk_fma_f32 v[190:191], v[190:191], v[238:239], v[14:15] neg_lo:[0,0,1] neg_hi:[0,0,1]
    v_mul_f32 v145, v145, v6
    v_fmac_f32 v145, v161, v7
    v_cvt_pk_bf16_f32 v136, v152, v153
    v_cvt_pk_bf16_f32 v137, v154, v155
    v_cvt_pk_bf16_f32 v138, v156, v157
    v_cvt_pk_bf16_f32 v139, v158, v159
    buffer_store_dwordx4 v[136:139], v3, s[12:15], s17 offen offset:256 sc1
    v_cvt_pk_bf16_f32 v132, v144, v145
    v_cvt_pk_bf16_f32 v133, v146, v147
    v_cvt_pk_bf16_f32 v134, v148, v149
    v_cvt_pk_bf16_f32 v135, v150, v151
    buffer_store_dwordx4 v[132:135], v3, s[12:15], s16 offen offset:256 sc1
    v_cvt_pk_bf16_f32 v116, v176, v177
    v_cvt_pk_bf16_f32 v117, v178, v179
    v_cvt_pk_bf16_f32 v118, v180, v181
    v_cvt_pk_bf16_f32 v119, v182, v183
    v_cvt_pk_bf16_f32 v120, v184, v185
    v_cvt_pk_bf16_f32 v121, v186, v187
    v_cvt_pk_bf16_f32 v122, v188, v189
    v_cvt_pk_bf16_f32 v123, v190, v191
    v_cvt_pk_bf16_f32 v124, v192, v193
    v_cvt_pk_bf16_f32 v125, v194, v195
    v_cvt_pk_bf16_f32 v126, v196, v197
    v_cvt_pk_bf16_f32 v127, v198, v199
    v_cvt_pk_bf16_f32 v128, v200, v201
    v_cvt_pk_bf16_f32 v129, v202, v203
    v_cvt_pk_bf16_f32 v130, v204, v205
    v_cvt_pk_bf16_f32 v131, v206, v207
    s_nop 1
    v_mfma_f32_16x16x32_bf16 v[192:195], v[112:115], v[116:119], 0
    v_mfma_f32_32x32x16_bf16 v[176:191], v[96:99], v[116:119], 0
    v_mfma_f32_16x16x32_bf16 v[192:195], v[112:115], v[120:123], v[192:195]
    v_mfma_f32_32x32x16_bf16 v[176:191], v[100:103], v[120:123], v[176:191]
    v_mfma_f32_32x32x16_bf16 v[176:191], v[104:107], v[124:127], v[176:191]
    v_mfma_f32_32x32x16_bf16 v[176:191], v[108:111], v[128:131], v[176:191]
    s_nop 3
    s_nop 11
    v_mul_f32 v177, v177, v6
    v_fmac_f32 v177, v193, v7
    v_cvt_pk_bf16_f32 v136, v184, v185
    v_cvt_pk_bf16_f32 v137, v186, v187
    v_cvt_pk_bf16_f32 v138, v188, v189
    v_cvt_pk_bf16_f32 v139, v190, v191
    buffer_store_dwordx4 v[136:139], v3, s[12:15], s17 offen offset:384 sc1
    v_cvt_pk_bf16_f32 v132, v176, v177
    v_cvt_pk_bf16_f32 v133, v178, v179
    v_cvt_pk_bf16_f32 v134, v180, v181
    v_cvt_pk_bf16_f32 v135, v182, v183
    buffer_store_dwordx4 v[132:135], v3, s[12:15], s16 offen offset:384 sc1
    s_branch K2_DONE
NXPF_k2_kernel:
    s_cmp_ge_u32 s2, 256
    s_cbranch_scc1 END_k2_kernel
    s_load_dwordx2 s[4:5], s[0:1], 64
    s_getpc_b64 s[60:61]
PF_k2_kernel_2:
    v_lshlrev_b32 v2, 7, v0
    v_min_u32 v2, LAST_ff_kernel-ff_kernel-4, v2
    v_add_u32 v2, ff_kernel-PF_k2_kernel_2, v2
    v_ashrrev_i32 v3, 31, v2
    v_lshl_add_u64 v[2:3], v[2:3], 0, s[60:61]
    global_load_dword v4, v[2:3], off
    s_branch FZ_k2_kernel
NXPFB_k2_kernel:
    s_cmp_ge_u32 s2, 256
    s_cbranch_scc1 END_k2_kernel
    s_load_dwordx2 s[4:5], s[0:1], 64
    s_getpc_b64 s[60:61]
PF_k2_kernel_3:
    v_lshlrev_b32 v2, 7, v0
    v_min_u32 v2, LAST_ffb_kernel-ffb_kernel-4, v2
    v_add_u32 v2, ffb_kernel-PF_k2_kernel_3, v2
    v_ashrrev_i32 v3, 31, v2
    v_lshl_add_u64 v[2:3], v[2:3], 0, s[60:61]
    global_load_dword v4, v[2:3], off
FZ_k2_kernel:
    v_lshlrev_b32 v6, 4, v0
    s_and_b32 s16, s2, 15
    s_lshl_b32 s16, s16, 13
    s_add_u32 s16, s16, 65011712
    s_add_u32 s16, s16, s50
    v_mov_b32 v8, 0
    v_mov_b32 v9, 0
    v_mov_b32 v10, 0
    v_mov_b32 v11, 0
    s_waitcnt lgkmcnt(0)
    s_mov_b32 s12, s4
    s_mov_b32 s13, s5
    s_mov_b32 s14, 268435456
    s_mov_b32 s15, 0x00020000
    buffer_store_dwordx4 v[8:11], v6, s[12:15], s16 offen sc1
    s_endpgm
BODY_k2_kernel:
    s_cmp_ge_u32 s2, 240
    s_cbranch_scc1 NXPFB_k2_kernel
    s_load_dwordx2 s[4:5], s[0:1], 64
    s_load_dwordx2 s[6:7], s[0:1], 40
    s_getpc_b64 s[60:61]
PF_k2_kernel_4:
    v_lshlrev_b32 v2, 7, v0
    v_min_u32 v2, BODY2_k2_kernel-PF_k2_kernel_4-4, v2
    v_mov_b32 v3, 0
    v_lshl_add_u64 v[2:3], v[2:3], 0, s[60:61]
    global_load_dword v160, v[2:3], off
    s_waitcnt vmcnt(0)
    s_getpc_b64 s[60:61]
PF_k2_kernel_5:
    v_lshlrev_b32 v2, 7, v0
    v_min_u32 v2, ffb_kernel+4096-ffb_kernel-4, v2
    v_add_u32 v2, ffb_kernel-PF_k2_kernel_5, v2
    v_ashrrev_i32 v3, 31, v2
    v_lshl_add_u64 v[2:3], v[2:3], 0, s[60:61]
    global_load_dword v4, v[2:3], off
    s_waitcnt vmcnt(0)
    v_lshrrev_b32 v1, 6, v0
    v_and_b32 v5, 63, v0
    v_readfirstlane_b32 s24, v1
    v_and_b32 v1, 3, v5
    v_bfe_u32 v2, v5, 3, 1
    v_lshl_add_u32 v1, v2, 2, v1
    v_lshlrev_b32 v1, 11, v1
    v_bfe_u32 v2, v5, 4, 1
    v_lshl_add_u32 v1, v2, 6, v1
    v_bfe_u32 v3, v5, 2, 1
    v_lshl_add_u32 v1, v3, 5, v1
    v_lshrrev_b32 v3, 5, v5
    v_lshl_add_u32 v1, v3, 4, v1
    s_sub_u32 s3, s2, 128
    s_and_b32 s16, s24, 3
    s_lshl2_add_u32 s3, s3, s16
    s_lshr_b32 s26, s24, 2
    s_lshl_b32 s16, s3, 14
    s_lshl_b32 s17, s26, 10
    s_add_u32 s16, s16, s17
    s_waitcnt lgkmcnt(0)
    s_mov_b32 s12, s4
    s_mov_b32 s13, s5
    s_mov_b32 s14, 268435456
    s_mov_b32 s15, 0x00020000
    s_mov_b32 s8, s6
    s_mov_b32 s9, s7
    s_mov_b32 s10, 7340032
    s_mov_b32 s11, 0x00020000
    v_mov_b32 v152, v1
    s_mul_i32 s25, s3, 586
    s_lshr_b32 s25, s25, 16
    s_mul_i32 s17, s25, 112
    s_sub_u32 s17, s3, s17
    s_lshr_b32 s18, s17, 2
    s_and_b32 s17, s17, 3
    s_mul_i32 s27, s25, 1835008
    s_lshl_b32 s17, s17, 9
    s_add_u32 s27, s27, s17
    s_add_u32 s27, s27, 117440512
    s_mul_i32 s17, s18, 37
    s_lshr_b32 s17, s17, 8
    s_mul_i32 s19, s17, 7
    s_sub_u32 s18, s18, s19
    s_mul_i32 s18, s18, 5
    s_mov_b32 s20, 2627930144
    s_mov_b32 s21, 4
    s_lshr_b64 s[20:21], s[20:21], s18
    s_and_b32 s20, s20, 31
    s_mov_b32 s22, 723986626
    s_mov_b32 s23, 6
    s_lshr_b64 s[22:23], s[22:23], s18
    s_and_b32 s22, s22, 31
    s_lshl_b32 s26, s26, 1
    s_add_u32 s18, s26, 0
    s_sub_u32 s19, s17, s18
    s_and_b32 s19, s19, 3
    s_add_u32 s21, s22, s19
    s_cmp_eq_u32 s19, 0
    s_cselect_b32 s21, s20, s21
    s_mul_i32 s18, s18, 458752
    s_add_u32 s18, s18, s27
    s_and_b32 s19, s21, 1
    s_lshl_b32 s19, s19, 11
    s_add_u32 s28, s18, s19
    s_lshr_b32 s30, s21, 1
    s_mul_i32 s18, s30, 6
    s_add_u32 s19, s30, 50
    s_cmp_lt_u32 s30, 10
    s_cselect_b32 s40, s18, s19
    s_cselect_b32 s42, 1, 4
    s_add_u32 s18, s26, 1
    s_sub_u32 s19, s17, s18
    s_and_b32 s19, s19, 3
    s_add_u32 s21, s22, s19
    s_cmp_eq_u32 s19, 0
    s_cselect_b32 s21, s20, s21
    s_mul_i32 s18, s18, 458752
    s_add_u32 s18, s18, s27
    s_and_b32 s19, s21, 1
    s_lshl_b32 s19, s19, 11
    s_add_u32 s29, s18, s19
    s_lshr_b32 s31, s21, 1
    s_mul_i32 s18, s31, 6
    s_add_u32 s19, s31, 50
    s_cmp_lt_u32 s31, 10
    s_cselect_b32 s41, s18, s19
    s_cselect_b32 s43, 1, 4
    s_lshl_b32 s25, s25, 1
    v_lshlrev_b32 v2, 1, v2
    v_subrev_u32 v2, s25, v2
    v_and_b32 v4, 15, v5
    v_lshl_add_u32 v4, v3, 4, v4
    v_lshlrev_b32 v4, 4, v4
    v_add_u32 v1, 6, v2
    v_and_b32 v1, 7, v1
    v_cmp_gt_u32 vcc, 6, v1
    v_mul_u32_u24 v14, s42, v1
    v_add_u32 v14, s40, v14
    v_mad_u32_u24 v15, v1, 14, s30
    v_cndmask_b32 v14, v15, v14, vcc
    v_lshl_add_u32 v6, v14, 12, v4
    v_mul_u32_u24 v14, s43, v1
    v_add_u32 v14, s41, v14
    v_mad_u32_u24 v15, v1, 14, s31
    v_cndmask_b32 v14, v15, v14, vcc
    v_lshl_add_u32 v10, v14, 12, v4
    v_add_u32 v1, 7, v2
    v_and_b32 v1, 7, v1
    v_cmp_gt_u32 vcc, 6, v1
    v_mul_u32_u24 v14, s42, v1
    v_add_u32 v14, s40, v14
    v_mad_u32_u24 v15, v1, 14, s30
    v_cndmask_b32 v14, v15, v14, vcc
    v_lshl_add_u32 v7, v14, 12, v4
    v_mul_u32_u24 v14, s43, v1
    v_add_u32 v14, s41, v14
    v_mad_u32_u24 v15, v1, 14, s31
    v_cndmask_b32 v14, v15, v14, vcc
    v_lshl_add_u32 v11, v14, 12, v4
    v_add_u32 v1, 10, v2
    v_and_b32 v1, 7, v1
    v_cmp_gt_u32 vcc, 6, v1
    v_mul_u32_u24 v14, s42, v1
    v_add_u32 v14, s40, v14
    v_mad_u32_u24 v15, v1, 14, s30
    v_cndmask_b32 v14, v15, v14, vcc
    v_lshl_add_u32 v8, v14, 12, v4
    v_mul_u32_u24 v14, s43, v1
    v_add_u32 v14, s41, v14
    v_mad_u32_u24 v15, v1, 14, s31
    v_cndmask_b32 v14, v15, v14, vcc
    v_lshl_add_u32 v12, v14, 12, v4
    v_add_u32 v1, 11, v2
    v_and_b32 v1, 7, v1
    v_cmp_gt_u32 vcc, 6, v1
    v_mul_u32_u24 v14, s42, v1
    v_add_u32 v14, s40, v14
    v_mad_u32_u24 v15, v1, 14, s30
    v_cndmask_b32 v14, v15, v14, vcc
    v_lshl_add_u32 v9, v14, 12, v4
    v_mul_u32_u24 v14, s43, v1
    v_add_u32 v14, s41, v14
    v_mad_u32_u24 v15, v1, 14, s31
    v_cndmask_b32 v14, v15, v14, vcc
    v_lshl_add_u32 v13, v14, 12, v4
    v_and_b32 v1, 1, v5
    v_lshlrev_b32 v1, 4, v1
    v_mov_b32 v2, 0x3f80
    v_lshlrev_b32 v1, v1, v2
    v_bfe_u32 v2, v5, 1, 4
    v_lshlrev_b32 v3, 2, v3
    v_sub_u32 v2, v2, v3
    v_mov_b32 v3, 0
    v_cmp_eq_u32 vcc, 0, v2
    s_nop 1
    v_cndmask_b32 v112, v3, v1, vcc
    v_cmp_eq_u32 vcc, 1, v2
    s_nop 1
    v_cndmask_b32 v113, v3, v1, vcc
    v_cmp_eq_u32 vcc, 2, v2
    s_nop 1
    v_cndmask_b32 v114, v3, v1, vcc
    v_cmp_eq_u32 vcc, 3, v2
    s_nop 1
    v_cndmask_b32 v115, v3, v1, vcc
    v_cmp_eq_u32 vcc, 8, v2
    s_nop 1
    v_cndmask_b32 v116, v3, v1, vcc
    v_cmp_eq_u32 vcc, 9, v2
    s_nop 1
    v_cndmask_b32 v117, v3, v1, vcc
    v_cmp_eq_u32 vcc, 10, v2
    s_nop 1
    v_cndmask_b32 v118, v3, v1, vcc
    v_cmp_eq_u32 vcc, 11, v2
    s_nop 1
    v_cndmask_b32 v119, v3, v1, vcc
    s_nop 1
    buffer_load_dwordx4 v[16:19], v152, s[8:11], s16 offen offset:0
    buffer_load_dwordx4 v[20:23], v152, s[8:11], s16 offen offset:128
    s_waitcnt vmcnt(0)
    buffer_load_dwordx4 v[24:27], v152, s[8:11], s16 offen offset:256
    buffer_load_dwordx4 v[28:31], v152, s[8:11], s16 offen offset:384
    v_mfma_f32_32x32x16_bf16 v[48:63], v[16:19], v[112:115], 0
    v_mfma_f32_32x32x16_bf16 v[48:63], v[20:23], v[116:119], v[48:63]
    s_nop 15
    v_cvt_pk_bf16_f32 v120, v48, v49
    v_cvt_pk_bf16_f32 v121, v50, v51
    v_cvt_pk_bf16_f32 v122, v52, v53
    v_cvt_pk_bf16_f32 v123, v54, v55
    buffer_store_dwordx4 v[120:123], v6, s[12:15], s28 offen sc1
    v_cvt_pk_bf16_f32 v124, v56, v57
    v_cvt_pk_bf16_f32 v125, v58, v59
    v_cvt_pk_bf16_f32 v126, v60, v61
    v_cvt_pk_bf16_f32 v127, v62, v63
    buffer_store_dwordx4 v[124:127], v7, s[12:15], s28 offen sc1
    s_waitcnt vmcnt(2)
    buffer_load_dwordx4 v[32:35], v152, s[8:11], s16 offen offset:512
    buffer_load_dwordx4 v[36:39], v152, s[8:11], s16 offen offset:640
    v_mfma_f32_32x32x16_bf16 v[64:79], v[24:27], v[112:115], 0
    v_mfma_f32_32x32x16_bf16 v[64:79], v[28:31], v[116:119], v[64:79]
    s_nop 15
    v_cvt_pk_bf16_f32 v128, v64, v65
    v_cvt_pk_bf16_f32 v129, v66, v67
    v_cvt_pk_bf16_f32 v130, v68, v69
    v_cvt_pk_bf16_f32 v131, v70, v71
    buffer_store_dwordx4 v[128:131], v8, s[12:15], s28 offen sc1
    v_cvt_pk_bf16_f32 v132, v72, v73
    v_cvt_pk_bf16_f32 v133, v74, v75
    v_cvt_pk_bf16_f32 v134, v76, v77
    v_cvt_pk_bf16_f32 v135, v78, v79
    buffer_store_dwordx4 v[132:135], v9, s[12:15], s28 offen sc1
    s_waitcnt vmcnt(2)
    buffer_load_dwordx4 v[40:43], v152, s[8:11], s16 offen offset:768
    buffer_load_dwordx4 v[44:47], v152, s[8:11], s16 offen offset:896
    v_mfma_f32_32x32x16_bf16 v[80:95], v[32:35], v[112:115], 0
    v_mfma_f32_32x32x16_bf16 v[80:95], v[36:39], v[116:119], v[80:95]
    s_nop 15
    v_cvt_pk_bf16_f32 v136, v80, v81
    v_cvt_pk_bf16_f32 v137, v82, v83
    v_cvt_pk_bf16_f32 v138, v84, v85
    v_cvt_pk_bf16_f32 v139, v86, v87
    buffer_store_dwordx4 v[136:139], v10, s[12:15], s29 offen sc1
    v_cvt_pk_bf16_f32 v140, v88, v89
    v_cvt_pk_bf16_f32 v141, v90, v91
    v_cvt_pk_bf16_f32 v142, v92, v93
    v_cvt_pk_bf16_f32 v143, v94, v95
    buffer_store_dwordx4 v[140:143], v11, s[12:15], s29 offen sc1
    s_waitcnt vmcnt(2)
    v_mfma_f32_32x32x16_bf16 v[96:111], v[40:43], v[112:115], 0
    v_mfma_f32_32x32x16_bf16 v[96:111], v[44:47], v[116:119], v[96:111]
    s_nop 15
    v_cvt_pk_bf16_f32 v144, v96, v97
    v_cvt_pk_bf16_f32 v145, v98, v99
    v_cvt_pk_bf16_f32 v146, v100, v101
    v_cvt_pk_bf16_f32 v147, v102, v103
    buffer_store_dwordx4 v[144:147], v12, s[12:15], s29 offen sc1
    v_cvt_pk_bf16_f32 v148, v104, v105
    v_cvt_pk_bf16_f32 v149, v106, v107
    v_cvt_pk_bf16_f32 v150, v108, v109
    v_cvt_pk_bf16_f32 v151, v110, v111
    buffer_store_dwordx4 v[148:151], v13, s[12:15], s29 offen sc1
    s_branch K2_DONE

.globl k2b_kernel
.p2align 8
.type k2b_kernel,@function
k2b_kernel:
    s_mov_b32 s50, 67108864
    s_cmp_ge_u32 s2, 128
    s_cbranch_scc1 BODY_k2_kernel
BODY2_k2_kernel:
    s_load_dwordx2 s[4:5], s[0:1], 64
    s_getpc_b64 s[60:61]
PF_k2b_kernel_1:
    v_lshlrev_b32 v2, 7, v0
    v_min_u32 v2, END_k2_kernel-PF_k2b_kernel_1-4, v2
    v_mov_b32 v3, 0
    v_lshl_add_u64 v[2:3], v[2:3], 0, s[60:61]
    global_load_dword v251, v[2:3], off
    s_mov_b32 s51, s2
    v_lshrrev_b32 v1, 6, v0
    v_and_b32 v5, 63, v0
    v_readfirstlane_b32 s24, v1
    v_lshlrev_b32 v4, 4, v5
    v_and_b32 v6, 31, v5
    v_lshrrev_b32 v7, 5, v5
    v_lshrrev_b32 v8, 3, v5
    v_and_b32 v3, 7, v5
    v_mul_u32_u24 v1, 16384, v8
    v_lshl_add_u32 v1, v3, 4, v1
    v_lshlrev_b32 v9, 4, v6
    v_lshl_add_u32 v9, v7, 12, v9
    s_lshr_b32 s25, s24, 1
    s_and_b32 s26, s24, 1
    s_and_b32 s20, s24, 3
    s_lshr_b32 s44, s24, 2
    s_lshl1_add_u32 s20, s20, s44
    s_mul_i32 s16, s20, 262144
    s_lshl_b32 s17, s51, 7
    s_add_u32 s16, s16, s17
    s_add_u32 s16, s16, 36700160
    s_add_u32 s16, s16, s50
    s_lshl_b32 s17, s20, 11
    s_lshl_b32 s29, s20, 9
    s_add_u32 s29, s29, 63963136
    s_add_u32 s17, s17, 65536
    s_add_u32 s29, s29, s50
    s_lshl_b32 s20, s44, 5
    s_and_b32 s21, s24, 3
    s_lshl_b32 s22, s21, 11
    s_lshl4_add_u32 s22, s20, s22
    s_cmp_eq_u32 s44, 0
    s_cselect_b32 s21, 0x3c800000, 0.5
    s_cselect_b32 s27, 0, 0xba000000
    s_and_b32 s45, s25, 1
    s_cselect_b32 s20, 0, s20
    s_cselect_b32 s21, s21, 0
    s_cselect_b32 s27, s27, 0
    s_lshl_b32 s23, s26, 4
    v_lshl_add_u32 v14, v7, 9, v4
    v_add_u32 v12, s22, v14
    v_lshlrev_b32 v10, s45, v6
    v_add_u32 v10, s20, v10
    v_lshl_add_u32 v11, v7, 2, s23
    v_cvt_f32_u32 v10, v10
    v_cvt_f32_u32 v11, v11
    v_mul_f32 v10, 0x3c800000, v10
    v_mul_f32 v13, s21, v10
    v_add_f32 v10, s27, v10
    v_fmac_f32 v13, v10, v11
    v_mul_f32 v67, 0x41000000, v10
    v_cos_f32 v48, v13
    v_sin_f32 v56, v13
    v_cos_f32 v64, v10
    v_sin_f32 v65, v10
    v_cos_f32 v66, v67
    v_mul_f32 v49, v48, v64
    v_mul_f32 v57, v56, v64
    v_fma_f32 v49, -v56, v65, v49
    v_fmac_f32 v57, v48, v65
    v_sin_f32 v67, v67
    v_mul_f32 v50, v49, v64
    v_mul_f32 v58, v57, v64
    v_fma_f32 v50, -v57, v65, v50
    v_fmac_f32 v58, v49, v65
    v_mul_f32 v51, v50, v64
    v_mul_f32 v59, v58, v64
    v_fma_f32 v51, -v58, v65, v51
    v_fmac_f32 v59, v50, v65
    v_pk_mul_f32 v[52:53], v[48:49], v[66:67] op_sel:[0,0] op_sel_hi:[1,0]
    v_pk_mul_f32 v[60:61], v[56:57], v[66:67] op_sel:[0,0] op_sel_hi:[1,0]
    v_pk_mul_f32 v[54:55], v[50:51], v[66:67] op_sel:[0,0] op_sel_hi:[1,0]
    v_pk_mul_f32 v[62:63], v[58:59], v[66:67] op_sel:[0,0] op_sel_hi:[1,0]
    v_pk_fma_f32 v[52:53], v[56:57], v[66:67], v[52:53] op_sel:[0,1,0] op_sel_hi:[1,1,1] neg_lo:[1,0,0] neg_hi:[1,0,0]
    v_pk_fma_f32 v[60:61], v[48:49], v[66:67], v[60:61] op_sel:[0,1,0] op_sel_hi:[1,1,1]
    v_pk_fma_f32 v[54:55], v[58:59], v[66:67], v[54:55] op_sel:[0,1,0] op_sel_hi:[1,1,1] neg_lo:[1,0,0] neg_hi:[1,0,0]
    v_pk_fma_f32 v[62:63], v[50:51], v[66:67], v[62:63] op_sel:[0,1,0] op_sel_hi:[1,1,1]
    v_cvt_pk_bf16_f32 v64, v48, v49
    v_cvt_pk_bf16_f32 v65, v50, v51
    v_cvt_pk_bf16_f32 v66, v52, v53
    v_cvt_pk_bf16_f32 v67, v54, v55
    v_cvt_pk_bf16_f32 v68, v56, v57
    v_cvt_pk_bf16_f32 v69, v58, v59
    v_cvt_pk_bf16_f32 v70, v60, v61
    v_cvt_pk_bf16_f32 v71, v62, v63
    v_cvt_pk_bf16_f32 v72, -v56, -v57
    v_cvt_pk_bf16_f32 v73, -v58, -v59
    v_cvt_pk_bf16_f32 v74, -v60, -v61
    v_cvt_pk_bf16_f32 v75, -v62, -v63
    ds_write_b128 v12, v[64:67] offset:0
    ds_write_b128 v12, v[68:71] offset:8192
    ds_write_b128 v12, v[72:75] offset:16384
    v_lshlrev_b32 v15, 5, v6
    s_cmp_eq_u32 s26, 0
    v_lshl_add_u32 v15, v7, 10, v15
    s_cselect_b64 vcc, -1, 0
    v_add_u32 v161, 4096, v14
    v_add_u32 v14, s23, v15
    v_cndmask_b32 v161, v161, v15, vcc
    s_waitcnt lgkmcnt(0)
    s_mov_b32 s12, s4
    s_mov_b32 s13, s5
    s_mov_b32 s14, 268435456
    s_mov_b32 s15, 0x00020000
    buffer_load_dwordx4 v[112:115], v9, s[12:15], s29 offen
    s_barrier
    s_add_u32 s18, s16, 2097152
    s_add_u32 s19, s16, 131072
    s_add_u32 s31, s16, 2228224
    buffer_load_dwordx4 v[96:99], v1, s[12:15], s16 offen
    ds_read_b128 v[48:51], v14 offset:0
    ds_read_b128 v[52:55], v14 offset:8192
    ds_read_b128 v[56:59], v14 offset:16384
    ds_read_b128 v[60:63], v14 offset:2048
    ds_read_b128 v[64:67], v14 offset:10240
    ds_read_b128 v[68:71], v14 offset:18432
    ds_read_b128 v[224:227], v15 offset:0
    ds_read_b128 v[228:231], v15 offset:2048
    ds_read_b128 v[232:235], v15 offset:8192
    ds_read_b128 v[236:239], v15 offset:10240
    ds_read_b128 v[240:243], v15 offset:16384
    ds_read_b128 v[244:247], v15 offset:18432
    v_lshrrev_b32 v9, 4, v5
    s_lshl_b32 s22, s24, 10
    v_xor_b32 v12, v3, v9
    s_add_u32 s22, s22, 24576
    v_lshlrev_b32 v12, 4, v12
    v_add_u32 v10, s22, v4
    buffer_load_dwordx4 v[100:103], v1, s[12:15], s18 offen
    v_lshl_add_u32 v12, v8, 7, v12
    v_lshl_add_u32 v11, v8, 5, s22
    v_add_u32 v12, s17, v12
    v_mov_b32 v2, 0x4227c5ac
    v_xor_b32 v15, 64, v12
    s_mov_b32 s30, 0x80008000
    buffer_load_dwordx4 v[104:107], v1, s[12:15], s19 offen
    s_lshl_b32 s23, s25, 13
    s_lshl_b32 s20, s26, 11
    s_add_u32 s23, s23, s20
    v_lshl_add_u32 v13, v6, 1, s26
    v_lshlrev_b32 v162, 2, v7
    v_cvt_f32_u32 v13, v13
    buffer_load_dwordx4 v[108:111], v1, s[12:15], s31 offen
    v_cvt_f32_u32 v162, v162
    v_mul_f32 v13, 0x3a000000, v13
    v_mul_f32 v162, v13, v162
    v_mul_f32 v171, 0x41000000, v13
    v_cos_f32 v128, v162
    v_sin_f32 v144, v162
    v_cos_f32 v168, v13
    v_sin_f32 v169, v13
    v_cos_f32 v170, v171
    v_mul_f32 v129, v128, v168
    v_mul_f32 v145, v144, v168
    v_fma_f32 v129, -v144, v169, v129
    v_fmac_f32 v145, v128, v169
    v_sin_f32 v171, v171
    v_mul_f32 v130, v129, v168
    v_mul_f32 v146, v145, v168
    v_fma_f32 v130, -v145, v169, v130
    v_fmac_f32 v146, v129, v169
    v_mul_f32 v131, v130, v168
    v_mul_f32 v147, v146, v168
    v_fma_f32 v131, -v146, v169, v131
    v_fmac_f32 v147, v130, v169
    s_lshr_b32 s28, s51, 5
    s_lshl2_add_u32 s28, s28, s25
    s_lshl_b32 s28, s28, 5
    s_and_b32 s20, s51, 31
    s_add_u32 s28, s28, s20
    s_sub_u32 s28, s28, 1
    s_and_b32 s28, s28, 511
    s_lshl_b32 s28, s28, 7
    s_mul_i32 s20, s26, 65536
    s_add_u32 s28, s28, s20
    s_add_u32 s28, s28, 58720256
    s_lshl_b32 s21, s24, 12
    s_add_u32 s21, s21, 98304
    v_mul_u32_u24 v160, 131072, v6
    v_lshl_add_u32 v160, v7, 6, v160
    s_waitcnt vmcnt(4)
    v_fmamk_f32 v112, v112, 0x45800000, v2
    v_fmamk_f32 v113, v113, 0x45800000, v2
    v_fmamk_f32 v114, v114, 0x45800000, v2
    v_fmamk_f32 v115, v115, 0x45800000, v2
    v_rsq_f32 v112, v112
    v_rsq_f32 v113, v113
    v_rsq_f32 v114, v114
    v_rsq_f32 v115, v115
    v_bfe_u32 v1, v5, 1, 3
    ds_write_b128 v10, v[112:115]
    ds_read_b128 v[192:195], v11 offset:0
    ds_read_b128 v[196:199], v11 offset:16
    ds_read_b128 v[200:203], v11 offset:512
    ds_read_b128 v[204:207], v11 offset:528
    ds_read_b128 v[208:211], v11 offset:256
    ds_read_b128 v[212:215], v11 offset:272
    ds_read_b128 v[216:219], v11 offset:768
    ds_read_b128 v[220:223], v11 offset:784
    s_lshl_b32 s20, s25, 1
    v_xor_b32 v2, s20, v1
    s_lshl_b32 s20, s26, 14
    s_add_u32 s20, s20, 65536
    v_lshl_add_u32 v2, v2, 4, s20
    v_lshl_add_u32 v6, v7, 1, v9
    v_lshl_add_u32 v2, v5, 7, v2
    v_mov_b32 v7, v161
    v_xor_b32 v14, 16, v2
    v_pk_mul_f32 v[132:133], v[128:129], v[170:171] op_sel:[0,0] op_sel_hi:[1,0]
    v_pk_mul_f32 v[148:149], v[144:145], v[170:171] op_sel:[0,0] op_sel_hi:[1,0]
    v_pk_mul_f32 v[134:135], v[130:131], v[170:171] op_sel:[0,0] op_sel_hi:[1,0]
    v_pk_mul_f32 v[150:151], v[146:147], v[170:171] op_sel:[0,0] op_sel_hi:[1,0]
    v_pk_fma_f32 v[132:133], v[144:145], v[170:171], v[132:133] op_sel:[0,1,0] op_sel_hi:[1,1,1] neg_lo:[1,0,0] neg_hi:[1,0,0]
    v_pk_fma_f32 v[148:149], v[128:129], v[170:171], v[148:149] op_sel:[0,1,0] op_sel_hi:[1,1,1]
    v_pk_fma_f32 v[134:135], v[146:147], v[170:171], v[134:135] op_sel:[0,1,0] op_sel_hi:[1,1,1] neg_lo:[1,0,0] neg_hi:[1,0,0]
    v_pk_fma_f32 v[150:151], v[130:131], v[170:171], v[150:151] op_sel:[0,1,0] op_sel_hi:[1,1,1]
    v_pk_mul_f32 v[136:137], v[132:133], v[170:171] op_sel:[0,0] op_sel_hi:[1,0]
    v_pk_mul_f32 v[152:153], v[148:149], v[170:171] op_sel:[0,0] op_sel_hi:[1,0]
    v_pk_mul_f32 v[138:139], v[134:135], v[170:171] op_sel:[0,0] op_sel_hi:[1,0]
    v_pk_mul_f32 v[154:155], v[150:151], v[170:171] op_sel:[0,0] op_sel_hi:[1,0]
    v_pk_fma_f32 v[136:137], v[148:149], v[170:171], v[136:137] op_sel:[0,1,0] op_sel_hi:[1,1,1] neg_lo:[1,0,0] neg_hi:[1,0,0]
    v_pk_fma_f32 v[152:153], v[132:133], v[170:171], v[152:153] op_sel:[0,1,0] op_sel_hi:[1,1,1]
    v_pk_fma_f32 v[138:139], v[150:151], v[170:171], v[138:139] op_sel:[0,1,0] op_sel_hi:[1,1,1] neg_lo:[1,0,0] neg_hi:[1,0,0]
    v_pk_fma_f32 v[154:155], v[134:135], v[170:171], v[154:155] op_sel:[0,1,0] op_sel_hi:[1,1,1]
    v_pk_mul_f32 v[140:141], v[136:137], v[170:171] op_sel:[0,0] op_sel_hi:[1,0]
    v_pk_mul_f32 v[156:157], v[152:153], v[170:171] op_sel:[0,0] op_sel_hi:[1,0]
    v_pk_mul_f32 v[142:143], v[138:139], v[170:171] op_sel:[0,0] op_sel_hi:[1,0]
    v_pk_mul_f32 v[158:159], v[154:155], v[170:171] op_sel:[0,0] op_sel_hi:[1,0]
    v_pk_fma_f32 v[140:141], v[152:153], v[170:171], v[140:141] op_sel:[0,1,0] op_sel_hi:[1,1,1] neg_lo:[1,0,0] neg_hi:[1,0,0]
    v_pk_fma_f32 v[156:157], v[136:137], v[170:171], v[156:157] op_sel:[0,1,0] op_sel_hi:[1,1,1]
    v_pk_fma_f32 v[142:143], v[154:155], v[170:171], v[142:143] op_sel:[0,1,0] op_sel_hi:[1,1,1] neg_lo:[1,0,0] neg_hi:[1,0,0]
    v_pk_fma_f32 v[158:159], v[138:139], v[170:171], v[158:159] op_sel:[0,1,0] op_sel_hi:[1,1,1]
    v_and_b32 v8, 13, v5
    v_and_b32 v1, 1, v1
    v_lshl_add_u32 v6, v6, 5, v8
    v_mul_u32_u24 v6, 16384, v6
    v_lshl_add_u32 v6, v1, 5, v6
    s_lshl2_add_u32 s40, s44, s26
    s_lshl3_add_u32 s16, s40, s45
    s_mul_i32 s16, s16, 32768
    s_lshl_b32 s20, s51, 7
    s_add_u32 s16, s16, s20
    s_add_u32 s16, s16, 36700160
    s_add_u32 s16, s16, s50
    s_waitcnt vmcnt(3) lgkmcnt(6)
    v_lshlrev_b32 v16, 16, v96
    v_and_b32 v17, 0xffff0000, v96
    v_lshlrev_b32 v18, 16, v97
    v_and_b32 v19, 0xffff0000, v97
    v_lshlrev_b32 v20, 16, v98
    v_and_b32 v21, 0xffff0000, v98
    v_lshlrev_b32 v22, 16, v99
    v_and_b32 v23, 0xffff0000, v99
    v_pk_mul_f32 v[16:17], v[16:17], v[192:193]
    v_pk_mul_f32 v[18:19], v[18:19], v[194:195]
    v_pk_mul_f32 v[20:21], v[20:21], v[196:197]
    v_pk_mul_f32 v[22:23], v[22:23], v[198:199]
    s_waitcnt vmcnt(2) lgkmcnt(4)
    v_lshlrev_b32 v24, 16, v100
    v_and_b32 v25, 0xffff0000, v100
    v_lshlrev_b32 v26, 16, v101
    v_and_b32 v27, 0xffff0000, v101
    v_lshlrev_b32 v28, 16, v102
    v_and_b32 v29, 0xffff0000, v102
    v_lshlrev_b32 v30, 16, v103
    v_and_b32 v31, 0xffff0000, v103
    v_pk_fma_f32 v[32:33], v[24:25], v[200:201], v[16:17]
    v_pk_fma_f32 v[34:35], v[26:27], v[202:203], v[18:19]
    v_pk_fma_f32 v[36:37], v[28:29], v[204:205], v[20:21]
    v_pk_fma_f32 v[38:39], v[30:31], v[206:207], v[22:23]
    v_cvt_pk_bf16_f32 v40, v32, v33
    v_cvt_pk_bf16_f32 v41, v34, v35
    v_cvt_pk_bf16_f32 v42, v36, v37
    v_cvt_pk_bf16_f32 v43, v38, v39
    ds_write_b128 v12, v[40:43] offset:0
    v_pk_fma_f32 v[16:17], v[24:25], v[200:201], v[16:17] neg_lo:[1,0,0] neg_hi:[1,0,0]
    v_pk_fma_f32 v[18:19], v[26:27], v[202:203], v[18:19] neg_lo:[1,0,0] neg_hi:[1,0,0]
    v_pk_fma_f32 v[20:21], v[28:29], v[204:205], v[20:21] neg_lo:[1,0,0] neg_hi:[1,0,0]
    v_pk_fma_f32 v[22:23], v[30:31], v[206:207], v[22:23] neg_lo:[1,0,0] neg_hi:[1,0,0]
    v_cvt_pk_bf16_f32 v44, v16, v17
    v_cvt_pk_bf16_f32 v45, v18, v19
    v_cvt_pk_bf16_f32 v46, v20, v21
    v_cvt_pk_bf16_f32 v47, v22, v23
    ds_write_b128 v12, v[44:47] offset:16384
    s_waitcnt vmcnt(1) lgkmcnt(4)
    v_lshlrev_b32 v16, 16, v104
    v_and_b32 v17, 0xffff0000, v104
    v_lshlrev_b32 v18, 16, v105
    v_and_b32 v19, 0xffff0000, v105
    v_lshlrev_b32 v20, 16, v106
    v_and_b32 v21, 0xffff0000, v106
    v_lshlrev_b32 v22, 16, v107
    v_and_b32 v23, 0xffff0000, v107
    v_pk_mul_f32 v[16:17], v[16:17], v[208:209]
    v_pk_mul_f32 v[18:19], v[18:19], v[210:211]
    v_pk_mul_f32 v[20:21], v[20:21], v[212:213]
    v_pk_mul_f32 v[22:23], v[22:23], v[214:215]
    s_waitcnt vmcnt(0) lgkmcnt(2)
    v_lshlrev_b32 v24, 16, v108
    v_and_b32 v25, 0xffff0000, v108
    v_lshlrev_b32 v26, 16, v109
    v_and_b32 v27, 0xffff0000, v109
    v_lshlrev_b32 v28, 16, v110
    v_and_b32 v29, 0xffff0000, v110
    v_lshlrev_b32 v30, 16, v111
    v_and_b32 v31, 0xffff0000, v111
    v_pk_fma_f32 v[32:33], v[24:25], v[216:217], v[16:17]
    v_pk_fma_f32 v[34:35], v[26:27], v[218:219], v[18:19]
    v_pk_fma_f32 v[36:37], v[28:29], v[220:221], v[20:21]
    v_pk_fma_f32 v[38:39], v[30:31], v[222:223], v[22:23]
    v_cvt_pk_bf16_f32 v72, v32, v33
    v_cvt_pk_bf16_f32 v73, v34, v35
    v_cvt_pk_bf16_f32 v74, v36, v37
    v_cvt_pk_bf16_f32 v75, v38, v39
    ds_write_b128 v15, v[72:75] offset:1024
    v_pk_fma_f32 v[16:17], v[24:25], v[216:217], v[16:17] neg_lo:[1,0,0] neg_hi:[1,0,0]
    v_pk_fma_f32 v[18:19], v[26:27], v[218:219], v[18:19] neg_lo:[1,0,0] neg_hi:[1,0,0]
    v_pk_fma_f32 v[20:21], v[28:29], v[220:221], v[20:21] neg_lo:[1,0,0] neg_hi:[1,0,0]
    v_pk_fma_f32 v[22:23], v[30:31], v[222:223], v[22:23] neg_lo:[1,0,0] neg_hi:[1,0,0]
    v_cvt_pk_bf16_f32 v76, v16, v17
    v_cvt_pk_bf16_f32 v77, v18, v19
    v_cvt_pk_bf16_f32 v78, v20, v21
    v_cvt_pk_bf16_f32 v79, v22, v23
    ds_write_b128 v15, v[76:79] offset:17408
    buffer_load_dwordx4 v[176:179], v160, s[12:15], s28 offen offset:0
    buffer_load_dwordx4 v[180:183], v160, s[12:15], s28 offen offset:16
    buffer_load_dwordx4 v[184:187], v160, s[12:15], s28 offen offset:32
    buffer_load_dwordx4 v[188:191], v160, s[12:15], s28 offen offset:48
    s_waitcnt lgkmcnt(0)
    s_barrier
    ds_read_b128 v[16:19], v2 offset:0
    ds_read_b128 v[20:23], v14 offset:0
    ds_read_b128 v[24:27], v2 offset:8192
    ds_read_b128 v[28:31], v14 offset:8192
    s_setprio 2
    s_waitcnt lgkmcnt(3)
    v_mfma_f32_32x32x16_bf16 v[96:111], v[16:19], v[48:51], 0
    v_lshlrev_b32 v10, 9, v9
    v_mul_u32_u24 v1, 8224, v1
    v_lshl_add_u32 v10, v8, 4, v10
    v_bfe_u32 v162, v5, 2, 1
    v_add_u32 v10, v10, v1
    v_bfe_u32 v1, v5, 3, 1
    v_mfma_f32_32x32x16_bf16 v[112:127], v[16:19], v[56:59], 0
    v_and_b32 v8, 3, v5
    v_mul_u32_u24 v3, 524288, v1
    v_lshl_add_u32 v11, v1, 2, v8
    v_lshl_add_u32 v3, v162, 8, v3
    v_lshl_add_u32 v11, v162, 3, v11
    s_lshl_b32 s20, s44, 8
    s_waitcnt lgkmcnt(2)
    v_mfma_f32_32x32x16_bf16 v[96:111], v[20:23], v[52:55], v[96:111]
    v_lshl_add_u32 v161, v11, 4, s20
    v_lshl_add_u32 v11, v9, 10, v161
    v_add_u32 v12, v11, v161
    v_mfma_f32_32x32x16_bf16 v[112:127], v[20:23], v[48:51], v[112:127]
    s_waitcnt lgkmcnt(1)
    v_mfma_f32_32x32x16_bf16 v[96:111], v[24:27], v[60:63], v[96:111]
    v_mfma_f32_32x32x16_bf16 v[112:127], v[24:27], v[68:71], v[112:127]
    s_waitcnt lgkmcnt(0)
    v_mfma_f32_32x32x16_bf16 v[96:111], v[28:31], v[64:67], v[96:111]
    v_mfma_f32_32x32x16_bf16 v[112:127], v[28:31], v[60:63], v[112:127]
    s_setprio 0
    s_nop 10
    v_pk_mul_f32 v[16:17], v[112:113], v[144:145]
    v_pk_mul_f32 v[18:19], v[114:115], v[146:147]
    v_pk_mul_f32 v[20:21], v[116:117], v[148:149]
    v_pk_mul_f32 v[22:23], v[118:119], v[150:151]
    v_pk_mul_f32 v[112:113], v[112:113], v[128:129]
    v_pk_mul_f32 v[114:115], v[114:115], v[130:131]
    v_pk_mul_f32 v[116:117], v[116:117], v[132:133]
    v_pk_mul_f32 v[118:119], v[118:119], v[134:135]
    v_pk_fma_f32 v[112:113], v[96:97], v[144:145], v[112:113] neg_lo:[1,0,0] neg_hi:[1,0,0]
    v_pk_fma_f32 v[114:115], v[98:99], v[146:147], v[114:115] neg_lo:[1,0,0] neg_hi:[1,0,0]
    v_pk_fma_f32 v[116:117], v[100:101], v[148:149], v[116:117] neg_lo:[1,0,0] neg_hi:[1,0,0]
    v_pk_fma_f32 v[118:119], v[102:103], v[150:151], v[118:119] neg_lo:[1,0,0] neg_hi:[1,0,0]
    v_pk_fma_f32 v[96:97], v[96:97], v[128:129], v[16:17]
    v_pk_fma_f32 v[98:99], v[98:99], v[130:131], v[18:19]
    v_pk_fma_f32 v[100:101], v[100:101], v[132:133], v[20:21]
    v_pk_fma_f32 v[102:103], v[102:103], v[134:135], v[22:23]
    v_pk_mul_f32 v[16:17], v[120:121], v[152:153]
    v_pk_mul_f32 v[18:19], v[122:123], v[154:155]
    v_pk_mul_f32 v[20:21], v[124:125], v[156:157]
    v_pk_mul_f32 v[22:23], v[126:127], v[158:159]
    v_pk_mul_f32 v[120:121], v[120:121], v[136:137]
    v_pk_mul_f32 v[122:123], v[122:123], v[138:139]
    v_pk_mul_f32 v[124:125], v[124:125], v[140:141]
    v_pk_mul_f32 v[126:127], v[126:127], v[142:143]
    v_pk_fma_f32 v[120:121], v[104:105], v[152:153], v[120:121] neg_lo:[1,0,0] neg_hi:[1,0,0]
    v_pk_fma_f32 v[122:123], v[106:107], v[154:155], v[122:123] neg_lo:[1,0,0] neg_hi:[1,0,0]
    v_pk_fma_f32 v[124:125], v[108:109], v[156:157], v[124:125] neg_lo:[1,0,0] neg_hi:[1,0,0]
    v_pk_fma_f32 v[126:127], v[110:111], v[158:159], v[126:127] neg_lo:[1,0,0] neg_hi:[1,0,0]
    v_pk_fma_f32 v[104:105], v[104:105], v[136:137], v[16:17]
    v_pk_fma_f32 v[106:107], v[106:107], v[138:139], v[18:19]
    v_pk_fma_f32 v[108:109], v[108:109], v[140:141], v[20:21]
    v_pk_fma_f32 v[110:111], v[110:111], v[142:143], v[22:23]
    v_cvt_pk_bf16_f32 v160, v96, v97
    v_cvt_pk_bf16_f32 v161, v98, v99
    v_cvt_pk_bf16_f32 v162, v100, v101
    v_cvt_pk_bf16_f32 v163, v102, v103
    v_cvt_pk_bf16_f32 v168, v112, v113
    v_cvt_pk_bf16_f32 v169, v114, v115
    v_cvt_pk_bf16_f32 v170, v116, v117
    v_cvt_pk_bf16_f32 v171, v118, v119
    v_cvt_pk_bf16_f32 v164, v104, v105
    v_cvt_pk_bf16_f32 v165, v106, v107
    v_cvt_pk_bf16_f32 v166, v108, v109
    v_cvt_pk_bf16_f32 v167, v110, v111
    v_cvt_pk_bf16_f32 v172, v120, v121
    v_cvt_pk_bf16_f32 v173, v122, v123
    v_cvt_pk_bf16_f32 v174, v124, v125
    v_cvt_pk_bf16_f32 v175, v126, v127
    s_setprio 2
    v_mfma_f32_32x32x16_bf16 v[96:111], v[224:227], v[160:163], 0
    ds_read_b128 v[48:51], v7 offset:0
    s_waitcnt vmcnt(3)
    v_lshlrev_b32 v192, 16, v176
    v_and_b32 v193, 0xffff0000, v176
    v_lshlrev_b32 v194, 16, v177
    v_and_b32 v195, 0xffff0000, v177
    v_mfma_f32_32x32x16_bf16 v[112:127], v[240:243], v[160:163], 0
    ds_read_b128 v[52:55], v7 offset:2048
    v_lshlrev_b32 v196, 16, v178
    v_and_b32 v197, 0xffff0000, v178
    v_lshlrev_b32 v198, 16, v179
    v_and_b32 v199, 0xffff0000, v179
    v_mfma_f32_32x32x16_bf16 v[96:111], v[232:235], v[168:171], v[96:111]
    ds_read_b128 v[56:59], v7 offset:8192
    s_waitcnt vmcnt(2)
    v_lshlrev_b32 v200, 16, v180
    v_and_b32 v201, 0xffff0000, v180
    v_lshlrev_b32 v202, 16, v181
    v_and_b32 v203, 0xffff0000, v181
    v_mfma_f32_32x32x16_bf16 v[112:127], v[224:227], v[168:171], v[112:127]
    ds_read_b128 v[60:63], v7 offset:10240
    v_lshlrev_b32 v204, 16, v182
    v_and_b32 v205, 0xffff0000, v182
    v_lshlrev_b32 v206, 16, v183
    v_and_b32 v207, 0xffff0000, v183
    v_mfma_f32_32x32x16_bf16 v[96:111], v[228:231], v[164:167], v[96:111]
    ds_read_b128 v[64:67], v7 offset:16384
    s_waitcnt vmcnt(1)
    v_lshlrev_b32 v208, 16, v184
    v_and_b32 v209, 0xffff0000, v184
    v_lshlrev_b32 v210, 16, v185
    v_and_b32 v211, 0xffff0000, v185
    v_mfma_f32_32x32x16_bf16 v[112:127], v[244:247], v[164:167], v[112:127]
    ds_read_b128 v[68:71], v7 offset:18432
    v_lshlrev_b32 v212, 16, v186
    v_and_b32 v213, 0xffff0000, v186
    v_lshlrev_b32 v214, 16, v187
    v_and_b32 v215, 0xffff0000, v187
    v_mfma_f32_32x32x16_bf16 v[96:111], v[236:239], v[172:175], v[96:111]
    s_waitcnt vmcnt(0)
    v_lshlrev_b32 v216, 16, v188
    v_and_b32 v217, 0xffff0000, v188
    v_lshlrev_b32 v218, 16, v189
    v_and_b32 v219, 0xffff0000, v189
    v_mfma_f32_32x32x16_bf16 v[112:127], v[228:231], v[172:175], v[112:127]
    v_lshlrev_b32 v220, 16, v190
    v_and_b32 v221, 0xffff0000, v190
    v_lshlrev_b32 v222, 16, v191
    v_and_b32 v223, 0xffff0000, v191
    buffer_load_dwordx4 v[80:83], v6, s[12:15], s16 offen offset:0
    buffer_load_dwordx4 v[84:87], v6, s[12:15], s16 offen offset:16
    buffer_load_dwordx4 v[88:91], v6, s[12:15], s16 offen offset:64
    buffer_load_dwordx4 v[92:95], v6, s[12:15], s16 offen offset:80
    s_setprio 1
    s_nop 2
    v_pk_mul_f32 v[16:17], v[112:113], v[208:209]
    v_pk_mul_f32 v[18:19], v[114:115], v[210:211]
    v_pk_mul_f32 v[20:21], v[116:117], v[212:213]
    v_pk_mul_f32 v[22:23], v[118:119], v[214:215]
    v_pk_mul_f32 v[112:113], v[112:113], v[192:193]
    v_pk_mul_f32 v[114:115], v[114:115], v[194:195]
    v_pk_mul_f32 v[116:117], v[116:117], v[196:197]
    v_pk_mul_f32 v[118:119], v[118:119], v[198:199]
    v_pk_fma_f32 v[112:113], v[96:97], v[208:209], v[112:113]
    v_pk_fma_f32 v[114:115], v[98:99], v[210:211], v[114:115]
    v_pk_fma_f32 v[116:117], v[100:101], v[212:213], v[116:117]
    v_pk_fma_f32 v[118:119], v[102:103], v[214:215], v[118:119]
    v_pk_fma_f32 v[96:97], v[96:97], v[192:193], v[16:17] neg_lo:[0,0,1] neg_hi:[0,0,1]
    v_pk_fma_f32 v[98:99], v[98:99], v[194:195], v[18:19] neg_lo:[0,0,1] neg_hi:[0,0,1]
    v_pk_fma_f32 v[100:101], v[100:101], v[196:197], v[20:21] neg_lo:[0,0,1] neg_hi:[0,0,1]
    v_pk_fma_f32 v[102:103], v[102:103], v[198:199], v[22:23] neg_lo:[0,0,1] neg_hi:[0,0,1]
    v_pk_mul_f32 v[16:17], v[120:121], v[216:217]
    v_pk_mul_f32 v[18:19], v[122:123], v[218:219]
    v_pk_mul_f32 v[20:21], v[124:125], v[220:221]
    v_pk_mul_f32 v[22:23], v[126:127], v[222:223]
    v_pk_mul_f32 v[120:121], v[120:121], v[200:201]
    v_pk_mul_f32 v[122:123], v[122:123], v[202:203]
    v_pk_mul_f32 v[124:125], v[124:125], v[204:205]
    v_pk_mul_f32 v[126:127], v[126:127], v[206:207]
    v_pk_fma_f32 v[120:121], v[104:105], v[216:217], v[120:121]
    v_pk_fma_f32 v[122:123], v[106:107], v[218:219], v[122:123]
    v_pk_fma_f32 v[124:125], v[108:109], v[220:221], v[124:125]
    v_pk_fma_f32 v[126:127], v[110:111], v[222:223], v[126:127]
    v_pk_fma_f32 v[104:105], v[104:105], v[200:201], v[16:17] neg_lo:[0,0,1] neg_hi:[0,0,1]
    v_pk_fma_f32 v[106:107], v[106:107], v[202:203], v[18:19] neg_lo:[0,0,1] neg_hi:[0,0,1]
    v_pk_fma_f32 v[108:109], v[108:109], v[204:205], v[20:21] neg_lo:[0,0,1] neg_hi:[0,0,1]
    v_pk_fma_f32 v[110:111], v[110:111], v[206:207], v[22:23] neg_lo:[0,0,1] neg_hi:[0,0,1]
    v_cvt_pk_bf16_f32 v160, v96, v97
    v_cvt_pk_bf16_f32 v161, v98, v99
    v_cvt_pk_bf16_f32 v162, v100, v101
    v_cvt_pk_bf16_f32 v163, v102, v103
    v_cvt_pk_bf16_f32 v168, v112, v113
    v_cvt_pk_bf16_f32 v169, v114, v115
    v_cvt_pk_bf16_f32 v170, v116, v117
    v_cvt_pk_bf16_f32 v171, v118, v119
    v_cvt_pk_bf16_f32 v164, v104, v105
    v_cvt_pk_bf16_f32 v165, v106, v107
    v_cvt_pk_bf16_f32 v166, v108, v109
    v_cvt_pk_bf16_f32 v167, v110, v111
    v_cvt_pk_bf16_f32 v172, v120, v121
    v_cvt_pk_bf16_f32 v173, v122, v123
    v_cvt_pk_bf16_f32 v174, v124, v125
    v_cvt_pk_bf16_f32 v175, v126, v127
    s_setprio 3
    s_waitcnt lgkmcnt(0)
    v_mfma_f32_32x32x16_bf16 v[96:111], v[160:163], v[48:51], 0
    ds_read_b128 v[24:27], v12 offset:0
    v_bfe_u32 v2, v5, 2, 2
    v_lshlrev_b32 v14, 1, v9
    s_lshl_b32 s20, s26, 8
    v_and_b32 v14, 2, v14
    v_mfma_f32_32x32x16_bf16 v[112:127], v[160:163], v[56:59], 0
    ds_read_b128 v[28:31], v11 offset:4608
    s_add_u32 s20, s20, 32768
    v_xor_b32 v2, v2, v14
    s_lshl_b32 s22, s45, 5
    v_cmp_eq_u32 vcc, 0, v2
    v_mfma_f32_32x32x16_bf16 v[96:111], v[168:171], v[64:67], v[96:111]
    ds_read_b128 v[32:35], v12 offset:8192
    v_cmp_eq_u32 s[18:19], 1, v2
    v_mov_b32 v1, 0x3f00
    v_mov_b32 v15, 0
    v_and_b32 v2, 48, v4
    v_mfma_f32_32x32x16_bf16 v[112:127], v[168:171], v[48:51], v[112:127]
    ds_read_b128 v[36:39], v11 offset:12800
    v_cndmask_b32 v14, 0, v1, vcc
    v_add_u32 v10, s20, v10
    v_lshlrev_b64 v[252:253], v2, v[14:15]
    s_add_u32 s20, s23, 32768
    v_mfma_f32_32x32x16_bf16 v[96:111], v[164:167], v[52:55], v[96:111]
    ds_read_b128 v[40:43], v12 offset:16384
    v_cndmask_b32 v14, 0, v1, s[18:19]
    v_xor_b32 v10, s22, v10
    v_lshlrev_b64 v[254:255], v2, v[14:15]
    v_xor_b32 v13, s22, v4
    v_mfma_f32_32x32x16_bf16 v[112:127], v[164:167], v[60:63], v[112:127]
    ds_read_b128 v[44:47], v11 offset:20992
    v_bfe_i32 v1, v5, 5, 1
    v_add_u32 v13, s20, v13
    s_lshl1_add_u32 s40, s40, s45
    v_and_b32 v1, s30, v1
    v_mfma_f32_32x32x16_bf16 v[96:111], v[172:175], v[68:71], v[96:111]
    s_mul_i32 s40, s40, 131072
    v_lshl_add_u32 v3, v9, 6, v3
    s_lshl_b32 s20, s51, 9
    v_add_u32 v3, v2, v3
    v_mfma_f32_32x32x16_bf16 v[112:127], v[172:175], v[52:55], v[112:127]
    s_add_u32 s40, s40, s20
    v_xor_b32 v248, v1, v252
    s_add_u32 s40, s40, 4194304
    v_xor_b32 v249, v1, v253
    s_add_u32 s40, s40, s50
    v_xor_b32 v250, v1, v254
    s_add_u32 s41, s40, 65536
    v_xor_b32 v251, v1, v255
    s_add_u32 s42, s40, 2097152
    s_add_u32 s43, s40, 2162688
    s_min_u32 s27, s51, 1
    s_mul_i32 s27, s27, 0x3f800000
    s_setprio 1
    v_pk_mul_f32 v[16:17], v[112:113], v[144:145]
    v_pk_mul_f32 v[18:19], v[114:115], v[146:147]
    v_pk_mul_f32 v[20:21], v[116:117], v[148:149]
    v_pk_mul_f32 v[22:23], v[118:119], v[150:151]
    v_pk_mul_f32 v[112:113], v[112:113], v[128:129]
    v_pk_mul_f32 v[114:115], v[114:115], v[130:131]
    v_pk_mul_f32 v[116:117], v[116:117], v[132:133]
    v_pk_mul_f32 v[118:119], v[118:119], v[134:135]
    v_pk_fma_f32 v[112:113], v[96:97], v[144:145], v[112:113]
    v_pk_fma_f32 v[114:115], v[98:99], v[146:147], v[114:115]
    v_pk_fma_f32 v[116:117], v[100:101], v[148:149], v[116:117]
    v_pk_fma_f32 v[118:119], v[102:103], v[150:151], v[118:119]
    v_pk_fma_f32 v[96:97], v[96:97], v[128:129], v[16:17] neg_lo:[0,0,1] neg_hi:[0,0,1]
    v_pk_fma_f32 v[98:99], v[98:99], v[130:131], v[18:19] neg_lo:[0,0,1] neg_hi:[0,0,1]
    v_pk_fma_f32 v[100:101], v[100:101], v[132:133], v[20:21] neg_lo:[0,0,1] neg_hi:[0,0,1]
    v_pk_fma_f32 v[102:103], v[102:103], v[134:135], v[22:23] neg_lo:[0,0,1] neg_hi:[0,0,1]
    v_pk_mul_f32 v[16:17], v[120:121], v[152:153]
    v_pk_mul_f32 v[18:19], v[122:123], v[154:155]
    v_pk_mul_f32 v[20:21], v[124:125], v[156:157]
    v_pk_mul_f32 v[22:23], v[126:127], v[158:159]
    v_pk_mul_f32 v[120:121], v[120:121], v[136:137]
    v_pk_mul_f32 v[122:123], v[122:123], v[138:139]
    v_pk_mul_f32 v[124:125], v[124:125], v[140:141]
    v_pk_mul_f32 v[126:127], v[126:127], v[142:143]
    v_pk_fma_f32 v[120:121], v[104:105], v[152:153], v[120:121]
    v_pk_fma_f32 v[122:123], v[106:107], v[154:155], v[122:123]
    v_pk_fma_f32 v[124:125], v[108:109], v[156:157], v[124:125]
    v_pk_fma_f32 v[126:127], v[110:111], v[158:159], v[126:127]
    v_pk_fma_f32 v[104:105], v[104:105], v[136:137], v[16:17] neg_lo:[0,0,1] neg_hi:[0,0,1]
    v_pk_fma_f32 v[106:107], v[106:107], v[138:139], v[18:19] neg_lo:[0,0,1] neg_hi:[0,0,1]
    v_pk_fma_f32 v[108:109], v[108:109], v[140:141], v[20:21] neg_lo:[0,0,1] neg_hi:[0,0,1]
    v_pk_fma_f32 v[110:111], v[110:111], v[142:143], v[22:23] neg_lo:[0,0,1] neg_hi:[0,0,1]
    v_cvt_pk_bf16_f32 v160, v96, v97
    v_cvt_pk_bf16_f32 v161, v98, v99
    v_cvt_pk_bf16_f32 v162, v100, v101
    v_cvt_pk_bf16_f32 v163, v102, v103
    ds_write_b128 v13, v[160:163] offset:0
    v_cvt_pk_bf16_f32 v168, v112, v113
    v_cvt_pk_bf16_f32 v169, v114, v115
    v_cvt_pk_bf16_f32 v170, v116, v117
    v_cvt_pk_bf16_f32 v171, v118, v119
    ds_write_b128 v13, v[168:171] offset:4096
    v_cvt_pk_bf16_f32 v164, v104, v105
    v_cvt_pk_bf16_f32 v165, v106, v107
    v_cvt_pk_bf16_f32 v166, v108, v109
    v_cvt_pk_bf16_f32 v167, v110, v111
    ds_write_b128 v13, v[164:167] offset:1024
    v_cvt_pk_bf16_f32 v172, v120, v121
    v_cvt_pk_bf16_f32 v173, v122, v123
    v_cvt_pk_bf16_f32 v174, v124, v125
    v_cvt_pk_bf16_f32 v175, v126, v127
    ds_write_b128 v13, v[172:175] offset:5120
    s_waitcnt vmcnt(0)
    v_mfma_f32_16x16x32_bf16 v[48:51], v[80:83], v[252:255], 0
    v_mfma_f32_16x16x32_bf16 v[52:55], v[84:87], v[252:255], 0
    v_mfma_f32_16x16x32_bf16 v[56:59], v[80:83], v[248:251], 0
    v_mfma_f32_16x16x32_bf16 v[60:63], v[84:87], v[248:251], 0
    v_mfma_f32_16x16x32_bf16 v[64:67], v[88:91], v[252:255], 0
    v_mfma_f32_16x16x32_bf16 v[68:71], v[92:95], v[252:255], 0
    v_mfma_f32_16x16x32_bf16 v[72:75], v[88:91], v[248:251], 0
    v_mfma_f32_16x16x32_bf16 v[76:79], v[92:95], v[248:251], 0
    s_waitcnt lgkmcnt(0)
    s_barrier
    ds_read_b128 v[96:99], v10 offset:0
    ds_read_b128 v[100:103], v10 offset:2048
    ds_read_b128 v[104:107], v10 offset:4096
    ds_read_b128 v[108:111], v10 offset:6144
    ds_read_b128 v[112:115], v10 offset:16384
    ds_read_b128 v[116:119], v10 offset:18432
    ds_read_b128 v[120:123], v10 offset:20480
    ds_read_b128 v[124:127], v10 offset:22528
    s_waitcnt lgkmcnt(7)
    v_mfma_f32_16x16x32_bf16 v[48:51], v[96:99], v[24:27], v[48:51]
    v_mfma_f32_16x16x32_bf16 v[52:55], v[96:99], v[32:35], v[52:55]
    s_waitcnt lgkmcnt(6)
    v_mfma_f32_16x16x32_bf16 v[56:59], v[100:103], v[28:31], v[56:59]
    v_mfma_f32_16x16x32_bf16 v[60:63], v[100:103], v[36:39], v[60:63]
    s_waitcnt lgkmcnt(5)
    v_mfma_f32_16x16x32_bf16 v[48:51], v[104:107], v[40:43], v[48:51]
    v_mfma_f32_16x16x32_bf16 v[52:55], v[104:107], v[24:27], v[52:55]
    s_waitcnt lgkmcnt(4)
    v_mfma_f32_16x16x32_bf16 v[56:59], v[108:111], v[44:47], v[56:59]
    v_mfma_f32_16x16x32_bf16 v[60:63], v[108:111], v[28:31], v[60:63]
    s_waitcnt lgkmcnt(3)
    v_mfma_f32_16x16x32_bf16 v[64:67], v[112:115], v[24:27], v[64:67]
    v_mfma_f32_16x16x32_bf16 v[68:71], v[112:115], v[32:35], v[68:71]
    s_waitcnt lgkmcnt(2)
    v_mfma_f32_16x16x32_bf16 v[72:75], v[116:119], v[28:31], v[72:75]
    v_mfma_f32_16x16x32_bf16 v[76:79], v[116:119], v[36:39], v[76:79]
    s_waitcnt lgkmcnt(1)
    v_mfma_f32_16x16x32_bf16 v[64:67], v[120:123], v[40:43], v[64:67]
    v_mfma_f32_16x16x32_bf16 v[68:71], v[120:123], v[24:27], v[68:71]
    s_waitcnt lgkmcnt(0)
    v_mfma_f32_16x16x32_bf16 v[72:75], v[124:127], v[44:47], v[72:75]
    v_mfma_f32_16x16x32_bf16 v[76:79], v[124:127], v[28:31], v[76:79]
    v_mul_f32 v48, s27, v48
    v_mul_f32 v49, s27, v49
    v_mul_f32 v56, s27, v56
    v_mul_f32 v57, s27, v57
    v_pk_add_f32 v[130:131], v[50:51], v[58:59]
    v_pk_add_f32 v[132:133], v[52:53], v[60:61]
    v_pk_add_f32 v[134:135], v[54:55], v[62:63]
    v_pk_add_f32 v[128:129], v[48:49], v[56:57]
    v_pk_add_f32 v[136:137], v[48:49], v[56:57] neg_lo:[0,1] neg_hi:[0,1]
    v_pk_add_f32 v[138:139], v[50:51], v[58:59] neg_lo:[0,1] neg_hi:[0,1]
    v_pk_add_f32 v[140:141], v[52:53], v[60:61] neg_lo:[0,1] neg_hi:[0,1]
    v_pk_add_f32 v[142:143], v[54:55], v[62:63] neg_lo:[0,1] neg_hi:[0,1]
    v_cvt_pk_bf16_f32 v160, v128, v132
    v_cvt_pk_bf16_f32 v161, v130, v134
    v_cvt_pk_bf16_f32 v164, v129, v133
    v_cvt_pk_bf16_f32 v165, v131, v135
    v_cvt_pk_bf16_f32 v168, v136, v140
    v_cvt_pk_bf16_f32 v169, v138, v142
    v_cvt_pk_bf16_f32 v172, v137, v141
    v_cvt_pk_bf16_f32 v173, v139, v143
    v_pk_add_f32 v[146:147], v[66:67], v[74:75]
    v_pk_add_f32 v[148:149], v[68:69], v[76:77]
    v_pk_add_f32 v[150:151], v[70:71], v[78:79]
    v_pk_add_f32 v[144:145], v[64:65], v[72:73]
    v_pk_add_f32 v[152:153], v[64:65], v[72:73] neg_lo:[0,1] neg_hi:[0,1]
    v_pk_add_f32 v[154:155], v[66:67], v[74:75] neg_lo:[0,1] neg_hi:[0,1]
    v_pk_add_f32 v[156:157], v[68:69], v[76:77] neg_lo:[0,1] neg_hi:[0,1]
    v_pk_add_f32 v[158:159], v[70:71], v[78:79] neg_lo:[0,1] neg_hi:[0,1]
    v_cvt_pk_bf16_f32 v162, v144, v148
    v_cvt_pk_bf16_f32 v163, v146, v150
    buffer_store_dwordx4 v[160:163], v3, s[12:15], s40 offen sc1
    v_cvt_pk_bf16_f32 v166, v145, v149
    v_cvt_pk_bf16_f32 v167, v147, v151
    buffer_store_dwordx4 v[164:167], v3, s[12:15], s41 offen sc1
    v_cvt_pk_bf16_f32 v170, v152, v156
    v_cvt_pk_bf16_f32 v171, v154, v158
    buffer_store_dwordx4 v[168:171], v3, s[12:15], s42 offen sc1
    v_cvt_pk_bf16_f32 v174, v153, v157
    v_cvt_pk_bf16_f32 v175, v155, v159
    buffer_store_dwordx4 v[172:175], v3, s[12:15], s43 offen sc1
K2_DONE:
END_k2_kernel:
    s_endpgm

.globl ff_kernel
.p2align 8
.type ff_kernel,@function
ff_kernel:
    s_cmp_ge_u32 s2, 256
    s_cbranch_scc1 END_ff_kernel
    s_mov_b32 s52, 0
    s_load_dwordx2 s[4:5], s[0:1], 64
    s_getpc_b64 s[60:61]
PF_ff_kernel_1:
    v_lshlrev_b32 v2, 7, v0
    v_min_u32 v2, MID_ff_kernel-PF_ff_kernel_1-4, v2
    v_mov_b32 v3, 0
    v_lshl_add_u64 v[2:3], v[2:3], 0, s[60:61]
    global_load_dword v63, v[2:3], off
    s_and_b32 s6, s2, 7
    s_lshr_b32 s7, s2, 3
    s_lshr_b32 s8, s6, 1
    s_and_b32 s9, s6, 1
    s_lshl_b32 s9, s9, 3
    s_lshr_b32 s10, s7, 2
    s_add_u32 s9, s9, s10
    s_and_b32 s10, s7, 3
    v_lshrrev_b32 v1, 6, v0
    v_and_b32 v5, 63, v0
    v_readfirstlane_b32 s11, v1
    v_lshlrev_b32 v4, 4, v5
    v_lshrrev_b32 v7, 4, v5
    v_lshlrev_b32 v1, 9, v7
    v_and_b32 v6, 15, v5
    v_lshl_add_u32 v1, v6, 4, v1
    s_lshl_b32 s19, s9, 2
    s_add_u32 s19, s19, s11
    s_lshl_b32 s16, s8, 2
    s_add_u32 s23, s16, s10
    s_mul_i32 s16, s23, 458752
    s_add_u32 s16, s16, 41943040
    s_lshl_b32 s22, s11, 12
    s_lshl_b32 s25, s11, 10
    s_add_u32 s17, s16, s25
    s_add_u32 s16, s16, s22
    s_nop 0
    s_mul_i32 s18, s19, 65536
    s_add_u32 s18, s18, 4194304
    v_lshlrev_b32 v0, 7, v0
    v_lshrrev_b32 v2, 1, v6
    v_xor_b32 v2, v2, v7
    v_lshlrev_b32 v2, 4, v2
    v_lshl_add_u32 v8, v6, 7, v2
    v_xor_b32 v10, 64, v8
    v_add_u32 v9, 0x10000, v8
    v_add_u32 v11, 0x10000, v10
    v_mov_b32 v12, v1
    v_add_u32 v13, 0x10000, v1
    v_lshrrev_b32 v14, 5, v5
    v_lshlrev_b32 v14, 9, v14
    v_lshl_add_u32 v14, v6, 4, v14
    v_and_b32 v2, 1, v7
    v_lshl_add_u32 v14, v2, 3, v14
    s_mul_i32 s20, s19, 224
    s_mul_i32 s21, s8, 56
    s_add_u32 s20, s20, s21
    s_lshl_b32 s20, s20, 10
    s_add_u32 s20, s20, 8388608
    s_add_u32 s21, s10, 0
    s_and_b32 s21, s21, 3
    s_mul_i32 s21, s21, 14336
    s_add_u32 s40, s20, s21
    s_add_u32 s21, s10, 1
    s_and_b32 s21, s21, 3
    s_mul_i32 s21, s21, 14336
    s_add_u32 s41, s20, s21
    s_add_u32 s21, s10, 2
    s_and_b32 s21, s21, 3
    s_mul_i32 s21, s21, 14336
    s_add_u32 s42, s20, s21
    s_add_u32 s21, s10, 3
    s_and_b32 s21, s21, 3
    s_mul_i32 s21, s21, 14336
    s_add_u32 s43, s20, s21
    s_lshl2_add_u32 s20, s19, s10
    s_mul_i32 s20, s20, 49152
    s_add_u32 s20, s20, 24117248
    s_add_u32 s21, s8, 1
    s_and_b32 s21, s21, 3
    s_mul_i32 s21, s21, 12288
    s_add_u32 s21, s21, 0
    s_add_u32 s24, s20, s21
    s_add_u32 s21, s8, 2
    s_and_b32 s21, s21, 3
    s_mul_i32 s21, s21, 12288
    s_add_u32 s21, s21, 4096
    s_add_u32 s29, s20, s21
    s_add_u32 s21, s8, 3
    s_and_b32 s21, s21, 3
    s_mul_i32 s21, s21, 12288
    s_add_u32 s21, s21, 8192
    s_add_u32 s44, s20, s21
    s_mul_i32 s21, s8, 12288
    s_add_u32 s50, s20, s21
    s_add_u32 s51, s50, 4096
    s_add_u32 s53, s50, 8192
    s_lshl_b32 s26, s19, 11
    s_add_u32 s26, s26, 65011712
    v_min_u32 v2, 2, v5
    v_add_u32 v2, 1, v2
    v_add_u32 v58, s10, v2
    v_and_b32 v58, 3, v58
    v_lshlrev_b32 v58, 7, v58
    s_lshl_b32 s20, s8, 9
    v_add_u32 v58, s20, v58
    v_and_b32 v15, 3, v5
    s_lshl_b32 s21, s11, 9
    v_lshl_add_u32 v15, v15, 7, s21
    s_lshl_b32 s21, s10, 7
    v_cmp_eq_u32 vcc, 0, v5
    v_bfrev_b32 v59, -2
    s_add_u32 s21, s21, s20
    v_mov_b32 v2, s21
    v_cndmask_b32 v59, v59, v2, vcc
    v_mov_b32 v60, 1
    s_lshl2_add_u32 s21, s10, s8
    s_lshl4_add_u32 s20, s9, s11
    s_mul_i32 s32, s20, 16384
    s_lshl_b32 s33, s21, 10
    s_add_u32 s32, s32, s33
    s_add_u32 s32, s32, 103809024
    s_lshl_b32 s33, s20, 5
    s_add_u32 s33, s33, 131072000
    s_mul_i32 s3, s19, 65536
    s_lshl_b32 s20, s21, 12
    s_add_u32 s3, s3, s20
    s_add_u32 s3, s3, 4194304
    s_mov_b32 s31, s21
    v_lshrrev_b32 v2, 2, v6
    v_cmp_eq_u32 vcc, v2, v7
    v_and_b32 v2, 1, v5
    v_lshlrev_b32 v2, 4, v2
    v_mov_b32 v3, 0x3f80
    v_lshlrev_b32 v2, v2, v3
    v_mov_b32 v16, 0
    v_cndmask_b32 v2, v16, v2, vcc
    v_and_b32 v3, 2, v5
    v_cmp_eq_u32 vcc, 0, v3
    v_mov_b32 v17, 0
    v_mov_b32 v20, 0
    v_mov_b32 v21, 0
    v_cndmask_b32 v18, v16, v2, vcc
    v_cndmask_b32 v19, v2, v16, vcc
    s_waitcnt lgkmcnt(0)
    s_mov_b32 s12, s4
    s_mov_b32 s13, s5
    s_mov_b32 s14, 268435456
    s_mov_b32 s15, 0x00020000
    s_mov_b32 s5, s18
    s_add_u32 m0, s25, 0
    s_nop 0
    buffer_load_dwordx4 v4, s[12:15], s17 offen lds
    buffer_load_dwordx4 a[0:3], v1, s[12:15], s18 offen offset:0
    buffer_load_dwordx4 a[4:7], v1, s[12:15], s18 offen offset:256
    buffer_load_dwordx4 a[8:11], v1, s[12:15], s18 offen offset:2048
    buffer_load_dwordx4 a[12:15], v1, s[12:15], s18 offen offset:2304
    s_add_u32 m0, s25, 4096
    s_add_u32 s17, s17, 4096
    buffer_load_dwordx4 v4, s[12:15], s17 offen lds
    s_add_u32 m0, s25, 8192
    s_add_u32 s17, s17, 4096
    buffer_load_dwordx4 v4, s[12:15], s17 offen lds
    s_add_u32 m0, s25, 12288
    s_add_u32 s17, s17, 4096
    buffer_load_dwordx4 v4, s[12:15], s17 offen lds
    s_add_u32 s18, s18, 4096
    buffer_load_dwordx4 a[16:19], v1, s[12:15], s18 offen offset:0
    buffer_load_dwordx4 a[20:23], v1, s[12:15], s18 offen offset:256
    buffer_load_dwordx4 a[24:27], v1, s[12:15], s18 offen offset:2048
    buffer_load_dwordx4 a[28:31], v1, s[12:15], s18 offen offset:2304
    s_add_u32 m0, s22, 16384
    s_add_u32 s16, s16, 16384
    buffer_load_dwordx4 v4, s[12:15], s16 offen offset:0 lds
    buffer_load_dwordx4 v4, s[12:15], s16 offen offset:1024 lds
    buffer_load_dwordx4 v4, s[12:15], s16 offen offset:2048 lds
    buffer_load_dwordx4 v4, s[12:15], s16 offen offset:3072 lds
    s_and_b32 s4, s2, 7
    s_lshl_b32 s4, s4, 7
    s_lshr_b32 s30, s2, 3
    s_lshl2_add_u32 s30, s30, s11
    s_lshl_b32 s30, s30, 15
    s_add_u32 s4, s4, s30
    s_add_u32 s4, s4, 58720128
    s_mov_b32 s96, 0x22222222
    s_mov_b32 s97, 0x22222222
    s_mov_b32 s98, 0x44444444
    s_mov_b32 s99, 0x44444444
    s_mov_b32 s100, 0x88888888
    s_mov_b32 s101, 0x88888888
    s_waitcnt vmcnt(15)
    s_barrier
    ds_read_b128 v[64:67], v8 offset:0
    ds_read_b128 v[68:71], v10 offset:0
    ds_read_b128 v[72:75], v8 offset:2048
    ds_read_b128 v[76:79], v10 offset:2048
    s_waitcnt vmcnt(14) lgkmcnt(3)
    v_mfma_f32_16x16x32_bf16 v[96:99], v[64:67], a[0:3], 0
    s_waitcnt vmcnt(12) lgkmcnt(2)
    s_add_u32 s18, s18, 4096
    v_mfma_f32_16x16x32_bf16 v[96:99], v[68:71], a[8:11], v[96:99]
    s_waitcnt vmcnt(11)
    s_waitcnt vmcnt(10)
    s_barrier
    v_mfma_f32_16x16x32_bf16 v[100:103], v[68:71], a[12:15], 0
    s_waitcnt lgkmcnt(1)
    ds_read_b128 v[80:83], v8 offset:4096
    ds_read_b128 v[84:87], v10 offset:4096
    v_mfma_f32_16x16x32_bf16 v[100:103], v[64:67], a[4:7], v[100:103]
    buffer_load_dwordx4 a[32:35], v1, s[12:15], s18 offen offset:0
    v_mfma_f32_16x16x32_bf16 v[108:111], v[72:75], a[4:7], 0
    s_waitcnt lgkmcnt(2)
    ds_read_b128 v[88:91], v8 offset:6144
    ds_read_b128 v[92:95], v10 offset:6144
    v_mfma_f32_16x16x32_bf16 v[108:111], v[76:79], a[12:15], v[108:111]
    s_waitcnt vmcnt(9)
    s_barrier
    v_mfma_f32_16x16x32_bf16 v[104:107], v[76:79], a[8:11], 0
    s_waitcnt lgkmcnt(3)
    ds_read_b128 v[64:67], v8 offset:8192
    ds_read_b128 v[68:71], v10 offset:8192
    v_mfma_f32_16x16x32_bf16 v[104:107], v[72:75], a[0:3], v[104:107]
    buffer_load_dwordx4 a[36:39], v1, s[12:15], s18 offen offset:256
    v_mfma_f32_16x16x32_bf16 v[112:115], v[80:83], a[0:3], 0
    s_waitcnt lgkmcnt(4)
    ds_read_b128 v[72:75], v8 offset:10240
    v_mfma_f32_16x16x32_bf16 v[112:115], v[84:87], a[8:11], v[112:115]
    buffer_load_dwordx4 a[40:43], v1, s[12:15], s18 offen offset:2048
    v_mfma_f32_4x4x4_16b_bf16 v[40:43], a[0:1], a[0:1], 0
    v_mfma_f32_4x4x4_16b_bf16 v[44:47], a[2:3], a[2:3], 0
    v_mfma_f32_4x4x4_16b_bf16 v[48:51], a[4:5], a[4:5], 0
    v_mfma_f32_4x4x4_16b_bf16 v[52:55], a[6:7], a[6:7], 0
    v_mfma_f32_4x4x4_16b_bf16 v[40:43], a[8:9], a[8:9], v[40:43]
    v_mfma_f32_4x4x4_16b_bf16 v[44:47], a[10:11], a[10:11], v[44:47]
    v_mfma_f32_4x4x4_16b_bf16 v[48:51], a[12:13], a[12:13], v[48:51]
    v_mfma_f32_4x4x4_16b_bf16 v[52:55], a[14:15], a[14:15], v[52:55]
    v_mfma_f32_16x16x32_bf16 v[116:119], v[84:87], a[12:15], 0
    s_waitcnt lgkmcnt(4)
    ds_read_b128 v[76:79], v10 offset:10240
    v_mfma_f32_16x16x32_bf16 v[116:119], v[80:83], a[4:7], v[116:119]
    buffer_load_dwordx4 a[44:47], v1, s[12:15], s18 offen offset:2304
    v_mfma_f32_16x16x32_bf16 v[124:127], v[88:91], a[4:7], 0
    s_waitcnt lgkmcnt(4)
    ds_read_b128 v[80:83], v8 offset:12288
    s_add_u32 m0, s22, 32768
    v_mfma_f32_16x16x32_bf16 v[124:127], v[92:95], a[12:15], v[124:127]
    s_add_u32 s16, s16, 16384
    v_mfma_f32_16x16x32_bf16 v[120:123], v[92:95], a[8:11], 0
    s_waitcnt lgkmcnt(4)
    ds_read_b128 v[84:87], v10 offset:12288
    v_mfma_f32_16x16x32_bf16 v[120:123], v[88:91], a[0:3], v[120:123]
    buffer_load_dwordx4 v4, s[12:15], s16 offen offset:0 lds
    v_mfma_f32_16x16x32_bf16 v[128:131], v[64:67], a[0:3], 0
    s_waitcnt lgkmcnt(4)
    ds_read_b128 v[88:91], v8 offset:14336
    v_mfma_f32_16x16x32_bf16 v[128:131], v[68:71], a[8:11], v[128:131]
    buffer_load_dwordx4 v4, s[12:15], s16 offen offset:1024 lds
    v_mfma_f32_16x16x32_bf16 v[132:135], v[68:71], a[12:15], 0
    s_waitcnt lgkmcnt(4)
    ds_read_b128 v[92:95], v10 offset:14336
    v_mfma_f32_16x16x32_bf16 v[132:135], v[64:67], a[4:7], v[132:135]
    s_waitcnt vmcnt(6)
    s_barrier
    v_mfma_f32_16x16x32_bf16 v[140:143], v[72:75], a[4:7], 0
    s_waitcnt lgkmcnt(4)
    ds_read_b128 v[64:67], v8 offset:16384
    v_mfma_f32_16x16x32_bf16 v[140:143], v[76:79], a[12:15], v[140:143]
    buffer_load_dwordx4 v4, s[12:15], s16 offen offset:2048 lds
    v_mfma_f32_16x16x32_bf16 v[136:139], v[76:79], a[8:11], 0
    s_waitcnt lgkmcnt(4)
    ds_read_b128 v[68:71], v10 offset:16384
    v_mfma_f32_16x16x32_bf16 v[136:139], v[72:75], a[0:3], v[136:139]
    buffer_load_dwordx4 v4, s[12:15], s16 offen offset:3072 lds
    v_mfma_f32_16x16x32_bf16 v[96:99], v[80:83], a[16:19], v[96:99]
    s_waitcnt lgkmcnt(4)
    ds_read_b128 v[72:75], v8 offset:18432
    s_add_u32 s18, s18, 4096
    v_mfma_f32_16x16x32_bf16 v[96:99], v[84:87], a[24:27], v[96:99]
    buffer_load_dwordx4 a[48:51], v1, s[12:15], s18 offen offset:0
    v_mfma_f32_16x16x32_bf16 v[100:103], v[84:87], a[28:31], v[100:103]
    s_waitcnt lgkmcnt(4)
    ds_read_b128 v[76:79], v10 offset:18432
    v_mfma_f32_16x16x32_bf16 v[100:103], v[80:83], a[20:23], v[100:103]
    buffer_load_dwordx4 a[52:55], v1, s[12:15], s18 offen offset:256
    v_mfma_f32_16x16x32_bf16 v[108:111], v[88:91], a[20:23], v[108:111]
    s_waitcnt lgkmcnt(4)
    ds_read_b128 v[80:83], v8 offset:20480
    v_mfma_f32_16x16x32_bf16 v[108:111], v[92:95], a[28:31], v[108:111]
    buffer_load_dwordx4 a[56:59], v1, s[12:15], s18 offen offset:2048
    v_mfma_f32_16x16x32_bf16 v[104:107], v[92:95], a[24:27], v[104:107]
    s_waitcnt lgkmcnt(4)
    ds_read_b128 v[84:87], v10 offset:20480
    v_mfma_f32_16x16x32_bf16 v[104:107], v[88:91], a[16:19], v[104:107]
    buffer_load_dwordx4 a[60:63], v1, s[12:15], s18 offen offset:2304
    v_mfma_f32_16x16x32_bf16 v[112:115], v[64:67], a[16:19], v[112:115]
    s_waitcnt lgkmcnt(4)
    ds_read_b128 v[88:91], v8 offset:22528
    s_add_u32 m0, s22, 49152
    v_mfma_f32_16x16x32_bf16 v[112:115], v[68:71], a[24:27], v[112:115]
    s_add_u32 s16, s16, 16384
    v_mfma_f32_4x4x4_16b_bf16 v[40:43], a[16:17], a[16:17], v[40:43]
    v_mfma_f32_4x4x4_16b_bf16 v[44:47], a[18:19], a[18:19], v[44:47]
    v_mfma_f32_4x4x4_16b_bf16 v[48:51], a[20:21], a[20:21], v[48:51]
    v_mfma_f32_4x4x4_16b_bf16 v[52:55], a[22:23], a[22:23], v[52:55]
    v_mfma_f32_4x4x4_16b_bf16 v[40:43], a[24:25], a[24:25], v[40:43]
    v_mfma_f32_4x4x4_16b_bf16 v[44:47], a[26:27], a[26:27], v[44:47]
    v_mfma_f32_4x4x4_16b_bf16 v[48:51], a[28:29], a[28:29], v[48:51]
    v_mfma_f32_4x4x4_16b_bf16 v[52:55], a[30:31], a[30:31], v[52:55]
    v_mfma_f32_16x16x32_bf16 v[116:119], v[68:71], a[28:31], v[116:119]
    s_waitcnt lgkmcnt(4)
    ds_read_b128 v[92:95], v10 offset:22528
    v_mfma_f32_16x16x32_bf16 v[116:119], v[64:67], a[20:23], v[116:119]
    buffer_load_dwordx4 v4, s[12:15], s16 offen offset:0 lds
    v_mfma_f32_16x16x32_bf16 v[124:127], v[72:75], a[20:23], v[124:127]
    s_waitcnt lgkmcnt(4)
    ds_read_b128 v[64:67], v8 offset:24576
    v_mfma_f32_16x16x32_bf16 v[124:127], v[76:79], a[28:31], v[124:127]
    buffer_load_dwordx4 v4, s[12:15], s16 offen offset:1024 lds
    v_mfma_f32_16x16x32_bf16 v[120:123], v[76:79], a[24:27], v[120:123]
    s_waitcnt lgkmcnt(4)
    ds_read_b128 v[68:71], v10 offset:24576
    v_mfma_f32_16x16x32_bf16 v[120:123], v[72:75], a[16:19], v[120:123]
    buffer_load_dwordx4 v4, s[12:15], s16 offen offset:2048 lds
    v_mfma_f32_16x16x32_bf16 v[128:131], v[80:83], a[16:19], v[128:131]
    s_waitcnt lgkmcnt(4)
    ds_read_b128 v[72:75], v8 offset:26624
    v_mfma_f32_16x16x32_bf16 v[128:131], v[84:87], a[24:27], v[128:131]
    buffer_load_dwordx4 v4, s[12:15], s16 offen offset:3072 lds
    v_mfma_f32_16x16x32_bf16 v[132:135], v[84:87], a[28:31], v[132:135]
    s_waitcnt lgkmcnt(4)
    ds_read_b128 v[76:79], v10 offset:26624
    s_add_u32 s18, s18, 4096
    v_mfma_f32_16x16x32_bf16 v[132:135], v[80:83], a[20:23], v[132:135]
    buffer_load_dwordx4 a[64:67], v1, s[12:15], s18 offen offset:0
    v_mfma_f32_16x16x32_bf16 v[140:143], v[88:91], a[20:23], v[140:143]
    s_waitcnt lgkmcnt(4)
    ds_read_b128 v[80:83], v8 offset:28672
    v_mfma_f32_16x16x32_bf16 v[140:143], v[92:95], a[28:31], v[140:143]
    v_mfma_f32_16x16x32_bf16 v[136:139], v[92:95], a[24:27], v[136:139]
    s_waitcnt lgkmcnt(4)
    ds_read_b128 v[84:87], v10 offset:28672
    v_mfma_f32_16x16x32_bf16 v[136:139], v[88:91], a[16:19], v[136:139]
    s_waitcnt vmcnt(16)
    buffer_load_dwordx4 a[68:71], v1, s[12:15], s18 offen offset:256
    v_mfma_f32_16x16x32_bf16 v[96:99], v[64:67], a[32:35], v[96:99]
    s_waitcnt vmcnt(15) lgkmcnt(4)
    ds_read_b128 v[88:91], v8 offset:30720
    v_mfma_f32_16x16x32_bf16 v[96:99], v[68:71], a[40:43], v[96:99]
    s_waitcnt vmcnt(14)
    v_mfma_f32_16x16x32_bf16 v[100:103], v[68:71], a[44:47], v[100:103]
    s_waitcnt lgkmcnt(4)
    ds_read_b128 v[92:95], v10 offset:30720
    v_mfma_f32_16x16x32_bf16 v[100:103], v[64:67], a[36:39], v[100:103]
    s_waitcnt vmcnt(10)
    s_barrier
    v_mfma_f32_16x16x32_bf16 v[108:111], v[72:75], a[36:39], v[108:111]
    s_waitcnt lgkmcnt(4)
    ds_read_b128 v[64:67], v8 offset:32768
    v_mfma_f32_16x16x32_bf16 v[108:111], v[76:79], a[44:47], v[108:111]
    buffer_load_dwordx4 a[72:75], v1, s[12:15], s18 offen offset:2048
    v_mfma_f32_16x16x32_bf16 v[104:107], v[76:79], a[40:43], v[104:107]
    s_waitcnt lgkmcnt(4)
    ds_read_b128 v[68:71], v10 offset:32768
    v_mfma_f32_16x16x32_bf16 v[104:107], v[72:75], a[32:35], v[104:107]
    buffer_load_dwordx4 a[76:79], v1, s[12:15], s18 offen offset:2304
    v_mfma_f32_16x16x32_bf16 v[112:115], v[80:83], a[32:35], v[112:115]
    s_waitcnt lgkmcnt(4)
    ds_read_b128 v[72:75], v8 offset:34816
    s_add_u32 s18, s18, 4096
    v_mfma_f32_16x16x32_bf16 v[112:115], v[84:87], a[40:43], v[112:115]
    buffer_load_dwordx4 a[80:83], v1, s[12:15], s18 offen offset:0
    v_mfma_f32_4x4x4_16b_bf16 v[40:43], a[32:33], a[32:33], v[40:43]
    v_mfma_f32_4x4x4_16b_bf16 v[44:47], a[34:35], a[34:35], v[44:47]
    v_mfma_f32_4x4x4_16b_bf16 v[48:51], a[36:37], a[36:37], v[48:51]
    v_mfma_f32_4x4x4_16b_bf16 v[52:55], a[38:39], a[38:39], v[52:55]
    v_mfma_f32_4x4x4_16b_bf16 v[40:43], a[40:41], a[40:41], v[40:43]
    v_mfma_f32_4x4x4_16b_bf16 v[44:47], a[42:43], a[42:43], v[44:47]
    v_mfma_f32_4x4x4_16b_bf16 v[48:51], a[44:45], a[44:45], v[48:51]
    v_mfma_f32_4x4x4_16b_bf16 v[52:55], a[46:47], a[46:47], v[52:55]
    v_mfma_f32_16x16x32_bf16 v[116:119], v[84:87], a[44:47], v[116:119]
    s_waitcnt lgkmcnt(4)
    ds_read_b128 v[76:79], v10 offset:34816
    v_mfma_f32_16x16x32_bf16 v[116:119], v[80:83], a[36:39], v[116:119]
    v_mfma_f32_16x16x32_bf16 v[124:127], v[88:91], a[36:39], v[124:127]
    s_waitcnt lgkmcnt(4)
    ds_read_b128 v[80:83], v8 offset:36864
    v_mfma_f32_16x16x32_bf16 v[124:127], v[92:95], a[44:47], v[124:127]
    buffer_load_dwordx4 a[84:87], v1, s[12:15], s18 offen offset:256
    v_mfma_f32_16x16x32_bf16 v[120:123], v[92:95], a[40:43], v[120:123]
    s_waitcnt lgkmcnt(4)
    ds_read_b128 v[84:87], v10 offset:36864
    v_mfma_f32_16x16x32_bf16 v[120:123], v[88:91], a[32:35], v[120:123]
    buffer_load_dwordx4 a[88:91], v1, s[12:15], s18 offen offset:2048
    v_mfma_f32_16x16x32_bf16 v[128:131], v[64:67], a[32:35], v[128:131]
    s_waitcnt lgkmcnt(4)
    ds_read_b128 v[88:91], v8 offset:38912
    v_mfma_f32_16x16x32_bf16 v[128:131], v[68:71], a[40:43], v[128:131]
    v_mfma_f32_16x16x32_bf16 v[132:135], v[68:71], a[44:47], v[132:135]
    s_waitcnt lgkmcnt(4)
    ds_read_b128 v[92:95], v10 offset:38912
    v_mfma_f32_16x16x32_bf16 v[132:135], v[64:67], a[36:39], v[132:135]
    buffer_load_dwordx4 a[92:95], v1, s[12:15], s18 offen offset:2304
    v_mfma_f32_16x16x32_bf16 v[140:143], v[72:75], a[36:39], v[140:143]
    s_waitcnt lgkmcnt(4)
    ds_read_b128 v[64:67], v8 offset:40960
    v_mfma_f32_16x16x32_bf16 v[140:143], v[76:79], a[44:47], v[140:143]
    v_mfma_f32_16x16x32_bf16 v[136:139], v[76:79], a[40:43], v[136:139]
    s_waitcnt lgkmcnt(4)
    ds_read_b128 v[68:71], v10 offset:40960
    s_add_u32 m0, s22, 65536
    v_mfma_f32_16x16x32_bf16 v[136:139], v[72:75], a[32:35], v[136:139]
    s_waitcnt vmcnt(15)
    s_add_u32 s16, s16, 16384
    v_mfma_f32_16x16x32_bf16 v[96:99], v[80:83], a[48:51], v[96:99]
    s_waitcnt vmcnt(13) lgkmcnt(4)
    ds_read_b128 v[72:75], v8 offset:43008
    v_mfma_f32_16x16x32_bf16 v[96:99], v[84:87], a[56:59], v[96:99]
    s_waitcnt vmcnt(12)
    buffer_load_dwordx4 v4, s[12:15], s16 offen offset:0 lds
    v_mfma_f32_16x16x32_bf16 v[100:103], v[84:87], a[60:63], v[100:103]
    s_waitcnt lgkmcnt(4)
    ds_read_b128 v[76:79], v10 offset:43008
    v_mfma_f32_16x16x32_bf16 v[100:103], v[80:83], a[52:55], v[100:103]
    buffer_load_dwordx4 v4, s[12:15], s16 offen offset:1024 lds
    v_mfma_f32_16x16x32_bf16 v[108:111], v[88:91], a[52:55], v[108:111]
    s_waitcnt lgkmcnt(4)
    ds_read_b128 v[80:83], v8 offset:45056
    v_mfma_f32_16x16x32_bf16 v[108:111], v[92:95], a[60:63], v[108:111]
    buffer_load_dwordx4 v4, s[12:15], s16 offen offset:2048 lds
    v_mfma_f32_16x16x32_bf16 v[104:107], v[92:95], a[56:59], v[104:107]
    s_waitcnt lgkmcnt(4)
    ds_read_b128 v[84:87], v10 offset:45056
    v_mfma_f32_16x16x32_bf16 v[104:107], v[88:91], a[48:51], v[104:107]
    v_mfma_f32_16x16x32_bf16 v[112:115], v[64:67], a[48:51], v[112:115]
    s_waitcnt lgkmcnt(4)
    ds_read_b128 v[88:91], v8 offset:47104
    v_mfma_f32_16x16x32_bf16 v[112:115], v[68:71], a[56:59], v[112:115]
    buffer_load_dwordx4 v4, s[12:15], s16 offen offset:3072 lds
    v_mfma_f32_4x4x4_16b_bf16 v[40:43], a[48:49], a[48:49], v[40:43]
    v_mfma_f32_4x4x4_16b_bf16 v[44:47], a[50:51], a[50:51], v[44:47]
    v_mfma_f32_4x4x4_16b_bf16 v[48:51], a[52:53], a[52:53], v[48:51]
    v_mfma_f32_4x4x4_16b_bf16 v[52:55], a[54:55], a[54:55], v[52:55]
    v_mfma_f32_4x4x4_16b_bf16 v[40:43], a[56:57], a[56:57], v[40:43]
    v_mfma_f32_4x4x4_16b_bf16 v[44:47], a[58:59], a[58:59], v[44:47]
    v_mfma_f32_4x4x4_16b_bf16 v[48:51], a[60:61], a[60:61], v[48:51]
    v_mfma_f32_4x4x4_16b_bf16 v[52:55], a[62:63], a[62:63], v[52:55]
    v_mfma_f32_16x16x32_bf16 v[116:119], v[68:71], a[60:63], v[116:119]
    s_waitcnt lgkmcnt(4)
    ds_read_b128 v[92:95], v10 offset:47104
    v_mfma_f32_16x16x32_bf16 v[116:119], v[64:67], a[52:55], v[116:119]
    s_waitcnt vmcnt(12)
    s_barrier
    v_mfma_f32_16x16x32_bf16 v[124:127], v[72:75], a[52:55], v[124:127]
    s_waitcnt lgkmcnt(4)
    ds_read_b128 v[64:67], v8 offset:49152
    s_add_u32 s18, s18, 4096
    v_mfma_f32_16x16x32_bf16 v[124:127], v[76:79], a[60:63], v[124:127]
    buffer_load_dwordx4 a[96:99], v1, s[12:15], s18 offen offset:0
    v_mfma_f32_16x16x32_bf16 v[120:123], v[76:79], a[56:59], v[120:123]
    s_waitcnt lgkmcnt(4)
    ds_read_b128 v[68:71], v10 offset:49152
    v_mfma_f32_16x16x32_bf16 v[120:123], v[72:75], a[48:51], v[120:123]
    buffer_load_dwordx4 a[100:103], v1, s[12:15], s18 offen offset:256
    v_mfma_f32_16x16x32_bf16 v[128:131], v[80:83], a[48:51], v[128:131]
    s_waitcnt lgkmcnt(4)
    ds_read_b128 v[72:75], v8 offset:51200
    v_mfma_f32_16x16x32_bf16 v[128:131], v[84:87], a[56:59], v[128:131]
    v_mfma_f32_16x16x32_bf16 v[132:135], v[84:87], a[60:63], v[132:135]
    s_waitcnt lgkmcnt(4)
    ds_read_b128 v[76:79], v10 offset:51200
    v_mfma_f32_16x16x32_bf16 v[132:135], v[80:83], a[52:55], v[132:135]
    buffer_load_dwordx4 a[104:107], v1, s[12:15], s18 offen offset:2048
    v_mfma_f32_16x16x32_bf16 v[140:143], v[88:91], a[52:55], v[140:143]
    s_waitcnt lgkmcnt(4)
    ds_read_b128 v[80:83], v8 offset:53248
    v_mfma_f32_16x16x32_bf16 v[140:143], v[92:95], a[60:63], v[140:143]
    v_mfma_f32_16x16x32_bf16 v[136:139], v[92:95], a[56:59], v[136:139]
    s_waitcnt lgkmcnt(4)
    ds_read_b128 v[84:87], v10 offset:53248
    v_mfma_f32_16x16x32_bf16 v[136:139], v[88:91], a[48:51], v[136:139]
    s_waitcnt vmcnt(14)
    buffer_load_dwordx4 a[108:111], v1, s[12:15], s18 offen offset:2304
    v_mfma_f32_16x16x32_bf16 v[96:99], v[64:67], a[64:67], v[96:99]
    s_waitcnt vmcnt(13) lgkmcnt(4)
    ds_read_b128 v[88:91], v8 offset:55296
    v_mfma_f32_16x16x32_bf16 v[96:99], v[68:71], a[72:75], v[96:99]
    s_waitcnt vmcnt(12)
    v_mfma_f32_16x16x32_bf16 v[100:103], v[68:71], a[76:79], v[100:103]
    s_waitcnt lgkmcnt(4)
    ds_read_b128 v[92:95], v10 offset:55296
    s_add_u32 m0, s22, 81920
    v_mfma_f32_16x16x32_bf16 v[100:103], v[64:67], a[68:71], v[100:103]
    s_add_u32 s16, s16, 16384
    v_mfma_f32_16x16x32_bf16 v[108:111], v[72:75], a[68:71], v[108:111]
    s_waitcnt lgkmcnt(4)
    ds_read_b128 v[64:67], v8 offset:57344
    v_mfma_f32_16x16x32_bf16 v[108:111], v[76:79], a[76:79], v[108:111]
    buffer_load_dwordx4 v4, s[12:15], s16 offen offset:0 lds
    v_mfma_f32_16x16x32_bf16 v[104:107], v[76:79], a[72:75], v[104:107]
    s_waitcnt lgkmcnt(4)
    ds_read_b128 v[68:71], v10 offset:57344
    v_mfma_f32_16x16x32_bf16 v[104:107], v[72:75], a[64:67], v[104:107]
    buffer_load_dwordx4 v4, s[12:15], s16 offen offset:1024 lds
    v_mfma_f32_16x16x32_bf16 v[112:115], v[80:83], a[64:67], v[112:115]
    s_waitcnt lgkmcnt(4)
    ds_read_b128 v[72:75], v8 offset:59392
    v_mfma_f32_16x16x32_bf16 v[112:115], v[84:87], a[72:75], v[112:115]
    buffer_load_dwordx4 v4, s[12:15], s16 offen offset:2048 lds
    v_mfma_f32_4x4x4_16b_bf16 v[40:43], a[64:65], a[64:65], v[40:43]
    v_mfma_f32_4x4x4_16b_bf16 v[44:47], a[66:67], a[66:67], v[44:47]
    v_mfma_f32_4x4x4_16b_bf16 v[48:51], a[68:69], a[68:69], v[48:51]
    v_mfma_f32_4x4x4_16b_bf16 v[52:55], a[70:71], a[70:71], v[52:55]
    v_mfma_f32_4x4x4_16b_bf16 v[40:43], a[72:73], a[72:73], v[40:43]
    v_mfma_f32_4x4x4_16b_bf16 v[44:47], a[74:75], a[74:75], v[44:47]
    v_mfma_f32_4x4x4_16b_bf16 v[48:51], a[76:77], a[76:77], v[48:51]
    v_mfma_f32_4x4x4_16b_bf16 v[52:55], a[78:79], a[78:79], v[52:55]
    v_mfma_f32_16x16x32_bf16 v[116:119], v[84:87], a[76:79], v[116:119]
    s_waitcnt lgkmcnt(4)
    ds_read_b128 v[76:79], v10 offset:59392
    v_mfma_f32_16x16x32_bf16 v[116:119], v[80:83], a[68:71], v[116:119]
    v_mfma_f32_16x16x32_bf16 v[124:127], v[88:91], a[68:71], v[124:127]
    s_waitcnt lgkmcnt(4)
    ds_read_b128 v[80:83], v8 offset:61440
    v_mfma_f32_16x16x32_bf16 v[124:127], v[92:95], a[76:79], v[124:127]
    buffer_load_dwordx4 v4, s[12:15], s16 offen offset:3072 lds
    v_mfma_f32_16x16x32_bf16 v[120:123], v[92:95], a[72:75], v[120:123]
    s_waitcnt lgkmcnt(4)
    ds_read_b128 v[84:87], v10 offset:61440
    s_add_u32 s18, s18, 4096
    v_mfma_f32_16x16x32_bf16 v[120:123], v[88:91], a[64:67], v[120:123]
    buffer_load_dwordx4 a[112:115], v1, s[12:15], s18 offen offset:0
    v_mfma_f32_16x16x32_bf16 v[128:131], v[64:67], a[64:67], v[128:131]
    s_waitcnt lgkmcnt(4)
    ds_read_b128 v[88:91], v8 offset:63488
    v_mfma_f32_16x16x32_bf16 v[128:131], v[68:71], a[72:75], v[128:131]
    v_mfma_f32_16x16x32_bf16 v[132:135], v[68:71], a[76:79], v[132:135]
    s_waitcnt lgkmcnt(4)
    ds_read_b128 v[92:95], v10 offset:63488
    v_mfma_f32_16x16x32_bf16 v[132:135], v[64:67], a[68:71], v[132:135]
    s_waitcnt vmcnt(9)
    s_barrier
    v_mfma_f32_16x16x32_bf16 v[140:143], v[72:75], a[68:71], v[140:143]
    s_waitcnt lgkmcnt(4)
    ds_read_b128 v[64:67], v9 offset:0
    v_mfma_f32_16x16x32_bf16 v[140:143], v[76:79], a[76:79], v[140:143]
    buffer_load_dwordx4 a[116:119], v1, s[12:15], s18 offen offset:256
    v_mfma_f32_16x16x32_bf16 v[136:139], v[76:79], a[72:75], v[136:139]
    s_waitcnt lgkmcnt(4)
    ds_read_b128 v[68:71], v11 offset:0
    v_mfma_f32_16x16x32_bf16 v[136:139], v[72:75], a[64:67], v[136:139]
    buffer_load_dwordx4 a[120:123], v1, s[12:15], s18 offen offset:2048
    v_mfma_f32_16x16x32_bf16 v[96:99], v[80:83], a[80:83], v[96:99]
    s_waitcnt lgkmcnt(4)
    ds_read_b128 v[72:75], v9 offset:2048
    v_mfma_f32_16x16x32_bf16 v[96:99], v[84:87], a[88:91], v[96:99]
    v_mfma_f32_16x16x32_bf16 v[100:103], v[84:87], a[92:95], v[100:103]
    s_waitcnt lgkmcnt(4)
    ds_read_b128 v[76:79], v11 offset:2048
    v_mfma_f32_16x16x32_bf16 v[100:103], v[80:83], a[84:87], v[100:103]
    buffer_load_dwordx4 a[124:127], v1, s[12:15], s18 offen offset:2304
    v_mfma_f32_16x16x32_bf16 v[108:111], v[88:91], a[84:87], v[108:111]
    s_waitcnt lgkmcnt(4)
    ds_read_b128 v[80:83], v9 offset:4096
    s_add_u32 m0, s22, 98304
    v_mfma_f32_16x16x32_bf16 v[108:111], v[92:95], a[92:95], v[108:111]
    s_add_u32 s16, s16, 16384
    v_mfma_f32_16x16x32_bf16 v[104:107], v[92:95], a[88:91], v[104:107]
    s_waitcnt lgkmcnt(4)
    ds_read_b128 v[84:87], v11 offset:4096
    v_mfma_f32_16x16x32_bf16 v[104:107], v[88:91], a[80:83], v[104:107]
    buffer_load_dwordx4 v4, s[12:15], s16 offen offset:0 lds
    v_mfma_f32_16x16x32_bf16 v[112:115], v[64:67], a[80:83], v[112:115]
    s_waitcnt lgkmcnt(4)
    ds_read_b128 v[88:91], v9 offset:6144
    v_mfma_f32_16x16x32_bf16 v[112:115], v[68:71], a[88:91], v[112:115]
    buffer_load_dwordx4 v4, s[12:15], s16 offen offset:1024 lds
    v_mfma_f32_4x4x4_16b_bf16 v[40:43], a[80:81], a[80:81], v[40:43]
    v_mfma_f32_4x4x4_16b_bf16 v[44:47], a[82:83], a[82:83], v[44:47]
    v_mfma_f32_4x4x4_16b_bf16 v[48:51], a[84:85], a[84:85], v[48:51]
    v_mfma_f32_4x4x4_16b_bf16 v[52:55], a[86:87], a[86:87], v[52:55]
    v_mfma_f32_4x4x4_16b_bf16 v[40:43], a[88:89], a[88:89], v[40:43]
    v_mfma_f32_4x4x4_16b_bf16 v[44:47], a[90:91], a[90:91], v[44:47]
    v_mfma_f32_4x4x4_16b_bf16 v[48:51], a[92:93], a[92:93], v[48:51]
    v_mfma_f32_4x4x4_16b_bf16 v[52:55], a[94:95], a[94:95], v[52:55]
    v_mfma_f32_16x16x32_bf16 v[116:119], v[68:71], a[92:95], v[116:119]
    s_waitcnt lgkmcnt(4)
    ds_read_b128 v[92:95], v11 offset:6144
    v_mfma_f32_16x16x32_bf16 v[116:119], v[64:67], a[84:87], v[116:119]
    v_mfma_f32_16x16x32_bf16 v[124:127], v[72:75], a[84:87], v[124:127]
    s_waitcnt lgkmcnt(4)
    ds_read_b128 v[64:67], v9 offset:8192
    v_mfma_f32_16x16x32_bf16 v[124:127], v[76:79], a[92:95], v[124:127]
    buffer_load_dwordx4 v4, s[12:15], s16 offen offset:2048 lds
    v_mfma_f32_16x16x32_bf16 v[120:123], v[76:79], a[88:91], v[120:123]
    s_waitcnt lgkmcnt(4)
    ds_read_b128 v[68:71], v11 offset:8192
    v_mfma_f32_16x16x32_bf16 v[120:123], v[72:75], a[80:83], v[120:123]
    buffer_load_dwordx4 v4, s[12:15], s16 offen offset:3072 lds
    v_mfma_f32_16x16x32_bf16 v[128:131], v[80:83], a[80:83], v[128:131]
    s_waitcnt lgkmcnt(4)
    ds_read_b128 v[72:75], v9 offset:10240
    v_mfma_f32_16x16x32_bf16 v[128:131], v[84:87], a[88:91], v[128:131]
    v_mfma_f32_16x16x32_bf16 v[132:135], v[84:87], a[92:95], v[132:135]
    s_waitcnt lgkmcnt(4)
    ds_read_b128 v[76:79], v11 offset:10240
    s_add_u32 s18, s18, 4096
    v_mfma_f32_16x16x32_bf16 v[132:135], v[80:83], a[84:87], v[132:135]
    buffer_load_dwordx4 a[128:131], v1, s[12:15], s18 offen offset:0
    v_mfma_f32_16x16x32_bf16 v[140:143], v[88:91], a[84:87], v[140:143]
    s_waitcnt lgkmcnt(4)
    ds_read_b128 v[80:83], v9 offset:12288
    v_mfma_f32_16x16x32_bf16 v[140:143], v[92:95], a[92:95], v[140:143]
    v_mfma_f32_16x16x32_bf16 v[136:139], v[92:95], a[88:91], v[136:139]
    s_waitcnt lgkmcnt(4)
    ds_read_b128 v[84:87], v11 offset:12288
    v_mfma_f32_16x16x32_bf16 v[136:139], v[88:91], a[80:83], v[136:139]
    s_waitcnt vmcnt(16)
    buffer_load_dwordx4 a[132:135], v1, s[12:15], s18 offen offset:256
    v_mfma_f32_16x16x32_bf16 v[96:99], v[64:67], a[96:99], v[96:99]
    s_waitcnt vmcnt(15) lgkmcnt(4)
    ds_read_b128 v[88:91], v9 offset:14336
    v_mfma_f32_16x16x32_bf16 v[96:99], v[68:71], a[104:107], v[96:99]
    s_waitcnt vmcnt(14)
    v_mfma_f32_16x16x32_bf16 v[100:103], v[68:71], a[108:111], v[100:103]
    s_waitcnt lgkmcnt(4)
    ds_read_b128 v[92:95], v11 offset:14336
    v_mfma_f32_16x16x32_bf16 v[100:103], v[64:67], a[100:103], v[100:103]
    s_waitcnt vmcnt(10)
    s_barrier
    v_mfma_f32_16x16x32_bf16 v[108:111], v[72:75], a[100:103], v[108:111]
    s_waitcnt lgkmcnt(4)
    ds_read_b128 v[64:67], v9 offset:16384
    v_mfma_f32_16x16x32_bf16 v[108:111], v[76:79], a[108:111], v[108:111]
    buffer_load_dwordx4 a[136:139], v1, s[12:15], s18 offen offset:2048
    v_mfma_f32_16x16x32_bf16 v[104:107], v[76:79], a[104:107], v[104:107]
    s_waitcnt lgkmcnt(4)
    ds_read_b128 v[68:71], v11 offset:16384
    v_mfma_f32_16x16x32_bf16 v[104:107], v[72:75], a[96:99], v[104:107]
    buffer_load_dwordx4 a[140:143], v1, s[12:15], s18 offen offset:2304
    v_mfma_f32_16x16x32_bf16 v[112:115], v[80:83], a[96:99], v[112:115]
    s_waitcnt lgkmcnt(4)
    ds_read_b128 v[72:75], v9 offset:18432
    s_add_u32 s18, s18, 4096
    v_mfma_f32_16x16x32_bf16 v[112:115], v[84:87], a[104:107], v[112:115]
    buffer_load_dwordx4 a[144:147], v1, s[12:15], s18 offen offset:0
    v_mfma_f32_4x4x4_16b_bf16 v[40:43], a[96:97], a[96:97], v[40:43]
    v_mfma_f32_4x4x4_16b_bf16 v[44:47], a[98:99], a[98:99], v[44:47]
    v_mfma_f32_4x4x4_16b_bf16 v[48:51], a[100:101], a[100:101], v[48:51]
    v_mfma_f32_4x4x4_16b_bf16 v[52:55], a[102:103], a[102:103], v[52:55]
    v_mfma_f32_4x4x4_16b_bf16 v[40:43], a[104:105], a[104:105], v[40:43]
    v_mfma_f32_4x4x4_16b_bf16 v[44:47], a[106:107], a[106:107], v[44:47]
    v_mfma_f32_4x4x4_16b_bf16 v[48:51], a[108:109], a[108:109], v[48:51]
    v_mfma_f32_4x4x4_16b_bf16 v[52:55], a[110:111], a[110:111], v[52:55]
    v_mfma_f32_16x16x32_bf16 v[116:119], v[84:87], a[108:111], v[116:119]
    s_waitcnt lgkmcnt(4)
    ds_read_b128 v[76:79], v11 offset:18432
    v_mfma_f32_16x16x32_bf16 v[116:119], v[80:83], a[100:103], v[116:119]
    v_mfma_f32_16x16x32_bf16 v[124:127], v[88:91], a[100:103], v[124:127]
    s_waitcnt lgkmcnt(4)
    ds_read_b128 v[80:83], v9 offset:20480
    v_mfma_f32_16x16x32_bf16 v[124:127], v[92:95], a[108:111], v[124:127]
    buffer_load_dwordx4 a[148:151], v1, s[12:15], s18 offen offset:256
    v_mfma_f32_16x16x32_bf16 v[120:123], v[92:95], a[104:107], v[120:123]
    s_waitcnt lgkmcnt(4)
    ds_read_b128 v[84:87], v11 offset:20480
    v_mfma_f32_16x16x32_bf16 v[120:123], v[88:91], a[96:99], v[120:123]
    buffer_load_dwordx4 a[152:155], v1, s[12:15], s18 offen offset:2048
    v_mfma_f32_16x16x32_bf16 v[128:131], v[64:67], a[96:99], v[128:131]
    s_waitcnt lgkmcnt(4)
    ds_read_b128 v[88:91], v9 offset:22528
    v_mfma_f32_16x16x32_bf16 v[128:131], v[68:71], a[104:107], v[128:131]
    v_mfma_f32_16x16x32_bf16 v[132:135], v[68:71], a[108:111], v[132:135]
    s_waitcnt lgkmcnt(4)
    ds_read_b128 v[92:95], v11 offset:22528
    v_mfma_f32_16x16x32_bf16 v[132:135], v[64:67], a[100:103], v[132:135]
    buffer_load_dwordx4 a[156:159], v1, s[12:15], s18 offen offset:2304
    v_mfma_f32_16x16x32_bf16 v[140:143], v[72:75], a[100:103], v[140:143]
    s_waitcnt lgkmcnt(4)
    ds_read_b128 v[64:67], v9 offset:24576
    v_mfma_f32_16x16x32_bf16 v[140:143], v[76:79], a[108:111], v[140:143]
    v_mfma_f32_16x16x32_bf16 v[136:139], v[76:79], a[104:107], v[136:139]
    s_waitcnt lgkmcnt(4)
    ds_read_b128 v[68:71], v11 offset:24576
    s_add_u32 m0, s22, 114688
    v_mfma_f32_16x16x32_bf16 v[136:139], v[72:75], a[96:99], v[136:139]
    s_waitcnt vmcnt(15)
    s_add_u32 s16, s16, 16384
    v_mfma_f32_16x16x32_bf16 v[96:99], v[80:83], a[112:115], v[96:99]
    s_waitcnt vmcnt(13) lgkmcnt(4)
    ds_read_b128 v[72:75], v9 offset:26624
    v_mfma_f32_16x16x32_bf16 v[96:99], v[84:87], a[120:123], v[96:99]
    s_waitcnt vmcnt(12)
    buffer_load_dwordx4 v4, s[12:15], s16 offen offset:0 lds
    v_mfma_f32_16x16x32_bf16 v[100:103], v[84:87], a[124:127], v[100:103]
    s_waitcnt lgkmcnt(4)
    ds_read_b128 v[76:79], v11 offset:26624
    v_mfma_f32_16x16x32_bf16 v[100:103], v[80:83], a[116:119], v[100:103]
    buffer_load_dwordx4 v4, s[12:15], s16 offen offset:1024 lds
    v_mfma_f32_16x16x32_bf16 v[108:111], v[88:91], a[116:119], v[108:111]
    s_waitcnt lgkmcnt(4)
    ds_read_b128 v[80:83], v9 offset:28672
    v_mfma_f32_16x16x32_bf16 v[108:111], v[92:95], a[124:127], v[108:111]
    buffer_load_dwordx4 v4, s[12:15], s16 offen offset:2048 lds
    v_mfma_f32_16x16x32_bf16 v[104:107], v[92:95], a[120:123], v[104:107]
    s_waitcnt lgkmcnt(4)
    ds_read_b128 v[84:87], v11 offset:28672
    v_mfma_f32_16x16x32_bf16 v[104:107], v[88:91], a[112:115], v[104:107]
    v_mfma_f32_16x16x32_bf16 v[112:115], v[64:67], a[112:115], v[112:115]
    s_waitcnt lgkmcnt(4)
    ds_read_b128 v[88:91], v9 offset:30720
    v_mfma_f32_16x16x32_bf16 v[112:115], v[68:71], a[120:123], v[112:115]
    buffer_load_dwordx4 v4, s[12:15], s16 offen offset:3072 lds
    v_mfma_f32_4x4x4_16b_bf16 v[40:43], a[112:113], a[112:113], v[40:43]
    v_mfma_f32_4x4x4_16b_bf16 v[44:47], a[114:115], a[114:115], v[44:47]
    v_mfma_f32_4x4x4_16b_bf16 v[48:51], a[116:117], a[116:117], v[48:51]
    v_mfma_f32_4x4x4_16b_bf16 v[52:55], a[118:119], a[118:119], v[52:55]
    v_mfma_f32_4x4x4_16b_bf16 v[40:43], a[120:121], a[120:121], v[40:43]
    v_mfma_f32_4x4x4_16b_bf16 v[44:47], a[122:123], a[122:123], v[44:47]
    v_mfma_f32_4x4x4_16b_bf16 v[48:51], a[124:125], a[124:125], v[48:51]
    v_mfma_f32_4x4x4_16b_bf16 v[52:55], a[126:127], a[126:127], v[52:55]
    v_mfma_f32_16x16x32_bf16 v[116:119], v[68:71], a[124:127], v[116:119]
    s_waitcnt lgkmcnt(4)
    ds_read_b128 v[92:95], v11 offset:30720
    v_mfma_f32_16x16x32_bf16 v[116:119], v[64:67], a[116:119], v[116:119]
    s_waitcnt vmcnt(12)
    s_barrier
    v_mfma_f32_16x16x32_bf16 v[124:127], v[72:75], a[116:119], v[124:127]
    s_waitcnt lgkmcnt(4)
    ds_read_b128 v[64:67], v9 offset:32768
    s_add_u32 s18, s18, 4096
    v_mfma_f32_16x16x32_bf16 v[124:127], v[76:79], a[124:127], v[124:127]
    buffer_load_dwordx4 a[160:163], v1, s[12:15], s18 offen offset:0
    v_mfma_f32_16x16x32_bf16 v[120:123], v[76:79], a[120:123], v[120:123]
    s_waitcnt lgkmcnt(4)
    ds_read_b128 v[68:71], v11 offset:32768
    v_mfma_f32_16x16x32_bf16 v[120:123], v[72:75], a[112:115], v[120:123]
    buffer_load_dwordx4 a[164:167], v1, s[12:15], s18 offen offset:256
    v_mfma_f32_16x16x32_bf16 v[128:131], v[80:83], a[112:115], v[128:131]
    s_waitcnt lgkmcnt(4)
    ds_read_b128 v[72:75], v9 offset:34816
    v_mfma_f32_16x16x32_bf16 v[128:131], v[84:87], a[120:123], v[128:131]
    v_mfma_f32_16x16x32_bf16 v[132:135], v[84:87], a[124:127], v[132:135]
    s_waitcnt lgkmcnt(4)
    ds_read_b128 v[76:79], v11 offset:34816
    v_mfma_f32_16x16x32_bf16 v[132:135], v[80:83], a[116:119], v[132:135]
    buffer_load_dwordx4 a[168:171], v1, s[12:15], s18 offen offset:2048
    v_mfma_f32_16x16x32_bf16 v[140:143], v[88:91], a[116:119], v[140:143]
    s_waitcnt lgkmcnt(4)
    ds_read_b128 v[80:83], v9 offset:36864
    v_mfma_f32_16x16x32_bf16 v[140:143], v[92:95], a[124:127], v[140:143]
    v_mfma_f32_16x16x32_bf16 v[136:139], v[92:95], a[120:123], v[136:139]
    s_waitcnt lgkmcnt(4)
    ds_read_b128 v[84:87], v11 offset:36864
    v_mfma_f32_16x16x32_bf16 v[136:139], v[88:91], a[112:115], v[136:139]
    s_waitcnt vmcnt(14)
    buffer_load_dwordx4 a[172:175], v1, s[12:15], s18 offen offset:2304
    v_mfma_f32_16x16x32_bf16 v[96:99], v[64:67], a[128:131], v[96:99]
    s_waitcnt vmcnt(13) lgkmcnt(4)
    ds_read_b128 v[88:91], v9 offset:38912
    v_mfma_f32_16x16x32_bf16 v[96:99], v[68:71], a[136:139], v[96:99]
    s_waitcnt vmcnt(12)
    v_mfma_f32_16x16x32_bf16 v[100:103], v[68:71], a[140:143], v[100:103]
    s_waitcnt lgkmcnt(4)
    ds_read_b128 v[92:95], v11 offset:38912
    s_add_u32 m0, s22, 0
    v_mfma_f32_16x16x32_bf16 v[100:103], v[64:67], a[132:135], v[100:103]
    s_add_u32 s16, s16, 16384
    v_mfma_f32_16x16x32_bf16 v[108:111], v[72:75], a[132:135], v[108:111]
    s_waitcnt lgkmcnt(4)
    ds_read_b128 v[64:67], v9 offset:40960
    v_mfma_f32_16x16x32_bf16 v[108:111], v[76:79], a[140:143], v[108:111]
    buffer_load_dwordx4 v4, s[12:15], s16 offen offset:0 lds
    v_mfma_f32_16x16x32_bf16 v[104:107], v[76:79], a[136:139], v[104:107]
    s_waitcnt lgkmcnt(4)
    ds_read_b128 v[68:71], v11 offset:40960
    v_mfma_f32_16x16x32_bf16 v[104:107], v[72:75], a[128:131], v[104:107]
    buffer_load_dwordx4 v4, s[12:15], s16 offen offset:1024 lds
    v_mfma_f32_16x16x32_bf16 v[112:115], v[80:83], a[128:131], v[112:115]
    s_waitcnt lgkmcnt(4)
    ds_read_b128 v[72:75], v9 offset:43008
    v_mfma_f32_16x16x32_bf16 v[112:115], v[84:87], a[136:139], v[112:115]
    buffer_load_dwordx4 v4, s[12:15], s16 offen offset:2048 lds
    v_mfma_f32_4x4x4_16b_bf16 v[40:43], a[128:129], a[128:129], v[40:43]
    v_mfma_f32_4x4x4_16b_bf16 v[44:47], a[130:131], a[130:131], v[44:47]
    v_mfma_f32_4x4x4_16b_bf16 v[48:51], a[132:133], a[132:133], v[48:51]
    v_mfma_f32_4x4x4_16b_bf16 v[52:55], a[134:135], a[134:135], v[52:55]
    v_mfma_f32_4x4x4_16b_bf16 v[40:43], a[136:137], a[136:137], v[40:43]
    v_mfma_f32_4x4x4_16b_bf16 v[44:47], a[138:139], a[138:139], v[44:47]
    v_mfma_f32_4x4x4_16b_bf16 v[48:51], a[140:141], a[140:141], v[48:51]
    v_mfma_f32_4x4x4_16b_bf16 v[52:55], a[142:143], a[142:143], v[52:55]
    v_mfma_f32_16x16x32_bf16 v[116:119], v[84:87], a[140:143], v[116:119]
    s_waitcnt lgkmcnt(4)
    ds_read_b128 v[76:79], v11 offset:43008
    v_mfma_f32_16x16x32_bf16 v[116:119], v[80:83], a[132:135], v[116:119]
    v_mfma_f32_16x16x32_bf16 v[124:127], v[88:91], a[132:135], v[124:127]
    s_waitcnt lgkmcnt(4)
    ds_read_b128 v[80:83], v9 offset:45056
    v_mfma_f32_16x16x32_bf16 v[124:127], v[92:95], a[140:143], v[124:127]
    buffer_load_dwordx4 v4, s[12:15], s16 offen offset:3072 lds
    v_mfma_f32_16x16x32_bf16 v[120:123], v[92:95], a[136:139], v[120:123]
    s_waitcnt lgkmcnt(4)
    ds_read_b128 v[84:87], v11 offset:45056
    s_add_u32 s18, s18, 4096
    v_mfma_f32_16x16x32_bf16 v[120:123], v[88:91], a[128:131], v[120:123]
    buffer_load_dwordx4 a[176:179], v1, s[12:15], s18 offen offset:0
    v_mfma_f32_16x16x32_bf16 v[128:131], v[64:67], a[128:131], v[128:131]
    s_waitcnt lgkmcnt(4)
    ds_read_b128 v[88:91], v9 offset:47104
    v_mfma_f32_16x16x32_bf16 v[128:131], v[68:71], a[136:139], v[128:131]
    v_mfma_f32_16x16x32_bf16 v[132:135], v[68:71], a[140:143], v[132:135]
    s_waitcnt lgkmcnt(4)
    ds_read_b128 v[92:95], v11 offset:47104
    v_mfma_f32_16x16x32_bf16 v[132:135], v[64:67], a[132:135], v[132:135]
    s_waitcnt vmcnt(9)
    s_barrier
    v_mfma_f32_16x16x32_bf16 v[140:143], v[72:75], a[132:135], v[140:143]
    s_waitcnt lgkmcnt(4)
    ds_read_b128 v[64:67], v9 offset:49152
    v_mfma_f32_16x16x32_bf16 v[140:143], v[76:79], a[140:143], v[140:143]
    buffer_load_dwordx4 a[180:183], v1, s[12:15], s18 offen offset:256
    v_mfma_f32_16x16x32_bf16 v[136:139], v[76:79], a[136:139], v[136:139]
    s_waitcnt lgkmcnt(4)
    ds_read_b128 v[68:71], v11 offset:49152
    v_mfma_f32_16x16x32_bf16 v[136:139], v[72:75], a[128:131], v[136:139]
    buffer_load_dwordx4 a[184:187], v1, s[12:15], s18 offen offset:2048
    v_mfma_f32_16x16x32_bf16 v[96:99], v[80:83], a[144:147], v[96:99]
    s_waitcnt lgkmcnt(4)
    ds_read_b128 v[72:75], v9 offset:51200
    v_mfma_f32_16x16x32_bf16 v[96:99], v[84:87], a[152:155], v[96:99]
    v_mfma_f32_16x16x32_bf16 v[100:103], v[84:87], a[156:159], v[100:103]
    s_waitcnt lgkmcnt(4)
    ds_read_b128 v[76:79], v11 offset:51200
    v_mfma_f32_16x16x32_bf16 v[100:103], v[80:83], a[148:151], v[100:103]
    buffer_load_dwordx4 a[188:191], v1, s[12:15], s18 offen offset:2304
    v_mfma_f32_16x16x32_bf16 v[108:111], v[88:91], a[148:151], v[108:111]
    s_waitcnt lgkmcnt(4)
    ds_read_b128 v[80:83], v9 offset:53248
    s_add_u32 m0, s22, 16384
    v_mfma_f32_16x16x32_bf16 v[108:111], v[92:95], a[156:159], v[108:111]
    s_add_u32 s16, s16, 16384
    v_mfma_f32_16x16x32_bf16 v[104:107], v[92:95], a[152:155], v[104:107]
    s_waitcnt lgkmcnt(4)
    ds_read_b128 v[84:87], v11 offset:53248
    v_mfma_f32_16x16x32_bf16 v[104:107], v[88:91], a[144:147], v[104:107]
    buffer_load_dwordx4 v4, s[12:15], s16 offen offset:0 lds
    v_mfma_f32_16x16x32_bf16 v[112:115], v[64:67], a[144:147], v[112:115]
    s_waitcnt lgkmcnt(4)
    ds_read_b128 v[88:91], v9 offset:55296
    v_mfma_f32_16x16x32_bf16 v[112:115], v[68:71], a[152:155], v[112:115]
    buffer_load_dwordx4 v4, s[12:15], s16 offen offset:1024 lds
    v_mfma_f32_4x4x4_16b_bf16 v[40:43], a[144:145], a[144:145], v[40:43]
    v_mfma_f32_4x4x4_16b_bf16 v[44:47], a[146:147], a[146:147], v[44:47]
    v_mfma_f32_4x4x4_16b_bf16 v[48:51], a[148:149], a[148:149], v[48:51]
    v_mfma_f32_4x4x4_16b_bf16 v[52:55], a[150:151], a[150:151], v[52:55]
    v_mfma_f32_4x4x4_16b_bf16 v[40:43], a[152:153], a[152:153], v[40:43]
    v_mfma_f32_4x4x4_16b_bf16 v[44:47], a[154:155], a[154:155], v[44:47]
    v_mfma_f32_4x4x4_16b_bf16 v[48:51], a[156:157], a[156:157], v[48:51]
    v_mfma_f32_4x4x4_16b_bf16 v[52:55], a[158:159], a[158:159], v[52:55]
    v_mfma_f32_16x16x32_bf16 v[116:119], v[68:71], a[156:159], v[116:119]
    s_waitcnt lgkmcnt(4)
    ds_read_b128 v[92:95], v11 offset:55296
    v_mfma_f32_16x16x32_bf16 v[116:119], v[64:67], a[148:151], v[116:119]
    v_mfma_f32_16x16x32_bf16 v[124:127], v[72:75], a[148:151], v[124:127]
    s_waitcnt lgkmcnt(4)
    ds_read_b128 v[64:67], v9 offset:57344
    v_mfma_f32_16x16x32_bf16 v[124:127], v[76:79], a[156:159], v[124:127]
    buffer_load_dwordx4 v4, s[12:15], s16 offen offset:2048 lds
    v_mfma_f32_16x16x32_bf16 v[120:123], v[76:79], a[152:155], v[120:123]
    s_waitcnt lgkmcnt(4)
    ds_read_b128 v[68:71], v11 offset:57344
    v_mfma_f32_16x16x32_bf16 v[120:123], v[72:75], a[144:147], v[120:123]
    buffer_load_dwordx4 v4, s[12:15], s16 offen offset:3072 lds
    v_mfma_f32_16x16x32_bf16 v[128:131], v[80:83], a[144:147], v[128:131]
    s_waitcnt lgkmcnt(4)
    ds_read_b128 v[72:75], v9 offset:59392
    v_mfma_f32_16x16x32_bf16 v[128:131], v[84:87], a[152:155], v[128:131]
    v_mfma_f32_16x16x32_bf16 v[132:135], v[84:87], a[156:159], v[132:135]
    s_waitcnt lgkmcnt(4)
    ds_read_b128 v[76:79], v11 offset:59392
    s_add_u32 s18, s18, 4096
    v_mfma_f32_16x16x32_bf16 v[132:135], v[80:83], a[148:151], v[132:135]
    buffer_load_dwordx4 a[192:195], v1, s[12:15], s18 offen offset:0
    v_mfma_f32_16x16x32_bf16 v[140:143], v[88:91], a[148:151], v[140:143]
    s_waitcnt lgkmcnt(4)
    ds_read_b128 v[80:83], v9 offset:61440
    v_mfma_f32_16x16x32_bf16 v[140:143], v[92:95], a[156:159], v[140:143]
    v_mfma_f32_16x16x32_bf16 v[136:139], v[92:95], a[152:155], v[136:139]
    s_waitcnt lgkmcnt(4)
    ds_read_b128 v[84:87], v11 offset:61440
    v_mfma_f32_16x16x32_bf16 v[136:139], v[88:91], a[144:147], v[136:139]
    s_waitcnt vmcnt(16)
    buffer_load_dwordx4 a[196:199], v1, s[12:15], s18 offen offset:256
    v_mfma_f32_16x16x32_bf16 v[96:99], v[64:67], a[160:163], v[96:99]
    s_waitcnt vmcnt(15) lgkmcnt(4)
    ds_read_b128 v[88:91], v9 offset:63488
    v_mfma_f32_16x16x32_bf16 v[96:99], v[68:71], a[168:171], v[96:99]
    s_waitcnt vmcnt(14)
    v_mfma_f32_16x16x32_bf16 v[100:103], v[68:71], a[172:175], v[100:103]
    s_waitcnt lgkmcnt(4)
    ds_read_b128 v[92:95], v11 offset:63488
    v_mfma_f32_16x16x32_bf16 v[100:103], v[64:67], a[164:167], v[100:103]
    s_waitcnt vmcnt(10)
    s_barrier
    v_mfma_f32_16x16x32_bf16 v[108:111], v[72:75], a[164:167], v[108:111]
    s_waitcnt lgkmcnt(4)
    ds_read_b128 v[64:67], v8 offset:0
    v_mfma_f32_16x16x32_bf16 v[108:111], v[76:79], a[172:175], v[108:111]
    buffer_load_dwordx4 a[200:203], v1, s[12:15], s18 offen offset:2048
    v_mfma_f32_16x16x32_bf16 v[104:107], v[76:79], a[168:171], v[104:107]
    s_waitcnt lgkmcnt(4)
    ds_read_b128 v[68:71], v10 offset:0
    v_mfma_f32_16x16x32_bf16 v[104:107], v[72:75], a[160:163], v[104:107]
    buffer_load_dwordx4 a[204:207], v1, s[12:15], s18 offen offset:2304
    v_mfma_f32_16x16x32_bf16 v[112:115], v[80:83], a[160:163], v[112:115]
    s_waitcnt lgkmcnt(4)
    ds_read_b128 v[72:75], v8 offset:2048
    s_add_u32 s18, s18, 4096
    v_mfma_f32_16x16x32_bf16 v[112:115], v[84:87], a[168:171], v[112:115]
    buffer_load_dwordx4 a[208:211], v1, s[12:15], s18 offen offset:0
    v_mfma_f32_4x4x4_16b_bf16 v[40:43], a[160:161], a[160:161], v[40:43]
    v_mfma_f32_4x4x4_16b_bf16 v[44:47], a[162:163], a[162:163], v[44:47]
    v_mfma_f32_4x4x4_16b_bf16 v[48:51], a[164:165], a[164:165], v[48:51]
    v_mfma_f32_4x4x4_16b_bf16 v[52:55], a[166:167], a[166:167], v[52:55]
    v_mfma_f32_4x4x4_16b_bf16 v[40:43], a[168:169], a[168:169], v[40:43]
    v_mfma_f32_4x4x4_16b_bf16 v[44:47], a[170:171], a[170:171], v[44:47]
    v_mfma_f32_4x4x4_16b_bf16 v[48:51], a[172:173], a[172:173], v[48:51]
    v_mfma_f32_4x4x4_16b_bf16 v[52:55], a[174:175], a[174:175], v[52:55]
    v_mfma_f32_16x16x32_bf16 v[116:119], v[84:87], a[172:175], v[116:119]
    s_waitcnt lgkmcnt(4)
    ds_read_b128 v[76:79], v10 offset:2048
    v_mfma_f32_16x16x32_bf16 v[116:119], v[80:83], a[164:167], v[116:119]
    v_mfma_f32_16x16x32_bf16 v[124:127], v[88:91], a[164:167], v[124:127]
    s_waitcnt lgkmcnt(4)
    ds_read_b128 v[80:83], v8 offset:4096
    v_mfma_f32_16x16x32_bf16 v[124:127], v[92:95], a[172:175], v[124:127]
    buffer_load_dwordx4 a[212:215], v1, s[12:15], s18 offen offset:256
    v_mfma_f32_16x16x32_bf16 v[120:123], v[92:95], a[168:171], v[120:123]
    s_waitcnt lgkmcnt(4)
    ds_read_b128 v[84:87], v10 offset:4096
    v_mfma_f32_16x16x32_bf16 v[120:123], v[88:91], a[160:163], v[120:123]
    buffer_load_dwordx4 a[216:219], v1, s[12:15], s18 offen offset:2048
    v_mfma_f32_16x16x32_bf16 v[128:131], v[64:67], a[160:163], v[128:131]
    s_waitcnt lgkmcnt(4)
    ds_read_b128 v[88:91], v8 offset:6144
    v_mfma_f32_16x16x32_bf16 v[128:131], v[68:71], a[168:171], v[128:131]
    v_mfma_f32_16x16x32_bf16 v[132:135], v[68:71], a[172:175], v[132:135]
    s_waitcnt lgkmcnt(4)
    ds_read_b128 v[92:95], v10 offset:6144
    v_mfma_f32_16x16x32_bf16 v[132:135], v[64:67], a[164:167], v[132:135]
    buffer_load_dwordx4 a[220:223], v1, s[12:15], s18 offen offset:2304
    v_mfma_f32_16x16x32_bf16 v[140:143], v[72:75], a[164:167], v[140:143]
    s_waitcnt lgkmcnt(4)
    ds_read_b128 v[64:67], v8 offset:8192
    v_mfma_f32_16x16x32_bf16 v[140:143], v[76:79], a[172:175], v[140:143]
    v_mfma_f32_16x16x32_bf16 v[136:139], v[76:79], a[168:171], v[136:139]
    s_waitcnt lgkmcnt(4)
    ds_read_b128 v[68:71], v10 offset:8192
    s_add_u32 m0, s22, 32768
    v_mfma_f32_16x16x32_bf16 v[136:139], v[72:75], a[160:163], v[136:139]
    s_waitcnt vmcnt(15)
    s_add_u32 s16, s16, 16384
    v_mfma_f32_16x16x32_bf16 v[96:99], v[80:83], a[176:179], v[96:99]
    s_waitcnt vmcnt(13) lgkmcnt(4)
    ds_read_b128 v[72:75], v8 offset:10240
    v_mfma_f32_16x16x32_bf16 v[96:99], v[84:87], a[184:187], v[96:99]
    s_waitcnt vmcnt(12)
    buffer_load_dwordx4 v4, s[12:15], s16 offen offset:0 lds
    v_mfma_f32_16x16x32_bf16 v[100:103], v[84:87], a[188:191], v[100:103]
    s_waitcnt lgkmcnt(4)
    ds_read_b128 v[76:79], v10 offset:10240
    v_mfma_f32_16x16x32_bf16 v[100:103], v[80:83], a[180:183], v[100:103]
    buffer_load_dwordx4 v4, s[12:15], s16 offen offset:1024 lds
    v_mfma_f32_16x16x32_bf16 v[108:111], v[88:91], a[180:183], v[108:111]
    s_waitcnt lgkmcnt(4)
    ds_read_b128 v[80:83], v8 offset:12288
    v_mfma_f32_16x16x32_bf16 v[108:111], v[92:95], a[188:191], v[108:111]
    buffer_load_dwordx4 v4, s[12:15], s16 offen offset:2048 lds
    v_mfma_f32_16x16x32_bf16 v[104:107], v[92:95], a[184:187], v[104:107]
    s_waitcnt lgkmcnt(4)
    ds_read_b128 v[84:87], v10 offset:12288
    v_mfma_f32_16x16x32_bf16 v[104:107], v[88:91], a[176:179], v[104:107]
    v_mfma_f32_16x16x32_bf16 v[112:115], v[64:67], a[176:179], v[112:115]
    s_waitcnt lgkmcnt(4)
    ds_read_b128 v[88:91], v8 offset:14336
    v_mfma_f32_16x16x32_bf16 v[112:115], v[68:71], a[184:187], v[112:115]
    buffer_load_dwordx4 v4, s[12:15], s16 offen offset:3072 lds
    v_mfma_f32_4x4x4_16b_bf16 v[40:43], a[176:177], a[176:177], v[40:43]
    v_mfma_f32_4x4x4_16b_bf16 v[44:47], a[178:179], a[178:179], v[44:47]
    v_mfma_f32_4x4x4_16b_bf16 v[48:51], a[180:181], a[180:181], v[48:51]
    v_mfma_f32_4x4x4_16b_bf16 v[52:55], a[182:183], a[182:183], v[52:55]
    v_mfma_f32_4x4x4_16b_bf16 v[40:43], a[184:185], a[184:185], v[40:43]
    v_mfma_f32_4x4x4_16b_bf16 v[44:47], a[186:187], a[186:187], v[44:47]
    v_mfma_f32_4x4x4_16b_bf16 v[48:51], a[188:189], a[188:189], v[48:51]
    v_mfma_f32_4x4x4_16b_bf16 v[52:55], a[190:191], a[190:191], v[52:55]
    v_mfma_f32_16x16x32_bf16 v[116:119], v[68:71], a[188:191], v[116:119]
    s_waitcnt lgkmcnt(4)
    ds_read_b128 v[92:95], v10 offset:14336
    v_mfma_f32_16x16x32_bf16 v[116:119], v[64:67], a[180:183], v[116:119]
    s_waitcnt vmcnt(12)
    s_barrier
    v_mfma_f32_16x16x32_bf16 v[124:127], v[72:75], a[180:183], v[124:127]
    s_waitcnt lgkmcnt(4)
    ds_read_b128 v[64:67], v8 offset:16384
    s_add_u32 s18, s18, 4096
    v_mfma_f32_16x16x32_bf16 v[124:127], v[76:79], a[188:191], v[124:127]
    buffer_load_dwordx4 a[224:227], v1, s[12:15], s18 offen offset:0
    v_mfma_f32_16x16x32_bf16 v[120:123], v[76:79], a[184:187], v[120:123]
    s_waitcnt lgkmcnt(4)
    ds_read_b128 v[68:71], v10 offset:16384
    v_mfma_f32_16x16x32_bf16 v[120:123], v[72:75], a[176:179], v[120:123]
    buffer_load_dwordx4 a[228:231], v1, s[12:15], s18 offen offset:256
    v_mfma_f32_16x16x32_bf16 v[128:131], v[80:83], a[176:179], v[128:131]
    s_waitcnt lgkmcnt(4)
    ds_read_b128 v[72:75], v8 offset:18432
    v_mfma_f32_16x16x32_bf16 v[128:131], v[84:87], a[184:187], v[128:131]
    v_mfma_f32_16x16x32_bf16 v[132:135], v[84:87], a[188:191], v[132:135]
    s_waitcnt lgkmcnt(4)
    ds_read_b128 v[76:79], v10 offset:18432
    v_mfma_f32_16x16x32_bf16 v[132:135], v[80:83], a[180:183], v[132:135]
    buffer_load_dwordx4 a[232:235], v1, s[12:15], s18 offen offset:2048
    v_mfma_f32_16x16x32_bf16 v[140:143], v[88:91], a[180:183], v[140:143]
    s_waitcnt lgkmcnt(4)
    ds_read_b128 v[80:83], v8 offset:20480
    v_mfma_f32_16x16x32_bf16 v[140:143], v[92:95], a[188:191], v[140:143]
    v_mfma_f32_16x16x32_bf16 v[136:139], v[92:95], a[184:187], v[136:139]
    s_waitcnt lgkmcnt(4)
    ds_read_b128 v[84:87], v10 offset:20480
    v_mfma_f32_16x16x32_bf16 v[136:139], v[88:91], a[176:179], v[136:139]
    s_waitcnt vmcnt(14)
    buffer_load_dwordx4 a[236:239], v1, s[12:15], s18 offen offset:2304
    v_mfma_f32_16x16x32_bf16 v[96:99], v[64:67], a[192:195], v[96:99]
    s_waitcnt vmcnt(13) lgkmcnt(4)
    ds_read_b128 v[88:91], v8 offset:22528
    v_mfma_f32_16x16x32_bf16 v[96:99], v[68:71], a[200:203], v[96:99]
    s_waitcnt vmcnt(12)
    v_mfma_f32_16x16x32_bf16 v[100:103], v[68:71], a[204:207], v[100:103]
    s_waitcnt lgkmcnt(4)
    ds_read_b128 v[92:95], v10 offset:22528
    s_add_u32 m0, s22, 49152
    v_mfma_f32_16x16x32_bf16 v[100:103], v[64:67], a[196:199], v[100:103]
    s_add_u32 s16, s16, 16384
    v_mfma_f32_16x16x32_bf16 v[108:111], v[72:75], a[196:199], v[108:111]
    s_waitcnt lgkmcnt(4)
    ds_read_b128 v[64:67], v8 offset:24576
    v_mfma_f32_16x16x32_bf16 v[108:111], v[76:79], a[204:207], v[108:111]
    buffer_load_dwordx4 v4, s[12:15], s16 offen offset:0 lds
    v_mfma_f32_16x16x32_bf16 v[104:107], v[76:79], a[200:203], v[104:107]
    s_waitcnt lgkmcnt(4)
    ds_read_b128 v[68:71], v10 offset:24576
    v_mfma_f32_16x16x32_bf16 v[104:107], v[72:75], a[192:195], v[104:107]
    buffer_load_dwordx4 v4, s[12:15], s16 offen offset:1024 lds
    v_mfma_f32_16x16x32_bf16 v[112:115], v[80:83], a[192:195], v[112:115]
    s_waitcnt lgkmcnt(4)
    ds_read_b128 v[72:75], v8 offset:26624
    v_mfma_f32_16x16x32_bf16 v[112:115], v[84:87], a[200:203], v[112:115]
    buffer_load_dwordx4 v4, s[12:15], s16 offen offset:2048 lds
    v_mfma_f32_4x4x4_16b_bf16 v[40:43], a[192:193], a[192:193], v[40:43]
    v_mfma_f32_4x4x4_16b_bf16 v[44:47], a[194:195], a[194:195], v[44:47]
    v_mfma_f32_4x4x4_16b_bf16 v[48:51], a[196:197], a[196:197], v[48:51]
    v_mfma_f32_4x4x4_16b_bf16 v[52:55], a[198:199], a[198:199], v[52:55]
    v_mfma_f32_4x4x4_16b_bf16 v[40:43], a[200:201], a[200:201], v[40:43]
    v_mfma_f32_4x4x4_16b_bf16 v[44:47], a[202:203], a[202:203], v[44:47]
    v_mfma_f32_4x4x4_16b_bf16 v[48:51], a[204:205], a[204:205], v[48:51]
    v_mfma_f32_4x4x4_16b_bf16 v[52:55], a[206:207], a[206:207], v[52:55]
    v_mfma_f32_16x16x32_bf16 v[116:119], v[84:87], a[204:207], v[116:119]
    s_waitcnt lgkmcnt(4)
    ds_read_b128 v[76:79], v10 offset:26624
    v_mfma_f32_16x16x32_bf16 v[116:119], v[80:83], a[196:199], v[116:119]
    v_mfma_f32_16x16x32_bf16 v[124:127], v[88:91], a[196:199], v[124:127]
    s_waitcnt lgkmcnt(4)
    ds_read_b128 v[80:83], v8 offset:28672
    v_mfma_f32_16x16x32_bf16 v[124:127], v[92:95], a[204:207], v[124:127]
    buffer_load_dwordx4 v4, s[12:15], s16 offen offset:3072 lds
    v_mfma_f32_16x16x32_bf16 v[120:123], v[92:95], a[200:203], v[120:123]
    s_waitcnt lgkmcnt(4)
    ds_read_b128 v[84:87], v10 offset:28672
    s_add_u32 s18, s18, 4096
    v_mfma_f32_16x16x32_bf16 v[120:123], v[88:91], a[192:195], v[120:123]
    buffer_load_dwordx4 a[240:243], v1, s[12:15], s18 offen offset:0
    v_mfma_f32_16x16x32_bf16 v[128:131], v[64:67], a[192:195], v[128:131]
    s_waitcnt lgkmcnt(4)
    ds_read_b128 v[88:91], v8 offset:30720
    v_mfma_f32_16x16x32_bf16 v[128:131], v[68:71], a[200:203], v[128:131]
    v_mfma_f32_16x16x32_bf16 v[132:135], v[68:71], a[204:207], v[132:135]
    s_waitcnt lgkmcnt(4)
    ds_read_b128 v[92:95], v10 offset:30720
    v_mfma_f32_16x16x32_bf16 v[132:135], v[64:67], a[196:199], v[132:135]
    s_waitcnt vmcnt(9)
    s_barrier
    v_mfma_f32_16x16x32_bf16 v[140:143], v[72:75], a[196:199], v[140:143]
    s_waitcnt lgkmcnt(4)
    ds_read_b128 v[64:67], v8 offset:32768
    v_mfma_f32_16x16x32_bf16 v[140:143], v[76:79], a[204:207], v[140:143]
    buffer_load_dwordx4 a[244:247], v1, s[12:15], s18 offen offset:256
    v_mfma_f32_16x16x32_bf16 v[136:139], v[76:79], a[200:203], v[136:139]
    s_waitcnt lgkmcnt(4)
    ds_read_b128 v[68:71], v10 offset:32768
    v_mfma_f32_16x16x32_bf16 v[136:139], v[72:75], a[192:195], v[136:139]
    buffer_load_dwordx4 a[248:251], v1, s[12:15], s18 offen offset:2048
    v_mfma_f32_16x16x32_bf16 v[96:99], v[80:83], a[208:211], v[96:99]
    s_waitcnt lgkmcnt(4)
    ds_read_b128 v[72:75], v8 offset:34816
    v_mfma_f32_16x16x32_bf16 v[96:99], v[84:87], a[216:219], v[96:99]
    v_mfma_f32_16x16x32_bf16 v[100:103], v[84:87], a[220:223], v[100:103]
    s_waitcnt lgkmcnt(4)
    ds_read_b128 v[76:79], v10 offset:34816
    v_mfma_f32_16x16x32_bf16 v[100:103], v[80:83], a[212:215], v[100:103]
    buffer_load_dwordx4 a[252:255], v1, s[12:15], s18 offen offset:2304
    v_mfma_f32_16x16x32_bf16 v[108:111], v[88:91], a[212:215], v[108:111]
    s_waitcnt lgkmcnt(4)
    ds_read_b128 v[80:83], v8 offset:36864
    s_add_u32 m0, s22, 65536
    v_mfma_f32_16x16x32_bf16 v[108:111], v[92:95], a[220:223], v[108:111]
    s_add_u32 s16, s16, 16384
    v_mfma_f32_16x16x32_bf16 v[104:107], v[92:95], a[216:219], v[104:107]
    s_waitcnt lgkmcnt(4)
    ds_read_b128 v[84:87], v10 offset:36864
    v_mfma_f32_16x16x32_bf16 v[104:107], v[88:91], a[208:211], v[104:107]
    buffer_load_dwordx4 v4, s[12:15], s16 offen offset:0 lds
    v_mfma_f32_16x16x32_bf16 v[112:115], v[64:67], a[208:211], v[112:115]
    s_waitcnt lgkmcnt(4)
    ds_read_b128 v[88:91], v8 offset:38912
    v_mfma_f32_16x16x32_bf16 v[112:115], v[68:71], a[216:219], v[112:115]
    buffer_load_dwordx4 v4, s[12:15], s16 offen offset:1024 lds
    v_mfma_f32_4x4x4_16b_bf16 v[40:43], a[208:209], a[208:209], v[40:43]
    v_mfma_f32_4x4x4_16b_bf16 v[44:47], a[210:211], a[210:211], v[44:47]
    v_mfma_f32_4x4x4_16b_bf16 v[48:51], a[212:213], a[212:213], v[48:51]
    v_mfma_f32_4x4x4_16b_bf16 v[52:55], a[214:215], a[214:215], v[52:55]
    v_mfma_f32_4x4x4_16b_bf16 v[40:43], a[216:217], a[216:217], v[40:43]
    v_mfma_f32_4x4x4_16b_bf16 v[44:47], a[218:219], a[218:219], v[44:47]
    v_mfma_f32_4x4x4_16b_bf16 v[48:51], a[220:221], a[220:221], v[48:51]
    v_mfma_f32_4x4x4_16b_bf16 v[52:55], a[222:223], a[222:223], v[52:55]
    v_mfma_f32_16x16x32_bf16 v[116:119], v[68:71], a[220:223], v[116:119]
    s_waitcnt lgkmcnt(4)
    ds_read_b128 v[92:95], v10 offset:38912
    v_mfma_f32_16x16x32_bf16 v[116:119], v[64:67], a[212:215], v[116:119]
    v_mfma_f32_16x16x32_bf16 v[124:127], v[72:75], a[212:215], v[124:127]
    s_waitcnt lgkmcnt(4)
    ds_read_b128 v[64:67], v8 offset:40960
    v_mfma_f32_16x16x32_bf16 v[124:127], v[76:79], a[220:223], v[124:127]
    buffer_load_dwordx4 v4, s[12:15], s16 offen offset:2048 lds
    v_mfma_f32_16x16x32_bf16 v[120:123], v[76:79], a[216:219], v[120:123]
    s_waitcnt lgkmcnt(4)
    ds_read_b128 v[68:71], v10 offset:40960
    v_mfma_f32_16x16x32_bf16 v[120:123], v[72:75], a[208:211], v[120:123]
    buffer_load_dwordx4 v4, s[12:15], s16 offen offset:3072 lds
    v_mfma_f32_16x16x32_bf16 v[128:131], v[80:83], a[208:211], v[128:131]
    s_waitcnt lgkmcnt(4)
    ds_read_b128 v[72:75], v8 offset:43008
    v_mfma_f32_16x16x32_bf16 v[128:131], v[84:87], a[216:219], v[128:131]
    v_mfma_f32_16x16x32_bf16 v[132:135], v[84:87], a[220:223], v[132:135]
    s_waitcnt lgkmcnt(4)
    ds_read_b128 v[76:79], v10 offset:43008
    s_add_u32 m0, s22, 81920
    v_mfma_f32_16x16x32_bf16 v[132:135], v[80:83], a[212:215], v[132:135]
    s_add_u32 s16, s16, 16384
    v_mfma_f32_16x16x32_bf16 v[140:143], v[88:91], a[212:215], v[140:143]
    s_waitcnt lgkmcnt(4)
    ds_read_b128 v[80:83], v8 offset:45056
    v_mfma_f32_16x16x32_bf16 v[140:143], v[92:95], a[220:223], v[140:143]
    buffer_load_dwordx4 v4, s[12:15], s16 offen offset:0 lds
    v_mfma_f32_16x16x32_bf16 v[136:139], v[92:95], a[216:219], v[136:139]
    s_waitcnt lgkmcnt(4)
    ds_read_b128 v[84:87], v10 offset:45056
    v_mfma_f32_16x16x32_bf16 v[136:139], v[88:91], a[208:211], v[136:139]
    s_waitcnt vmcnt(16)
    buffer_load_dwordx4 v4, s[12:15], s16 offen offset:1024 lds
    v_mfma_f32_16x16x32_bf16 v[96:99], v[64:67], a[224:227], v[96:99]
    s_waitcnt vmcnt(15) lgkmcnt(4)
    ds_read_b128 v[88:91], v8 offset:47104
    v_mfma_f32_16x16x32_bf16 v[96:99], v[68:71], a[232:235], v[96:99]
    s_waitcnt vmcnt(14)
    v_mfma_f32_16x16x32_bf16 v[100:103], v[68:71], a[236:239], v[100:103]
    s_waitcnt lgkmcnt(4)
    ds_read_b128 v[92:95], v10 offset:47104
    v_mfma_f32_16x16x32_bf16 v[100:103], v[64:67], a[228:231], v[100:103]
    s_waitcnt vmcnt(10)
    s_barrier
    v_mfma_f32_16x16x32_bf16 v[108:111], v[72:75], a[228:231], v[108:111]
    s_waitcnt lgkmcnt(4)
    ds_read_b128 v[64:67], v8 offset:49152
    v_mfma_f32_16x16x32_bf16 v[108:111], v[76:79], a[236:239], v[108:111]
    buffer_load_dwordx4 v4, s[12:15], s16 offen offset:2048 lds
    v_mfma_f32_16x16x32_bf16 v[104:107], v[76:79], a[232:235], v[104:107]
    s_waitcnt lgkmcnt(4)
    ds_read_b128 v[68:71], v10 offset:49152
    v_mfma_f32_16x16x32_bf16 v[104:107], v[72:75], a[224:227], v[104:107]
    buffer_load_dwordx4 v4, s[12:15], s16 offen offset:3072 lds
    v_mfma_f32_16x16x32_bf16 v[112:115], v[80:83], a[224:227], v[112:115]
    s_waitcnt lgkmcnt(4)
    ds_read_b128 v[72:75], v8 offset:51200
    s_add_u32 m0, s22, 98304
    v_mfma_f32_16x16x32_bf16 v[112:115], v[84:87], a[232:235], v[112:115]
    s_add_u32 s16, s16, 16384
    v_mfma_f32_4x4x4_16b_bf16 v[40:43], a[224:225], a[224:225], v[40:43]
    v_mfma_f32_4x4x4_16b_bf16 v[44:47], a[226:227], a[226:227], v[44:47]
    v_mfma_f32_4x4x4_16b_bf16 v[48:51], a[228:229], a[228:229], v[48:51]
    v_mfma_f32_4x4x4_16b_bf16 v[52:55], a[230:231], a[230:231], v[52:55]
    v_mfma_f32_4x4x4_16b_bf16 v[40:43], a[232:233], a[232:233], v[40:43]
    v_mfma_f32_4x4x4_16b_bf16 v[44:47], a[234:235], a[234:235], v[44:47]
    v_mfma_f32_4x4x4_16b_bf16 v[48:51], a[236:237], a[236:237], v[48:51]
    v_mfma_f32_4x4x4_16b_bf16 v[52:55], a[238:239], a[238:239], v[52:55]
    v_mfma_f32_16x16x32_bf16 v[116:119], v[84:87], a[236:239], v[116:119]
    s_waitcnt lgkmcnt(4)
    ds_read_b128 v[76:79], v10 offset:51200
    v_mfma_f32_16x16x32_bf16 v[116:119], v[80:83], a[228:231], v[116:119]
    buffer_load_dwordx4 v4, s[12:15], s16 offen offset:0 lds
    v_mfma_f32_16x16x32_bf16 v[124:127], v[88:91], a[228:231], v[124:127]
    s_waitcnt lgkmcnt(4)
    ds_read_b128 v[80:83], v8 offset:53248
    v_mfma_f32_16x16x32_bf16 v[124:127], v[92:95], a[236:239], v[124:127]
    buffer_load_dwordx4 v4, s[12:15], s16 offen offset:1024 lds
    v_mfma_f32_16x16x32_bf16 v[120:123], v[92:95], a[232:235], v[120:123]
    s_waitcnt lgkmcnt(4)
    ds_read_b128 v[84:87], v10 offset:53248
    v_mfma_f32_16x16x32_bf16 v[120:123], v[88:91], a[224:227], v[120:123]
    buffer_load_dwordx4 v4, s[12:15], s16 offen offset:2048 lds
    v_mfma_f32_16x16x32_bf16 v[128:131], v[64:67], a[224:227], v[128:131]
    s_waitcnt lgkmcnt(4)
    ds_read_b128 v[88:91], v8 offset:55296
    v_mfma_f32_16x16x32_bf16 v[128:131], v[68:71], a[232:235], v[128:131]
    v_mfma_f32_16x16x32_bf16 v[132:135], v[68:71], a[236:239], v[132:135]
    s_waitcnt lgkmcnt(4)
    ds_read_b128 v[92:95], v10 offset:55296
    v_mfma_f32_16x16x32_bf16 v[132:135], v[64:67], a[228:231], v[132:135]
    buffer_load_dwordx4 v4, s[12:15], s16 offen offset:3072 lds
    v_mfma_f32_16x16x32_bf16 v[140:143], v[72:75], a[228:231], v[140:143]
    s_waitcnt lgkmcnt(4)
    ds_read_b128 v[64:67], v8 offset:57344
    v_mfma_f32_16x16x32_bf16 v[140:143], v[76:79], a[236:239], v[140:143]
    v_mfma_f32_16x16x32_bf16 v[136:139], v[76:79], a[232:235], v[136:139]
    s_waitcnt lgkmcnt(4)
    ds_read_b128 v[68:71], v10 offset:57344
    s_add_u32 m0, s22, 114688
    v_mfma_f32_16x16x32_bf16 v[136:139], v[72:75], a[224:227], v[136:139]
    s_waitcnt vmcnt(15)
    s_add_u32 s16, s16, 16384
    v_mfma_f32_16x16x32_bf16 v[96:99], v[80:83], a[240:243], v[96:99]
    s_waitcnt vmcnt(13) lgkmcnt(4)
    ds_read_b128 v[72:75], v8 offset:59392
    v_mfma_f32_16x16x32_bf16 v[96:99], v[84:87], a[248:251], v[96:99]
    s_waitcnt vmcnt(12)
    buffer_load_dwordx4 v4, s[12:15], s16 offen offset:0 lds
    v_mfma_f32_16x16x32_bf16 v[100:103], v[84:87], a[252:255], v[100:103]
    s_waitcnt lgkmcnt(4)
    ds_read_b128 v[76:79], v10 offset:59392
    v_mfma_f32_16x16x32_bf16 v[100:103], v[80:83], a[244:247], v[100:103]
    buffer_load_dwordx4 v4, s[12:15], s16 offen offset:1024 lds
    v_mfma_f32_16x16x32_bf16 v[108:111], v[88:91], a[244:247], v[108:111]
    s_waitcnt lgkmcnt(4)
    ds_read_b128 v[80:83], v8 offset:61440
    v_mfma_f32_16x16x32_bf16 v[108:111], v[92:95], a[252:255], v[108:111]
    buffer_load_dwordx4 v4, s[12:15], s16 offen offset:2048 lds
    v_mfma_f32_16x16x32_bf16 v[104:107], v[92:95], a[248:251], v[104:107]
    s_waitcnt lgkmcnt(4)
    ds_read_b128 v[84:87], v10 offset:61440
    v_mfma_f32_16x16x32_bf16 v[104:107], v[88:91], a[240:243], v[104:107]
    buffer_load_dwordx4 v4, s[12:15], s16 offen offset:3072 lds
    v_mfma_f32_16x16x32_bf16 v[112:115], v[64:67], a[240:243], v[112:115]
    s_waitcnt lgkmcnt(4)
    ds_read_b128 v[88:91], v8 offset:63488
    s_add_u32 m0, s22, 0
    v_mfma_f32_16x16x32_bf16 v[112:115], v[68:71], a[248:251], v[112:115]
    s_add_u32 s16, s16, 16384
    v_mfma_f32_4x4x4_16b_bf16 v[40:43], a[240:241], a[240:241], v[40:43]
    v_mfma_f32_4x4x4_16b_bf16 v[44:47], a[242:243], a[242:243], v[44:47]
    v_mfma_f32_4x4x4_16b_bf16 v[48:51], a[244:245], a[244:245], v[48:51]
    v_mfma_f32_4x4x4_16b_bf16 v[52:55], a[246:247], a[246:247], v[52:55]
    v_mfma_f32_4x4x4_16b_bf16 v[40:43], a[248:249], a[248:249], v[40:43]
    v_mfma_f32_4x4x4_16b_bf16 v[44:47], a[250:251], a[250:251], v[44:47]
    v_mfma_f32_4x4x4_16b_bf16 v[48:51], a[252:253], a[252:253], v[48:51]
    v_mfma_f32_4x4x4_16b_bf16 v[52:55], a[254:255], a[254:255], v[52:55]
    v_mfma_f32_16x16x32_bf16 v[116:119], v[68:71], a[252:255], v[116:119]
    s_waitcnt lgkmcnt(4)
    ds_read_b128 v[92:95], v10 offset:63488
    v_mov_b32 v3, 0x3727c5ac
    v_mfma_f32_16x16x32_bf16 v[116:119], v[64:67], a[244:247], v[116:119]
    s_waitcnt vmcnt(12)
    s_barrier
    v_mfma_f32_16x16x32_bf16 v[124:127], v[72:75], a[244:247], v[124:127]
    s_waitcnt lgkmcnt(4)
    ds_read_b128 v[64:67], v9 offset:0
    v_mfma_f32_16x16x32_bf16 v[124:127], v[76:79], a[252:255], v[124:127]
    buffer_load_dwordx4 v4, s[12:15], s16 offen offset:0 lds
    v_mfma_f32_16x16x32_bf16 v[120:123], v[76:79], a[248:251], v[120:123]
    s_waitcnt lgkmcnt(4)
    ds_read_b128 v[68:71], v11 offset:0
    v_add_f32 v40, v40, v44
    v_mfma_f32_16x16x32_bf16 v[120:123], v[72:75], a[240:243], v[120:123]
    buffer_load_dwordx4 v4, s[12:15], s16 offen offset:1024 lds
    v_mfma_f32_16x16x32_bf16 v[128:131], v[80:83], a[240:243], v[128:131]
    s_waitcnt lgkmcnt(4)
    ds_read_b128 v[72:75], v9 offset:2048
    s_add_u32 s27, s40, 0
    v_mfma_f32_16x16x32_bf16 v[128:131], v[84:87], a[248:251], v[128:131]
    buffer_load_dwordx4 v4, s[12:15], s16 offen offset:2048 lds
    v_mfma_f32_16x16x32_bf16 v[132:135], v[84:87], a[252:255], v[132:135]
    s_waitcnt lgkmcnt(4)
    ds_read_b128 v[76:79], v11 offset:2048
    v_add_f32 v41, v41, v45
    v_mfma_f32_16x16x32_bf16 v[132:135], v[80:83], a[244:247], v[132:135]
    buffer_load_dwordx4 v4, s[12:15], s16 offen offset:3072 lds
    v_mfma_f32_16x16x32_bf16 v[140:143], v[88:91], a[244:247], v[140:143]
    s_waitcnt lgkmcnt(4)
    ds_read_b128 v[80:83], v9 offset:6144
    s_add_u32 m0, s22, 16384
    v_mfma_f32_16x16x32_bf16 v[140:143], v[92:95], a[252:255], v[140:143]
    s_add_u32 s16, s16, 16384
    v_add_f32 v42, v42, v46
    v_add_f32 v43, v43, v47
    v_mfma_f32_16x16x32_bf16 v[136:139], v[92:95], a[248:251], v[136:139]
    s_waitcnt lgkmcnt(4)
    ds_read_b128 v[84:87], v11 offset:6144
    v_cndmask_b32 v40, v40, v41, s[96:97]
    v_mfma_f32_16x16x32_bf16 v[136:139], v[88:91], a[240:243], v[136:139]
    buffer_load_dwordx4 v4, s[12:15], s16 offen offset:0 lds
    v_mfma_f32_16x16x32_bf16 v[144:147], v[64:67], a[0:3], 0
    s_waitcnt lgkmcnt(4)
    ds_read_b128 v[88:91], v9 offset:4096
    s_add_u32 s45, s40, 2048
    v_mfma_f32_16x16x32_bf16 v[144:147], v[68:71], a[8:11], v[144:147]
    v_cndmask_b32 v40, v40, v42, s[98:99]
    v_add_f32 v48, v48, v52
    v_mfma_f32_16x16x32_bf16 v[148:151], v[68:71], a[12:15], 0
    s_waitcnt lgkmcnt(4)
    ds_read_b128 v[92:95], v11 offset:4096
    v_cndmask_b32 v40, v40, v43, s[100:101]
    v_mfma_f32_16x16x32_bf16 v[148:151], v[64:67], a[4:7], v[148:151]
    buffer_load_dwordx4 v4, s[12:15], s16 offen offset:1024 lds
    v_mfma_f32_16x16x32_bf16 v[156:159], v[72:75], a[4:7], 0
    s_waitcnt lgkmcnt(4)
    ds_read_b128 v[64:67], v9 offset:8192
    v_mov_b32 v41, v40
    v_mfma_f32_16x16x32_bf16 v[156:159], v[76:79], a[12:15], v[156:159]
    s_nop 0
    v_add_f32 v49, v49, v53
    v_add_f32 v50, v50, v54
    v_mfma_f32_16x16x32_bf16 v[152:155], v[76:79], a[8:11], 0
    s_waitcnt lgkmcnt(4)
    ds_read_b128 v[68:71], v11 offset:8192
    v_permlane32_swap_b32 v40, v41
    v_mfma_f32_16x16x32_bf16 v[152:155], v[72:75], a[0:3], v[152:155]
    buffer_load_dwordx4 v4, s[12:15], s16 offen offset:2048 lds
    v_mfma_f32_16x16x32_bf16 v[152:155], v[80:83], a[16:19], v[152:155]
    s_waitcnt lgkmcnt(4)
    ds_read_b128 v[72:75], v9 offset:10240
    v_add_f32 v40, v40, v41
    v_mfma_f32_16x16x32_bf16 v[152:155], v[84:87], a[24:27], v[152:155]
    v_mov_b32 v41, v40
    v_add_f32 v51, v51, v55
    v_mfma_f32_16x16x32_bf16 v[156:159], v[84:87], a[28:31], v[156:159]
    s_waitcnt lgkmcnt(4)
    ds_read_b128 v[76:79], v11 offset:10240
    s_nop 0
    v_mfma_f32_16x16x32_bf16 v[156:159], v[80:83], a[20:23], v[156:159]
    buffer_load_dwordx4 v4, s[12:15], s16 offen offset:3072 lds
    v_mfma_f32_16x16x32_bf16 v[148:151], v[88:91], a[20:23], v[148:151]
    s_waitcnt lgkmcnt(4)
    ds_read_b128 v[80:83], v9 offset:14336
    s_add_u32 m0, s22, 32768
    v_mfma_f32_16x16x32_bf16 v[148:151], v[92:95], a[28:31], v[148:151]
    s_add_u32 s16, s16, 16384
    v_permlane16_swap_b32 v40, v41
    v_mfma_f32_16x16x32_bf16 v[144:147], v[92:95], a[24:27], v[144:147]
    s_waitcnt lgkmcnt(4)
    ds_read_b128 v[84:87], v11 offset:14336
    v_add_f32 v40, v40, v41
    v_mfma_f32_16x16x32_bf16 v[144:147], v[88:91], a[16:19], v[144:147]
    buffer_load_dwordx4 v4, s[12:15], s16 offen offset:0 lds
    v_mfma_f32_16x16x32_bf16 v[144:147], v[64:67], a[32:35], v[144:147]
    s_waitcnt lgkmcnt(4)
    ds_read_b128 v[88:91], v9 offset:12288
    v_fmamk_f32 v40, v40, 0x3a800000, v3
    v_mfma_f32_16x16x32_bf16 v[144:147], v[68:71], a[40:43], v[144:147]
    v_rsq_f32 v22, v40
    v_mfma_f32_16x16x32_bf16 v[148:151], v[68:71], a[44:47], v[148:151]
    s_waitcnt lgkmcnt(4)
    ds_read_b128 v[92:95], v11 offset:12288
    v_sqrt_f32 v23, v40
    v_mfma_f32_16x16x32_bf16 v[148:151], v[64:67], a[36:39], v[148:151]
    s_waitcnt vmcnt(17)
    s_barrier
    v_mfma_f32_16x16x32_bf16 v[156:159], v[72:75], a[36:39], v[156:159]
    s_waitcnt lgkmcnt(4)
    ds_read_b128 v[64:67], v9 offset:16384
    v_mul_f32 v22, 0xbfb8aa3b, v22
    v_mfma_f32_16x16x32_bf16 v[156:159], v[76:79], a[44:47], v[156:159]
    buffer_load_dwordx4 v4, s[12:15], s16 offen offset:1024 lds
    v_mfma_f32_16x16x32_bf16 v[152:155], v[76:79], a[40:43], v[152:155]
    s_waitcnt lgkmcnt(4)
    ds_read_b128 v[68:71], v11 offset:16384
    v_cndmask_b32 v48, v48, v49, s[96:97]
    v_mfma_f32_16x16x32_bf16 v[152:155], v[72:75], a[32:35], v[152:155]
    v_cndmask_b32 v48, v48, v50, s[98:99]
    v_mfma_f32_16x16x32_bf16 v[152:155], v[80:83], a[48:51], v[152:155]
    s_waitcnt lgkmcnt(4)
    ds_read_b128 v[72:75], v9 offset:18432
    v_cndmask_b32 v48, v48, v51, s[100:101]
    v_mfma_f32_16x16x32_bf16 v[152:155], v[84:87], a[56:59], v[152:155]
    buffer_load_dwordx4 v4, s[12:15], s16 offen offset:2048 lds
    v_mfma_f32_16x16x32_bf16 v[156:159], v[84:87], a[60:63], v[156:159]
    s_waitcnt lgkmcnt(4)
    ds_read_b128 v[76:79], v11 offset:18432
    v_mov_b32 v49, v48
    v_mfma_f32_16x16x32_bf16 v[156:159], v[80:83], a[52:55], v[156:159]
    s_nop 0
    v_mfma_f32_16x16x32_bf16 v[148:151], v[88:91], a[52:55], v[148:151]
    s_waitcnt lgkmcnt(4)
    ds_read_b128 v[80:83], v9 offset:22528
    v_permlane32_swap_b32 v48, v49
    v_mfma_f32_16x16x32_bf16 v[148:151], v[92:95], a[60:63], v[148:151]
    buffer_load_dwordx4 v4, s[12:15], s16 offen offset:3072 lds
    v_mfma_f32_16x16x32_bf16 v[144:147], v[92:95], a[56:59], v[144:147]
    s_waitcnt lgkmcnt(4)
    ds_read_b128 v[84:87], v11 offset:22528
    s_add_u32 m0, s22, 49152
    v_mfma_f32_16x16x32_bf16 v[144:147], v[88:91], a[48:51], v[144:147]
    s_add_u32 s16, s16, 16384
    v_add_f32 v48, v48, v49
    v_mfma_f32_16x16x32_bf16 v[144:147], v[64:67], a[64:67], v[144:147]
    s_waitcnt lgkmcnt(4)
    ds_read_b128 v[88:91], v9 offset:20480
    v_mov_b32 v49, v48
    v_mfma_f32_16x16x32_bf16 v[144:147], v[68:71], a[72:75], v[144:147]
    buffer_load_dwordx4 v4, s[12:15], s16 offen offset:0 lds
    v_mfma_f32_16x16x32_bf16 v[148:151], v[68:71], a[76:79], v[148:151]
    s_waitcnt lgkmcnt(4)
    ds_read_b128 v[92:95], v11 offset:20480
    s_nop 0
    v_mfma_f32_16x16x32_bf16 v[148:151], v[64:67], a[68:71], v[148:151]
    v_permlane16_swap_b32 v48, v49
    v_mfma_f32_16x16x32_bf16 v[156:159], v[72:75], a[68:71], v[156:159]
    s_waitcnt lgkmcnt(4)
    ds_read_b128 v[64:67], v9 offset:24576
    v_add_f32 v48, v48, v49
    v_mfma_f32_16x16x32_bf16 v[156:159], v[76:79], a[76:79], v[156:159]
    buffer_load_dwordx4 v4, s[12:15], s16 offen offset:1024 lds
    v_mfma_f32_16x16x32_bf16 v[152:155], v[76:79], a[72:75], v[152:155]
    s_waitcnt lgkmcnt(4)
    ds_read_b128 v[68:71], v11 offset:24576
    v_fmamk_f32 v48, v48, 0x3a800000, v3
    v_mfma_f32_16x16x32_bf16 v[152:155], v[72:75], a[64:67], v[152:155]
    v_rsq_f32 v56, v48
    v_mfma_f32_16x16x32_bf16 v[152:155], v[80:83], a[80:83], v[152:155]
    s_waitcnt lgkmcnt(4)
    ds_read_b128 v[72:75], v9 offset:26624
    v_sqrt_f32 v57, v48
    v_mfma_f32_16x16x32_bf16 v[152:155], v[84:87], a[88:91], v[152:155]
    buffer_load_dwordx4 v4, s[12:15], s16 offen offset:2048 lds
    v_mfma_f32_16x16x32_bf16 v[156:159], v[84:87], a[92:95], v[156:159]
    s_waitcnt lgkmcnt(4)
    ds_read_b128 v[76:79], v11 offset:26624
    v_mul_f32 v56, 0xbfb8aa3b, v56
    v_mfma_f32_16x16x32_bf16 v[156:159], v[80:83], a[84:87], v[156:159]
    s_nop 0
    v_mfma_f32_16x16x32_bf16 v[148:151], v[88:91], a[84:87], v[148:151]
    s_waitcnt lgkmcnt(4)
    ds_read_b128 v[80:83], v9 offset:30720
    v_mul_f32 v24, v96, v22
    v_mfma_f32_16x16x32_bf16 v[148:151], v[92:95], a[92:95], v[148:151]
    buffer_load_dwordx4 v4, s[12:15], s16 offen offset:3072 lds
    v_mfma_f32_16x16x32_bf16 v[144:147], v[92:95], a[88:91], v[144:147]
    s_waitcnt lgkmcnt(4)
    ds_read_b128 v[84:87], v11 offset:30720
    v_exp_f32 v24, v24
    v_mfma_f32_16x16x32_bf16 v[144:147], v[88:91], a[80:83], v[144:147]
    v_fma_f32 v24, v24, v23, v23
    v_mul_f32 v25, v97, v22
    v_mfma_f32_16x16x32_bf16 v[144:147], v[64:67], a[96:99], v[144:147]
    s_waitcnt lgkmcnt(4)
    ds_read_b128 v[88:91], v9 offset:28672
    v_rcp_f32 v24, v24
    v_mfma_f32_16x16x32_bf16 v[144:147], v[68:71], a[104:107], v[144:147]
    v_mul_f32 v24, v24, v96
    v_mul_f32 v26, v98, v22
    v_mfma_f32_16x16x32_bf16 v[148:151], v[68:71], a[108:111], v[148:151]
    s_waitcnt lgkmcnt(4)
    ds_read_b128 v[92:95], v11 offset:28672
    v_exp_f32 v25, v25
    v_mfma_f32_16x16x32_bf16 v[148:151], v[64:67], a[100:103], v[148:151]
    s_waitcnt vmcnt(20)
    s_barrier
    v_mfma_f32_16x16x32_bf16 v[156:159], v[72:75], a[100:103], v[156:159]
    s_waitcnt lgkmcnt(4)
    ds_read_b128 v[64:67], v9 offset:32768
    s_add_u32 m0, s22, 65536
    v_mfma_f32_16x16x32_bf16 v[156:159], v[76:79], a[108:111], v[156:159]
    s_add_u32 s16, s16, 16384
    v_fma_f32 v25, v25, v23, v23
    v_mul_f32 v27, v99, v22
    v_mfma_f32_16x16x32_bf16 v[152:155], v[76:79], a[104:107], v[152:155]
    s_waitcnt lgkmcnt(4)
    ds_read_b128 v[68:71], v11 offset:32768
    v_rcp_f32 v25, v25
    v_mfma_f32_16x16x32_bf16 v[152:155], v[72:75], a[96:99], v[152:155]
    buffer_load_dwordx4 v4, s[12:15], s16 offen offset:0 lds
    v_mfma_f32_16x16x32_bf16 v[152:155], v[80:83], a[112:115], v[152:155]
    s_waitcnt lgkmcnt(4)
    ds_read_b128 v[72:75], v9 offset:34816
    v_exp_f32 v26, v26
    v_mfma_f32_16x16x32_bf16 v[152:155], v[84:87], a[120:123], v[152:155]
    v_mul_f32 v25, v25, v97
    v_fma_f32 v26, v26, v23, v23
    v_mfma_f32_16x16x32_bf16 v[156:159], v[84:87], a[124:127], v[156:159]
    s_waitcnt lgkmcnt(4)
    ds_read_b128 v[76:79], v11 offset:34816
    v_rcp_f32 v26, v26
    v_mfma_f32_16x16x32_bf16 v[156:159], v[80:83], a[116:119], v[156:159]
    buffer_load_dwordx4 v4, s[12:15], s16 offen offset:1024 lds
    v_mfma_f32_16x16x32_bf16 v[148:151], v[88:91], a[116:119], v[148:151]
    s_waitcnt lgkmcnt(4)
    ds_read_b128 v[80:83], v9 offset:38912
    v_exp_f32 v27, v27
    v_mfma_f32_16x16x32_bf16 v[148:151], v[92:95], a[124:127], v[148:151]
    v_mul_f32 v26, v26, v98
    v_fma_f32 v27, v27, v23, v23
    v_mfma_f32_16x16x32_bf16 v[144:147], v[92:95], a[120:123], v[144:147]
    s_waitcnt lgkmcnt(4)
    ds_read_b128 v[84:87], v11 offset:38912
    v_rcp_f32 v27, v27
    v_mfma_f32_16x16x32_bf16 v[144:147], v[88:91], a[112:115], v[144:147]
    buffer_load_dwordx4 v4, s[12:15], s16 offen offset:2048 lds
    v_mfma_f32_16x16x32_bf16 v[144:147], v[64:67], a[128:131], v[144:147]
    s_waitcnt lgkmcnt(4)
    ds_read_b128 v[88:91], v9 offset:36864
    v_mul_f32 v27, v27, v99
    v_mfma_f32_16x16x32_bf16 v[144:147], v[68:71], a[136:139], v[144:147]
    v_mul_f32 v28, v104, v22
    v_mul_f32 v29, v105, v22
    v_mfma_f32_16x16x32_bf16 v[148:151], v[68:71], a[140:143], v[148:151]
    s_waitcnt lgkmcnt(4)
    ds_read_b128 v[92:95], v11 offset:36864
    v_exp_f32 v28, v28
    v_mfma_f32_16x16x32_bf16 v[148:151], v[64:67], a[132:135], v[148:151]
    buffer_load_dwordx4 v4, s[12:15], s16 offen offset:3072 lds
    v_mfma_f32_16x16x32_bf16 v[156:159], v[72:75], a[132:135], v[156:159]
    s_waitcnt lgkmcnt(4)
    ds_read_b128 v[64:67], v9 offset:40960
    v_exp_f32 v29, v29
    v_mfma_f32_16x16x32_bf16 v[156:159], v[76:79], a[140:143], v[156:159]
    v_fma_f32 v28, v28, v23, v23
    v_fma_f32 v29, v29, v23, v23
    v_mfma_f32_16x16x32_bf16 v[152:155], v[76:79], a[136:139], v[152:155]
    s_waitcnt lgkmcnt(4)
    ds_read_b128 v[68:71], v11 offset:40960
    v_rcp_f32 v28, v28
    v_mfma_f32_16x16x32_bf16 v[152:155], v[72:75], a[128:131], v[152:155]
    v_mul_f32 v28, v28, v104
    v_mul_f32 v30, v106, v22
    v_mfma_f32_16x16x32_bf16 v[152:155], v[80:83], a[144:147], v[152:155]
    s_waitcnt lgkmcnt(4)
    ds_read_b128 v[72:75], v9 offset:43008
    v_rcp_f32 v29, v29
    v_mfma_f32_16x16x32_bf16 v[152:155], v[84:87], a[152:155], v[152:155]
    v_mul_f32 v29, v29, v105
    v_mul_f32 v31, v107, v22
    v_mfma_f32_16x16x32_bf16 v[156:159], v[84:87], a[156:159], v[156:159]
    s_waitcnt lgkmcnt(4)
    ds_read_b128 v[76:79], v11 offset:43008
    v_exp_f32 v30, v30
    v_mfma_f32_16x16x32_bf16 v[156:159], v[80:83], a[148:151], v[156:159]
    v_fma_f32 v30, v30, v23, v23
    v_cvt_pk_bf16_f32 v96, v24, v25
    v_mfma_f32_16x16x32_bf16 v[148:151], v[88:91], a[148:151], v[148:151]
    s_waitcnt lgkmcnt(4)
    ds_read_b128 v[80:83], v9 offset:47104
    v_rcp_f32 v30, v30
    v_mfma_f32_16x16x32_bf16 v[148:151], v[92:95], a[156:159], v[148:151]
    v_mul_f32 v30, v30, v106
    v_cvt_pk_bf16_f32 v97, v26, v27
    v_mfma_f32_16x16x32_bf16 v[144:147], v[92:95], a[152:155], v[144:147]
    s_waitcnt lgkmcnt(4)
    ds_read_b128 v[84:87], v11 offset:47104
    v_exp_f32 v31, v31
    v_mfma_f32_16x16x32_bf16 v[144:147], v[88:91], a[144:147], v[144:147]
    v_fma_f32 v31, v31, v23, v23
    v_cvt_pk_bf16_f32 v98, v28, v29
    v_mfma_f32_16x16x32_bf16 v[144:147], v[64:67], a[160:163], v[144:147]
    s_waitcnt lgkmcnt(4)
    ds_read_b128 v[88:91], v9 offset:45056
    v_rcp_f32 v31, v31
    v_mfma_f32_16x16x32_bf16 v[144:147], v[68:71], a[168:171], v[144:147]
    v_mul_f32 v31, v31, v107
    v_mul_f32 v32, v100, v56
    v_mfma_f32_16x16x32_bf16 v[148:151], v[68:71], a[172:175], v[148:151]
    s_waitcnt lgkmcnt(4)
    ds_read_b128 v[92:95], v11 offset:45056
    v_exp_f32 v32, v32
    v_mfma_f32_16x16x32_bf16 v[148:151], v[64:67], a[164:167], v[148:151]
    s_waitcnt vmcnt(20)
    s_barrier
    v_mfma_f32_16x16x32_bf16 v[156:159], v[72:75], a[164:167], v[156:159]
    s_waitcnt lgkmcnt(4)
    ds_read_b128 v[64:67], v9 offset:49152
    s_add_u32 m0, s22, 81920
    v_mfma_f32_16x16x32_bf16 v[156:159], v[76:79], a[172:175], v[156:159]
    s_add_u32 s16, s16, 16384
    v_cvt_pk_bf16_f32 v99, v30, v31
    v_fma_f32 v32, v32, v57, v57
    v_mfma_f32_16x16x32_bf16 v[152:155], v[76:79], a[168:171], v[152:155]
    s_waitcnt lgkmcnt(4)
    ds_read_b128 v[68:71], v11 offset:49152
    v_rcp_f32 v32, v32
    v_mfma_f32_16x16x32_bf16 v[152:155], v[72:75], a[160:163], v[152:155]
    buffer_store_dwordx4 v[96:99], v1, s[12:15], s27 offen offset:0 sc1
    v_mfma_f32_16x16x32_bf16 v[152:155], v[80:83], a[176:179], v[152:155]
    s_waitcnt lgkmcnt(4)
    ds_read_b128 v[72:75], v9 offset:51200
    v_mul_f32 v32, v32, v100
    v_mfma_f32_16x16x32_bf16 v[152:155], v[84:87], a[184:187], v[152:155]
    v_mul_f32 v33, v101, v56
    v_mul_f32 v34, v102, v56
    v_mfma_f32_16x16x32_bf16 v[156:159], v[84:87], a[188:191], v[156:159]
    s_waitcnt lgkmcnt(4)
    ds_read_b128 v[76:79], v11 offset:51200
    v_exp_f32 v33, v33
    v_mfma_f32_16x16x32_bf16 v[156:159], v[80:83], a[180:183], v[156:159]
    buffer_load_dwordx4 v4, s[12:15], s16 offen offset:0 lds
    v_mfma_f32_16x16x32_bf16 v[148:151], v[88:91], a[180:183], v[148:151]
    s_waitcnt lgkmcnt(4)
    ds_read_b128 v[80:83], v9 offset:55296
    v_exp_f32 v34, v34
    v_mfma_f32_16x16x32_bf16 v[148:151], v[92:95], a[188:191], v[148:151]
    v_fma_f32 v33, v33, v57, v57
    v_fma_f32 v34, v34, v57, v57
    v_mfma_f32_16x16x32_bf16 v[144:147], v[92:95], a[184:187], v[144:147]
    s_waitcnt lgkmcnt(4)
    ds_read_b128 v[84:87], v11 offset:55296
    v_rcp_f32 v33, v33
    v_mfma_f32_16x16x32_bf16 v[144:147], v[88:91], a[176:179], v[144:147]
    buffer_load_dwordx4 v4, s[12:15], s16 offen offset:1024 lds
    v_mfma_f32_16x16x32_bf16 v[144:147], v[64:67], a[192:195], v[144:147]
    s_waitcnt lgkmcnt(4)
    ds_read_b128 v[88:91], v9 offset:53248
    v_rcp_f32 v34, v34
    v_mfma_f32_16x16x32_bf16 v[144:147], v[68:71], a[200:203], v[144:147]
    v_mul_f32 v33, v33, v101
    v_mul_f32 v34, v34, v102
    v_mfma_f32_16x16x32_bf16 v[148:151], v[68:71], a[204:207], v[148:151]
    s_waitcnt lgkmcnt(4)
    ds_read_b128 v[92:95], v11 offset:53248
    v_mul_f32 v35, v103, v56
    v_mfma_f32_16x16x32_bf16 v[148:151], v[64:67], a[196:199], v[148:151]
    buffer_load_dwordx4 v4, s[12:15], s16 offen offset:2048 lds
    v_mfma_f32_16x16x32_bf16 v[156:159], v[72:75], a[196:199], v[156:159]
    s_waitcnt lgkmcnt(4)
    ds_read_b128 v[64:67], v9 offset:57344
    v_exp_f32 v35, v35
    v_mfma_f32_16x16x32_bf16 v[156:159], v[76:79], a[204:207], v[156:159]
    v_fma_f32 v35, v35, v57, v57
    v_mul_f32 v36, v108, v56
    v_mfma_f32_16x16x32_bf16 v[152:155], v[76:79], a[200:203], v[152:155]
    s_waitcnt lgkmcnt(4)
    ds_read_b128 v[68:71], v11 offset:57344
    v_rcp_f32 v35, v35
    v_mfma_f32_16x16x32_bf16 v[152:155], v[72:75], a[192:195], v[152:155]
    buffer_load_dwordx4 v4, s[12:15], s16 offen offset:3072 lds
    v_mfma_f32_16x16x32_bf16 v[152:155], v[80:83], a[208:211], v[152:155]
    s_waitcnt lgkmcnt(4)
    ds_read_b128 v[72:75], v9 offset:59392
    v_exp_f32 v36, v36
    v_mfma_f32_16x16x32_bf16 v[152:155], v[84:87], a[216:219], v[152:155]
    v_mul_f32 v35, v35, v103
    v_fma_f32 v36, v36, v57, v57
    v_mfma_f32_16x16x32_bf16 v[156:159], v[84:87], a[220:223], v[156:159]
    s_waitcnt lgkmcnt(4)
    ds_read_b128 v[76:79], v11 offset:59392
    v_rcp_f32 v36, v36
    v_mfma_f32_16x16x32_bf16 v[156:159], v[80:83], a[212:215], v[156:159]
    v_mul_f32 v36, v36, v108
    v_mul_f32 v37, v109, v56
    v_mfma_f32_16x16x32_bf16 v[148:151], v[88:91], a[212:215], v[148:151]
    s_waitcnt lgkmcnt(4)
    ds_read_b128 v[80:83], v9 offset:63488
    v_exp_f32 v37, v37
    v_mfma_f32_16x16x32_bf16 v[148:151], v[92:95], a[220:223], v[148:151]
    v_fma_f32 v37, v37, v57, v57
    v_mul_f32 v38, v110, v56
    v_mfma_f32_16x16x32_bf16 v[144:147], v[92:95], a[216:219], v[144:147]
    s_waitcnt lgkmcnt(4)
    ds_read_b128 v[84:87], v11 offset:63488
    v_rcp_f32 v37, v37
    v_mfma_f32_16x16x32_bf16 v[144:147], v[88:91], a[208:211], v[144:147]
    v_mul_f32 v37, v37, v109
    v_mul_f32 v39, v111, v56
    v_mfma_f32_16x16x32_bf16 v[144:147], v[64:67], a[224:227], v[144:147]
    s_waitcnt lgkmcnt(4)
    ds_read_b128 v[88:91], v9 offset:61440
    v_exp_f32 v38, v38
    v_mfma_f32_16x16x32_bf16 v[144:147], v[68:71], a[232:235], v[144:147]
    v_fma_f32 v38, v38, v57, v57
    v_cvt_pk_bf16_f32 v100, v32, v33
    v_mfma_f32_16x16x32_bf16 v[148:151], v[68:71], a[236:239], v[148:151]
    s_waitcnt lgkmcnt(4)
    ds_read_b128 v[92:95], v11 offset:61440
    v_rcp_f32 v38, v38
    v_mfma_f32_16x16x32_bf16 v[148:151], v[64:67], a[228:231], v[148:151]
    s_waitcnt vmcnt(21)
    s_barrier
    v_mfma_f32_16x16x32_bf16 v[156:159], v[72:75], a[228:231], v[156:159]
    s_waitcnt lgkmcnt(4)
    ds_read_b128 v[64:67], v8 offset:0
    s_add_u32 m0, s22, 98304
    v_mfma_f32_16x16x32_bf16 v[156:159], v[76:79], a[236:239], v[156:159]
    s_add_u32 s16, s16, 16384
    v_mul_f32 v38, v38, v110
    v_cvt_pk_bf16_f32 v101, v34, v35
    v_mfma_f32_16x16x32_bf16 v[152:155], v[76:79], a[232:235], v[152:155]
    s_waitcnt lgkmcnt(4)
    ds_read_b128 v[68:71], v10 offset:0
    v_exp_f32 v39, v39
    v_mfma_f32_16x16x32_bf16 v[152:155], v[72:75], a[224:227], v[152:155]
    buffer_load_dwordx4 v4, s[12:15], s16 offen offset:0 lds
    v_mfma_f32_16x16x32_bf16 v[152:155], v[80:83], a[240:243], v[152:155]
    s_waitcnt lgkmcnt(4)
    ds_read_b128 v[72:75], v8 offset:2048
    v_fma_f32 v39, v39, v57, v57
    v_mfma_f32_16x16x32_bf16 v[152:155], v[84:87], a[248:251], v[152:155]
    v_rcp_f32 v39, v39
    v_mfma_f32_16x16x32_bf16 v[156:159], v[84:87], a[252:255], v[156:159]
    s_waitcnt lgkmcnt(4)
    ds_read_b128 v[76:79], v10 offset:2048
    v_mul_f32 v39, v39, v111
    v_mfma_f32_16x16x32_bf16 v[156:159], v[80:83], a[244:247], v[156:159]
    buffer_load_dwordx4 v4, s[12:15], s16 offen offset:1024 lds
    v_mfma_f32_16x16x32_bf16 v[148:151], v[88:91], a[244:247], v[148:151]
    s_waitcnt lgkmcnt(4)
    ds_read_b128 v[80:83], v8 offset:6144
    v_cvt_pk_bf16_f32 v102, v36, v37
    v_mfma_f32_16x16x32_bf16 v[148:151], v[92:95], a[252:255], v[148:151]
    v_cvt_pk_bf16_f32 v103, v38, v39
    v_mul_f32 v24, v112, v22
    v_mfma_f32_16x16x32_bf16 v[144:147], v[92:95], a[248:251], v[144:147]
    s_waitcnt lgkmcnt(4)
    ds_read_b128 v[84:87], v10 offset:6144
    v_exp_f32 v24, v24
    v_mfma_f32_16x16x32_bf16 v[144:147], v[88:91], a[240:243], v[144:147]
    buffer_store_dwordx4 v[100:103], v1, s[12:15], s27 offen offset:256 sc1
    v_mfma_f32_16x16x32_bf16 v[160:163], v[64:67], a[0:3], 0
    s_waitcnt lgkmcnt(4)
    ds_read_b128 v[88:91], v8 offset:4096
    s_add_u32 s27, s40, 4096
    v_mfma_f32_16x16x32_bf16 v[160:163], v[68:71], a[8:11], v[160:163]
    v_lshlrev_b32 v105, 5, v5
    v_fma_f32 v24, v24, v23, v23
    v_mfma_f32_16x16x32_bf16 v[164:167], v[68:71], a[12:15], 0
    s_waitcnt lgkmcnt(4)
    ds_read_b128 v[92:95], v10 offset:4096
    v_rcp_f32 v24, v24
    v_mfma_f32_16x16x32_bf16 v[164:167], v[64:67], a[4:7], v[164:167]
    buffer_load_dwordx4 v4, s[12:15], s16 offen offset:2048 lds
    v_mfma_f32_16x16x32_bf16 v[172:175], v[72:75], a[4:7], 0
    s_waitcnt lgkmcnt(4)
    ds_read_b128 v[64:67], v8 offset:8192
    v_mul_f32 v24, v24, v112
    v_mfma_f32_16x16x32_bf16 v[172:175], v[76:79], a[12:15], v[172:175]
    v_mul_f32 v25, v113, v22
    v_mul_f32 v26, v114, v22
    v_mfma_f32_16x16x32_bf16 v[168:171], v[76:79], a[8:11], 0
    s_waitcnt lgkmcnt(4)
    ds_read_b128 v[68:71], v10 offset:8192
    v_exp_f32 v25, v25
    v_mfma_f32_16x16x32_bf16 v[168:171], v[72:75], a[0:3], v[168:171]
    buffer_load_dwordx4 v4, s[12:15], s16 offen offset:3072 lds
    v_mfma_f32_16x16x32_bf16 v[168:171], v[80:83], a[16:19], v[168:171]
    s_waitcnt lgkmcnt(4)
    ds_read_b128 v[72:75], v8 offset:10240
    v_exp_f32 v26, v26
    v_mfma_f32_16x16x32_bf16 v[168:171], v[84:87], a[24:27], v[168:171]
    v_fma_f32 v25, v25, v23, v23
    v_fma_f32 v26, v26, v23, v23
    v_mfma_f32_16x16x32_bf16 v[172:175], v[84:87], a[28:31], v[172:175]
    s_waitcnt lgkmcnt(4)
    ds_read_b128 v[76:79], v10 offset:10240
    v_rcp_f32 v25, v25
    v_mfma_f32_16x16x32_bf16 v[172:175], v[80:83], a[20:23], v[172:175]
    v_mul_f32 v25, v25, v113
    v_mul_f32 v27, v115, v22
    v_mfma_f32_16x16x32_bf16 v[164:167], v[88:91], a[20:23], v[164:167]
    s_waitcnt lgkmcnt(4)
    ds_read_b128 v[80:83], v8 offset:14336
    v_rcp_f32 v26, v26
    v_mfma_f32_16x16x32_bf16 v[164:167], v[92:95], a[28:31], v[164:167]
    v_mul_f32 v26, v26, v114
    v_mul_f32 v28, v120, v22
    v_mfma_f32_16x16x32_bf16 v[160:163], v[92:95], a[24:27], v[160:163]
    s_waitcnt lgkmcnt(4)
    ds_read_b128 v[84:87], v10 offset:14336
    v_exp_f32 v27, v27
    v_mfma_f32_16x16x32_bf16 v[160:163], v[88:91], a[16:19], v[160:163]
    v_fma_f32 v27, v27, v23, v23
    v_mul_f32 v29, v121, v22
    v_mfma_f32_16x16x32_bf16 v[160:163], v[64:67], a[32:35], v[160:163]
    s_waitcnt lgkmcnt(4)
    ds_read_b128 v[88:91], v8 offset:12288
    v_rcp_f32 v27, v27
    v_mfma_f32_16x16x32_bf16 v[160:163], v[68:71], a[40:43], v[160:163]
    v_mul_f32 v27, v27, v115
    v_mul_f32 v30, v122, v22
    v_mfma_f32_16x16x32_bf16 v[164:167], v[68:71], a[44:47], v[164:167]
    s_waitcnt lgkmcnt(4)
    ds_read_b128 v[92:95], v10 offset:12288
    v_exp_f32 v28, v28
    v_mfma_f32_16x16x32_bf16 v[164:167], v[64:67], a[36:39], v[164:167]
    s_waitcnt vmcnt(22)
    s_barrier
    v_mfma_f32_16x16x32_bf16 v[172:175], v[72:75], a[36:39], v[172:175]
    s_waitcnt lgkmcnt(4)
    ds_read_b128 v[64:67], v8 offset:16384
    s_add_u32 m0, s22, 114688
    v_mfma_f32_16x16x32_bf16 v[172:175], v[76:79], a[44:47], v[172:175]
    s_add_u32 s16, s16, 16384
    v_fma_f32 v28, v28, v23, v23
    v_mul_f32 v31, v123, v22
    v_mfma_f32_16x16x32_bf16 v[168:171], v[76:79], a[40:43], v[168:171]
    s_waitcnt lgkmcnt(4)
    ds_read_b128 v[68:71], v10 offset:16384
    v_rcp_f32 v28, v28
    v_mfma_f32_16x16x32_bf16 v[168:171], v[72:75], a[32:35], v[168:171]
    buffer_load_dwordx4 v4, s[12:15], s16 offen offset:0 lds
    v_mfma_f32_16x16x32_bf16 v[168:171], v[80:83], a[48:51], v[168:171]
    s_waitcnt lgkmcnt(4)
    ds_read_b128 v[72:75], v8 offset:18432
    v_exp_f32 v29, v29
    v_mfma_f32_16x16x32_bf16 v[168:171], v[84:87], a[56:59], v[168:171]
    v_mul_f32 v28, v28, v120
    v_fma_f32 v29, v29, v23, v23
    v_mfma_f32_16x16x32_bf16 v[172:175], v[84:87], a[60:63], v[172:175]
    s_waitcnt lgkmcnt(4)
    ds_read_b128 v[76:79], v10 offset:18432
    v_rcp_f32 v29, v29
    v_mfma_f32_16x16x32_bf16 v[172:175], v[80:83], a[52:55], v[172:175]
    buffer_load_dwordx4 v4, s[12:15], s16 offen offset:1024 lds
    v_mfma_f32_16x16x32_bf16 v[164:167], v[88:91], a[52:55], v[164:167]
    s_waitcnt lgkmcnt(4)
    ds_read_b128 v[80:83], v8 offset:22528
    v_exp_f32 v30, v30
    v_mfma_f32_16x16x32_bf16 v[164:167], v[92:95], a[60:63], v[164:167]
    v_mul_f32 v29, v29, v121
    v_fma_f32 v30, v30, v23, v23
    v_mfma_f32_16x16x32_bf16 v[160:163], v[92:95], a[56:59], v[160:163]
    s_waitcnt lgkmcnt(4)
    ds_read_b128 v[84:87], v10 offset:22528
    v_rcp_f32 v30, v30
    v_mfma_f32_16x16x32_bf16 v[160:163], v[88:91], a[48:51], v[160:163]
    buffer_load_dwordx4 v4, s[12:15], s16 offen offset:2048 lds
    v_mfma_f32_16x16x32_bf16 v[160:163], v[64:67], a[64:67], v[160:163]
    s_waitcnt lgkmcnt(4)
    ds_read_b128 v[88:91], v8 offset:20480
    v_exp_f32 v31, v31
    v_mfma_f32_16x16x32_bf16 v[160:163], v[68:71], a[72:75], v[160:163]
    v_mul_f32 v30, v30, v122
    v_fma_f32 v31, v31, v23, v23
    v_mfma_f32_16x16x32_bf16 v[164:167], v[68:71], a[76:79], v[164:167]
    s_waitcnt lgkmcnt(4)
    ds_read_b128 v[92:95], v10 offset:20480
    v_rcp_f32 v31, v31
    v_mfma_f32_16x16x32_bf16 v[164:167], v[64:67], a[68:71], v[164:167]
    buffer_load_dwordx4 v4, s[12:15], s16 offen offset:3072 lds
    v_mfma_f32_16x16x32_bf16 v[172:175], v[72:75], a[68:71], v[172:175]
    s_waitcnt lgkmcnt(4)
    ds_read_b128 v[64:67], v8 offset:24576
    v_mul_f32 v31, v31, v123
    v_mfma_f32_16x16x32_bf16 v[172:175], v[76:79], a[76:79], v[172:175]
    v_cvt_pk_bf16_f32 v112, v24, v25
    v_cvt_pk_bf16_f32 v113, v26, v27
    v_mfma_f32_16x16x32_bf16 v[168:171], v[76:79], a[72:75], v[168:171]
    s_waitcnt lgkmcnt(4)
    ds_read_b128 v[68:71], v10 offset:24576
    v_cvt_pk_bf16_f32 v114, v28, v29
    v_mfma_f32_16x16x32_bf16 v[168:171], v[72:75], a[64:67], v[168:171]
    v_cvt_pk_bf16_f32 v115, v30, v31
    v_mul_f32 v32, v116, v56
    v_mfma_f32_16x16x32_bf16 v[168:171], v[80:83], a[80:83], v[168:171]
    s_waitcnt lgkmcnt(4)
    ds_read_b128 v[72:75], v8 offset:26624
    v_exp_f32 v32, v32
    v_mfma_f32_16x16x32_bf16 v[168:171], v[84:87], a[88:91], v[168:171]
    buffer_store_dwordx4 v[112:115], v1, s[12:15], s45 offen offset:0 sc1
    v_mfma_f32_16x16x32_bf16 v[172:175], v[84:87], a[92:95], v[172:175]
    s_waitcnt lgkmcnt(4)
    ds_read_b128 v[76:79], v10 offset:26624
    v_fma_f32 v32, v32, v57, v57
    v_mfma_f32_16x16x32_bf16 v[172:175], v[80:83], a[84:87], v[172:175]
    v_rcp_f32 v32, v32
    v_mfma_f32_16x16x32_bf16 v[164:167], v[88:91], a[84:87], v[164:167]
    s_waitcnt lgkmcnt(4)
    ds_read_b128 v[80:83], v8 offset:30720
    v_mul_f32 v32, v32, v116
    v_mfma_f32_16x16x32_bf16 v[164:167], v[92:95], a[92:95], v[164:167]
    v_mul_f32 v33, v117, v56
    v_mul_f32 v34, v118, v56
    v_mfma_f32_16x16x32_bf16 v[160:163], v[92:95], a[88:91], v[160:163]
    s_waitcnt lgkmcnt(4)
    ds_read_b128 v[84:87], v10 offset:30720
    v_exp_f32 v33, v33
    v_mfma_f32_16x16x32_bf16 v[160:163], v[88:91], a[80:83], v[160:163]
    v_fma_f32 v33, v33, v57, v57
    v_mul_f32 v35, v119, v56
    v_mfma_f32_16x16x32_bf16 v[160:163], v[64:67], a[96:99], v[160:163]
    s_waitcnt lgkmcnt(4)
    ds_read_b128 v[88:91], v8 offset:28672
    v_rcp_f32 v33, v33
    v_mfma_f32_16x16x32_bf16 v[160:163], v[68:71], a[104:107], v[160:163]
    v_mul_f32 v33, v33, v117
    v_mul_f32 v36, v124, v56
    v_mfma_f32_16x16x32_bf16 v[164:167], v[68:71], a[108:111], v[164:167]
    s_waitcnt lgkmcnt(4)
    ds_read_b128 v[92:95], v10 offset:28672
    v_exp_f32 v34, v34
    v_mfma_f32_16x16x32_bf16 v[164:167], v[64:67], a[100:103], v[164:167]
    s_waitcnt vmcnt(23)
    s_barrier
    v_mfma_f32_16x16x32_bf16 v[172:175], v[72:75], a[100:103], v[172:175]
    s_waitcnt lgkmcnt(4)
    ds_read_b128 v[64:67], v8 offset:32768
    s_add_u32 m0, s22, 0
    v_mfma_f32_16x16x32_bf16 v[172:175], v[76:79], a[108:111], v[172:175]
    s_add_u32 s16, s16, 16384
    v_fma_f32 v34, v34, v57, v57
    v_mul_f32 v37, v125, v56
    v_mfma_f32_16x16x32_bf16 v[168:171], v[76:79], a[104:107], v[168:171]
    s_waitcnt lgkmcnt(4)
    ds_read_b128 v[68:71], v10 offset:32768
    v_rcp_f32 v34, v34
    v_mfma_f32_16x16x32_bf16 v[168:171], v[72:75], a[96:99], v[168:171]
    buffer_load_dwordx4 v4, s[12:15], s16 offen offset:0 lds
    v_mfma_f32_16x16x32_bf16 v[168:171], v[80:83], a[112:115], v[168:171]
    s_waitcnt lgkmcnt(4)
    ds_read_b128 v[72:75], v8 offset:34816
    v_exp_f32 v35, v35
    v_mfma_f32_16x16x32_bf16 v[168:171], v[84:87], a[120:123], v[168:171]
    v_mul_f32 v34, v34, v118
    v_fma_f32 v35, v35, v57, v57
    v_mfma_f32_16x16x32_bf16 v[172:175], v[84:87], a[124:127], v[172:175]
    s_waitcnt lgkmcnt(4)
    ds_read_b128 v[76:79], v10 offset:34816
    v_rcp_f32 v35, v35
    v_mfma_f32_16x16x32_bf16 v[172:175], v[80:83], a[116:119], v[172:175]
    buffer_load_dwordx4 v4, s[12:15], s16 offen offset:1024 lds
    v_mfma_f32_16x16x32_bf16 v[164:167], v[88:91], a[116:119], v[164:167]
    s_waitcnt lgkmcnt(4)
    ds_read_b128 v[80:83], v8 offset:38912
    v_exp_f32 v36, v36
    v_mfma_f32_16x16x32_bf16 v[164:167], v[92:95], a[124:127], v[164:167]
    s_waitcnt vmcnt(9)
    buffer_store_dword v60, v59, s[12:15], s26 offen sc1
    v_mfma_f32_16x16x32_bf16 v[160:163], v[92:95], a[120:123], v[160:163]
    s_waitcnt lgkmcnt(4)
    ds_read_b128 v[84:87], v10 offset:38912
    v_exp_f32 v37, v37
    v_mfma_f32_16x16x32_bf16 v[160:163], v[88:91], a[112:115], v[160:163]
    v_mov_b32 v60, 2
    v_mul_f32 v35, v35, v119
    v_mfma_f32_16x16x32_bf16 v[160:163], v[64:67], a[128:131], v[160:163]
    s_waitcnt lgkmcnt(4)
    ds_read_b128 v[88:91], v8 offset:36864
    v_fma_f32 v36, v36, v57, v57
    v_mfma_f32_16x16x32_bf16 v[160:163], v[68:71], a[136:139], v[160:163]
    buffer_load_dwordx4 v4, s[12:15], s16 offen offset:2048 lds
    v_mfma_f32_16x16x32_bf16 v[164:167], v[68:71], a[140:143], v[164:167]
    s_waitcnt lgkmcnt(4)
    ds_read_b128 v[92:95], v10 offset:36864
    v_rcp_f32 v36, v36
    v_mfma_f32_16x16x32_bf16 v[164:167], v[64:67], a[132:135], v[164:167]
    v_mul_f32 v36, v36, v124
    v_fma_f32 v37, v37, v57, v57
    v_mfma_f32_16x16x32_bf16 v[172:175], v[72:75], a[132:135], v[172:175]
    s_waitcnt lgkmcnt(4)
    ds_read_b128 v[64:67], v8 offset:40960
    v_rcp_f32 v37, v37
    v_mfma_f32_16x16x32_bf16 v[172:175], v[76:79], a[140:143], v[172:175]
    buffer_load_dwordx4 v4, s[12:15], s16 offen offset:3072 lds
    v_mfma_f32_16x16x32_bf16 v[168:171], v[76:79], a[136:139], v[168:171]
    s_waitcnt lgkmcnt(4)
    ds_read_b128 v[68:71], v10 offset:40960
    v_mul_f32 v37, v37, v125
    v_mfma_f32_16x16x32_bf16 v[168:171], v[72:75], a[128:131], v[168:171]
    v_mul_f32 v38, v126, v56
    v_mul_f32 v39, v127, v56
    v_mfma_f32_16x16x32_bf16 v[168:171], v[80:83], a[144:147], v[168:171]
    s_waitcnt lgkmcnt(4)
    ds_read_b128 v[72:75], v8 offset:43008
    v_exp_f32 v38, v38
    v_mfma_f32_16x16x32_bf16 v[168:171], v[84:87], a[152:155], v[168:171]
    v_fma_f32 v38, v38, v57, v57
    v_cvt_pk_bf16_f32 v116, v32, v33
    v_mfma_f32_16x16x32_bf16 v[172:175], v[84:87], a[156:159], v[172:175]
    s_waitcnt lgkmcnt(4)
    ds_read_b128 v[76:79], v10 offset:43008
    v_rcp_f32 v38, v38
    v_mfma_f32_16x16x32_bf16 v[172:175], v[80:83], a[148:151], v[172:175]
    v_mul_f32 v38, v38, v126
    v_cvt_pk_bf16_f32 v117, v34, v35
    v_mfma_f32_16x16x32_bf16 v[164:167], v[88:91], a[148:151], v[164:167]
    s_waitcnt lgkmcnt(4)
    ds_read_b128 v[80:83], v8 offset:47104
    v_exp_f32 v39, v39
    v_mfma_f32_16x16x32_bf16 v[164:167], v[92:95], a[156:159], v[164:167]
    v_fma_f32 v39, v39, v57, v57
    v_cvt_pk_bf16_f32 v118, v36, v37
    v_mfma_f32_16x16x32_bf16 v[160:163], v[92:95], a[152:155], v[160:163]
    s_waitcnt lgkmcnt(4)
    ds_read_b128 v[84:87], v10 offset:47104
    v_rcp_f32 v39, v39
    v_mfma_f32_16x16x32_bf16 v[160:163], v[88:91], a[144:147], v[160:163]
    v_mul_f32 v39, v39, v127
    v_mul_f32 v24, v128, v22
    v_mfma_f32_16x16x32_bf16 v[160:163], v[64:67], a[160:163], v[160:163]
    s_waitcnt lgkmcnt(4)
    ds_read_b128 v[88:91], v8 offset:45056
    v_exp_f32 v24, v24
    v_mfma_f32_16x16x32_bf16 v[160:163], v[68:71], a[168:171], v[160:163]
    v_cvt_pk_bf16_f32 v119, v38, v39
    v_fma_f32 v24, v24, v23, v23
    v_mfma_f32_16x16x32_bf16 v[164:167], v[68:71], a[172:175], v[164:167]
    s_waitcnt lgkmcnt(4)
    ds_read_b128 v[92:95], v10 offset:45056
    v_rcp_f32 v24, v24
    v_mfma_f32_16x16x32_bf16 v[164:167], v[64:67], a[164:167], v[164:167]
    s_barrier
    v_mfma_f32_16x16x32_bf16 v[172:175], v[72:75], a[164:167], v[172:175]
    s_waitcnt lgkmcnt(4)
    ds_read_b128 v[64:67], v8 offset:49152
    s_add_u32 m0, s22, 16384
    v_mfma_f32_16x16x32_bf16 v[172:175], v[76:79], a[172:175], v[172:175]
    buffer_store_dwordx4 v[116:119], v1, s[12:15], s45 offen offset:256 sc1
    v_mfma_f32_16x16x32_bf16 v[168:171], v[76:79], a[168:171], v[168:171]
    s_waitcnt lgkmcnt(4)
    ds_read_b128 v[68:71], v10 offset:49152
    s_add_u32 s16, s16, 16384
    v_mfma_f32_16x16x32_bf16 v[168:171], v[72:75], a[160:163], v[168:171]
    s_add_u32 s45, s40, 6144
    v_mul_f32 v24, v24, v128
    v_mul_f32 v25, v129, v22
    v_mfma_f32_16x16x32_bf16 v[168:171], v[80:83], a[176:179], v[168:171]
    s_waitcnt lgkmcnt(4)
    ds_read_b128 v[72:75], v8 offset:51200
    v_exp_f32 v25, v25
    v_mfma_f32_16x16x32_bf16 v[168:171], v[84:87], a[184:187], v[168:171]
    buffer_load_dwordx4 v4, s[12:15], s16 offen offset:0 lds
    v_mfma_f32_16x16x32_bf16 v[172:175], v[84:87], a[188:191], v[172:175]
    s_waitcnt lgkmcnt(4)
    ds_read_b128 v[76:79], v10 offset:51200
    v_fma_f32 v25, v25, v23, v23
    v_mfma_f32_16x16x32_bf16 v[172:175], v[80:83], a[180:183], v[172:175]
    v_rcp_f32 v25, v25
    v_mfma_f32_16x16x32_bf16 v[164:167], v[88:91], a[180:183], v[164:167]
    s_waitcnt lgkmcnt(4)
    ds_read_b128 v[80:83], v8 offset:55296
    v_mul_f32 v25, v25, v129
    v_mfma_f32_16x16x32_bf16 v[164:167], v[92:95], a[188:191], v[164:167]
    buffer_load_dwordx4 v4, s[12:15], s16 offen offset:1024 lds
    v_mfma_f32_16x16x32_bf16 v[160:163], v[92:95], a[184:187], v[160:163]
    s_waitcnt lgkmcnt(4)
    ds_read_b128 v[84:87], v10 offset:55296
    v_mul_f32 v26, v130, v22
    v_mfma_f32_16x16x32_bf16 v[160:163], v[88:91], a[176:179], v[160:163]
    buffer_load_dword v61, v58, s[12:15], s26 offen sc1
    v_mfma_f32_16x16x32_bf16 v[160:163], v[64:67], a[192:195], v[160:163]
    s_waitcnt lgkmcnt(4)
    ds_read_b128 v[88:91], v8 offset:53248
    v_exp_f32 v26, v26
    v_mfma_f32_16x16x32_bf16 v[160:163], v[68:71], a[200:203], v[160:163]
    v_fma_f32 v26, v26, v23, v23
    v_mul_f32 v27, v131, v22
    v_mfma_f32_16x16x32_bf16 v[164:167], v[68:71], a[204:207], v[164:167]
    s_waitcnt lgkmcnt(4)
    ds_read_b128 v[92:95], v10 offset:53248
    v_rcp_f32 v26, v26
    v_mfma_f32_16x16x32_bf16 v[164:167], v[64:67], a[196:199], v[164:167]
    buffer_load_dwordx4 v4, s[12:15], s16 offen offset:2048 lds
    v_mfma_f32_16x16x32_bf16 v[172:175], v[72:75], a[196:199], v[172:175]
    s_waitcnt lgkmcnt(4)
    ds_read_b128 v[64:67], v8 offset:57344
    v_exp_f32 v27, v27
    v_mfma_f32_16x16x32_bf16 v[172:175], v[76:79], a[204:207], v[172:175]
    v_mul_f32 v26, v26, v130
    v_fma_f32 v27, v27, v23, v23
    v_mfma_f32_16x16x32_bf16 v[168:171], v[76:79], a[200:203], v[168:171]
    s_waitcnt lgkmcnt(4)
    ds_read_b128 v[68:71], v10 offset:57344
    v_rcp_f32 v27, v27
    v_mfma_f32_16x16x32_bf16 v[168:171], v[72:75], a[192:195], v[168:171]
    buffer_load_dwordx4 v4, s[12:15], s16 offen offset:3072 lds
    v_mfma_f32_16x16x32_bf16 v[168:171], v[80:83], a[208:211], v[168:171]
    s_waitcnt lgkmcnt(4)
    ds_read_b128 v[72:75], v8 offset:59392
    v_mul_f32 v27, v27, v131
    v_mfma_f32_16x16x32_bf16 v[168:171], v[84:87], a[216:219], v[168:171]
    v_mul_f32 v28, v136, v22
    v_mul_f32 v29, v137, v22
    v_mfma_f32_16x16x32_bf16 v[172:175], v[84:87], a[220:223], v[172:175]
    s_waitcnt lgkmcnt(4)
    ds_read_b128 v[76:79], v10 offset:59392
    v_exp_f32 v28, v28
    v_mfma_f32_16x16x32_bf16 v[172:175], v[80:83], a[212:215], v[172:175]
    v_fma_f32 v28, v28, v23, v23
    v_mul_f32 v30, v138, v22
    v_mfma_f32_16x16x32_bf16 v[164:167], v[88:91], a[212:215], v[164:167]
    s_waitcnt lgkmcnt(4)
    ds_read_b128 v[80:83], v8 offset:63488
    v_rcp_f32 v28, v28
    v_mfma_f32_16x16x32_bf16 v[164:167], v[92:95], a[220:223], v[164:167]
    v_mul_f32 v28, v28, v136
    v_mul_f32 v31, v139, v22
    v_mfma_f32_16x16x32_bf16 v[160:163], v[92:95], a[216:219], v[160:163]
    s_waitcnt lgkmcnt(4)
    ds_read_b128 v[84:87], v10 offset:63488
    v_exp_f32 v29, v29
    v_mfma_f32_16x16x32_bf16 v[160:163], v[88:91], a[208:211], v[160:163]
    v_fma_f32 v29, v29, v23, v23
    v_cvt_pk_bf16_f32 v128, v24, v25
    v_mfma_f32_16x16x32_bf16 v[160:163], v[64:67], a[224:227], v[160:163]
    s_waitcnt lgkmcnt(4)
    ds_read_b128 v[88:91], v8 offset:61440
    v_rcp_f32 v29, v29
    v_mfma_f32_16x16x32_bf16 v[160:163], v[68:71], a[232:235], v[160:163]
    v_mul_f32 v29, v29, v137
    v_cvt_pk_bf16_f32 v129, v26, v27
    v_mfma_f32_16x16x32_bf16 v[164:167], v[68:71], a[236:239], v[164:167]
    s_waitcnt lgkmcnt(4)
    ds_read_b128 v[92:95], v10 offset:61440
    v_exp_f32 v30, v30
    v_mfma_f32_16x16x32_bf16 v[164:167], v[64:67], a[228:231], v[164:167]
    s_barrier
    v_mfma_f32_16x16x32_bf16 v[172:175], v[72:75], a[228:231], v[172:175]
    s_waitcnt lgkmcnt(4)
    ds_read_b128 v[64:67], v9 offset:0
    s_add_u32 m0, s22, 32768
    v_mfma_f32_16x16x32_bf16 v[172:175], v[76:79], a[236:239], v[172:175]
    s_add_u32 s16, s16, 16384
    v_fma_f32 v30, v30, v23, v23
    v_cvt_pk_bf16_f32 v130, v28, v29
    v_mfma_f32_16x16x32_bf16 v[168:171], v[76:79], a[232:235], v[168:171]
    s_waitcnt lgkmcnt(4)
    ds_read_b128 v[68:71], v11 offset:0
    v_rcp_f32 v30, v30
    v_mfma_f32_16x16x32_bf16 v[168:171], v[72:75], a[224:227], v[168:171]
    buffer_load_dwordx4 v4, s[12:15], s16 offen offset:0 lds
    v_mfma_f32_16x16x32_bf16 v[168:171], v[80:83], a[240:243], v[168:171]
    s_waitcnt lgkmcnt(4)
    ds_read_b128 v[72:75], v9 offset:2048
    v_exp_f32 v31, v31
    v_mfma_f32_16x16x32_bf16 v[168:171], v[84:87], a[248:251], v[168:171]
    v_mul_f32 v30, v30, v138
    v_fma_f32 v31, v31, v23, v23
    v_mfma_f32_16x16x32_bf16 v[172:175], v[84:87], a[252:255], v[172:175]
    s_waitcnt lgkmcnt(4)
    ds_read_b128 v[76:79], v11 offset:2048
    v_rcp_f32 v31, v31
    v_mfma_f32_16x16x32_bf16 v[172:175], v[80:83], a[244:247], v[172:175]
    buffer_load_dwordx4 v4, s[12:15], s16 offen offset:1024 lds
    v_mfma_f32_16x16x32_bf16 v[164:167], v[88:91], a[244:247], v[164:167]
    s_waitcnt lgkmcnt(4)
    ds_read_b128 v[80:83], v9 offset:6144
    v_mul_f32 v31, v31, v139
    v_mfma_f32_16x16x32_bf16 v[164:167], v[92:95], a[252:255], v[164:167]
    v_cvt_pk_bf16_f32 v131, v30, v31
    v_mul_f32 v32, v132, v56
    v_mfma_f32_16x16x32_bf16 v[160:163], v[92:95], a[248:251], v[160:163]
    s_waitcnt lgkmcnt(4)
    ds_read_b128 v[84:87], v11 offset:6144
    v_exp_f32 v32, v32
    v_mfma_f32_16x16x32_bf16 v[160:163], v[88:91], a[240:243], v[160:163]
    buffer_store_dwordx4 v[128:131], v1, s[12:15], s27 offen offset:0 sc1
    v_mfma_f32_16x16x32_bf16 v[176:179], v[64:67], a[0:3], 0
    s_waitcnt lgkmcnt(4)
    ds_read_b128 v[88:91], v9 offset:4096
    v_fma_f32 v32, v32, v57, v57
    v_mfma_f32_16x16x32_bf16 v[176:179], v[68:71], a[8:11], v[176:179]
    v_rcp_f32 v32, v32
    v_mfma_f32_16x16x32_bf16 v[180:183], v[68:71], a[12:15], 0
    s_waitcnt lgkmcnt(4)
    ds_read_b128 v[92:95], v11 offset:4096
    v_mul_f32 v32, v32, v132
    v_mfma_f32_16x16x32_bf16 v[180:183], v[64:67], a[4:7], v[180:183]
    buffer_load_dwordx4 v4, s[12:15], s16 offen offset:2048 lds
    v_mfma_f32_16x16x32_bf16 v[188:191], v[72:75], a[4:7], 0
    s_waitcnt lgkmcnt(4)
    ds_read_b128 v[64:67], v9 offset:8192
    v_mul_f32 v33, v133, v56
    v_mfma_f32_16x16x32_bf16 v[188:191], v[76:79], a[12:15], v[188:191]
    v_exp_f32 v33, v33
    v_mfma_f32_16x16x32_bf16 v[184:187], v[76:79], a[8:11], 0
    s_waitcnt lgkmcnt(4)
    ds_read_b128 v[68:71], v11 offset:8192
    v_fma_f32 v33, v33, v57, v57
    v_mfma_f32_16x16x32_bf16 v[184:187], v[72:75], a[0:3], v[184:187]
    buffer_load_dwordx4 v4, s[12:15], s16 offen offset:3072 lds
    v_mfma_f32_16x16x32_bf16 v[184:187], v[80:83], a[16:19], v[184:187]
    s_waitcnt lgkmcnt(4)
    ds_read_b128 v[72:75], v9 offset:10240
    v_rcp_f32 v33, v33
    v_mfma_f32_16x16x32_bf16 v[184:187], v[84:87], a[24:27], v[184:187]
    v_mul_f32 v33, v33, v133
    v_mul_f32 v34, v134, v56
    v_mfma_f32_16x16x32_bf16 v[188:191], v[84:87], a[28:31], v[188:191]
    s_waitcnt lgkmcnt(4)
    ds_read_b128 v[76:79], v11 offset:10240
    v_exp_f32 v34, v34
    v_mfma_f32_16x16x32_bf16 v[188:191], v[80:83], a[20:23], v[188:191]
    v_fma_f32 v34, v34, v57, v57
    v_mul_f32 v35, v135, v56
    v_mfma_f32_16x16x32_bf16 v[180:183], v[88:91], a[20:23], v[180:183]
    s_waitcnt lgkmcnt(4)
    ds_read_b128 v[80:83], v9 offset:14336
    v_rcp_f32 v34, v34
    v_mfma_f32_16x16x32_bf16 v[180:183], v[92:95], a[28:31], v[180:183]
    v_mul_f32 v34, v34, v134
    v_mul_f32 v36, v140, v56
    v_mfma_f32_16x16x32_bf16 v[176:179], v[92:95], a[24:27], v[176:179]
    s_waitcnt lgkmcnt(4)
    ds_read_b128 v[84:87], v11 offset:14336
    v_exp_f32 v35, v35
    v_mfma_f32_16x16x32_bf16 v[176:179], v[88:91], a[16:19], v[176:179]
    v_fma_f32 v35, v35, v57, v57
    v_mul_f32 v37, v141, v56
    v_mfma_f32_16x16x32_bf16 v[176:179], v[64:67], a[32:35], v[176:179]
    s_waitcnt lgkmcnt(4)
    ds_read_b128 v[88:91], v9 offset:12288
    v_rcp_f32 v35, v35
    v_mfma_f32_16x16x32_bf16 v[176:179], v[68:71], a[40:43], v[176:179]
    v_mul_f32 v35, v35, v135
    v_mul_f32 v38, v142, v56
    v_mfma_f32_16x16x32_bf16 v[180:183], v[68:71], a[44:47], v[180:183]
    s_waitcnt lgkmcnt(4)
    ds_read_b128 v[92:95], v11 offset:12288
    v_exp_f32 v36, v36
    v_mfma_f32_16x16x32_bf16 v[180:183], v[64:67], a[36:39], v[180:183]
    s_barrier
    v_mfma_f32_16x16x32_bf16 v[188:191], v[72:75], a[36:39], v[188:191]
    s_waitcnt lgkmcnt(4)
    ds_read_b128 v[64:67], v9 offset:16384
    v_exp_f32 v37, v37
    v_mfma_f32_16x16x32_bf16 v[188:191], v[76:79], a[44:47], v[188:191]
    s_waitcnt vmcnt(10)
    buffer_store_dword v60, v59, s[12:15], s26 offen sc1
    v_mfma_f32_16x16x32_bf16 v[184:187], v[76:79], a[40:43], v[184:187]
    s_waitcnt lgkmcnt(4)
    ds_read_b128 v[68:71], v11 offset:16384
    s_add_u32 m0, s22, 49152
    v_mfma_f32_16x16x32_bf16 v[184:187], v[72:75], a[32:35], v[184:187]
    s_add_u32 s16, s16, 16384
    v_mov_b32 v60, 3
    v_fma_f32 v36, v36, v57, v57
    v_mfma_f32_16x16x32_bf16 v[184:187], v[80:83], a[48:51], v[184:187]
    s_waitcnt lgkmcnt(4)
    ds_read_b128 v[72:75], v9 offset:18432
    v_rcp_f32 v36, v36
    v_mfma_f32_16x16x32_bf16 v[184:187], v[84:87], a[56:59], v[184:187]
    buffer_load_dwordx4 v4, s[12:15], s16 offen offset:0 lds
    v_mfma_f32_16x16x32_bf16 v[188:191], v[84:87], a[60:63], v[188:191]
    s_waitcnt lgkmcnt(4)
    ds_read_b128 v[76:79], v11 offset:18432
    v_exp_f32 v38, v38
    v_mfma_f32_16x16x32_bf16 v[188:191], v[80:83], a[52:55], v[188:191]
    v_mul_f32 v36, v36, v140
    v_fma_f32 v37, v37, v57, v57
    v_mfma_f32_16x16x32_bf16 v[180:183], v[88:91], a[52:55], v[180:183]
    s_waitcnt lgkmcnt(4)
    ds_read_b128 v[80:83], v9 offset:22528
    v_rcp_f32 v37, v37
    v_mfma_f32_16x16x32_bf16 v[180:183], v[92:95], a[60:63], v[180:183]
    buffer_load_dwordx4 v4, s[12:15], s16 offen offset:1024 lds
    v_mfma_f32_16x16x32_bf16 v[176:179], v[92:95], a[56:59], v[176:179]
    s_waitcnt lgkmcnt(4)
    ds_read_b128 v[84:87], v11 offset:22528
    v_mul_f32 v37, v37, v141
    v_mfma_f32_16x16x32_bf16 v[176:179], v[88:91], a[48:51], v[176:179]
    s_waitcnt vmcnt(10)
    v_cmp_gt_u32 vcc, 1, v61
    v_fma_f32 v38, v38, v57, v57
    v_mfma_f32_16x16x32_bf16 v[176:179], v[64:67], a[64:67], v[176:179]
    s_waitcnt lgkmcnt(4)
    ds_read_b128 v[88:91], v9 offset:20480
    s_cbranch_vccnz SLOW0_ff_kernel
BACK0_ff_kernel:
    v_mfma_f32_16x16x32_bf16 v[176:179], v[68:71], a[72:75], v[176:179]
    buffer_load_dwordx4 v4, s[12:15], s16 offen offset:2048 lds
    v_mfma_f32_16x16x32_bf16 v[180:183], v[68:71], a[76:79], v[180:183]
    s_waitcnt lgkmcnt(4)
    ds_read_b128 v[92:95], v11 offset:20480
    v_rcp_f32 v38, v38
    v_mfma_f32_16x16x32_bf16 v[180:183], v[64:67], a[68:71], v[180:183]
    v_mul_f32 v38, v38, v142
    v_mul_f32 v39, v143, v56
    v_mfma_f32_16x16x32_bf16 v[188:191], v[72:75], a[68:71], v[188:191]
    s_waitcnt lgkmcnt(4)
    ds_read_b128 v[64:67], v9 offset:24576
    v_exp_f32 v39, v39
    v_mfma_f32_16x16x32_bf16 v[188:191], v[76:79], a[76:79], v[188:191]
    buffer_load_dwordx4 v4, s[12:15], s16 offen offset:3072 lds
    v_mfma_f32_16x16x32_bf16 v[184:187], v[76:79], a[72:75], v[184:187]
    s_waitcnt lgkmcnt(4)
    ds_read_b128 v[68:71], v11 offset:24576
    v_fma_f32 v39, v39, v57, v57
    v_mfma_f32_16x16x32_bf16 v[184:187], v[72:75], a[64:67], v[184:187]
    v_rcp_f32 v39, v39
    v_mfma_f32_16x16x32_bf16 v[184:187], v[80:83], a[80:83], v[184:187]
    s_waitcnt lgkmcnt(4)
    ds_read_b128 v[72:75], v9 offset:26624
    v_mul_f32 v39, v39, v143
    v_mfma_f32_16x16x32_bf16 v[184:187], v[84:87], a[88:91], v[184:187]
    v_cvt_pk_bf16_f32 v132, v32, v33
    v_cvt_pk_bf16_f32 v133, v34, v35
    v_mfma_f32_16x16x32_bf16 v[188:191], v[84:87], a[92:95], v[188:191]
    s_waitcnt lgkmcnt(4)
    ds_read_b128 v[76:79], v11 offset:26624
    v_cvt_pk_bf16_f32 v134, v36, v37
    v_mfma_f32_16x16x32_bf16 v[188:191], v[80:83], a[84:87], v[188:191]
    v_cvt_pk_bf16_f32 v135, v38, v39
    v_mul_f32 v24, v144, v22
    v_mfma_f32_16x16x32_bf16 v[180:183], v[88:91], a[84:87], v[180:183]
    s_waitcnt lgkmcnt(4)
    ds_read_b128 v[80:83], v9 offset:30720
    v_exp_f32 v24, v24
    v_mfma_f32_16x16x32_bf16 v[180:183], v[92:95], a[92:95], v[180:183]
    buffer_store_dwordx4 v[132:135], v1, s[12:15], s27 offen offset:256 sc1
    v_mfma_f32_16x16x32_bf16 v[176:179], v[92:95], a[88:91], v[176:179]
    s_waitcnt lgkmcnt(4)
    ds_read_b128 v[84:87], v11 offset:30720
    s_add_u32 s27, s40, 8192
    v_mfma_f32_16x16x32_bf16 v[176:179], v[88:91], a[80:83], v[176:179]
    v_fma_f32 v24, v24, v23, v23
    v_mul_f32 v25, v145, v22
    v_mfma_f32_16x16x32_bf16 v[176:179], v[64:67], a[96:99], v[176:179]
    s_waitcnt lgkmcnt(4)
    ds_read_b128 v[88:91], v9 offset:28672
    v_rcp_f32 v24, v24
    v_mfma_f32_16x16x32_bf16 v[176:179], v[68:71], a[104:107], v[176:179]
    v_mul_f32 v24, v24, v144
    v_mul_f32 v26, v146, v22
    v_mfma_f32_16x16x32_bf16 v[180:183], v[68:71], a[108:111], v[180:183]
    s_waitcnt lgkmcnt(4)
    ds_read_b128 v[92:95], v11 offset:28672
    v_exp_f32 v25, v25
    v_mfma_f32_16x16x32_bf16 v[180:183], v[64:67], a[100:103], v[180:183]
    s_barrier
    v_mfma_f32_16x16x32_bf16 v[188:191], v[72:75], a[100:103], v[188:191]
    s_waitcnt lgkmcnt(4)
    ds_read_b128 v[64:67], v9 offset:32768
    v_exp_f32 v26, v26
    v_mfma_f32_16x16x32_bf16 v[188:191], v[76:79], a[108:111], v[188:191]
    buffer_load_dword v62, v58, s[12:15], s26 offen sc1
    v_mfma_f32_16x16x32_bf16 v[184:187], v[76:79], a[104:107], v[184:187]
    s_waitcnt lgkmcnt(4)
    ds_read_b128 v[68:71], v11 offset:32768
    s_add_u32 m0, s22, 65536
    v_mfma_f32_16x16x32_bf16 v[184:187], v[72:75], a[96:99], v[184:187]
    s_add_u32 s16, s16, 7946240
    v_fma_f32 v25, v25, v23, v23
    v_fma_f32 v26, v26, v23, v23
    v_mfma_f32_16x16x32_bf16 v[184:187], v[80:83], a[112:115], v[184:187]
    s_waitcnt lgkmcnt(4)
    ds_read_b128 v[72:75], v9 offset:34816
    v_rcp_f32 v25, v25
    v_mfma_f32_16x16x32_bf16 v[184:187], v[84:87], a[120:123], v[184:187]
    buffer_load_dwordx4 v4, s[12:15], s16 offen offset:0 lds
    v_mfma_f32_16x16x32_bf16 v[188:191], v[84:87], a[124:127], v[188:191]
    s_waitcnt lgkmcnt(4)
    ds_read_b128 v[76:79], v11 offset:34816
    v_rcp_f32 v26, v26
    v_mfma_f32_16x16x32_bf16 v[188:191], v[80:83], a[116:119], v[188:191]
    v_mul_f32 v25, v25, v145
    v_mul_f32 v26, v26, v146
    v_mfma_f32_16x16x32_bf16 v[180:183], v[88:91], a[116:119], v[180:183]
    s_waitcnt lgkmcnt(4)
    ds_read_b128 v[80:83], v9 offset:38912
    v_mul_f32 v27, v147, v22
    v_mfma_f32_16x16x32_bf16 v[180:183], v[92:95], a[124:127], v[180:183]
    buffer_load_dwordx4 v4, s[12:15], s16 offen offset:1024 lds
    v_mfma_f32_16x16x32_bf16 v[176:179], v[92:95], a[120:123], v[176:179]
    s_waitcnt lgkmcnt(4)
    ds_read_b128 v[84:87], v11 offset:38912
    v_exp_f32 v27, v27
    v_mfma_f32_16x16x32_bf16 v[176:179], v[88:91], a[112:115], v[176:179]
    v_fma_f32 v27, v27, v23, v23
    v_mul_f32 v28, v152, v22
    v_mfma_f32_16x16x32_bf16 v[176:179], v[64:67], a[128:131], v[176:179]
    s_waitcnt lgkmcnt(4)
    ds_read_b128 v[88:91], v9 offset:36864
    v_rcp_f32 v27, v27
    v_mfma_f32_16x16x32_bf16 v[176:179], v[68:71], a[136:139], v[176:179]
    buffer_load_dwordx4 v4, s[12:15], s16 offen offset:2048 lds
    v_mfma_f32_16x16x32_bf16 v[180:183], v[68:71], a[140:143], v[180:183]
    s_waitcnt lgkmcnt(4)
    ds_read_b128 v[92:95], v11 offset:36864
    v_exp_f32 v28, v28
    v_mfma_f32_16x16x32_bf16 v[180:183], v[64:67], a[132:135], v[180:183]
    v_mul_f32 v27, v27, v147
    v_fma_f32 v28, v28, v23, v23
    v_mfma_f32_16x16x32_bf16 v[188:191], v[72:75], a[132:135], v[188:191]
    s_waitcnt lgkmcnt(4)
    ds_read_b128 v[64:67], v9 offset:40960
    v_rcp_f32 v28, v28
    v_mfma_f32_16x16x32_bf16 v[188:191], v[76:79], a[140:143], v[188:191]
    buffer_load_dwordx4 v4, s[12:15], s16 offen offset:3072 lds
    v_mfma_f32_16x16x32_bf16 v[184:187], v[76:79], a[136:139], v[184:187]
    s_waitcnt lgkmcnt(4)
    ds_read_b128 v[68:71], v11 offset:40960
    v_mul_f32 v28, v28, v152
    v_mfma_f32_16x16x32_bf16 v[184:187], v[72:75], a[128:131], v[184:187]
    v_mul_f32 v29, v153, v22
    v_mul_f32 v30, v154, v22
    v_mfma_f32_16x16x32_bf16 v[184:187], v[80:83], a[144:147], v[184:187]
    s_waitcnt lgkmcnt(4)
    ds_read_b128 v[72:75], v9 offset:43008
    v_exp_f32 v29, v29
    v_mfma_f32_16x16x32_bf16 v[184:187], v[84:87], a[152:155], v[184:187]
    v_fma_f32 v29, v29, v23, v23
    v_mul_f32 v31, v155, v22
    v_mfma_f32_16x16x32_bf16 v[188:191], v[84:87], a[156:159], v[188:191]
    s_waitcnt lgkmcnt(4)
    ds_read_b128 v[76:79], v11 offset:43008
    v_rcp_f32 v29, v29
    v_mfma_f32_16x16x32_bf16 v[188:191], v[80:83], a[148:151], v[188:191]
    v_mul_f32 v29, v29, v153
    v_cvt_pk_bf16_f32 v144, v24, v25
    v_mfma_f32_16x16x32_bf16 v[180:183], v[88:91], a[148:151], v[180:183]
    s_waitcnt lgkmcnt(4)
    ds_read_b128 v[80:83], v9 offset:47104
    v_exp_f32 v30, v30
    v_mfma_f32_16x16x32_bf16 v[180:183], v[92:95], a[156:159], v[180:183]
    v_fma_f32 v30, v30, v23, v23
    v_cvt_pk_bf16_f32 v145, v26, v27
    v_mfma_f32_16x16x32_bf16 v[176:179], v[92:95], a[152:155], v[176:179]
    s_waitcnt lgkmcnt(4)
    ds_read_b128 v[84:87], v11 offset:47104
    v_rcp_f32 v30, v30
    v_mfma_f32_16x16x32_bf16 v[176:179], v[88:91], a[144:147], v[176:179]
    v_mul_f32 v30, v30, v154
    v_cvt_pk_bf16_f32 v146, v28, v29
    v_mfma_f32_16x16x32_bf16 v[176:179], v[64:67], a[160:163], v[176:179]
    s_waitcnt lgkmcnt(4)
    ds_read_b128 v[88:91], v9 offset:45056
    v_exp_f32 v31, v31
    v_mfma_f32_16x16x32_bf16 v[176:179], v[68:71], a[168:171], v[176:179]
    v_fma_f32 v31, v31, v23, v23
    v_mul_f32 v32, v148, v56
    v_mfma_f32_16x16x32_bf16 v[180:183], v[68:71], a[172:175], v[180:183]
    s_waitcnt lgkmcnt(4)
    ds_read_b128 v[92:95], v11 offset:45056
    v_rcp_f32 v31, v31
    v_mfma_f32_16x16x32_bf16 v[180:183], v[64:67], a[164:167], v[180:183]
    s_barrier
    v_mfma_f32_16x16x32_bf16 v[188:191], v[72:75], a[164:167], v[188:191]
    s_waitcnt lgkmcnt(4)
    ds_read_b128 v[64:67], v9 offset:49152
    s_add_u32 m0, s22, 81920
    v_mfma_f32_16x16x32_bf16 v[188:191], v[76:79], a[172:175], v[188:191]
    s_add_u32 s16, s16, 16384
    v_mul_f32 v31, v31, v155
    v_mul_f32 v33, v149, v56
    v_mfma_f32_16x16x32_bf16 v[184:187], v[76:79], a[168:171], v[184:187]
    s_waitcnt lgkmcnt(4)
    ds_read_b128 v[68:71], v11 offset:49152
    v_exp_f32 v32, v32
    v_mfma_f32_16x16x32_bf16 v[184:187], v[72:75], a[160:163], v[184:187]
    buffer_load_dwordx4 v4, s[12:15], s16 offen offset:0 lds
    v_mfma_f32_16x16x32_bf16 v[184:187], v[80:83], a[176:179], v[184:187]
    s_waitcnt lgkmcnt(4)
    ds_read_b128 v[72:75], v9 offset:51200
    v_exp_f32 v33, v33
    v_mfma_f32_16x16x32_bf16 v[184:187], v[84:87], a[184:187], v[184:187]
    v_cvt_pk_bf16_f32 v147, v30, v31
    v_fma_f32 v32, v32, v57, v57
    v_mfma_f32_16x16x32_bf16 v[188:191], v[84:87], a[188:191], v[188:191]
    s_waitcnt lgkmcnt(4)
    ds_read_b128 v[76:79], v11 offset:51200
    v_rcp_f32 v32, v32
    v_mfma_f32_16x16x32_bf16 v[188:191], v[80:83], a[180:183], v[188:191]
    buffer_store_dwordx4 v[144:147], v1, s[12:15], s45 offen offset:0 sc1
    v_mfma_f32_16x16x32_bf16 v[180:183], v[88:91], a[180:183], v[180:183]
    s_waitcnt lgkmcnt(4)
    ds_read_b128 v[80:83], v9 offset:55296
    v_mul_f32 v32, v32, v148
    v_mfma_f32_16x16x32_bf16 v[180:183], v[92:95], a[188:191], v[180:183]
    v_fma_f32 v33, v33, v57, v57
    v_mul_f32 v34, v150, v56
    v_mfma_f32_16x16x32_bf16 v[176:179], v[92:95], a[184:187], v[176:179]
    s_waitcnt lgkmcnt(4)
    ds_read_b128 v[84:87], v11 offset:55296
    v_rcp_f32 v33, v33
    v_mfma_f32_16x16x32_bf16 v[176:179], v[88:91], a[176:179], v[176:179]
    buffer_load_dwordx4 v4, s[12:15], s16 offen offset:1024 lds
    v_mfma_f32_16x16x32_bf16 v[176:179], v[64:67], a[192:195], v[176:179]
    s_waitcnt lgkmcnt(4)
    ds_read_b128 v[88:91], v9 offset:53248
    v_exp_f32 v34, v34
    v_mfma_f32_16x16x32_bf16 v[176:179], v[68:71], a[200:203], v[176:179]
    v_mul_f32 v33, v33, v149
    v_fma_f32 v34, v34, v57, v57
    v_mfma_f32_16x16x32_bf16 v[180:183], v[68:71], a[204:207], v[180:183]
    s_waitcnt lgkmcnt(4)
    ds_read_b128 v[92:95], v11 offset:53248
    v_rcp_f32 v34, v34
    v_mfma_f32_16x16x32_bf16 v[180:183], v[64:67], a[196:199], v[180:183]
    buffer_load_dwordx4 v4, s[12:15], s16 offen offset:2048 lds
    v_mfma_f32_16x16x32_bf16 v[188:191], v[72:75], a[196:199], v[188:191]
    s_waitcnt lgkmcnt(4)
    ds_read_b128 v[64:67], v9 offset:57344
    v_mul_f32 v34, v34, v150
    v_mfma_f32_16x16x32_bf16 v[188:191], v[76:79], a[204:207], v[188:191]
    v_mul_f32 v35, v151, v56
    v_mul_f32 v36, v156, v56
    v_mfma_f32_16x16x32_bf16 v[184:187], v[76:79], a[200:203], v[184:187]
    s_waitcnt lgkmcnt(4)
    ds_read_b128 v[68:71], v11 offset:57344
    v_exp_f32 v35, v35
    v_mfma_f32_16x16x32_bf16 v[184:187], v[72:75], a[192:195], v[184:187]
    buffer_load_dwordx4 v4, s[12:15], s16 offen offset:3072 lds
    v_mfma_f32_16x16x32_bf16 v[184:187], v[80:83], a[208:211], v[184:187]
    s_waitcnt lgkmcnt(4)
    ds_read_b128 v[72:75], v9 offset:59392
    v_exp_f32 v36, v36
    v_mfma_f32_16x16x32_bf16 v[184:187], v[84:87], a[216:219], v[184:187]
    v_fma_f32 v35, v35, v57, v57
    v_fma_f32 v36, v36, v57, v57
    v_mfma_f32_16x16x32_bf16 v[188:191], v[84:87], a[220:223], v[188:191]
    s_waitcnt lgkmcnt(4)
    ds_read_b128 v[76:79], v11 offset:59392
    v_rcp_f32 v35, v35
    v_mfma_f32_16x16x32_bf16 v[188:191], v[80:83], a[212:215], v[188:191]
    s_waitcnt vmcnt(10)
    buffer_store_dword v60, v59, s[12:15], s26 offen sc1
    v_mfma_f32_16x16x32_bf16 v[180:183], v[88:91], a[212:215], v[180:183]
    s_waitcnt lgkmcnt(4)
    ds_read_b128 v[80:83], v9 offset:63488
    v_rcp_f32 v36, v36
    v_mfma_f32_16x16x32_bf16 v[180:183], v[92:95], a[220:223], v[180:183]
    v_mov_b32 v60, 4
    v_mul_f32 v35, v35, v151
    v_mfma_f32_16x16x32_bf16 v[176:179], v[92:95], a[216:219], v[176:179]
    s_waitcnt lgkmcnt(4)
    ds_read_b128 v[84:87], v11 offset:63488
    v_mul_f32 v36, v36, v156
    v_mfma_f32_16x16x32_bf16 v[176:179], v[88:91], a[208:211], v[176:179]
    v_mul_f32 v37, v157, v56
    v_mul_f32 v38, v158, v56
    v_mfma_f32_16x16x32_bf16 v[176:179], v[64:67], a[224:227], v[176:179]
    s_waitcnt lgkmcnt(4)
    ds_read_b128 v[88:91], v9 offset:61440
    v_exp_f32 v37, v37
    v_mfma_f32_16x16x32_bf16 v[176:179], v[68:71], a[232:235], v[176:179]
    v_fma_f32 v37, v37, v57, v57
    v_mul_f32 v39, v159, v56
    v_mfma_f32_16x16x32_bf16 v[180:183], v[68:71], a[236:239], v[180:183]
    s_waitcnt lgkmcnt(4)
    ds_read_b128 v[92:95], v11 offset:61440
    v_rcp_f32 v37, v37
    v_mfma_f32_16x16x32_bf16 v[180:183], v[64:67], a[228:231], v[180:183]
    s_barrier
    v_mfma_f32_16x16x32_bf16 v[188:191], v[72:75], a[228:231], v[188:191]
    s_waitcnt lgkmcnt(4)
    ds_read_b128 v[64:67], v8 offset:0
    s_add_u32 m0, s22, 98304
    v_mfma_f32_16x16x32_bf16 v[188:191], v[76:79], a[236:239], v[188:191]
    s_waitcnt vmcnt(10)
    v_cmp_gt_u32 vcc, 2, v62
    v_mul_f32 v37, v37, v157
    v_mfma_f32_16x16x32_bf16 v[184:187], v[76:79], a[232:235], v[184:187]
    s_waitcnt lgkmcnt(4)
    ds_read_b128 v[68:71], v10 offset:0
    s_add_u32 s16, s16, 16384
    v_mfma_f32_16x16x32_bf16 v[184:187], v[72:75], a[224:227], v[184:187]
    buffer_load_dwordx4 v4, s[12:15], s16 offen offset:0 lds
    v_mfma_f32_16x16x32_bf16 v[184:187], v[80:83], a[240:243], v[184:187]
    s_waitcnt lgkmcnt(4)
    ds_read_b128 v[72:75], v8 offset:2048
    s_cbranch_vccnz SLOW1_ff_kernel
BACK1_ff_kernel:
    v_mfma_f32_16x16x32_bf16 v[184:187], v[84:87], a[248:251], v[184:187]
    v_exp_f32 v38, v38
    v_mfma_f32_16x16x32_bf16 v[188:191], v[84:87], a[252:255], v[188:191]
    s_waitcnt lgkmcnt(4)
    ds_read_b128 v[76:79], v10 offset:2048
    v_exp_f32 v39, v39
    v_mfma_f32_16x16x32_bf16 v[188:191], v[80:83], a[244:247], v[188:191]
    buffer_load_dwordx4 v4, s[12:15], s16 offen offset:1024 lds
    v_mfma_f32_16x16x32_bf16 v[180:183], v[88:91], a[244:247], v[180:183]
    s_waitcnt lgkmcnt(4)
    ds_read_b128 v[80:83], v8 offset:6144
    v_fma_f32 v38, v38, v57, v57
    v_mfma_f32_16x16x32_bf16 v[180:183], v[92:95], a[252:255], v[180:183]
    v_rcp_f32 v38, v38
    v_mfma_f32_16x16x32_bf16 v[176:179], v[92:95], a[248:251], v[176:179]
    s_waitcnt lgkmcnt(4)
    ds_read_b128 v[84:87], v10 offset:6144
    v_mul_f32 v38, v38, v158
    v_mfma_f32_16x16x32_bf16 v[176:179], v[88:91], a[240:243], v[176:179]
    buffer_load_dwordx4 v4, s[12:15], s16 offen offset:2048 lds
    v_mfma_f32_16x16x32_bf16 v[192:195], v[64:67], a[0:3], 0
    s_waitcnt lgkmcnt(4)
    ds_read_b128 v[88:91], v8 offset:4096
    v_fma_f32 v39, v39, v57, v57
    v_mfma_f32_16x16x32_bf16 v[192:195], v[68:71], a[8:11], v[192:195]
    v_rcp_f32 v39, v39
    v_mfma_f32_16x16x32_bf16 v[196:199], v[68:71], a[12:15], 0
    s_waitcnt lgkmcnt(4)
    ds_read_b128 v[92:95], v10 offset:4096
    v_mul_f32 v39, v39, v159
    v_mfma_f32_16x16x32_bf16 v[196:199], v[64:67], a[4:7], v[196:199]
    buffer_load_dwordx4 v4, s[12:15], s16 offen offset:3072 lds
    v_mfma_f32_16x16x32_bf16 v[204:207], v[72:75], a[4:7], 0
    s_waitcnt lgkmcnt(4)
    ds_read_b128 v[64:67], v8 offset:8192
    v_cvt_pk_bf16_f32 v148, v32, v33
    v_mfma_f32_16x16x32_bf16 v[204:207], v[76:79], a[12:15], v[204:207]
    v_cvt_pk_bf16_f32 v149, v34, v35
    v_cvt_pk_bf16_f32 v150, v36, v37
    v_mfma_f32_16x16x32_bf16 v[200:203], v[76:79], a[8:11], 0
    s_waitcnt lgkmcnt(4)
    ds_read_b128 v[68:71], v10 offset:8192
    v_cvt_pk_bf16_f32 v151, v38, v39
    v_mfma_f32_16x16x32_bf16 v[200:203], v[72:75], a[0:3], v[200:203]
    buffer_store_dwordx4 v[148:151], v1, s[12:15], s45 offen offset:256 sc1
    v_mfma_f32_16x16x32_bf16 v[200:203], v[80:83], a[16:19], v[200:203]
    s_waitcnt lgkmcnt(4)
    ds_read_b128 v[72:75], v8 offset:10240
    s_add_u32 s28, s41, 0
    v_mfma_f32_16x16x32_bf16 v[200:203], v[84:87], a[24:27], v[200:203]
    s_add_u32 s45, s40, 10240
    v_mul_f32 v24, v160, v22
    v_mul_f32 v25, v161, v22
    v_mfma_f32_16x16x32_bf16 v[204:207], v[84:87], a[28:31], v[204:207]
    s_waitcnt lgkmcnt(4)
    ds_read_b128 v[76:79], v10 offset:10240
    v_exp_f32 v24, v24
    v_mfma_f32_16x16x32_bf16 v[204:207], v[80:83], a[20:23], v[204:207]
    buffer_load_dwordx4 a[0:3], v1, s[12:15], s28 offen offset:0 sc1
    v_mfma_f32_16x16x32_bf16 v[196:199], v[88:91], a[20:23], v[196:199]
    s_waitcnt lgkmcnt(4)
    ds_read_b128 v[80:83], v8 offset:14336
    v_exp_f32 v25, v25
    v_mfma_f32_16x16x32_bf16 v[196:199], v[92:95], a[28:31], v[196:199]
    v_fma_f32 v24, v24, v23, v23
    v_fma_f32 v25, v25, v23, v23
    v_mfma_f32_16x16x32_bf16 v[192:195], v[92:95], a[24:27], v[192:195]
    s_waitcnt lgkmcnt(4)
    ds_read_b128 v[84:87], v10 offset:14336
    v_rcp_f32 v24, v24
    v_mfma_f32_16x16x32_bf16 v[192:195], v[88:91], a[16:19], v[192:195]
    buffer_load_dwordx4 a[4:7], v1, s[12:15], s28 offen offset:256 sc1
    v_mfma_f32_16x16x32_bf16 v[192:195], v[64:67], a[32:35], v[192:195]
    s_waitcnt lgkmcnt(4)
    ds_read_b128 v[88:91], v8 offset:12288
    s_add_u32 s28, s42, 0
    v_mfma_f32_16x16x32_bf16 v[192:195], v[68:71], a[40:43], v[192:195]
    v_mul_f32 v24, v24, v160
    v_mul_f32 v26, v162, v22
    v_mfma_f32_16x16x32_bf16 v[196:199], v[68:71], a[44:47], v[196:199]
    s_waitcnt lgkmcnt(4)
    ds_read_b128 v[92:95], v10 offset:12288
    v_rcp_f32 v25, v25
    v_mfma_f32_16x16x32_bf16 v[196:199], v[64:67], a[36:39], v[196:199]
    s_barrier
    v_mfma_f32_16x16x32_bf16 v[204:207], v[72:75], a[36:39], v[204:207]
    s_waitcnt lgkmcnt(4)
    ds_read_b128 v[64:67], v8 offset:16384
    v_exp_f32 v26, v26
    v_mfma_f32_16x16x32_bf16 v[204:207], v[76:79], a[44:47], v[204:207]
    buffer_load_dwordx4 a[8:11], v1, s[12:15], s28 offen offset:0 sc1
    v_mfma_f32_16x16x32_bf16 v[200:203], v[76:79], a[40:43], v[200:203]
    s_waitcnt lgkmcnt(4)
    ds_read_b128 v[68:71], v10 offset:16384
    v_mul_f32 v25, v25, v161
    v_mfma_f32_16x16x32_bf16 v[200:203], v[72:75], a[32:35], v[200:203]
    v_fma_f32 v26, v26, v23, v23
    v_mul_f32 v27, v163, v22
    v_mfma_f32_16x16x32_bf16 v[200:203], v[80:83], a[48:51], v[200:203]
    s_waitcnt lgkmcnt(4)
    ds_read_b128 v[72:75], v8 offset:18432
    v_rcp_f32 v26, v26
    v_mfma_f32_16x16x32_bf16 v[200:203], v[84:87], a[56:59], v[200:203]
    buffer_load_dwordx4 a[12:15], v1, s[12:15], s28 offen offset:256 sc1
    v_mfma_f32_16x16x32_bf16 v[204:207], v[84:87], a[60:63], v[204:207]
    s_waitcnt lgkmcnt(4)
    ds_read_b128 v[76:79], v10 offset:18432
    s_add_u32 s28, s43, 0
    v_mfma_f32_16x16x32_bf16 v[204:207], v[80:83], a[52:55], v[204:207]
    v_mul_f32 v26, v26, v162
    v_mul_f32 v28, v168, v22
    v_mfma_f32_16x16x32_bf16 v[196:199], v[88:91], a[52:55], v[196:199]
    s_waitcnt lgkmcnt(4)
    ds_read_b128 v[80:83], v8 offset:22528
    v_exp_f32 v27, v27
    v_mfma_f32_16x16x32_bf16 v[196:199], v[92:95], a[60:63], v[196:199]
    buffer_load_dwordx4 a[16:19], v1, s[12:15], s28 offen offset:0 sc1
    v_mfma_f32_16x16x32_bf16 v[192:195], v[92:95], a[56:59], v[192:195]
    s_waitcnt lgkmcnt(4)
    ds_read_b128 v[84:87], v10 offset:22528
    v_exp_f32 v28, v28
    v_mfma_f32_16x16x32_bf16 v[192:195], v[88:91], a[48:51], v[192:195]
    v_fma_f32 v27, v27, v23, v23
    v_fma_f32 v28, v28, v23, v23
    v_mfma_f32_16x16x32_bf16 v[192:195], v[64:67], a[64:67], v[192:195]
    s_waitcnt lgkmcnt(4)
    ds_read_b128 v[88:91], v8 offset:20480
    v_rcp_f32 v27, v27
    v_mfma_f32_16x16x32_bf16 v[192:195], v[68:71], a[72:75], v[192:195]
    buffer_load_dwordx4 a[20:23], v1, s[12:15], s28 offen offset:256 sc1
    v_mfma_f32_16x16x32_bf16 v[196:199], v[68:71], a[76:79], v[196:199]
    s_waitcnt lgkmcnt(4)
    ds_read_b128 v[92:95], v10 offset:20480
    v_rcp_f32 v28, v28
    v_mfma_f32_16x16x32_bf16 v[196:199], v[64:67], a[68:71], v[196:199]
    buffer_load_dword v61, v58, s[12:15], s26 offen sc1
    v_mfma_f32_16x16x32_bf16 v[204:207], v[72:75], a[68:71], v[204:207]
    s_waitcnt lgkmcnt(4)
    ds_read_b128 v[64:67], v8 offset:24576
    s_add_u32 s28, s41, 2048
    v_mfma_f32_16x16x32_bf16 v[204:207], v[76:79], a[76:79], v[204:207]
    v_mul_f32 v27, v27, v163
    v_mul_f32 v28, v28, v168
    v_mfma_f32_16x16x32_bf16 v[200:203], v[76:79], a[72:75], v[200:203]
    s_waitcnt lgkmcnt(4)
    ds_read_b128 v[68:71], v10 offset:24576
    v_mul_f32 v29, v169, v22
    v_mfma_f32_16x16x32_bf16 v[200:203], v[72:75], a[64:67], v[200:203]
    buffer_load_dwordx4 a[24:27], v1, s[12:15], s28 offen offset:0 sc1
    v_mfma_f32_16x16x32_bf16 v[200:203], v[80:83], a[80:83], v[200:203]
    s_waitcnt lgkmcnt(4)
    ds_read_b128 v[72:75], v8 offset:26624
    v_exp_f32 v29, v29
    v_mfma_f32_16x16x32_bf16 v[200:203], v[84:87], a[88:91], v[200:203]
    v_fma_f32 v29, v29, v23, v23
    v_mul_f32 v30, v170, v22
    v_mfma_f32_16x16x32_bf16 v[204:207], v[84:87], a[92:95], v[204:207]
    s_waitcnt lgkmcnt(4)
    ds_read_b128 v[76:79], v10 offset:26624
    v_rcp_f32 v29, v29
    v_mfma_f32_16x16x32_bf16 v[204:207], v[80:83], a[84:87], v[204:207]
    buffer_load_dwordx4 a[28:31], v1, s[12:15], s28 offen offset:256 sc1
    v_mfma_f32_16x16x32_bf16 v[196:199], v[88:91], a[84:87], v[196:199]
    s_waitcnt lgkmcnt(4)
    ds_read_b128 v[80:83], v8 offset:30720
    s_add_u32 s28, s42, 2048
    v_mfma_f32_16x16x32_bf16 v[196:199], v[92:95], a[92:95], v[196:199]
    v_mul_f32 v29, v29, v169
    v_mul_f32 v31, v171, v22
    v_mfma_f32_16x16x32_bf16 v[192:195], v[92:95], a[88:91], v[192:195]
    s_waitcnt lgkmcnt(4)
    ds_read_b128 v[84:87], v10 offset:30720
    v_exp_f32 v30, v30
    v_mfma_f32_16x16x32_bf16 v[192:195], v[88:91], a[80:83], v[192:195]
    buffer_load_dwordx4 a[32:35], v1, s[12:15], s28 offen offset:0 sc1
    v_mfma_f32_16x16x32_bf16 v[192:195], v[64:67], a[96:99], v[192:195]
    s_waitcnt lgkmcnt(4)
    ds_read_b128 v[88:91], v8 offset:28672
    v_exp_f32 v31, v31
    v_mfma_f32_16x16x32_bf16 v[192:195], v[68:71], a[104:107], v[192:195]
    v_fma_f32 v30, v30, v23, v23
    v_fma_f32 v31, v31, v23, v23
    v_mfma_f32_16x16x32_bf16 v[196:199], v[68:71], a[108:111], v[196:199]
    s_waitcnt lgkmcnt(4)
    ds_read_b128 v[92:95], v10 offset:28672
    v_rcp_f32 v30, v30
    v_mfma_f32_16x16x32_bf16 v[196:199], v[64:67], a[100:103], v[196:199]
    s_barrier
    v_mfma_f32_16x16x32_bf16 v[204:207], v[72:75], a[100:103], v[204:207]
    s_waitcnt lgkmcnt(4)
    ds_read_b128 v[64:67], v8 offset:32768
    v_rcp_f32 v31, v31
    v_mfma_f32_16x16x32_bf16 v[204:207], v[76:79], a[108:111], v[204:207]
    buffer_load_dwordx4 a[36:39], v1, s[12:15], s28 offen offset:256 sc1
    v_mfma_f32_16x16x32_bf16 v[200:203], v[76:79], a[104:107], v[200:203]
    s_waitcnt lgkmcnt(4)
    ds_read_b128 v[68:71], v10 offset:32768
    s_add_u32 s28, s43, 2048
    v_mfma_f32_16x16x32_bf16 v[200:203], v[72:75], a[96:99], v[200:203]
    v_mul_f32 v30, v30, v170
    v_mul_f32 v31, v31, v171
    v_mfma_f32_16x16x32_bf16 v[200:203], v[80:83], a[112:115], v[200:203]
    s_waitcnt lgkmcnt(4)
    ds_read_b128 v[72:75], v8 offset:34816
    v_cvt_pk_bf16_f32 v160, v24, v25
    v_mfma_f32_16x16x32_bf16 v[200:203], v[84:87], a[120:123], v[200:203]
    buffer_load_dwordx4 a[40:43], v1, s[12:15], s28 offen offset:0 sc1
    v_mfma_f32_16x16x32_bf16 v[204:207], v[84:87], a[124:127], v[204:207]
    s_waitcnt lgkmcnt(4)
    ds_read_b128 v[76:79], v10 offset:34816
    v_cvt_pk_bf16_f32 v161, v26, v27
    v_mfma_f32_16x16x32_bf16 v[204:207], v[80:83], a[116:119], v[204:207]
    v_cvt_pk_bf16_f32 v162, v28, v29
    v_cvt_pk_bf16_f32 v163, v30, v31
    v_mfma_f32_16x16x32_bf16 v[196:199], v[88:91], a[116:119], v[196:199]
    s_waitcnt lgkmcnt(4)
    ds_read_b128 v[80:83], v8 offset:38912
    v_mul_f32 v32, v164, v56
    v_mfma_f32_16x16x32_bf16 v[196:199], v[92:95], a[124:127], v[196:199]
    buffer_store_dwordx4 v[160:163], v1, s[12:15], s27 offen offset:0 sc1
    v_mfma_f32_16x16x32_bf16 v[192:195], v[92:95], a[120:123], v[192:195]
    s_waitcnt lgkmcnt(4)
    ds_read_b128 v[84:87], v10 offset:38912
    v_exp_f32 v32, v32
    v_mfma_f32_16x16x32_bf16 v[192:195], v[88:91], a[112:115], v[192:195]
    v_fma_f32 v32, v32, v57, v57
    v_mul_f32 v33, v165, v56
    v_mfma_f32_16x16x32_bf16 v[192:195], v[64:67], a[128:131], v[192:195]
    s_waitcnt lgkmcnt(4)
    ds_read_b128 v[88:91], v8 offset:36864
    v_rcp_f32 v32, v32
    v_mfma_f32_16x16x32_bf16 v[192:195], v[68:71], a[136:139], v[192:195]
    buffer_load_dwordx4 a[44:47], v1, s[12:15], s28 offen offset:256 sc1
    v_mfma_f32_16x16x32_bf16 v[196:199], v[68:71], a[140:143], v[196:199]
    s_waitcnt lgkmcnt(4)
    ds_read_b128 v[92:95], v10 offset:36864
    s_add_u32 m0, s22, 114688
    v_mfma_f32_16x16x32_bf16 v[196:199], v[64:67], a[132:135], v[196:199]
    s_add_u32 s16, s16, 16384
    v_mul_f32 v32, v32, v164
    v_mul_f32 v34, v166, v56
    v_mfma_f32_16x16x32_bf16 v[204:207], v[72:75], a[132:135], v[204:207]
    s_waitcnt lgkmcnt(4)
    ds_read_b128 v[64:67], v8 offset:40960
    v_exp_f32 v33, v33
    v_mfma_f32_16x16x32_bf16 v[204:207], v[76:79], a[140:143], v[204:207]
    buffer_load_dwordx4 v4, s[12:15], s16 offen offset:0 lds
    v_mfma_f32_16x16x32_bf16 v[200:203], v[76:79], a[136:139], v[200:203]
    s_waitcnt lgkmcnt(4)
    ds_read_b128 v[68:71], v10 offset:40960
    v_exp_f32 v34, v34
    v_mfma_f32_16x16x32_bf16 v[200:203], v[72:75], a[128:131], v[200:203]
    s_waitcnt vmcnt(15)
    buffer_store_dword v60, v59, s[12:15], s26 offen sc1
    v_mfma_f32_16x16x32_bf16 v[200:203], v[80:83], a[144:147], v[200:203]
    s_waitcnt lgkmcnt(4)
    ds_read_b128 v[72:75], v8 offset:43008
    v_mov_b32 v60, 5
    v_mfma_f32_16x16x32_bf16 v[200:203], v[84:87], a[152:155], v[200:203]
    v_fma_f32 v33, v33, v57, v57
    v_fma_f32 v34, v34, v57, v57
    v_mfma_f32_16x16x32_bf16 v[204:207], v[84:87], a[156:159], v[204:207]
    s_waitcnt lgkmcnt(4)
    ds_read_b128 v[76:79], v10 offset:43008
    v_rcp_f32 v33, v33
    v_mfma_f32_16x16x32_bf16 v[204:207], v[80:83], a[148:151], v[204:207]
    buffer_load_dwordx4 v4, s[12:15], s16 offen offset:1024 lds
    v_mfma_f32_16x16x32_bf16 v[196:199], v[88:91], a[148:151], v[196:199]
    s_waitcnt lgkmcnt(4)
    ds_read_b128 v[80:83], v8 offset:47104
    v_rcp_f32 v34, v34
    v_mfma_f32_16x16x32_bf16 v[196:199], v[92:95], a[156:159], v[196:199]
    v_mul_f32 v33, v33, v165
    v_mul_f32 v34, v34, v166
    v_mfma_f32_16x16x32_bf16 v[192:195], v[92:95], a[152:155], v[192:195]
    s_waitcnt lgkmcnt(4)
    ds_read_b128 v[84:87], v10 offset:47104
    v_mul_f32 v35, v167, v56
    v_mfma_f32_16x16x32_bf16 v[192:195], v[88:91], a[144:147], v[192:195]
    buffer_load_dwordx4 v4, s[12:15], s16 offen offset:2048 lds
    v_mfma_f32_16x16x32_bf16 v[192:195], v[64:67], a[160:163], v[192:195]
    s_waitcnt lgkmcnt(4)
    ds_read_b128 v[88:91], v8 offset:45056
    v_exp_f32 v35, v35
    v_mfma_f32_16x16x32_bf16 v[192:195], v[68:71], a[168:171], v[192:195]
    v_fma_f32 v35, v35, v57, v57
    v_mul_f32 v36, v172, v56
    v_mfma_f32_16x16x32_bf16 v[196:199], v[68:71], a[172:175], v[196:199]
    s_waitcnt lgkmcnt(4)
    ds_read_b128 v[92:95], v10 offset:45056
    v_rcp_f32 v35, v35
    v_mfma_f32_16x16x32_bf16 v[196:199], v[64:67], a[164:167], v[196:199]
    s_barrier
    v_mfma_f32_16x16x32_bf16 v[204:207], v[72:75], a[164:167], v[204:207]
    s_waitcnt lgkmcnt(4)
    ds_read_b128 v[64:67], v8 offset:49152
    v_exp_f32 v36, v36
    v_mfma_f32_16x16x32_bf16 v[204:207], v[76:79], a[172:175], v[204:207]
    buffer_load_dwordx4 v4, s[12:15], s16 offen offset:3072 lds
    v_mfma_f32_16x16x32_bf16 v[200:203], v[76:79], a[168:171], v[200:203]
    s_waitcnt lgkmcnt(4)
    ds_read_b128 v[68:71], v10 offset:49152
    s_add_u32 m0, s22, 0
    v_mfma_f32_16x16x32_bf16 v[200:203], v[72:75], a[160:163], v[200:203]
    s_add_u32 s16, s16, 16384
    v_mul_f32 v35, v35, v167
    v_fma_f32 v36, v36, v57, v57
    v_mfma_f32_16x16x32_bf16 v[200:203], v[80:83], a[176:179], v[200:203]
    s_waitcnt lgkmcnt(4)
    ds_read_b128 v[72:75], v8 offset:51200
    v_rcp_f32 v36, v36
    v_mfma_f32_16x16x32_bf16 v[200:203], v[84:87], a[184:187], v[200:203]
    buffer_load_dwordx4 v4, s[12:15], s16 offen offset:0 lds
    v_mfma_f32_16x16x32_bf16 v[204:207], v[84:87], a[188:191], v[204:207]
    s_waitcnt lgkmcnt(4)
    ds_read_b128 v[76:79], v10 offset:51200
    v_mul_f32 v36, v36, v172
    v_mfma_f32_16x16x32_bf16 v[204:207], v[80:83], a[180:183], v[204:207]
    v_mul_f32 v37, v173, v56
    v_mul_f32 v38, v174, v56
    v_mfma_f32_16x16x32_bf16 v[196:199], v[88:91], a[180:183], v[196:199]
    s_waitcnt lgkmcnt(4)
    ds_read_b128 v[80:83], v8 offset:55296
    v_exp_f32 v37, v37
    v_mfma_f32_16x16x32_bf16 v[196:199], v[92:95], a[188:191], v[196:199]
    buffer_load_dwordx4 v4, s[12:15], s16 offen offset:1024 lds
    v_mfma_f32_16x16x32_bf16 v[192:195], v[92:95], a[184:187], v[192:195]
    s_waitcnt lgkmcnt(4)
    ds_read_b128 v[84:87], v10 offset:55296
    v_exp_f32 v38, v38
    v_mfma_f32_16x16x32_bf16 v[192:195], v[88:91], a[176:179], v[192:195]
    v_fma_f32 v37, v37, v57, v57
    v_fma_f32 v38, v38, v57, v57
    v_mfma_f32_16x16x32_bf16 v[192:195], v[64:67], a[192:195], v[192:195]
    s_waitcnt lgkmcnt(4)
    ds_read_b128 v[88:91], v8 offset:53248
    v_rcp_f32 v37, v37
    v_mfma_f32_16x16x32_bf16 v[192:195], v[68:71], a[200:203], v[192:195]
    buffer_load_dwordx4 v4, s[12:15], s16 offen offset:2048 lds
    v_mfma_f32_16x16x32_bf16 v[196:199], v[68:71], a[204:207], v[196:199]
    s_waitcnt lgkmcnt(4)
    ds_read_b128 v[92:95], v10 offset:53248
    v_rcp_f32 v38, v38
    v_mfma_f32_16x16x32_bf16 v[196:199], v[64:67], a[196:199], v[196:199]
    s_waitcnt vmcnt(15)
    v_cmp_gt_u32 vcc, 3, v61
    v_mul_f32 v37, v37, v173
    v_mfma_f32_16x16x32_bf16 v[204:207], v[72:75], a[196:199], v[204:207]
    s_waitcnt lgkmcnt(4)
    ds_read_b128 v[64:67], v8 offset:57344
    s_cbranch_vccnz SLOW2_ff_kernel
BACK2_ff_kernel:
    v_mfma_f32_16x16x32_bf16 v[204:207], v[76:79], a[204:207], v[204:207]
    buffer_load_dwordx4 v4, s[12:15], s16 offen offset:3072 lds
    v_mfma_f32_16x16x32_bf16 v[200:203], v[76:79], a[200:203], v[200:203]
    s_waitcnt lgkmcnt(4)
    ds_read_b128 v[68:71], v10 offset:57344
    v_mul_f32 v38, v38, v174
    v_mfma_f32_16x16x32_bf16 v[200:203], v[72:75], a[192:195], v[200:203]
    buffer_load_dword v62, v58, s[12:15], s26 offen sc1
    v_mfma_f32_16x16x32_bf16 v[200:203], v[80:83], a[208:211], v[200:203]
    s_waitcnt lgkmcnt(4)
    ds_read_b128 v[72:75], v8 offset:59392
    s_add_u32 s28, s41, 4096
    v_mfma_f32_16x16x32_bf16 v[200:203], v[84:87], a[216:219], v[200:203]
    v_mul_f32 v39, v175, v56
    v_cvt_pk_bf16_f32 v164, v32, v33
    v_mfma_f32_16x16x32_bf16 v[204:207], v[84:87], a[220:223], v[204:207]
    s_waitcnt lgkmcnt(4)
    ds_read_b128 v[76:79], v10 offset:59392
    v_exp_f32 v39, v39
    v_mfma_f32_16x16x32_bf16 v[204:207], v[80:83], a[212:215], v[204:207]
    buffer_load_dwordx4 a[48:51], v1, s[12:15], s28 offen offset:0 sc1
    v_mfma_f32_16x16x32_bf16 v[196:199], v[88:91], a[212:215], v[196:199]
    s_waitcnt lgkmcnt(4)
    ds_read_b128 v[80:83], v8 offset:63488
    v_fma_f32 v39, v39, v57, v57
    v_mfma_f32_16x16x32_bf16 v[196:199], v[92:95], a[220:223], v[196:199]
    v_rcp_f32 v39, v39
    v_mfma_f32_16x16x32_bf16 v[192:195], v[92:95], a[216:219], v[192:195]
    s_waitcnt lgkmcnt(4)
    ds_read_b128 v[84:87], v10 offset:63488
    v_mul_f32 v39, v39, v175
    v_mfma_f32_16x16x32_bf16 v[192:195], v[88:91], a[208:211], v[192:195]
    buffer_load_dwordx4 a[52:55], v1, s[12:15], s28 offen offset:256 sc1
    v_mfma_f32_16x16x32_bf16 v[192:195], v[64:67], a[224:227], v[192:195]
    s_waitcnt lgkmcnt(4)
    ds_read_b128 v[88:91], v8 offset:61440
    s_add_u32 s28, s42, 4096
    v_mfma_f32_16x16x32_bf16 v[192:195], v[68:71], a[232:235], v[192:195]
MID_ff_kernel:
    s_getpc_b64 s[60:61]
PF_ff_kernel_2:
    v_lshlrev_b32 v2, 0, v0
    v_min_u32 v2, END_ff_kernel-PF_ff_kernel_2-4, v2
    v_mov_b32 v3, 0
    v_lshl_add_u64 v[2:3], v[2:3], 0, s[60:61]
    global_load_dword v63, v[2:3], off
    v_cvt_pk_bf16_f32 v165, v34, v35
    v_cvt_pk_bf16_f32 v166, v36, v37
    v_mfma_f32_16x16x32_bf16 v[196:199], v[68:71], a[236:239], v[196:199]
    s_waitcnt lgkmcnt(4)
    ds_read_b128 v[92:95], v10 offset:61440
    v_cvt_pk_bf16_f32 v167, v38, v39
    v_mfma_f32_16x16x32_bf16 v[196:199], v[64:67], a[228:231], v[196:199]
    s_barrier
    v_mfma_f32_16x16x32_bf16 v[204:207], v[72:75], a[228:231], v[204:207]
    s_waitcnt lgkmcnt(4)
    ds_read_b128 v[64:67], v13 offset:0
    v_mul_f32 v24, v176, v22
    v_mfma_f32_16x16x32_bf16 v[204:207], v[76:79], a[236:239], v[204:207]
    buffer_store_dwordx4 v[164:167], v1, s[12:15], s27 offen offset:256 sc1
    v_mfma_f32_16x16x32_bf16 v[200:203], v[76:79], a[232:235], v[200:203]
    s_waitcnt lgkmcnt(4)
    ds_read_b128 v[68:71], v13 offset:2048
    v_exp_f32 v24, v24
    v_mfma_f32_16x16x32_bf16 v[200:203], v[72:75], a[224:227], v[200:203]
    v_fma_f32 v24, v24, v23, v23
    v_mul_f32 v25, v177, v22
    v_mfma_f32_16x16x32_bf16 v[200:203], v[80:83], a[240:243], v[200:203]
    s_waitcnt lgkmcnt(4)
    ds_read_b128 v[72:75], v13 offset:256
    v_rcp_f32 v24, v24
    v_mfma_f32_16x16x32_bf16 v[200:203], v[84:87], a[248:251], v[200:203]
    buffer_load_dwordx4 a[56:59], v1, s[12:15], s28 offen offset:0 sc1
    v_mfma_f32_16x16x32_bf16 v[204:207], v[84:87], a[252:255], v[204:207]
    s_waitcnt lgkmcnt(4)
    ds_read_b128 v[76:79], v13 offset:2304
    v_exp_f32 v25, v25
    v_mfma_f32_16x16x32_bf16 v[204:207], v[80:83], a[244:247], v[204:207]
    v_mul_f32 v24, v24, v176
    v_fma_f32 v25, v25, v23, v23
    v_mfma_f32_16x16x32_bf16 v[196:199], v[88:91], a[244:247], v[196:199]
    s_waitcnt lgkmcnt(4)
    ds_read_b128 v[80:83], v13 offset:4096
    v_rcp_f32 v25, v25
    v_mfma_f32_16x16x32_bf16 v[196:199], v[92:95], a[252:255], v[196:199]
    buffer_load_dwordx4 a[60:63], v1, s[12:15], s28 offen offset:256 sc1
    v_mfma_f32_16x16x32_bf16 v[192:195], v[92:95], a[248:251], v[192:195]
    s_waitcnt lgkmcnt(4)
    ds_read_b128 v[84:87], v13 offset:6144
    s_add_u32 s28, s43, 4096
    v_mfma_f32_16x16x32_bf16 v[192:195], v[88:91], a[240:243], v[192:195]
    v_mul_f32 v25, v25, v177
    v_mul_f32 v26, v178, v22
    v_mfma_f32_16x16x32_bf16 a[168:171], v[96:99], v[64:67], 0
    s_waitcnt lgkmcnt(4)
    ds_read_b128 v[88:91], v13 offset:4352
    v_exp_f32 v26, v26
    v_mfma_f32_16x16x32_bf16 a[168:171], v[112:115], v[68:71], a[168:171]
    buffer_load_dwordx4 a[64:67], v1, s[12:15], s28 offen offset:0 sc1
    v_mfma_f32_16x16x32_bf16 a[172:175], v[116:119], v[68:71], 0
    s_waitcnt lgkmcnt(4)
    ds_read_b128 v[92:95], v13 offset:6400
    v_fma_f32 v26, v26, v23, v23
    v_mfma_f32_16x16x32_bf16 a[172:175], v[100:103], v[64:67], a[172:175]
    v_rcp_f32 v26, v26
    v_mfma_f32_16x16x32_bf16 a[180:183], v[100:103], v[72:75], 0
    s_waitcnt lgkmcnt(4)
    ds_read_b128 v[64:67], v13 offset:8192
    v_mul_f32 v26, v26, v178
    v_mfma_f32_16x16x32_bf16 a[180:183], v[116:119], v[76:79], a[180:183]
    buffer_load_dwordx4 a[68:71], v1, s[12:15], s28 offen offset:256 sc1
    v_mfma_f32_16x16x32_bf16 a[176:179], v[112:115], v[76:79], 0
    s_waitcnt lgkmcnt(4)
    ds_read_b128 v[68:71], v13 offset:10240
    s_add_u32 m0, s22, 16384
    v_mfma_f32_16x16x32_bf16 a[176:179], v[96:99], v[72:75], a[176:179]
    s_add_u32 s16, s16, 16384
    v_mul_f32 v27, v179, v22
    v_mul_f32 v28, v184, v22
    v_mfma_f32_16x16x32_bf16 a[184:187], v[96:99], v[80:83], 0
    s_waitcnt lgkmcnt(4)
    ds_read_b128 v[72:75], v13 offset:8448
    s_add_u32 s27, s40, 12288
    v_mfma_f32_16x16x32_bf16 a[184:187], v[112:115], v[84:87], a[184:187]
    buffer_load_dwordx4 v4, s[12:15], s16 offen offset:0 lds
    v_mfma_f32_16x16x32_bf16 a[188:191], v[116:119], v[84:87], 0
    s_waitcnt lgkmcnt(4)
    ds_read_b128 v[76:79], v13 offset:10496
    v_exp_f32 v27, v27
    v_mfma_f32_16x16x32_bf16 a[188:191], v[100:103], v[80:83], a[188:191]
    v_fma_f32 v27, v27, v23, v23
    v_mul_f32 v29, v185, v22
    v_mfma_f32_16x16x32_bf16 a[196:199], v[100:103], v[88:91], 0
    s_waitcnt lgkmcnt(4)
    ds_read_b128 v[80:83], v13 offset:12288
    v_rcp_f32 v27, v27
    v_mfma_f32_16x16x32_bf16 a[196:199], v[116:119], v[92:95], a[196:199]
    buffer_load_dwordx4 v4, s[12:15], s16 offen offset:1024 lds
    v_mfma_f32_16x16x32_bf16 a[192:195], v[112:115], v[92:95], 0
    s_waitcnt lgkmcnt(4)
    ds_read_b128 v[84:87], v13 offset:14336
    v_exp_f32 v28, v28
    v_mfma_f32_16x16x32_bf16 a[192:195], v[96:99], v[88:91], a[192:195]
    v_mul_f32 v27, v27, v179
    v_fma_f32 v28, v28, v23, v23
    v_mfma_f32_16x16x32_bf16 a[200:203], v[96:99], v[64:67], 0
    s_waitcnt lgkmcnt(4)
    ds_read_b128 v[88:91], v13 offset:12544
    v_rcp_f32 v28, v28
    v_mfma_f32_16x16x32_bf16 a[200:203], v[112:115], v[68:71], a[200:203]
    buffer_load_dwordx4 v4, s[12:15], s16 offen offset:2048 lds
    v_mfma_f32_16x16x32_bf16 a[204:207], v[116:119], v[68:71], 0
    s_waitcnt lgkmcnt(4)
    ds_read_b128 v[92:95], v13 offset:14592
    v_exp_f32 v29, v29
    v_mfma_f32_16x16x32_bf16 a[204:207], v[100:103], v[64:67], a[204:207]
    s_barrier
    v_mfma_f32_16x16x32_bf16 a[212:215], v[100:103], v[72:75], 0
    s_waitcnt lgkmcnt(4)
    ds_read_b128 v[64:67], v13 offset:16384
    v_mul_f32 v28, v28, v184
    v_mfma_f32_16x16x32_bf16 a[212:215], v[116:119], v[76:79], a[212:215]
    buffer_load_dwordx4 v4, s[12:15], s16 offen offset:3072 lds
    v_mfma_f32_16x16x32_bf16 a[208:211], v[112:115], v[76:79], 0
    s_waitcnt lgkmcnt(4)
    ds_read_b128 v[68:71], v13 offset:18432
    s_add_u32 m0, s22, 32768
    v_mfma_f32_16x16x32_bf16 a[208:211], v[96:99], v[72:75], a[208:211]
    s_add_u32 s16, s16, 16384
    v_fma_f32 v29, v29, v23, v23
    v_mul_f32 v30, v186, v22
    v_mfma_f32_16x16x32_bf16 a[216:219], v[96:99], v[80:83], 0
    s_waitcnt lgkmcnt(4)
    ds_read_b128 v[72:75], v13 offset:16640
    v_rcp_f32 v29, v29
    v_mfma_f32_16x16x32_bf16 a[216:219], v[112:115], v[84:87], a[216:219]
    buffer_load_dwordx4 v4, s[12:15], s16 offen offset:0 lds
    v_mfma_f32_16x16x32_bf16 a[220:223], v[116:119], v[84:87], 0
    s_waitcnt lgkmcnt(4)
    ds_read_b128 v[76:79], v13 offset:18688
    s_add_u32 s17, s23, 12
    v_mfma_f32_16x16x32_bf16 a[220:223], v[100:103], v[80:83], a[220:223]
    s_and_b32 s17, s17, 15
    v_or_b32 v10, 64, v7
    v_and_b32 v2, 1, v5
    v_mfma_f32_16x16x32_bf16 a[228:231], v[100:103], v[88:91], 0
    s_waitcnt lgkmcnt(4)
    ds_read_b128 v[80:83], v13 offset:20480
    s_lshl_b32 s17, s17, 7
    v_mfma_f32_16x16x32_bf16 a[228:231], v[116:119], v[92:95], a[228:231]
    buffer_load_dwordx2 v[120:121], v14, s[12:15], s3 offen offset:0
    v_mfma_f32_16x16x32_bf16 a[224:227], v[112:115], v[92:95], 0
    s_waitcnt lgkmcnt(4)
    ds_read_b128 v[84:87], v13 offset:22528
    s_add_u32 s17, s17, s26
    v_mfma_f32_16x16x32_bf16 a[224:227], v[96:99], v[88:91], a[224:227]
    s_add_u32 s18, s23, 8
    v_lshlrev_b32 v10, 7, v10
    v_lshrrev_b32 v9, 2, v6
    v_mfma_f32_16x16x32_bf16 a[232:235], v[96:99], v[64:67], 0
    s_waitcnt lgkmcnt(4)
    ds_read_b128 v[88:91], v13 offset:20736
    s_and_b32 s18, s18, 15
    v_mfma_f32_16x16x32_bf16 a[232:235], v[112:115], v[68:71], a[232:235]
    buffer_load_dwordx2 v[122:123], v14, s[12:15], s3 offen offset:1024
    v_mfma_f32_16x16x32_bf16 a[236:239], v[116:119], v[68:71], 0
    s_waitcnt lgkmcnt(4)
    ds_read_b128 v[92:95], v13 offset:22784
    s_lshl_b32 s18, s18, 7
    v_mfma_f32_16x16x32_bf16 a[236:239], v[100:103], v[64:67], a[236:239]
    s_add_u32 s18, s18, s26
    v_lshlrev_b32 v9, 3, v9
    v_mul_u32_u24 v8, 65536, v7
    v_mfma_f32_16x16x32_bf16 a[244:247], v[100:103], v[72:75], 0
    s_waitcnt lgkmcnt(4)
    ds_read_b128 v[64:67], v13 offset:24576
    v_exp_f32 v30, v30
    v_mfma_f32_16x16x32_bf16 a[244:247], v[116:119], v[76:79], a[244:247]
    buffer_load_dwordx2 v[124:125], v14, s[12:15], s3 offen offset:256
    v_mfma_f32_16x16x32_bf16 a[240:243], v[112:115], v[76:79], 0
    s_waitcnt lgkmcnt(4)
    ds_read_b128 v[68:71], v13 offset:26624
    v_lshl_add_u32 v9, v7, 7, v9
    v_mfma_f32_16x16x32_bf16 a[240:243], v[96:99], v[72:75], a[240:243]
    s_waitcnt vmcnt(16)
    v_cmp_gt_u32 vcc, 4, v62
    v_lshl_add_u32 v9, v2, 2, v9
    v_mfma_f32_16x16x32_bf16 v[208:211], v[96:99], v[80:83], 0
    s_waitcnt lgkmcnt(4)
    ds_read_b128 v[72:75], v13 offset:24832
    s_cbranch_vccnz SLOW3_ff_kernel
BACK3_ff_kernel:
    v_mfma_f32_16x16x32_bf16 v[208:211], v[112:115], v[84:87], v[208:211]
    buffer_load_dwordx2 v[126:127], v14, s[12:15], s3 offen offset:1280
    v_mfma_f32_16x16x32_bf16 v[212:215], v[116:119], v[84:87], 0
    s_waitcnt lgkmcnt(4)
    ds_read_b128 v[76:79], v13 offset:26880
    v_and_b32 v2, 2, v5
    v_mfma_f32_16x16x32_bf16 v[212:215], v[100:103], v[80:83], v[212:215]
    v_lshl_add_u32 v9, v2, 29, v9
    v_lshl_add_u32 v8, v6, 4, v8
    v_mfma_f32_16x16x32_bf16 v[220:223], v[100:103], v[88:91], 0
    s_waitcnt lgkmcnt(4)
    ds_read_b128 v[80:83], v13 offset:28672
    v_or_b32 v2, s31, v6
    v_mfma_f32_16x16x32_bf16 v[220:223], v[116:119], v[92:95], v[220:223]
    buffer_load_dwordx2 v[136:137], v14, s[12:15], s3 offen offset:2048
    v_mfma_f32_16x16x32_bf16 v[216:219], v[112:115], v[92:95], 0
    s_waitcnt lgkmcnt(4)
    ds_read_b128 v[84:87], v13 offset:30720
    v_min_u32 v2, 1, v2
    v_mfma_f32_16x16x32_bf16 v[216:219], v[96:99], v[88:91], v[216:219]
    v_lshl_add_u32 v10, v2, 30, v10
    v_cvt_f32_u32 v11, v2
    v_mfma_f32_16x16x32_bf16 a[168:171], v[128:131], v[64:67], a[168:171]
    s_waitcnt lgkmcnt(4)
    ds_read_b128 v[88:91], v13 offset:28928
    v_min_u32 v104, 2, v5
    v_mfma_f32_16x16x32_bf16 a[168:171], a[0:3], v[68:71], a[168:171]
    buffer_load_dwordx2 v[138:139], v14, s[12:15], s3 offen offset:3072
    v_mfma_f32_16x16x32_bf16 a[172:175], a[4:7], v[68:71], a[172:175]
    s_waitcnt lgkmcnt(4)
    ds_read_b128 v[92:95], v13 offset:30976
    v_sub_u32 v108, 3, v104
    v_mfma_f32_16x16x32_bf16 a[172:175], v[132:135], v[64:67], a[172:175]
    s_barrier
    v_mfma_f32_16x16x32_bf16 a[180:183], v[132:135], v[72:75], a[180:183]
    s_waitcnt lgkmcnt(4)
    ds_read_b128 v[64:67], v13 offset:32768
    v_lshl_add_u32 v108, v108, 2, s23
    v_mfma_f32_16x16x32_bf16 a[180:183], a[4:7], v[76:79], a[180:183]
    s_waitcnt vmcnt(15)
    buffer_store_dword v60, v59, s[12:15], s26 offen sc1
    v_mfma_f32_16x16x32_bf16 a[176:179], a[0:3], v[76:79], a[176:179]
    s_waitcnt lgkmcnt(4)
    ds_read_b128 v[68:71], v13 offset:34816
    v_mov_b32 v60, 6
    v_mfma_f32_16x16x32_bf16 a[176:179], v[128:131], v[72:75], a[176:179]
    v_and_b32 v108, 15, v108
    v_add_u32 v104, 8, v104
    v_mfma_f32_16x16x32_bf16 a[184:187], v[128:131], v[80:83], a[184:187]
    s_waitcnt lgkmcnt(4)
    ds_read_b128 v[72:75], v13 offset:33024
    v_lshlrev_b32 v108, 7, v108
    v_mfma_f32_16x16x32_bf16 a[184:187], a[0:3], v[84:87], a[184:187]
    buffer_load_dwordx2 v[140:141], v14, s[12:15], s3 offen offset:2304
    v_mfma_f32_16x16x32_bf16 a[188:191], a[4:7], v[84:87], a[188:191]
    s_waitcnt lgkmcnt(4)
    ds_read_b128 v[76:79], v13 offset:35072
    s_nop 0
    v_mfma_f32_16x16x32_bf16 a[188:191], v[132:135], v[80:83], a[188:191]
    v_mul_f32 v29, v29, v185
    v_fma_f32 v30, v30, v23, v23
    v_mfma_f32_16x16x32_bf16 a[196:199], v[132:135], v[88:91], a[196:199]
    s_waitcnt lgkmcnt(4)
    ds_read_b128 v[80:83], v13 offset:36864
    v_rcp_f32 v30, v30
    v_mfma_f32_16x16x32_bf16 a[196:199], a[4:7], v[92:95], a[196:199]
    buffer_load_dwordx2 v[142:143], v14, s[12:15], s3 offen offset:3328
    v_mfma_f32_16x16x32_bf16 a[192:195], a[0:3], v[92:95], a[192:195]
    s_waitcnt lgkmcnt(4)
    ds_read_b128 v[84:87], v13 offset:38912
    s_add_u32 s28, s41, 6144
    v_mfma_f32_16x16x32_bf16 a[192:195], v[128:131], v[88:91], a[192:195]
    v_mul_f32 v30, v30, v186
    v_mul_f32 v31, v187, v22
    v_mfma_f32_16x16x32_bf16 a[200:203], v[128:131], v[64:67], a[200:203]
    s_waitcnt lgkmcnt(4)
    ds_read_b128 v[88:91], v13 offset:37120
    v_exp_f32 v31, v31
    v_mfma_f32_16x16x32_bf16 a[200:203], a[0:3], v[68:71], a[200:203]
    buffer_load_dwordx4 a[72:75], v1, s[12:15], s28 offen offset:0 sc1
    v_mfma_f32_16x16x32_bf16 a[204:207], a[4:7], v[68:71], a[204:207]
    s_waitcnt lgkmcnt(4)
    ds_read_b128 v[92:95], v13 offset:39168
    v_fma_f32 v31, v31, v23, v23
    v_mfma_f32_16x16x32_bf16 a[204:207], v[132:135], v[64:67], a[204:207]
    v_rcp_f32 v31, v31
    v_mfma_f32_16x16x32_bf16 a[212:215], v[132:135], v[72:75], a[212:215]
    s_waitcnt lgkmcnt(4)
    ds_read_b128 v[64:67], v13 offset:40960
    v_mul_f32 v31, v31, v187
    v_mfma_f32_16x16x32_bf16 a[212:215], a[4:7], v[76:79], a[212:215]
    buffer_load_dwordx4 a[76:79], v1, s[12:15], s28 offen offset:256 sc1
    v_mfma_f32_16x16x32_bf16 a[208:211], a[0:3], v[76:79], a[208:211]
    s_waitcnt lgkmcnt(4)
    ds_read_b128 v[68:71], v13 offset:43008
    s_add_u32 s28, s42, 6144
    v_mfma_f32_16x16x32_bf16 a[208:211], v[128:131], v[72:75], a[208:211]
    v_cvt_pk_bf16_f32 v176, v24, v25
    v_cvt_pk_bf16_f32 v177, v26, v27
    v_mfma_f32_16x16x32_bf16 a[216:219], v[128:131], v[80:83], a[216:219]
    s_waitcnt lgkmcnt(4)
    ds_read_b128 v[72:75], v13 offset:41216
    v_cvt_pk_bf16_f32 v178, v28, v29
    v_mfma_f32_16x16x32_bf16 a[216:219], a[0:3], v[84:87], a[216:219]
    buffer_load_dwordx4 a[80:83], v1, s[12:15], s28 offen offset:0 sc1
    v_mfma_f32_16x16x32_bf16 a[220:223], a[4:7], v[84:87], a[220:223]
    s_waitcnt lgkmcnt(4)
    ds_read_b128 v[76:79], v13 offset:43264
    v_cvt_pk_bf16_f32 v179, v30, v31
    v_mfma_f32_16x16x32_bf16 a[220:223], v[132:135], v[80:83], a[220:223]
    buffer_store_dwordx4 v[176:179], v1, s[12:15], s45 offen offset:0 sc1
    v_mfma_f32_16x16x32_bf16 a[228:231], v[132:135], v[88:91], a[228:231]
    s_waitcnt lgkmcnt(4)
    ds_read_b128 v[80:83], v13 offset:45056
    v_mul_f32 v32, v180, v56
    v_mfma_f32_16x16x32_bf16 a[228:231], a[4:7], v[92:95], a[228:231]
    v_exp_f32 v32, v32
    v_mfma_f32_16x16x32_bf16 a[224:227], a[0:3], v[92:95], a[224:227]
    s_waitcnt lgkmcnt(4)
    ds_read_b128 v[84:87], v13 offset:47104
    v_fma_f32 v32, v32, v57, v57
    v_mfma_f32_16x16x32_bf16 a[224:227], v[128:131], v[88:91], a[224:227]
    buffer_load_dwordx4 a[84:87], v1, s[12:15], s28 offen offset:256 sc1
    v_mfma_f32_16x16x32_bf16 a[232:235], v[128:131], v[64:67], a[232:235]
    s_waitcnt lgkmcnt(4)
    ds_read_b128 v[88:91], v13 offset:45312
    s_add_u32 s28, s43, 6144
    v_mfma_f32_16x16x32_bf16 a[232:235], a[0:3], v[68:71], a[232:235]
    v_rcp_f32 v32, v32
    v_mfma_f32_16x16x32_bf16 a[236:239], a[4:7], v[68:71], a[236:239]
    s_waitcnt lgkmcnt(4)
    ds_read_b128 v[92:95], v13 offset:47360
    v_mul_f32 v32, v32, v180
    v_mfma_f32_16x16x32_bf16 a[236:239], v[132:135], v[64:67], a[236:239]
    s_barrier
    v_mfma_f32_16x16x32_bf16 a[244:247], v[132:135], v[72:75], a[244:247]
    s_waitcnt lgkmcnt(4)
    ds_read_b128 v[64:67], v13 offset:49152
    v_mul_f32 v33, v181, v56
    v_mfma_f32_16x16x32_bf16 a[244:247], a[4:7], v[76:79], a[244:247]
    buffer_load_dwordx4 a[88:91], v1, s[12:15], s28 offen offset:0 sc1
    v_mfma_f32_16x16x32_bf16 a[240:243], a[0:3], v[76:79], a[240:243]
    s_waitcnt lgkmcnt(4)
    ds_read_b128 v[68:71], v13 offset:51200
    v_exp_f32 v33, v33
    v_mfma_f32_16x16x32_bf16 a[240:243], v[128:131], v[72:75], a[240:243]
    v_fma_f32 v33, v33, v57, v57
    v_mul_f32 v34, v182, v56
    v_mfma_f32_16x16x32_bf16 v[208:211], v[128:131], v[80:83], v[208:211]
    s_waitcnt lgkmcnt(4)
    ds_read_b128 v[72:75], v13 offset:49408
    v_rcp_f32 v33, v33
    v_mfma_f32_16x16x32_bf16 v[208:211], a[0:3], v[84:87], v[208:211]
    buffer_load_dwordx4 a[92:95], v1, s[12:15], s28 offen offset:256 sc1
    v_mfma_f32_16x16x32_bf16 v[212:215], a[4:7], v[84:87], v[212:215]
    s_waitcnt lgkmcnt(4)
    ds_read_b128 v[76:79], v13 offset:51456
    v_exp_f32 v34, v34
    v_mfma_f32_16x16x32_bf16 v[212:215], v[132:135], v[80:83], v[212:215]
    buffer_load_dword v61, v58, s[12:15], s26 offen sc1
    v_mfma_f32_16x16x32_bf16 v[220:223], v[132:135], v[88:91], v[220:223]
    s_waitcnt lgkmcnt(4)
    ds_read_b128 v[80:83], v13 offset:53248
    v_mul_f32 v33, v33, v181
    v_mfma_f32_16x16x32_bf16 v[220:223], a[4:7], v[92:95], v[220:223]
    v_fma_f32 v34, v34, v57, v57
    v_mul_f32 v35, v183, v56
    v_mfma_f32_16x16x32_bf16 v[216:219], a[0:3], v[92:95], v[216:219]
    s_waitcnt lgkmcnt(4)
    ds_read_b128 v[84:87], v13 offset:55296
    v_rcp_f32 v34, v34
    v_mfma_f32_16x16x32_bf16 v[216:219], v[128:131], v[88:91], v[216:219]
    buffer_load_dwordx4 v4, s[12:15], s16 offen offset:1024 lds
    v_mfma_f32_16x16x32_bf16 a[168:171], a[8:11], v[64:67], a[168:171]
    s_waitcnt lgkmcnt(4)
    ds_read_b128 v[88:91], v13 offset:53504
    v_exp_f32 v35, v35
    v_mfma_f32_16x16x32_bf16 a[168:171], a[16:19], v[68:71], a[168:171]
    v_mul_f32 v34, v34, v182
    v_fma_f32 v35, v35, v57, v57
    v_mfma_f32_16x16x32_bf16 a[172:175], a[20:23], v[68:71], a[172:175]
    s_waitcnt lgkmcnt(4)
    ds_read_b128 v[92:95], v13 offset:55552
    v_rcp_f32 v35, v35
    v_mfma_f32_16x16x32_bf16 a[172:175], a[12:15], v[64:67], a[172:175]
    buffer_load_dwordx4 v4, s[12:15], s16 offen offset:2048 lds
    v_mfma_f32_16x16x32_bf16 a[180:183], a[12:15], v[72:75], a[180:183]
    s_waitcnt lgkmcnt(4)
    ds_read_b128 v[64:67], v13 offset:57344
    v_mul_f32 v35, v35, v183
    v_mfma_f32_16x16x32_bf16 a[180:183], a[20:23], v[76:79], a[180:183]
    v_mul_f32 v36, v188, v56
    v_mul_f32 v37, v189, v56
    v_mfma_f32_16x16x32_bf16 a[176:179], a[16:19], v[76:79], a[176:179]
    s_waitcnt lgkmcnt(4)
    ds_read_b128 v[68:71], v13 offset:59392
    v_exp_f32 v36, v36
    v_mfma_f32_16x16x32_bf16 a[176:179], a[8:11], v[72:75], a[176:179]
    buffer_load_dwordx4 v4, s[12:15], s16 offen offset:3072 lds
    v_mfma_f32_16x16x32_bf16 a[184:187], a[8:11], v[80:83], a[184:187]
    s_waitcnt lgkmcnt(4)
    ds_read_b128 v[72:75], v13 offset:57600
    s_add_u32 m0, s22, 49152
    v_mfma_f32_16x16x32_bf16 a[184:187], a[16:19], v[84:87], a[184:187]
    s_add_u32 s16, s16, 16384
    v_fma_f32 v36, v36, v57, v57
    v_mul_f32 v38, v190, v56
    v_mfma_f32_16x16x32_bf16 a[188:191], a[20:23], v[84:87], a[188:191]
    s_waitcnt lgkmcnt(4)
    ds_read_b128 v[76:79], v13 offset:59648
    v_rcp_f32 v36, v36
    v_mfma_f32_16x16x32_bf16 a[188:191], a[12:15], v[80:83], a[188:191]
    buffer_load_dwordx4 v4, s[12:15], s16 offen offset:0 lds
    v_mfma_f32_16x16x32_bf16 a[196:199], a[12:15], v[88:91], a[196:199]
    s_waitcnt lgkmcnt(4)
    ds_read_b128 v[80:83], v13 offset:61440
    v_exp_f32 v37, v37
    v_mfma_f32_16x16x32_bf16 a[196:199], a[20:23], v[92:95], a[196:199]
    v_mul_f32 v36, v36, v188
    v_fma_f32 v37, v37, v57, v57
    v_mfma_f32_16x16x32_bf16 a[192:195], a[16:19], v[92:95], a[192:195]
    s_waitcnt lgkmcnt(4)
    ds_read_b128 v[84:87], v13 offset:63488
    v_rcp_f32 v37, v37
    v_mfma_f32_16x16x32_bf16 a[192:195], a[8:11], v[88:91], a[192:195]
    buffer_load_dwordx4 v4, s[12:15], s16 offen offset:1024 lds
    v_mfma_f32_16x16x32_bf16 a[200:203], a[8:11], v[64:67], a[200:203]
    s_waitcnt lgkmcnt(4)
    ds_read_b128 v[88:91], v13 offset:61696
    v_exp_f32 v38, v38
    v_mfma_f32_16x16x32_bf16 a[200:203], a[16:19], v[68:71], a[200:203]
    v_mul_f32 v37, v37, v189
    v_fma_f32 v38, v38, v57, v57
    v_mfma_f32_16x16x32_bf16 a[204:207], a[20:23], v[68:71], a[204:207]
    s_waitcnt lgkmcnt(4)
    ds_read_b128 v[92:95], v13 offset:63744
    v_rcp_f32 v38, v38
    v_mfma_f32_16x16x32_bf16 a[204:207], a[12:15], v[64:67], a[204:207]
    s_barrier
    v_mfma_f32_16x16x32_bf16 a[212:215], a[12:15], v[72:75], a[212:215]
    s_waitcnt lgkmcnt(4)
    ds_read_b128 v[64:67], v12 offset:0
    v_mul_f32 v38, v38, v190
    v_mfma_f32_16x16x32_bf16 a[212:215], a[20:23], v[76:79], a[212:215]
    buffer_load_dwordx4 v4, s[12:15], s16 offen offset:2048 lds
    v_mfma_f32_16x16x32_bf16 a[208:211], a[16:19], v[76:79], a[208:211]
    s_waitcnt lgkmcnt(4)
    ds_read_b128 v[68:71], v12 offset:2048
    v_mul_f32 v39, v191, v56
    v_mfma_f32_16x16x32_bf16 a[208:211], a[8:11], v[72:75], a[208:211]
    v_exp_f32 v39, v39
    v_mfma_f32_16x16x32_bf16 a[216:219], a[8:11], v[80:83], a[216:219]
    s_waitcnt lgkmcnt(4)
    ds_read_b128 v[72:75], v12 offset:256
    v_fma_f32 v39, v39, v57, v57
    v_mfma_f32_16x16x32_bf16 a[216:219], a[16:19], v[84:87], a[216:219]
    buffer_load_dwordx4 v4, s[12:15], s16 offen offset:3072 lds
    v_mfma_f32_16x16x32_bf16 a[220:223], a[20:23], v[84:87], a[220:223]
    s_waitcnt lgkmcnt(4)
    ds_read_b128 v[76:79], v12 offset:2304
    s_add_u32 m0, s22, 65536
    v_mfma_f32_16x16x32_bf16 a[220:223], a[12:15], v[80:83], a[220:223]
    s_add_u32 s16, s16, 16384
    v_rcp_f32 v39, v39
    v_mfma_f32_16x16x32_bf16 a[228:231], a[12:15], v[88:91], a[228:231]
    s_waitcnt lgkmcnt(4)
    ds_read_b128 v[80:83], v12 offset:4096
    v_mul_f32 v39, v39, v191
    v_mfma_f32_16x16x32_bf16 a[228:231], a[20:23], v[92:95], a[228:231]
    buffer_load_dwordx4 v4, s[12:15], s16 offen offset:0 lds
    v_mfma_f32_16x16x32_bf16 a[224:227], a[16:19], v[92:95], a[224:227]
    s_waitcnt lgkmcnt(4)
    ds_read_b128 v[84:87], v12 offset:6144
    v_cvt_pk_bf16_f32 v180, v32, v33
    v_mfma_f32_16x16x32_bf16 a[224:227], a[8:11], v[88:91], a[224:227]
    v_cvt_pk_bf16_f32 v181, v34, v35
    v_cvt_pk_bf16_f32 v182, v36, v37
    v_mfma_f32_16x16x32_bf16 a[232:235], a[8:11], v[64:67], a[232:235]
    s_waitcnt lgkmcnt(4)
    ds_read_b128 v[88:91], v12 offset:4352
    v_cvt_pk_bf16_f32 v183, v38, v39
    v_mfma_f32_16x16x32_bf16 a[232:235], a[16:19], v[68:71], a[232:235]
    buffer_store_dwordx4 v[180:183], v1, s[12:15], s45 offen offset:256 sc1
    v_mfma_f32_16x16x32_bf16 a[236:239], a[20:23], v[68:71], a[236:239]
    s_waitcnt lgkmcnt(4)
    ds_read_b128 v[92:95], v12 offset:6400
    v_mul_f32 v24, v192, v22
    v_mfma_f32_16x16x32_bf16 a[236:239], a[12:15], v[64:67], a[236:239]
    v_exp_f32 v24, v24
    v_mfma_f32_16x16x32_bf16 a[244:247], a[12:15], v[72:75], a[244:247]
    s_waitcnt lgkmcnt(4)
    ds_read_b128 v[64:67], v12 offset:8192
    v_fma_f32 v24, v24, v23, v23
    v_mfma_f32_16x16x32_bf16 a[244:247], a[20:23], v[76:79], a[244:247]
    buffer_load_dwordx4 v4, s[12:15], s16 offen offset:1024 lds
    v_mfma_f32_16x16x32_bf16 a[240:243], a[16:19], v[76:79], a[240:243]
    s_waitcnt lgkmcnt(4)
    ds_read_b128 v[68:71], v12 offset:10240
    v_rcp_f32 v24, v24
    v_mfma_f32_16x16x32_bf16 a[240:243], a[8:11], v[72:75], a[240:243]
    v_mul_f32 v24, v24, v192
    v_mul_f32 v25, v193, v22
    v_mfma_f32_16x16x32_bf16 v[208:211], a[8:11], v[80:83], v[208:211]
    s_waitcnt lgkmcnt(4)
    ds_read_b128 v[72:75], v12 offset:8448
    v_exp_f32 v25, v25
    v_mfma_f32_16x16x32_bf16 v[208:211], a[16:19], v[84:87], v[208:211]
    buffer_load_dwordx4 v4, s[12:15], s16 offen offset:2048 lds
    v_mfma_f32_16x16x32_bf16 v[212:215], a[20:23], v[84:87], v[212:215]
    s_waitcnt lgkmcnt(4)
    ds_read_b128 v[76:79], v12 offset:10496
    v_fma_f32 v25, v25, v23, v23
    v_mfma_f32_16x16x32_bf16 v[212:215], a[12:15], v[80:83], v[212:215]
    v_rcp_f32 v25, v25
    v_mfma_f32_16x16x32_bf16 v[220:223], a[12:15], v[88:91], v[220:223]
    s_waitcnt lgkmcnt(4)
    ds_read_b128 v[80:83], v12 offset:12288
    v_mul_f32 v25, v25, v193
    v_mfma_f32_16x16x32_bf16 v[220:223], a[20:23], v[92:95], v[220:223]
    buffer_load_dwordx4 v4, s[12:15], s16 offen offset:3072 lds
    v_mfma_f32_16x16x32_bf16 v[216:219], a[16:19], v[92:95], v[216:219]
    s_waitcnt lgkmcnt(4)
    ds_read_b128 v[84:87], v12 offset:14336
    s_add_u32 m0, s22, 81920
    v_mfma_f32_16x16x32_bf16 v[216:219], a[8:11], v[88:91], v[216:219]
    s_add_u32 s16, s16, 16384
    v_mul_f32 v26, v194, v22
    v_mul_f32 v27, v195, v22
    v_mfma_f32_16x16x32_bf16 a[168:171], v[144:147], v[64:67], a[168:171]
    s_waitcnt lgkmcnt(4)
    ds_read_b128 v[88:91], v12 offset:12544
    v_exp_f32 v26, v26
    v_mfma_f32_16x16x32_bf16 a[168:171], a[24:27], v[68:71], a[168:171]
    buffer_load_dwordx4 v4, s[12:15], s16 offen offset:0 lds
    v_mfma_f32_16x16x32_bf16 a[172:175], a[28:31], v[68:71], a[172:175]
    s_waitcnt lgkmcnt(4)
    ds_read_b128 v[92:95], v12 offset:14592
    v_exp_f32 v27, v27
    v_mfma_f32_16x16x32_bf16 a[172:175], v[148:151], v[64:67], a[172:175]
    s_waitcnt vmcnt(31)
    s_barrier
    v_mfma_f32_16x16x32_bf16 a[180:183], v[148:151], v[72:75], a[180:183]
    s_waitcnt lgkmcnt(4)
    ds_read_b128 v[64:67], v12 offset:16384
    v_fma_f32 v26, v26, v23, v23
    v_mfma_f32_16x16x32_bf16 a[180:183], a[28:31], v[76:79], a[180:183]
    buffer_load_dwordx4 v4, s[12:15], s16 offen offset:1024 lds
    v_mfma_f32_16x16x32_bf16 a[176:179], a[24:27], v[76:79], a[176:179]
    s_waitcnt lgkmcnt(4)
    ds_read_b128 v[68:71], v12 offset:18432
    v_rcp_f32 v26, v26
    v_mfma_f32_16x16x32_bf16 a[176:179], v[144:147], v[72:75], a[176:179]
    v_mul_f32 v26, v26, v194
    v_fma_f32 v27, v27, v23, v23
    v_mfma_f32_16x16x32_bf16 a[184:187], v[144:147], v[80:83], a[184:187]
    s_waitcnt lgkmcnt(4)
    ds_read_b128 v[72:75], v12 offset:16640
    v_rcp_f32 v27, v27
    v_mfma_f32_16x16x32_bf16 a[184:187], a[24:27], v[84:87], a[184:187]
    buffer_load_dwordx4 v4, s[12:15], s16 offen offset:2048 lds
    v_mfma_f32_16x16x32_bf16 a[188:191], a[28:31], v[84:87], a[188:191]
    s_waitcnt lgkmcnt(4)
    ds_read_b128 v[76:79], v12 offset:18688
    v_mul_f32 v27, v27, v195
    v_mfma_f32_16x16x32_bf16 a[188:191], v[148:151], v[80:83], a[188:191]
    s_waitcnt vmcnt(15)
    v_cmp_gt_u32 vcc, 5, v61
    v_mul_f32 v28, v200, v22
    v_mfma_f32_16x16x32_bf16 a[196:199], v[148:151], v[88:91], a[196:199]
    s_waitcnt lgkmcnt(4)
    ds_read_b128 v[80:83], v12 offset:20480
    s_cbranch_vccnz SLOW4_ff_kernel
BACK4_ff_kernel:
    v_mfma_f32_16x16x32_bf16 a[196:199], a[28:31], v[92:95], a[196:199]
    buffer_load_dwordx4 v4, s[12:15], s16 offen offset:3072 lds
    v_mfma_f32_16x16x32_bf16 a[192:195], a[24:27], v[92:95], a[192:195]
    s_waitcnt lgkmcnt(4)
    ds_read_b128 v[84:87], v12 offset:22528
    s_add_u32 s28, s41, 8192
    v_mfma_f32_16x16x32_bf16 a[192:195], v[144:147], v[88:91], a[192:195]
    v_exp_f32 v28, v28
    v_mfma_f32_16x16x32_bf16 a[200:203], v[144:147], v[64:67], a[200:203]
    s_waitcnt lgkmcnt(4)
    ds_read_b128 v[88:91], v12 offset:20736
    v_fma_f32 v28, v28, v23, v23
    v_mfma_f32_16x16x32_bf16 a[200:203], a[24:27], v[68:71], a[200:203]
    buffer_load_dwordx4 a[96:99], v1, s[12:15], s28 offen offset:0 sc1
    v_mfma_f32_16x16x32_bf16 a[204:207], a[28:31], v[68:71], a[204:207]
    s_waitcnt lgkmcnt(4)
    ds_read_b128 v[92:95], v12 offset:22784
    v_rcp_f32 v28, v28
    v_mfma_f32_16x16x32_bf16 a[204:207], v[148:151], v[64:67], a[204:207]
    v_mul_f32 v28, v28, v200
    v_mul_f32 v29, v201, v22
    v_mfma_f32_16x16x32_bf16 a[212:215], v[148:151], v[72:75], a[212:215]
    s_waitcnt lgkmcnt(4)
    ds_read_b128 v[64:67], v12 offset:24576
    v_exp_f32 v29, v29
    v_mfma_f32_16x16x32_bf16 a[212:215], a[28:31], v[76:79], a[212:215]
    buffer_load_dwordx4 a[100:103], v1, s[12:15], s28 offen offset:256 sc1
    v_mfma_f32_16x16x32_bf16 a[208:211], a[24:27], v[76:79], a[208:211]
    s_waitcnt lgkmcnt(4)
    ds_read_b128 v[68:71], v12 offset:26624
    s_add_u32 s28, s42, 8192
    v_mfma_f32_16x16x32_bf16 a[208:211], v[144:147], v[72:75], a[208:211]
    v_fma_f32 v29, v29, v23, v23
    v_mul_f32 v30, v202, v22
    v_mfma_f32_16x16x32_bf16 a[216:219], v[144:147], v[80:83], a[216:219]
    s_waitcnt lgkmcnt(4)
    ds_read_b128 v[72:75], v12 offset:24832
    v_rcp_f32 v29, v29
    v_mfma_f32_16x16x32_bf16 a[216:219], a[24:27], v[84:87], a[216:219]
    buffer_load_dwordx4 a[104:107], v1, s[12:15], s28 offen offset:0 sc1
    v_mfma_f32_16x16x32_bf16 a[220:223], a[28:31], v[84:87], a[220:223]
    s_waitcnt lgkmcnt(4)
    ds_read_b128 v[76:79], v12 offset:26880
    v_exp_f32 v30, v30
    v_mfma_f32_16x16x32_bf16 a[220:223], v[148:151], v[80:83], a[220:223]
    v_mul_f32 v29, v29, v201
    v_fma_f32 v30, v30, v23, v23
    v_mfma_f32_16x16x32_bf16 a[228:231], v[148:151], v[88:91], a[228:231]
    s_waitcnt lgkmcnt(4)
    ds_read_b128 v[80:83], v12 offset:28672
    v_rcp_f32 v30, v30
    v_mfma_f32_16x16x32_bf16 a[228:231], a[28:31], v[92:95], a[228:231]
    buffer_load_dwordx4 a[108:111], v1, s[12:15], s28 offen offset:256 sc1
    v_mfma_f32_16x16x32_bf16 a[224:227], a[24:27], v[92:95], a[224:227]
    s_waitcnt lgkmcnt(4)
    ds_read_b128 v[84:87], v12 offset:30720
    s_add_u32 s28, s43, 8192
    v_mfma_f32_16x16x32_bf16 a[224:227], v[144:147], v[88:91], a[224:227]
    v_mul_f32 v30, v30, v202
    v_mul_f32 v31, v203, v22
    v_mfma_f32_16x16x32_bf16 a[232:235], v[144:147], v[64:67], a[232:235]
    s_waitcnt lgkmcnt(4)
    ds_read_b128 v[88:91], v12 offset:28928
    v_exp_f32 v31, v31
    v_mfma_f32_16x16x32_bf16 a[232:235], a[24:27], v[68:71], a[232:235]
    buffer_load_dwordx4 a[112:115], v1, s[12:15], s28 offen offset:0 sc1
    v_mfma_f32_16x16x32_bf16 a[236:239], a[28:31], v[68:71], a[236:239]
    s_waitcnt lgkmcnt(4)
    ds_read_b128 v[92:95], v12 offset:30976
    v_fma_f32 v31, v31, v23, v23
    v_mfma_f32_16x16x32_bf16 a[236:239], v[148:151], v[64:67], a[236:239]
    s_waitcnt vmcnt(18)
    s_barrier
    v_mfma_f32_16x16x32_bf16 a[244:247], v[148:151], v[72:75], a[244:247]
    s_waitcnt lgkmcnt(4)
    ds_read_b128 v[64:67], v12 offset:32768
    v_rcp_f32 v31, v31
    v_mfma_f32_16x16x32_bf16 a[244:247], a[28:31], v[76:79], a[244:247]
    buffer_load_dwordx4 a[116:119], v1, s[12:15], s28 offen offset:256 sc1
    v_mfma_f32_16x16x32_bf16 a[240:243], a[24:27], v[76:79], a[240:243]
    s_waitcnt lgkmcnt(4)
    ds_read_b128 v[68:71], v12 offset:34816
    s_add_u32 m0, s22, 98304
    v_mfma_f32_16x16x32_bf16 a[240:243], v[144:147], v[72:75], a[240:243]
    s_add_u32 s16, s16, 16384
    v_mul_f32 v31, v31, v203
    v_cvt_pk_bf16_f32 v192, v24, v25
    v_mfma_f32_16x16x32_bf16 v[208:211], v[144:147], v[80:83], v[208:211]
    s_waitcnt lgkmcnt(4)
    ds_read_b128 v[72:75], v12 offset:33024
    v_cvt_pk_bf16_f32 v193, v26, v27
    v_mfma_f32_16x16x32_bf16 v[208:211], a[24:27], v[84:87], v[208:211]
    buffer_load_dwordx4 v4, s[12:15], s16 offen offset:0 lds
    v_mfma_f32_16x16x32_bf16 v[212:215], a[28:31], v[84:87], v[212:215]
    s_waitcnt lgkmcnt(4)
    ds_read_b128 v[76:79], v12 offset:35072
    v_cvt_pk_bf16_f32 v194, v28, v29
    v_mfma_f32_16x16x32_bf16 v[212:215], v[148:151], v[80:83], v[212:215]
    v_cvt_pk_bf16_f32 v195, v30, v31
    v_mul_f32 v32, v196, v56
    v_mfma_f32_16x16x32_bf16 v[220:223], v[148:151], v[88:91], v[220:223]
    s_waitcnt lgkmcnt(4)
    ds_read_b128 v[80:83], v12 offset:36864
    v_exp_f32 v32, v32
    v_mfma_f32_16x16x32_bf16 v[220:223], a[28:31], v[92:95], v[220:223]
    buffer_store_dwordx4 v[192:195], v1, s[12:15], s27 offen offset:0 sc1
    v_mfma_f32_16x16x32_bf16 v[216:219], a[24:27], v[92:95], v[216:219]
    s_waitcnt lgkmcnt(4)
    ds_read_b128 v[84:87], v12 offset:38912
    v_fma_f32 v32, v32, v57, v57
    v_mfma_f32_16x16x32_bf16 v[216:219], v[144:147], v[88:91], v[216:219]
    v_rcp_f32 v32, v32
    v_mfma_f32_16x16x32_bf16 a[168:171], a[32:35], v[64:67], a[168:171]
    s_waitcnt lgkmcnt(4)
    ds_read_b128 v[88:91], v12 offset:37120
    v_mul_f32 v32, v32, v196
    v_mfma_f32_16x16x32_bf16 a[168:171], a[40:43], v[68:71], a[168:171]
    buffer_load_dwordx4 v4, s[12:15], s16 offen offset:1024 lds
    v_mfma_f32_16x16x32_bf16 a[172:175], a[44:47], v[68:71], a[172:175]
    s_waitcnt lgkmcnt(4)
    ds_read_b128 v[92:95], v12 offset:39168
    v_mul_f32 v33, v197, v56
    v_mfma_f32_16x16x32_bf16 a[172:175], a[36:39], v[64:67], a[172:175]
    s_waitcnt vmcnt(16)
    buffer_store_dword v60, v59, s[12:15], s26 offen sc1
    v_mfma_f32_16x16x32_bf16 a[180:183], a[36:39], v[72:75], a[180:183]
    s_waitcnt lgkmcnt(4)
    ds_read_b128 v[64:67], v12 offset:40960
    v_exp_f32 v33, v33
    v_mfma_f32_16x16x32_bf16 a[180:183], a[44:47], v[76:79], a[180:183]
    v_mov_b32 v60, 7
    v_fma_f32 v33, v33, v57, v57
    v_mfma_f32_16x16x32_bf16 a[176:179], a[40:43], v[76:79], a[176:179]
    s_waitcnt lgkmcnt(4)
    ds_read_b128 v[68:71], v12 offset:43008
    v_rcp_f32 v33, v33
    v_mfma_f32_16x16x32_bf16 a[176:179], a[32:35], v[72:75], a[176:179]
    buffer_load_dwordx4 v4, s[12:15], s16 offen offset:2048 lds
    v_mfma_f32_16x16x32_bf16 a[184:187], a[32:35], v[80:83], a[184:187]
    s_waitcnt lgkmcnt(4)
    ds_read_b128 v[72:75], v12 offset:41216
    v_mul_f32 v33, v33, v197
    v_mfma_f32_16x16x32_bf16 a[184:187], a[40:43], v[84:87], a[184:187]
    v_mul_f32 v34, v198, v56
    v_mul_f32 v35, v199, v56
    v_mfma_f32_16x16x32_bf16 a[188:191], a[44:47], v[84:87], a[188:191]
    s_waitcnt lgkmcnt(4)
    ds_read_b128 v[76:79], v12 offset:43264
    v_exp_f32 v34, v34
    v_mfma_f32_16x16x32_bf16 a[188:191], a[36:39], v[80:83], a[188:191]
    buffer_load_dwordx4 v4, s[12:15], s16 offen offset:3072 lds
    v_mfma_f32_16x16x32_bf16 a[196:199], a[36:39], v[88:91], a[196:199]
    s_waitcnt lgkmcnt(4)
    ds_read_b128 v[80:83], v12 offset:45056
    s_add_u32 m0, s22, 114688
    v_mfma_f32_16x16x32_bf16 a[196:199], a[44:47], v[92:95], a[196:199]
    s_add_u32 s16, s16, 16384
    v_fma_f32 v34, v34, v57, v57
    v_mul_f32 v36, v204, v56
    v_mfma_f32_16x16x32_bf16 a[192:195], a[40:43], v[92:95], a[192:195]
    s_waitcnt lgkmcnt(4)
    ds_read_b128 v[84:87], v12 offset:47104
    v_rcp_f32 v34, v34
    v_mfma_f32_16x16x32_bf16 a[192:195], a[32:35], v[88:91], a[192:195]
    buffer_load_dwordx4 v4, s[12:15], s16 offen offset:0 lds
    v_mfma_f32_16x16x32_bf16 a[200:203], a[32:35], v[64:67], a[200:203]
    s_waitcnt lgkmcnt(4)
    ds_read_b128 v[88:91], v12 offset:45312
    v_exp_f32 v35, v35
    v_mfma_f32_16x16x32_bf16 a[200:203], a[40:43], v[68:71], a[200:203]
    v_mul_f32 v34, v34, v198
    v_fma_f32 v35, v35, v57, v57
    v_mfma_f32_16x16x32_bf16 a[204:207], a[44:47], v[68:71], a[204:207]
    s_waitcnt lgkmcnt(4)
    ds_read_b128 v[92:95], v12 offset:47360
    v_rcp_f32 v35, v35
    v_mfma_f32_16x16x32_bf16 a[204:207], a[36:39], v[64:67], a[204:207]
    s_barrier
    v_mfma_f32_16x16x32_bf16 a[212:215], a[36:39], v[72:75], a[212:215]
    s_waitcnt lgkmcnt(4)
    ds_read_b128 v[64:67], v12 offset:49152
    v_exp_f32 v36, v36
    v_mfma_f32_16x16x32_bf16 a[212:215], a[44:47], v[76:79], a[212:215]
    buffer_load_dwordx4 v4, s[12:15], s16 offen offset:1024 lds
    v_mfma_f32_16x16x32_bf16 a[208:211], a[40:43], v[76:79], a[208:211]
    s_waitcnt lgkmcnt(4)
    ds_read_b128 v[68:71], v12 offset:51200
    v_mul_f32 v35, v35, v199
    v_mfma_f32_16x16x32_bf16 a[208:211], a[32:35], v[72:75], a[208:211]
    v_fma_f32 v36, v36, v57, v57
    v_mul_f32 v37, v205, v56
    v_mfma_f32_16x16x32_bf16 a[216:219], a[32:35], v[80:83], a[216:219]
    s_waitcnt lgkmcnt(4)
    ds_read_b128 v[72:75], v12 offset:49408
    v_rcp_f32 v36, v36
    v_mfma_f32_16x16x32_bf16 a[216:219], a[40:43], v[84:87], a[216:219]
    buffer_load_dwordx4 v4, s[12:15], s16 offen offset:2048 lds
    v_mfma_f32_16x16x32_bf16 a[220:223], a[44:47], v[84:87], a[220:223]
    s_waitcnt lgkmcnt(4)
    ds_read_b128 v[76:79], v12 offset:51456
    v_exp_f32 v37, v37
    v_mfma_f32_16x16x32_bf16 a[220:223], a[36:39], v[80:83], a[220:223]
    v_mul_f32 v36, v36, v204
    v_fma_f32 v37, v37, v57, v57
    v_mfma_f32_16x16x32_bf16 a[228:231], a[36:39], v[88:91], a[228:231]
    s_waitcnt lgkmcnt(4)
    ds_read_b128 v[80:83], v12 offset:53248
    v_rcp_f32 v37, v37
    v_mfma_f32_16x16x32_bf16 a[228:231], a[44:47], v[92:95], a[228:231]
    buffer_load_dwordx4 v4, s[12:15], s16 offen offset:3072 lds
    v_mfma_f32_16x16x32_bf16 a[224:227], a[40:43], v[92:95], a[224:227]
    s_waitcnt lgkmcnt(4)
    ds_read_b128 v[84:87], v12 offset:55296
    s_add_u32 m0, s22, 0
    v_mfma_f32_16x16x32_bf16 a[224:227], a[32:35], v[88:91], a[224:227]
    s_add_u32 s16, s16, 16384
    v_mul_f32 v37, v37, v205
    v_mul_f32 v38, v206, v56
    v_mfma_f32_16x16x32_bf16 a[232:235], a[32:35], v[64:67], a[232:235]
    s_waitcnt lgkmcnt(4)
    ds_read_b128 v[88:91], v12 offset:53504
    v_mul_f32 v39, v207, v56
    v_mfma_f32_16x16x32_bf16 a[232:235], a[40:43], v[68:71], a[232:235]
    buffer_load_dwordx4 v4, s[12:15], s16 offen offset:0 lds
    v_mfma_f32_16x16x32_bf16 a[236:239], a[44:47], v[68:71], a[236:239]
    s_waitcnt lgkmcnt(4)
    ds_read_b128 v[92:95], v12 offset:55552
    v_cvt_pk_bf16_f32 v196, v32, v33
    v_mfma_f32_16x16x32_bf16 a[236:239], a[36:39], v[64:67], a[236:239]
    buffer_load_dword v62, v58, s[12:15], s26 offen sc1
    v_mfma_f32_16x16x32_bf16 a[244:247], a[36:39], v[72:75], a[244:247]
    s_waitcnt lgkmcnt(4)
    ds_read_b128 v[64:67], v12 offset:57344
    v_cvt_pk_bf16_f32 v197, v34, v35
    v_mfma_f32_16x16x32_bf16 a[244:247], a[44:47], v[76:79], a[244:247]
    v_exp_f32 v38, v38
    v_mfma_f32_16x16x32_bf16 a[240:243], a[40:43], v[76:79], a[240:243]
    s_waitcnt lgkmcnt(4)
    ds_read_b128 v[68:71], v12 offset:59392
    v_fma_f32 v38, v38, v57, v57
    v_mfma_f32_16x16x32_bf16 a[240:243], a[32:35], v[72:75], a[240:243]
    buffer_load_dwordx4 v4, s[12:15], s16 offen offset:1024 lds
    v_mfma_f32_16x16x32_bf16 v[208:211], a[32:35], v[80:83], v[208:211]
    s_waitcnt lgkmcnt(4)
    ds_read_b128 v[72:75], v12 offset:57600
    v_cvt_pk_bf16_f32 v198, v36, v37
    v_mfma_f32_16x16x32_bf16 v[208:211], a[40:43], v[84:87], v[208:211]
    v_rcp_f32 v38, v38
    v_mfma_f32_16x16x32_bf16 v[212:215], a[44:47], v[84:87], v[212:215]
    s_waitcnt lgkmcnt(4)
    ds_read_b128 v[76:79], v12 offset:59648
    v_mul_f32 v38, v38, v206
    v_mfma_f32_16x16x32_bf16 v[212:215], a[36:39], v[80:83], v[212:215]
    buffer_load_dwordx4 v4, s[12:15], s16 offen offset:2048 lds
    v_mfma_f32_16x16x32_bf16 v[220:223], a[36:39], v[88:91], v[220:223]
    s_waitcnt lgkmcnt(4)
    ds_read_b128 v[80:83], v12 offset:61440
    v_mfma_f32_16x16x32_bf16 v[220:223], a[44:47], v[92:95], v[220:223]
    v_exp_f32 v39, v39
    v_mfma_f32_16x16x32_bf16 v[216:219], a[40:43], v[92:95], v[216:219]
    s_waitcnt lgkmcnt(4)
    ds_read_b128 v[84:87], v12 offset:63488
    v_fma_f32 v39, v39, v57, v57
    v_mfma_f32_16x16x32_bf16 v[216:219], a[32:35], v[88:91], v[216:219]
    buffer_load_dwordx4 v4, s[12:15], s16 offen offset:3072 lds
    v_mfma_f32_16x16x32_bf16 a[168:171], v[160:163], v[64:67], a[168:171]
    s_waitcnt lgkmcnt(4)
    ds_read_b128 v[88:91], v12 offset:61696
    s_add_u32 m0, s22, 16384
    v_mfma_f32_16x16x32_bf16 a[168:171], a[48:51], v[68:71], a[168:171]
    s_add_u32 s16, s16, 16384
    v_rcp_f32 v39, v39
    v_mfma_f32_16x16x32_bf16 a[172:175], a[52:55], v[68:71], a[172:175]
    s_waitcnt lgkmcnt(4)
    ds_read_b128 v[92:95], v12 offset:63744
    v_mul_f32 v39, v39, v207
    v_mfma_f32_16x16x32_bf16 a[172:175], v[164:167], v[64:67], a[172:175]
    s_waitcnt vmcnt(25)
    s_barrier
    v_mfma_f32_16x16x32_bf16 a[180:183], v[164:167], v[72:75], a[180:183]
    s_waitcnt lgkmcnt(4)
    ds_read_b128 v[64:67], v13 offset:0
    v_cvt_pk_bf16_f32 v199, v38, v39
    v_mfma_f32_16x16x32_bf16 a[180:183], a[52:55], v[76:79], a[180:183]
    buffer_store_dwordx4 v[196:199], v1, s[12:15], s27 offen offset:256 sc1
    v_mfma_f32_16x16x32_bf16 a[176:179], a[48:51], v[76:79], a[176:179]
    s_waitcnt lgkmcnt(4)
    ds_read_b128 v[68:71], v13 offset:2048
    v_mfma_f32_16x16x32_bf16 a[176:179], v[160:163], v[72:75], a[176:179]
    v_mfma_f32_16x16x32_bf16 a[184:187], v[160:163], v[80:83], a[184:187]
    s_waitcnt lgkmcnt(4)
    ds_read_b128 v[72:75], v13 offset:256
    v_mfma_f32_16x16x32_bf16 a[184:187], a[48:51], v[84:87], a[184:187]
    buffer_load_dwordx4 v4, s[12:15], s16 offen offset:0 lds
    v_mfma_f32_16x16x32_bf16 a[188:191], a[52:55], v[84:87], a[188:191]
    s_waitcnt lgkmcnt(4)
    ds_read_b128 v[76:79], v13 offset:2304
    v_mfma_f32_16x16x32_bf16 a[188:191], v[164:167], v[80:83], a[188:191]
    v_mfma_f32_16x16x32_bf16 a[196:199], v[164:167], v[88:91], a[196:199]
    s_waitcnt lgkmcnt(4)
    ds_read_b128 v[80:83], v13 offset:4096
    v_mfma_f32_16x16x32_bf16 a[196:199], a[52:55], v[92:95], a[196:199]
    buffer_load_dwordx4 v4, s[12:15], s16 offen offset:1024 lds
    v_mfma_f32_16x16x32_bf16 a[192:195], a[48:51], v[92:95], a[192:195]
    s_waitcnt lgkmcnt(4)
    ds_read_b128 v[84:87], v13 offset:6144
    v_mfma_f32_16x16x32_bf16 a[192:195], v[160:163], v[88:91], a[192:195]
    v_mfma_f32_16x16x32_bf16 a[200:203], v[160:163], v[64:67], a[200:203]
    s_waitcnt lgkmcnt(4)
    ds_read_b128 v[88:91], v13 offset:4352
    v_mfma_f32_16x16x32_bf16 a[200:203], a[48:51], v[68:71], a[200:203]
    buffer_load_dwordx4 v4, s[12:15], s16 offen offset:2048 lds
    v_mfma_f32_16x16x32_bf16 a[204:207], a[52:55], v[68:71], a[204:207]
    s_waitcnt lgkmcnt(4)
    ds_read_b128 v[92:95], v13 offset:6400
    v_mfma_f32_16x16x32_bf16 a[204:207], v[164:167], v[64:67], a[204:207]
    v_mfma_f32_16x16x32_bf16 a[212:215], v[164:167], v[72:75], a[212:215]
    s_waitcnt lgkmcnt(4)
    ds_read_b128 v[64:67], v13 offset:8192
    v_mfma_f32_16x16x32_bf16 a[212:215], a[52:55], v[76:79], a[212:215]
    buffer_load_dwordx4 v4, s[12:15], s16 offen offset:3072 lds
    v_mfma_f32_16x16x32_bf16 a[208:211], a[48:51], v[76:79], a[208:211]
    s_waitcnt lgkmcnt(4)
    ds_read_b128 v[68:71], v13 offset:10240
    s_add_u32 m0, s22, 32768
    v_mfma_f32_16x16x32_bf16 a[208:211], v[160:163], v[72:75], a[208:211]
    s_add_u32 s16, s16, 16384
    v_mfma_f32_16x16x32_bf16 a[216:219], v[160:163], v[80:83], a[216:219]
    s_waitcnt lgkmcnt(4)
    ds_read_b128 v[72:75], v13 offset:8448
    v_mfma_f32_16x16x32_bf16 a[216:219], a[48:51], v[84:87], a[216:219]
    buffer_load_dwordx4 v4, s[12:15], s16 offen offset:0 lds
    v_mfma_f32_16x16x32_bf16 a[220:223], a[52:55], v[84:87], a[220:223]
    s_waitcnt lgkmcnt(4)
    ds_read_b128 v[76:79], v13 offset:10496
    v_mfma_f32_16x16x32_bf16 a[220:223], v[164:167], v[80:83], a[220:223]
    v_mfma_f32_16x16x32_bf16 a[228:231], v[164:167], v[88:91], a[228:231]
    s_waitcnt lgkmcnt(4)
    ds_read_b128 v[80:83], v13 offset:12288
    v_mfma_f32_16x16x32_bf16 a[228:231], a[52:55], v[92:95], a[228:231]
    buffer_load_dwordx4 v4, s[12:15], s16 offen offset:1024 lds
    v_mfma_f32_16x16x32_bf16 a[224:227], a[48:51], v[92:95], a[224:227]
    s_waitcnt lgkmcnt(4)
    ds_read_b128 v[84:87], v13 offset:14336
    v_mfma_f32_16x16x32_bf16 a[224:227], v[160:163], v[88:91], a[224:227]
    v_mfma_f32_16x16x32_bf16 a[232:235], v[160:163], v[64:67], a[232:235]
    s_waitcnt lgkmcnt(4)
    ds_read_b128 v[88:91], v13 offset:12544
    v_mfma_f32_16x16x32_bf16 a[232:235], a[48:51], v[68:71], a[232:235]
    buffer_load_dwordx4 v4, s[12:15], s16 offen offset:2048 lds
    v_mfma_f32_16x16x32_bf16 a[236:239], a[52:55], v[68:71], a[236:239]
    s_waitcnt lgkmcnt(4)
    ds_read_b128 v[92:95], v13 offset:14592
    v_mfma_f32_16x16x32_bf16 a[236:239], v[164:167], v[64:67], a[236:239]
    s_waitcnt vmcnt(29)
    s_barrier
    v_mfma_f32_16x16x32_bf16 a[244:247], v[164:167], v[72:75], a[244:247]
    s_waitcnt lgkmcnt(4)
    ds_read_b128 v[64:67], v13 offset:16384
    v_mfma_f32_16x16x32_bf16 a[244:247], a[52:55], v[76:79], a[244:247]
    buffer_load_dwordx4 v4, s[12:15], s16 offen offset:3072 lds
    v_mfma_f32_16x16x32_bf16 a[240:243], a[48:51], v[76:79], a[240:243]
    s_waitcnt lgkmcnt(4)
    ds_read_b128 v[68:71], v13 offset:18432
    s_add_u32 m0, s22, 49152
    v_mfma_f32_16x16x32_bf16 a[240:243], v[160:163], v[72:75], a[240:243]
    s_add_u32 s16, s16, 16384
    v_mfma_f32_16x16x32_bf16 v[208:211], v[160:163], v[80:83], v[208:211]
    s_waitcnt lgkmcnt(4)
    ds_read_b128 v[72:75], v13 offset:16640
    v_mfma_f32_16x16x32_bf16 v[208:211], a[48:51], v[84:87], v[208:211]
    buffer_load_dwordx4 v4, s[12:15], s16 offen offset:0 lds
    v_mfma_f32_16x16x32_bf16 v[212:215], a[52:55], v[84:87], v[212:215]
    s_waitcnt lgkmcnt(4)
    ds_read_b128 v[76:79], v13 offset:18688
    v_mfma_f32_16x16x32_bf16 v[212:215], v[164:167], v[80:83], v[212:215]
    v_mfma_f32_16x16x32_bf16 v[220:223], v[164:167], v[88:91], v[220:223]
    s_waitcnt lgkmcnt(4)
    ds_read_b128 v[80:83], v13 offset:20480
    v_mfma_f32_16x16x32_bf16 v[220:223], a[52:55], v[92:95], v[220:223]
    buffer_load_dwordx4 v4, s[12:15], s16 offen offset:1024 lds
    v_mfma_f32_16x16x32_bf16 v[216:219], a[48:51], v[92:95], v[216:219]
    s_waitcnt lgkmcnt(4)
    ds_read_b128 v[84:87], v13 offset:22528
    v_mfma_f32_16x16x32_bf16 v[216:219], v[160:163], v[88:91], v[216:219]
    v_mfma_f32_16x16x32_bf16 a[168:171], a[56:59], v[64:67], a[168:171]
    s_waitcnt lgkmcnt(4)
    ds_read_b128 v[88:91], v13 offset:20736
    v_mfma_f32_16x16x32_bf16 a[168:171], a[64:67], v[68:71], a[168:171]
    buffer_load_dwordx4 v4, s[12:15], s16 offen offset:2048 lds
    v_mfma_f32_16x16x32_bf16 a[172:175], a[68:71], v[68:71], a[172:175]
    s_waitcnt lgkmcnt(4)
    ds_read_b128 v[92:95], v13 offset:22784
    v_mfma_f32_16x16x32_bf16 a[172:175], a[60:63], v[64:67], a[172:175]
    s_waitcnt vmcnt(15)
    v_cmp_gt_u32 vcc, 6, v62
    v_mfma_f32_16x16x32_bf16 a[180:183], a[60:63], v[72:75], a[180:183]
    s_waitcnt lgkmcnt(4)
    ds_read_b128 v[64:67], v13 offset:24576
    s_cbranch_vccnz SLOW5_ff_kernel
BACK5_ff_kernel:
    v_mfma_f32_16x16x32_bf16 a[180:183], a[68:71], v[76:79], a[180:183]
    buffer_load_dwordx4 v4, s[12:15], s16 offen offset:3072 lds
    v_mfma_f32_16x16x32_bf16 a[176:179], a[64:67], v[76:79], a[176:179]
    s_waitcnt lgkmcnt(4)
    ds_read_b128 v[68:71], v13 offset:26624
    s_add_u32 s28, s41, 10240
    v_mfma_f32_16x16x32_bf16 a[176:179], a[56:59], v[72:75], a[176:179]
    v_mfma_f32_16x16x32_bf16 a[184:187], a[56:59], v[80:83], a[184:187]
    s_waitcnt lgkmcnt(4)
    ds_read_b128 v[72:75], v13 offset:24832
    v_mfma_f32_16x16x32_bf16 a[184:187], a[64:67], v[84:87], a[184:187]
    buffer_load_dwordx4 a[120:123], v1, s[12:15], s28 offen offset:0 sc1
    v_mfma_f32_16x16x32_bf16 a[188:191], a[68:71], v[84:87], a[188:191]
    s_waitcnt lgkmcnt(4)
    ds_read_b128 v[76:79], v13 offset:26880
    v_mfma_f32_16x16x32_bf16 a[188:191], a[60:63], v[80:83], a[188:191]
    v_mfma_f32_16x16x32_bf16 a[196:199], a[60:63], v[88:91], a[196:199]
    s_waitcnt lgkmcnt(4)
    ds_read_b128 v[80:83], v13 offset:28672
    v_mfma_f32_16x16x32_bf16 a[196:199], a[68:71], v[92:95], a[196:199]
    buffer_load_dwordx4 a[124:127], v1, s[12:15], s28 offen offset:256 sc1
    v_mfma_f32_16x16x32_bf16 a[192:195], a[64:67], v[92:95], a[192:195]
    s_waitcnt lgkmcnt(4)
    ds_read_b128 v[84:87], v13 offset:30720
    s_add_u32 s28, s42, 10240
    v_mfma_f32_16x16x32_bf16 a[192:195], a[56:59], v[88:91], a[192:195]
    v_mfma_f32_16x16x32_bf16 a[200:203], a[56:59], v[64:67], a[200:203]
    s_waitcnt lgkmcnt(4)
    ds_read_b128 v[88:91], v13 offset:28928
    v_mfma_f32_16x16x32_bf16 a[200:203], a[64:67], v[68:71], a[200:203]
    buffer_load_dwordx4 a[128:131], v1, s[12:15], s28 offen offset:0 sc1
    v_mfma_f32_16x16x32_bf16 a[204:207], a[68:71], v[68:71], a[204:207]
    s_waitcnt lgkmcnt(4)
    ds_read_b128 v[92:95], v13 offset:30976
    v_mfma_f32_16x16x32_bf16 a[204:207], a[60:63], v[64:67], a[204:207]
    s_barrier
    v_mfma_f32_16x16x32_bf16 a[212:215], a[60:63], v[72:75], a[212:215]
    s_waitcnt lgkmcnt(4)
    ds_read_b128 v[64:67], v13 offset:32768
    v_mfma_f32_16x16x32_bf16 a[212:215], a[68:71], v[76:79], a[212:215]
    s_waitcnt vmcnt(15)
    buffer_store_dword v60, v59, s[12:15], s26 offen sc1
    v_mfma_f32_16x16x32_bf16 a[208:211], a[64:67], v[76:79], a[208:211]
    s_waitcnt lgkmcnt(4)
    ds_read_b128 v[68:71], v13 offset:34816
    v_mov_b32 v60, 8
    v_mfma_f32_16x16x32_bf16 a[208:211], a[56:59], v[72:75], a[208:211]
    v_mfma_f32_16x16x32_bf16 a[216:219], a[56:59], v[80:83], a[216:219]
    s_waitcnt lgkmcnt(4)
    ds_read_b128 v[72:75], v13 offset:33024
    v_mfma_f32_16x16x32_bf16 a[216:219], a[64:67], v[84:87], a[216:219]
    buffer_load_dwordx4 a[132:135], v1, s[12:15], s28 offen offset:256 sc1
    v_mfma_f32_16x16x32_bf16 a[220:223], a[68:71], v[84:87], a[220:223]
    s_waitcnt lgkmcnt(4)
    ds_read_b128 v[76:79], v13 offset:35072
    s_add_u32 s28, s43, 10240
    v_mfma_f32_16x16x32_bf16 a[220:223], a[60:63], v[80:83], a[220:223]
    v_mfma_f32_16x16x32_bf16 a[228:231], a[60:63], v[88:91], a[228:231]
    s_waitcnt lgkmcnt(4)
    ds_read_b128 v[80:83], v13 offset:36864
    v_mfma_f32_16x16x32_bf16 a[228:231], a[68:71], v[92:95], a[228:231]
    buffer_load_dwordx4 a[136:139], v1, s[12:15], s28 offen offset:0 sc1
    v_mfma_f32_16x16x32_bf16 a[224:227], a[64:67], v[92:95], a[224:227]
    s_waitcnt lgkmcnt(4)
    ds_read_b128 v[84:87], v13 offset:38912
    v_mfma_f32_16x16x32_bf16 a[224:227], a[56:59], v[88:91], a[224:227]
    v_mfma_f32_16x16x32_bf16 a[232:235], a[56:59], v[64:67], a[232:235]
    s_waitcnt lgkmcnt(4)
    ds_read_b128 v[88:91], v13 offset:37120
    v_mfma_f32_16x16x32_bf16 a[232:235], a[64:67], v[68:71], a[232:235]
    buffer_load_dwordx4 a[140:143], v1, s[12:15], s28 offen offset:256 sc1
    v_mfma_f32_16x16x32_bf16 a[236:239], a[68:71], v[68:71], a[236:239]
    s_waitcnt lgkmcnt(4)
    ds_read_b128 v[92:95], v13 offset:39168
    s_add_u32 m0, s22, 65536
    v_mfma_f32_16x16x32_bf16 a[236:239], a[60:63], v[64:67], a[236:239]
    s_add_u32 s16, s16, 16384
    v_mfma_f32_16x16x32_bf16 a[244:247], a[60:63], v[72:75], a[244:247]
    s_waitcnt lgkmcnt(4)
    ds_read_b128 v[64:67], v13 offset:40960
    v_mfma_f32_16x16x32_bf16 a[244:247], a[68:71], v[76:79], a[244:247]
    buffer_load_dwordx4 v4, s[12:15], s16 offen offset:0 lds
    v_mfma_f32_16x16x32_bf16 a[240:243], a[64:67], v[76:79], a[240:243]
    s_waitcnt lgkmcnt(4)
    ds_read_b128 v[68:71], v13 offset:43008
    v_mfma_f32_16x16x32_bf16 a[240:243], a[56:59], v[72:75], a[240:243]
    v_mfma_f32_16x16x32_bf16 v[208:211], a[56:59], v[80:83], v[208:211]
    s_waitcnt lgkmcnt(4)
    ds_read_b128 v[72:75], v13 offset:41216
    v_mfma_f32_16x16x32_bf16 v[208:211], a[64:67], v[84:87], v[208:211]
    buffer_load_dwordx4 v4, s[12:15], s16 offen offset:1024 lds
    v_mfma_f32_16x16x32_bf16 v[212:215], a[68:71], v[84:87], v[212:215]
    s_waitcnt lgkmcnt(4)
    ds_read_b128 v[76:79], v13 offset:43264
    v_mfma_f32_16x16x32_bf16 v[212:215], a[60:63], v[80:83], v[212:215]
    v_mfma_f32_16x16x32_bf16 v[220:223], a[60:63], v[88:91], v[220:223]
    s_waitcnt lgkmcnt(4)
    ds_read_b128 v[80:83], v13 offset:45056
    v_mfma_f32_16x16x32_bf16 v[220:223], a[68:71], v[92:95], v[220:223]
    buffer_load_dwordx4 v4, s[12:15], s16 offen offset:2048 lds
    v_mfma_f32_16x16x32_bf16 v[216:219], a[64:67], v[92:95], v[216:219]
    s_waitcnt lgkmcnt(4)
    ds_read_b128 v[84:87], v13 offset:47104
    v_mfma_f32_16x16x32_bf16 v[216:219], a[56:59], v[88:91], v[216:219]
    v_mfma_f32_16x16x32_bf16 a[168:171], v[176:179], v[64:67], a[168:171]
    s_waitcnt lgkmcnt(4)
    ds_read_b128 v[88:91], v13 offset:45312
    v_mfma_f32_16x16x32_bf16 a[168:171], a[72:75], v[68:71], a[168:171]
    buffer_load_dwordx4 v4, s[12:15], s16 offen offset:3072 lds
    v_mfma_f32_16x16x32_bf16 a[172:175], a[76:79], v[68:71], a[172:175]
    s_waitcnt lgkmcnt(4)
    ds_read_b128 v[92:95], v13 offset:47360
    v_mfma_f32_16x16x32_bf16 a[172:175], v[180:183], v[64:67], a[172:175]
    s_barrier
    v_mfma_f32_16x16x32_bf16 a[180:183], v[180:183], v[72:75], a[180:183]
    s_waitcnt lgkmcnt(4)
    ds_read_b128 v[64:67], v13 offset:49152
    v_mfma_f32_16x16x32_bf16 a[180:183], a[76:79], v[76:79], a[180:183]
    buffer_load_dword v61, v58, s[12:15], s26 offen sc1
    v_mfma_f32_16x16x32_bf16 a[176:179], a[72:75], v[76:79], a[176:179]
    s_waitcnt lgkmcnt(4)
    ds_read_b128 v[68:71], v13 offset:51200
    s_add_u32 m0, s22, 81920
    v_mfma_f32_16x16x32_bf16 a[176:179], v[176:179], v[72:75], a[176:179]
    s_add_u32 s16, s16, 16384
    v_mfma_f32_16x16x32_bf16 a[184:187], v[176:179], v[80:83], a[184:187]
    s_waitcnt lgkmcnt(4)
    ds_read_b128 v[72:75], v13 offset:49408
    v_mfma_f32_16x16x32_bf16 a[184:187], a[72:75], v[84:87], a[184:187]
    buffer_load_dwordx4 v4, s[12:15], s16 offen offset:0 lds
    v_mfma_f32_16x16x32_bf16 a[188:191], a[76:79], v[84:87], a[188:191]
    s_waitcnt lgkmcnt(4)
    ds_read_b128 v[76:79], v13 offset:51456
    v_mfma_f32_16x16x32_bf16 a[188:191], v[180:183], v[80:83], a[188:191]
    v_mfma_f32_16x16x32_bf16 a[196:199], v[180:183], v[88:91], a[196:199]
    s_waitcnt lgkmcnt(4)
    ds_read_b128 v[80:83], v13 offset:53248
    v_mfma_f32_16x16x32_bf16 a[196:199], a[76:79], v[92:95], a[196:199]
    buffer_load_dwordx4 v4, s[12:15], s16 offen offset:1024 lds
    v_mfma_f32_16x16x32_bf16 a[192:195], a[72:75], v[92:95], a[192:195]
    s_waitcnt lgkmcnt(4)
    ds_read_b128 v[84:87], v13 offset:55296
    v_mfma_f32_16x16x32_bf16 a[192:195], v[176:179], v[88:91], a[192:195]
    v_mfma_f32_16x16x32_bf16 a[200:203], v[176:179], v[64:67], a[200:203]
    s_waitcnt lgkmcnt(4)
    ds_read_b128 v[88:91], v13 offset:53504
    v_mfma_f32_16x16x32_bf16 a[200:203], a[72:75], v[68:71], a[200:203]
    buffer_load_dwordx4 v4, s[12:15], s16 offen offset:2048 lds
    v_mfma_f32_16x16x32_bf16 a[204:207], a[76:79], v[68:71], a[204:207]
    s_waitcnt lgkmcnt(4)
    ds_read_b128 v[92:95], v13 offset:55552
    v_mfma_f32_16x16x32_bf16 a[204:207], v[180:183], v[64:67], a[204:207]
    v_mfma_f32_16x16x32_bf16 a[212:215], v[180:183], v[72:75], a[212:215]
    s_waitcnt lgkmcnt(4)
    ds_read_b128 v[64:67], v13 offset:57344
    v_mfma_f32_16x16x32_bf16 a[212:215], a[76:79], v[76:79], a[212:215]
    buffer_load_dwordx4 v4, s[12:15], s16 offen offset:3072 lds
    v_mfma_f32_16x16x32_bf16 a[208:211], a[72:75], v[76:79], a[208:211]
    s_waitcnt lgkmcnt(4)
    ds_read_b128 v[68:71], v13 offset:59392
    v_mfma_f32_16x16x32_bf16 a[208:211], v[176:179], v[72:75], a[208:211]
    v_mfma_f32_16x16x32_bf16 a[216:219], v[176:179], v[80:83], a[216:219]
    s_waitcnt lgkmcnt(4)
    ds_read_b128 v[72:75], v13 offset:57600
    v_mfma_f32_16x16x32_bf16 a[216:219], a[72:75], v[84:87], a[216:219]
    v_mfma_f32_16x16x32_bf16 a[220:223], a[76:79], v[84:87], a[220:223]
    s_waitcnt lgkmcnt(4)
    ds_read_b128 v[76:79], v13 offset:59648
    v_mfma_f32_16x16x32_bf16 a[220:223], v[180:183], v[80:83], a[220:223]
    v_mfma_f32_16x16x32_bf16 a[228:231], v[180:183], v[88:91], a[228:231]
    s_waitcnt lgkmcnt(4)
    ds_read_b128 v[80:83], v13 offset:61440
    v_mfma_f32_16x16x32_bf16 a[228:231], a[76:79], v[92:95], a[228:231]
    v_mfma_f32_16x16x32_bf16 a[224:227], a[72:75], v[92:95], a[224:227]
    s_waitcnt lgkmcnt(4)
    ds_read_b128 v[84:87], v13 offset:63488
    v_mfma_f32_16x16x32_bf16 a[224:227], v[176:179], v[88:91], a[224:227]
    v_mfma_f32_16x16x32_bf16 a[232:235], v[176:179], v[64:67], a[232:235]
    s_waitcnt lgkmcnt(4)
    ds_read_b128 v[88:91], v13 offset:61696
    v_mfma_f32_16x16x32_bf16 a[232:235], a[72:75], v[68:71], a[232:235]
    v_mfma_f32_16x16x32_bf16 a[236:239], a[76:79], v[68:71], a[236:239]
    s_waitcnt lgkmcnt(4)
    ds_read_b128 v[92:95], v13 offset:63744
    v_mfma_f32_16x16x32_bf16 a[236:239], v[180:183], v[64:67], a[236:239]
    s_barrier
    v_mfma_f32_16x16x32_bf16 a[244:247], v[180:183], v[72:75], a[244:247]
    s_waitcnt lgkmcnt(4)
    ds_read_b128 v[64:67], v12 offset:0
    s_add_u32 m0, s22, 98304
    v_mfma_f32_16x16x32_bf16 a[244:247], a[76:79], v[76:79], a[244:247]
    s_add_u32 s16, s16, 16384
    v_mfma_f32_16x16x32_bf16 a[240:243], a[72:75], v[76:79], a[240:243]
    s_waitcnt lgkmcnt(4)
    ds_read_b128 v[68:71], v12 offset:2048
    v_mfma_f32_16x16x32_bf16 a[240:243], v[176:179], v[72:75], a[240:243]
    buffer_load_dwordx4 v4, s[12:15], s16 offen offset:0 lds
    v_mfma_f32_16x16x32_bf16 v[208:211], v[176:179], v[80:83], v[208:211]
    s_waitcnt lgkmcnt(4)
    ds_read_b128 v[72:75], v12 offset:256
    v_mfma_f32_16x16x32_bf16 v[208:211], a[72:75], v[84:87], v[208:211]
    v_mfma_f32_16x16x32_bf16 v[212:215], a[76:79], v[84:87], v[212:215]
    s_waitcnt lgkmcnt(4)
    ds_read_b128 v[76:79], v12 offset:2304
    v_mfma_f32_16x16x32_bf16 v[212:215], v[180:183], v[80:83], v[212:215]
    buffer_load_dwordx4 v4, s[12:15], s16 offen offset:1024 lds
    v_mfma_f32_16x16x32_bf16 v[220:223], v[180:183], v[88:91], v[220:223]
    s_waitcnt lgkmcnt(4)
    ds_read_b128 v[80:83], v12 offset:4096
    v_mfma_f32_16x16x32_bf16 v[220:223], a[76:79], v[92:95], v[220:223]
    v_mfma_f32_16x16x32_bf16 v[216:219], a[72:75], v[92:95], v[216:219]
    s_waitcnt lgkmcnt(4)
    ds_read_b128 v[84:87], v12 offset:6144
    v_mfma_f32_16x16x32_bf16 v[216:219], v[176:179], v[88:91], v[216:219]
    buffer_load_dwordx4 v4, s[12:15], s16 offen offset:2048 lds
    v_mfma_f32_16x16x32_bf16 a[168:171], a[80:83], v[64:67], a[168:171]
    s_waitcnt lgkmcnt(4)
    ds_read_b128 v[88:91], v12 offset:4352
    v_mfma_f32_16x16x32_bf16 a[168:171], a[88:91], v[68:71], a[168:171]
    v_mfma_f32_16x16x32_bf16 a[172:175], a[92:95], v[68:71], a[172:175]
    s_waitcnt lgkmcnt(4)
    ds_read_b128 v[92:95], v12 offset:6400
    v_mfma_f32_16x16x32_bf16 a[172:175], a[84:87], v[64:67], a[172:175]
    buffer_load_dwordx4 v4, s[12:15], s16 offen offset:3072 lds
    v_mfma_f32_16x16x32_bf16 a[180:183], a[84:87], v[72:75], a[180:183]
    s_waitcnt lgkmcnt(4)
    ds_read_b128 v[64:67], v12 offset:8192
    v_lshrrev_b32 v105, 2, v5
    v_mfma_f32_16x16x32_bf16 a[180:183], a[92:95], v[76:79], a[180:183]
    v_lshlrev_b32 v105, 10, v105
    v_mfma_f32_16x16x32_bf16 a[176:179], a[88:91], v[76:79], a[176:179]
    s_waitcnt lgkmcnt(4)
    ds_read_b128 v[68:71], v12 offset:10240
    v_mfma_f32_16x16x32_bf16 a[176:179], a[80:83], v[72:75], a[176:179]
    buffer_load_dword v63, v105, s[12:15], s4 offen
    v_mfma_f32_16x16x32_bf16 a[184:187], a[80:83], v[80:83], a[184:187]
    s_waitcnt lgkmcnt(4)
    ds_read_b128 v[72:75], v12 offset:8448
    v_mfma_f32_16x16x32_bf16 a[184:187], a[88:91], v[84:87], a[184:187]
    v_mfma_f32_16x16x32_bf16 a[188:191], a[92:95], v[84:87], a[188:191]
    s_waitcnt lgkmcnt(4)
    ds_read_b128 v[76:79], v12 offset:10496
    v_mfma_f32_16x16x32_bf16 a[188:191], a[84:87], v[80:83], a[188:191]
    v_mfma_f32_16x16x32_bf16 a[196:199], a[84:87], v[88:91], a[196:199]
    s_waitcnt lgkmcnt(4)
    ds_read_b128 v[80:83], v12 offset:12288
    v_mfma_f32_16x16x32_bf16 a[196:199], a[92:95], v[92:95], a[196:199]
    v_mfma_f32_16x16x32_bf16 a[192:195], a[88:91], v[92:95], a[192:195]
    s_waitcnt lgkmcnt(4)
    ds_read_b128 v[84:87], v12 offset:14336
    v_mfma_f32_16x16x32_bf16 a[192:195], a[80:83], v[88:91], a[192:195]
    v_mfma_f32_16x16x32_bf16 a[200:203], a[80:83], v[64:67], a[200:203]
    s_waitcnt lgkmcnt(4)
    ds_read_b128 v[88:91], v12 offset:12544
    v_mfma_f32_16x16x32_bf16 a[200:203], a[88:91], v[68:71], a[200:203]
    v_mfma_f32_16x16x32_bf16 a[204:207], a[92:95], v[68:71], a[204:207]
    s_waitcnt lgkmcnt(4)
    ds_read_b128 v[92:95], v12 offset:14592
    v_mfma_f32_16x16x32_bf16 a[204:207], a[84:87], v[64:67], a[204:207]
    s_waitcnt vmcnt(29)
    s_barrier
    v_mfma_f32_16x16x32_bf16 a[212:215], a[84:87], v[72:75], a[212:215]
    s_waitcnt lgkmcnt(4)
    ds_read_b128 v[64:67], v12 offset:16384
    s_add_u32 m0, s22, 114688
    v_mfma_f32_16x16x32_bf16 a[212:215], a[92:95], v[76:79], a[212:215]
    s_waitcnt vmcnt(9)
    v_cmp_gt_u32 vcc, 7, v61
    v_mfma_f32_16x16x32_bf16 a[208:211], a[88:91], v[76:79], a[208:211]
    s_waitcnt lgkmcnt(4)
    ds_read_b128 v[68:71], v12 offset:18432
    s_add_u32 s16, s16, 16384
    v_mfma_f32_16x16x32_bf16 a[208:211], a[80:83], v[72:75], a[208:211]
    buffer_load_dwordx4 v4, s[12:15], s16 offen offset:0 lds
    v_mfma_f32_16x16x32_bf16 a[216:219], a[80:83], v[80:83], a[216:219]
    s_waitcnt lgkmcnt(4)
    ds_read_b128 v[72:75], v12 offset:16640
    s_cbranch_vccnz SLOW6_ff_kernel
BACK6_ff_kernel:
    v_mfma_f32_16x16x32_bf16 a[216:219], a[88:91], v[84:87], a[216:219]
    v_mfma_f32_16x16x32_bf16 a[220:223], a[92:95], v[84:87], a[220:223]
    s_waitcnt lgkmcnt(4)
    ds_read_b128 v[76:79], v12 offset:18688
    v_mfma_f32_16x16x32_bf16 a[220:223], a[84:87], v[80:83], a[220:223]
    buffer_load_dwordx4 v4, s[12:15], s16 offen offset:1024 lds
    v_mfma_f32_16x16x32_bf16 a[228:231], a[84:87], v[88:91], a[228:231]
    s_waitcnt lgkmcnt(4)
    ds_read_b128 v[80:83], v12 offset:20480
    s_add_u32 s28, s41, 12288
    v_mfma_f32_16x16x32_bf16 a[228:231], a[92:95], v[92:95], a[228:231]
    v_mfma_f32_16x16x32_bf16 a[224:227], a[88:91], v[92:95], a[224:227]
    s_waitcnt lgkmcnt(4)
    ds_read_b128 v[84:87], v12 offset:22528
    v_mfma_f32_16x16x32_bf16 a[224:227], a[80:83], v[88:91], a[224:227]
    buffer_load_dwordx4 a[144:147], v1, s[12:15], s28 offen offset:0 sc1
    v_mfma_f32_16x16x32_bf16 a[232:235], a[80:83], v[64:67], a[232:235]
    s_waitcnt lgkmcnt(4)
    ds_read_b128 v[88:91], v12 offset:20736
    v_mfma_f32_16x16x32_bf16 a[232:235], a[88:91], v[68:71], a[232:235]
    v_mfma_f32_16x16x32_bf16 a[236:239], a[92:95], v[68:71], a[236:239]
    s_waitcnt lgkmcnt(4)
    ds_read_b128 v[92:95], v12 offset:22784
    v_mfma_f32_16x16x32_bf16 a[236:239], a[84:87], v[64:67], a[236:239]
    buffer_load_dwordx4 a[148:151], v1, s[12:15], s28 offen offset:256 sc1
    v_mfma_f32_16x16x32_bf16 a[244:247], a[84:87], v[72:75], a[244:247]
    s_waitcnt lgkmcnt(4)
    ds_read_b128 v[64:67], v12 offset:24576
    s_add_u32 s28, s42, 12288
    v_mfma_f32_16x16x32_bf16 a[244:247], a[92:95], v[76:79], a[244:247]
    v_mfma_f32_16x16x32_bf16 a[240:243], a[88:91], v[76:79], a[240:243]
    s_waitcnt lgkmcnt(4)
    ds_read_b128 v[68:71], v12 offset:26624
    v_mfma_f32_16x16x32_bf16 a[240:243], a[80:83], v[72:75], a[240:243]
    buffer_load_dwordx4 a[152:155], v1, s[12:15], s28 offen offset:0 sc1
    v_mfma_f32_16x16x32_bf16 v[208:211], a[80:83], v[80:83], v[208:211]
    s_waitcnt lgkmcnt(4)
    ds_read_b128 v[72:75], v12 offset:24832
    v_mfma_f32_16x16x32_bf16 v[208:211], a[88:91], v[84:87], v[208:211]
    v_mfma_f32_16x16x32_bf16 v[212:215], a[92:95], v[84:87], v[212:215]
    s_waitcnt lgkmcnt(4)
    ds_read_b128 v[76:79], v12 offset:26880
    v_mfma_f32_16x16x32_bf16 v[212:215], a[84:87], v[80:83], v[212:215]
    buffer_load_dwordx4 a[156:159], v1, s[12:15], s28 offen offset:256 sc1
    v_mfma_f32_16x16x32_bf16 v[220:223], a[84:87], v[88:91], v[220:223]
    s_waitcnt lgkmcnt(4)
    ds_read_b128 v[80:83], v12 offset:28672
    s_add_u32 s28, s43, 12288
    v_mfma_f32_16x16x32_bf16 v[220:223], a[92:95], v[92:95], v[220:223]
    v_mfma_f32_16x16x32_bf16 v[216:219], a[88:91], v[92:95], v[216:219]
    s_waitcnt lgkmcnt(4)
    ds_read_b128 v[84:87], v12 offset:30720
    v_mfma_f32_16x16x32_bf16 v[216:219], a[80:83], v[88:91], v[216:219]
    buffer_load_dwordx4 a[160:163], v1, s[12:15], s28 offen offset:0 sc1
    v_mfma_f32_16x16x32_bf16 a[168:171], v[192:195], v[64:67], a[168:171]
    s_waitcnt lgkmcnt(4)
    ds_read_b128 v[88:91], v12 offset:28928
    v_mfma_f32_16x16x32_bf16 a[168:171], a[96:99], v[68:71], a[168:171]
    v_mfma_f32_16x16x32_bf16 a[172:175], a[100:103], v[68:71], a[172:175]
    s_waitcnt lgkmcnt(4)
    ds_read_b128 v[92:95], v12 offset:30976
    v_mfma_f32_16x16x32_bf16 a[172:175], v[196:199], v[64:67], a[172:175]
    s_barrier
    v_mfma_f32_16x16x32_bf16 a[180:183], v[196:199], v[72:75], a[180:183]
    s_waitcnt lgkmcnt(4)
    ds_read_b128 v[64:67], v12 offset:32768
    v_mfma_f32_16x16x32_bf16 a[180:183], a[100:103], v[76:79], a[180:183]
    buffer_load_dwordx4 a[164:167], v1, s[12:15], s28 offen offset:256 sc1
    v_mfma_f32_16x16x32_bf16 a[176:179], a[96:99], v[76:79], a[176:179]
    s_waitcnt lgkmcnt(4)
    ds_read_b128 v[68:71], v12 offset:34816
    v_mfma_f32_16x16x32_bf16 a[176:179], v[192:195], v[72:75], a[176:179]
    v_mfma_f32_16x16x32_bf16 a[184:187], v[192:195], v[80:83], a[184:187]
    s_waitcnt lgkmcnt(4)
    ds_read_b128 v[72:75], v12 offset:33024
    v_mfma_f32_16x16x32_bf16 a[184:187], a[96:99], v[84:87], a[184:187]
    buffer_load_dwordx4 v4, s[12:15], s16 offen offset:2048 lds
    v_mfma_f32_16x16x32_bf16 a[188:191], a[100:103], v[84:87], a[188:191]
    s_waitcnt lgkmcnt(4)
    ds_read_b128 v[76:79], v12 offset:35072
    v_mfma_f32_16x16x32_bf16 a[188:191], v[196:199], v[80:83], a[188:191]
    v_mfma_f32_16x16x32_bf16 a[196:199], v[196:199], v[88:91], a[196:199]
    s_waitcnt lgkmcnt(4)
    ds_read_b128 v[80:83], v12 offset:36864
    v_mfma_f32_16x16x32_bf16 a[196:199], a[100:103], v[92:95], a[196:199]
    buffer_load_dwordx4 v4, s[12:15], s16 offen offset:3072 lds
    v_mfma_f32_16x16x32_bf16 a[192:195], a[96:99], v[92:95], a[192:195]
    s_waitcnt lgkmcnt(4)
    ds_read_b128 v[84:87], v12 offset:38912
    s_add_u32 s4, s4, 16384
    v_mfma_f32_16x16x32_bf16 a[192:195], v[192:195], v[88:91], a[192:195]
    v_mfma_f32_16x16x32_bf16 a[200:203], v[192:195], v[64:67], a[200:203]
    s_waitcnt lgkmcnt(4)
    ds_read_b128 v[88:91], v12 offset:37120
    v_mfma_f32_16x16x32_bf16 a[200:203], a[96:99], v[68:71], a[200:203]
    buffer_load_dword v63, v105, s[12:15], s4 offen
    v_mfma_f32_16x16x32_bf16 a[204:207], a[100:103], v[68:71], a[204:207]
    s_waitcnt lgkmcnt(4)
    ds_read_b128 v[92:95], v12 offset:39168
    s_add_u32 m0, s22, 0
    v_mfma_f32_16x16x32_bf16 a[204:207], v[196:199], v[64:67], a[204:207]
    s_add_u32 s16, s16, 16384
    v_mfma_f32_16x16x32_bf16 a[212:215], v[196:199], v[72:75], a[212:215]
    s_waitcnt lgkmcnt(4)
    ds_read_b128 v[64:67], v12 offset:40960
    v_mfma_f32_16x16x32_bf16 a[212:215], a[100:103], v[76:79], a[212:215]
    buffer_load_dwordx4 v4, s[12:15], s16 offen offset:0 lds
    v_mfma_f32_16x16x32_bf16 a[208:211], a[96:99], v[76:79], a[208:211]
    s_waitcnt lgkmcnt(4)
    ds_read_b128 v[68:71], v12 offset:43008
    v_mfma_f32_16x16x32_bf16 a[208:211], v[192:195], v[72:75], a[208:211]
    v_mfma_f32_16x16x32_bf16 a[216:219], v[192:195], v[80:83], a[216:219]
    s_waitcnt lgkmcnt(4)
    ds_read_b128 v[72:75], v12 offset:41216
    v_mfma_f32_16x16x32_bf16 a[216:219], a[96:99], v[84:87], a[216:219]
    buffer_load_dwordx4 v4, s[12:15], s16 offen offset:1024 lds
    v_mfma_f32_16x16x32_bf16 a[220:223], a[100:103], v[84:87], a[220:223]
    s_waitcnt lgkmcnt(4)
    ds_read_b128 v[76:79], v12 offset:43264
    v_mfma_f32_16x16x32_bf16 a[220:223], v[196:199], v[80:83], a[220:223]
    v_mfma_f32_16x16x32_bf16 a[228:231], v[196:199], v[88:91], a[228:231]
    s_waitcnt lgkmcnt(4)
    ds_read_b128 v[80:83], v12 offset:45056
    v_mfma_f32_16x16x32_bf16 a[228:231], a[100:103], v[92:95], a[228:231]
    buffer_load_dwordx4 v4, s[12:15], s16 offen offset:2048 lds
    v_mfma_f32_16x16x32_bf16 a[224:227], a[96:99], v[92:95], a[224:227]
    s_waitcnt lgkmcnt(4)
    ds_read_b128 v[84:87], v12 offset:47104
    v_mfma_f32_16x16x32_bf16 a[224:227], v[192:195], v[88:91], a[224:227]
    v_mfma_f32_16x16x32_bf16 a[232:235], v[192:195], v[64:67], a[232:235]
    s_waitcnt lgkmcnt(4)
    ds_read_b128 v[88:91], v12 offset:45312
    v_mfma_f32_16x16x32_bf16 a[232:235], a[96:99], v[68:71], a[232:235]
    buffer_load_dwordx4 v4, s[12:15], s16 offen offset:3072 lds
    v_mfma_f32_16x16x32_bf16 a[236:239], a[100:103], v[68:71], a[236:239]
    s_waitcnt lgkmcnt(4)
    ds_read_b128 v[92:95], v12 offset:47360
    v_mfma_f32_16x16x32_bf16 a[236:239], v[196:199], v[64:67], a[236:239]
    s_barrier
    v_mfma_f32_16x16x32_bf16 a[244:247], v[196:199], v[72:75], a[244:247]
    s_waitcnt lgkmcnt(4)
    ds_read_b128 v[64:67], v12 offset:49152
    s_add_u32 m0, s22, 16384
    v_mfma_f32_16x16x32_bf16 a[244:247], a[100:103], v[76:79], a[244:247]
    s_add_u32 s16, s16, 16384
    v_mfma_f32_16x16x32_bf16 a[240:243], a[96:99], v[76:79], a[240:243]
    s_waitcnt lgkmcnt(4)
    ds_read_b128 v[68:71], v12 offset:51200
    v_mfma_f32_16x16x32_bf16 a[240:243], v[192:195], v[72:75], a[240:243]
    buffer_load_dwordx4 v4, s[12:15], s16 offen offset:0 lds
    v_mfma_f32_16x16x32_bf16 v[208:211], v[192:195], v[80:83], v[208:211]
    s_waitcnt lgkmcnt(4)
    ds_read_b128 v[72:75], v12 offset:49408
    v_mfma_f32_16x16x32_bf16 v[208:211], a[96:99], v[84:87], v[208:211]
    v_mfma_f32_16x16x32_bf16 v[212:215], a[100:103], v[84:87], v[212:215]
    s_waitcnt lgkmcnt(4)
    ds_read_b128 v[76:79], v12 offset:51456
    v_mfma_f32_16x16x32_bf16 v[212:215], v[196:199], v[80:83], v[212:215]
    buffer_load_dwordx4 v4, s[12:15], s16 offen offset:1024 lds
    v_mfma_f32_16x16x32_bf16 v[220:223], v[196:199], v[88:91], v[220:223]
    s_waitcnt lgkmcnt(4)
    ds_read_b128 v[80:83], v12 offset:53504
    v_mfma_f32_16x16x32_bf16 v[220:223], a[100:103], v[92:95], v[220:223]
    v_mfma_f32_16x16x32_bf16 v[216:219], a[96:99], v[92:95], v[216:219]
    s_waitcnt lgkmcnt(4)
    ds_read_b128 v[84:87], v12 offset:55552
    v_mfma_f32_16x16x32_bf16 v[216:219], v[192:195], v[88:91], v[216:219]
    buffer_load_dwordx4 v4, s[12:15], s16 offen offset:2048 lds
    v_mfma_f32_16x16x32_bf16 a[168:171], a[104:107], v[64:67], a[168:171]
    s_waitcnt lgkmcnt(4)
    ds_read_b128 v[88:91], v12 offset:53248
    v_mfma_f32_16x16x32_bf16 a[168:171], a[112:115], v[68:71], a[168:171]
    v_mfma_f32_16x16x32_bf16 a[172:175], a[116:119], v[68:71], a[172:175]
    s_waitcnt lgkmcnt(4)
    ds_read_b128 v[92:95], v12 offset:55296
    v_mfma_f32_16x16x32_bf16 a[172:175], a[108:111], v[64:67], a[172:175]
    buffer_load_dwordx4 v4, s[12:15], s16 offen offset:3072 lds
    v_mfma_f32_16x16x32_bf16 a[180:183], a[108:111], v[72:75], a[180:183]
    s_waitcnt lgkmcnt(4)
    ds_read_b128 v[64:67], v12 offset:57344
    v_mfma_f32_16x16x32_bf16 a[180:183], a[116:119], v[76:79], a[180:183]
    v_mfma_f32_16x16x32_bf16 a[176:179], a[112:115], v[76:79], a[176:179]
    s_waitcnt lgkmcnt(4)
    ds_read_b128 v[68:71], v12 offset:59392
    v_mfma_f32_16x16x32_bf16 a[176:179], a[104:107], v[72:75], a[176:179]
    v_mfma_f32_16x16x32_bf16 a[176:179], a[120:123], v[80:83], a[176:179]
    s_waitcnt lgkmcnt(4)
    ds_read_b128 v[72:75], v12 offset:57600
    v_mfma_f32_16x16x32_bf16 a[176:179], a[128:131], v[84:87], a[176:179]
    v_mfma_f32_16x16x32_bf16 a[180:183], a[132:135], v[84:87], a[180:183]
    s_waitcnt lgkmcnt(4)
    ds_read_b128 v[76:79], v12 offset:59648
    v_mfma_f32_16x16x32_bf16 a[180:183], a[124:127], v[80:83], a[180:183]
    v_mfma_f32_16x16x32_bf16 a[172:175], a[124:127], v[88:91], a[172:175]
    s_waitcnt lgkmcnt(4)
    ds_read_b128 v[80:83], v12 offset:61696
    v_mfma_f32_16x16x32_bf16 a[172:175], a[132:135], v[92:95], a[172:175]
    v_mfma_f32_16x16x32_bf16 a[168:171], a[128:131], v[92:95], a[168:171]
    s_waitcnt lgkmcnt(4)
    ds_read_b128 v[84:87], v12 offset:63744
    v_mfma_f32_16x16x32_bf16 a[168:171], a[120:123], v[88:91], a[168:171]
    v_mfma_f32_16x16x32_bf16 a[168:171], a[136:139], v[64:67], a[168:171]
    s_waitcnt vmcnt(16) lgkmcnt(4)
    ds_read_b128 v[88:91], v12 offset:61440
    v_mfma_f32_16x16x32_bf16 a[168:171], a[144:147], v[68:71], a[168:171]
    s_waitcnt vmcnt(15)
    v_mfma_f32_16x16x32_bf16 a[172:175], a[148:151], v[68:71], a[172:175]
    s_waitcnt lgkmcnt(4)
    ds_read_b128 v[92:95], v12 offset:63488
    v_mfma_f32_16x16x32_bf16 a[172:175], a[140:143], v[64:67], a[172:175]
    s_barrier
    v_mfma_f32_16x16x32_bf16 a[180:183], a[140:143], v[72:75], a[180:183]
    s_waitcnt lgkmcnt(4)
    ds_read_b128 v[64:67], v13 offset:0
    s_add_u32 m0, s22, 32768
    v_mfma_f32_16x16x32_bf16 a[180:183], a[148:151], v[76:79], a[180:183]
    s_add_u32 s16, s16, 16384
    v_mfma_f32_16x16x32_bf16 a[176:179], a[144:147], v[76:79], a[176:179]
    s_waitcnt lgkmcnt(4)
    ds_read_b128 v[68:71], v13 offset:2048
    v_mfma_f32_16x16x32_bf16 a[176:179], a[136:139], v[72:75], a[176:179]
    s_waitcnt vmcnt(14)
    buffer_load_dwordx4 v4, s[12:15], s16 offen offset:0 lds
    v_mfma_f32_16x16x32_bf16 a[176:179], a[152:155], v[80:83], a[176:179]
    s_waitcnt vmcnt(13) lgkmcnt(4)
    ds_read_b128 v[72:75], v13 offset:256
    v_mfma_f32_16x16x32_bf16 a[176:179], a[160:163], v[84:87], a[176:179]
    s_waitcnt vmcnt(12)
    v_mfma_f32_16x16x32_bf16 a[180:183], a[164:167], v[84:87], a[180:183]
    s_waitcnt lgkmcnt(4)
    ds_read_b128 v[76:79], v13 offset:2304
    v_mfma_f32_16x16x32_bf16 a[180:183], a[156:159], v[80:83], a[180:183]
    buffer_load_dwordx4 v4, s[12:15], s16 offen offset:1024 lds
    v_mfma_f32_16x16x32_bf16 a[172:175], a[156:159], v[88:91], a[172:175]
    s_waitcnt lgkmcnt(4)
    ds_read_b128 v[80:83], v13 offset:4352
    v_mfma_f32_16x16x32_bf16 a[172:175], a[164:167], v[92:95], a[172:175]
    v_mfma_f32_16x16x32_bf16 a[168:171], a[160:163], v[92:95], a[168:171]
    s_waitcnt lgkmcnt(4)
    ds_read_b128 v[84:87], v13 offset:6400
    v_mfma_f32_16x16x32_bf16 a[168:171], a[152:155], v[88:91], a[168:171]
    buffer_load_dwordx4 v4, s[12:15], s16 offen offset:2048 lds
    v_mfma_f32_16x16x32_bf16 a[184:187], a[104:107], v[64:67], a[184:187]
    s_waitcnt lgkmcnt(4)
    ds_read_b128 v[88:91], v13 offset:4096
    v_mfma_f32_16x16x32_bf16 a[184:187], a[112:115], v[68:71], a[184:187]
    v_mfma_f32_16x16x32_bf16 a[188:191], a[116:119], v[68:71], a[188:191]
    s_waitcnt lgkmcnt(4)
    ds_read_b128 v[92:95], v13 offset:6144
    v_mfma_f32_16x16x32_bf16 a[188:191], a[108:111], v[64:67], a[188:191]
    buffer_load_dwordx4 v4, s[12:15], s16 offen offset:3072 lds
    v_mfma_f32_16x16x32_bf16 a[196:199], a[108:111], v[72:75], a[196:199]
    s_waitcnt lgkmcnt(4)
    ds_read_b128 v[64:67], v13 offset:8192
    v_mfma_f32_16x16x32_bf16 a[196:199], a[116:119], v[76:79], a[196:199]
    v_mfma_f32_16x16x32_bf16 a[192:195], a[112:115], v[76:79], a[192:195]
    s_waitcnt lgkmcnt(4)
    ds_read_b128 v[68:71], v13 offset:10240
    v_mfma_f32_16x16x32_bf16 a[192:195], a[104:107], v[72:75], a[192:195]
    v_accvgpr_read_b32 v24, a168
    v_accvgpr_read_b32 v25, a169
    v_mfma_f32_16x16x32_bf16 a[192:195], a[120:123], v[80:83], a[192:195]
    s_waitcnt lgkmcnt(4)
    ds_read_b128 v[72:75], v13 offset:8448
    v_accvgpr_read_b32 v26, a170
    v_mfma_f32_16x16x32_bf16 a[192:195], a[128:131], v[84:87], a[192:195]
    v_accvgpr_read_b32 v27, a171
    v_accvgpr_read_b32 v28, a172
    v_mfma_f32_16x16x32_bf16 a[196:199], a[132:135], v[84:87], a[196:199]
    s_waitcnt lgkmcnt(4)
    ds_read_b128 v[76:79], v13 offset:10496
    v_accvgpr_read_b32 v29, a173
    v_mfma_f32_16x16x32_bf16 a[196:199], a[124:127], v[80:83], a[196:199]
    v_accvgpr_read_b32 v30, a174
    v_accvgpr_read_b32 v31, a175
    v_mfma_f32_16x16x32_bf16 a[188:191], a[124:127], v[88:91], a[188:191]
    s_waitcnt lgkmcnt(4)
    ds_read_b128 v[80:83], v13 offset:12544
    v_cvt_pk_bf16_f32 v40, v24, v25
    v_mfma_f32_16x16x32_bf16 a[188:191], a[132:135], v[92:95], a[188:191]
    v_cvt_pk_bf16_f32 v41, v26, v27
    v_cvt_pk_bf16_f32 v42, v28, v29
    v_mfma_f32_16x16x32_bf16 a[184:187], a[128:131], v[92:95], a[184:187]
    s_waitcnt lgkmcnt(4)
    ds_read_b128 v[84:87], v13 offset:14592
    v_cvt_pk_bf16_f32 v43, v30, v31
    v_mfma_f32_16x16x32_bf16 a[184:187], a[120:123], v[88:91], a[184:187]
    buffer_store_dwordx4 v[40:43], v4, s[12:15], s24 offen offset:0 sc1
    v_mfma_f32_16x16x32_bf16 a[184:187], a[136:139], v[64:67], a[184:187]
    s_waitcnt lgkmcnt(4)
    ds_read_b128 v[88:91], v13 offset:12288
    s_nop 0
    v_mfma_f32_16x16x32_bf16 a[184:187], a[144:147], v[68:71], a[184:187]
    v_accvgpr_read_b32 v32, a176
    v_accvgpr_read_b32 v33, a177
    v_mfma_f32_16x16x32_bf16 a[188:191], a[148:151], v[68:71], a[188:191]
    s_waitcnt lgkmcnt(4)
    ds_read_b128 v[92:95], v13 offset:14336
    v_accvgpr_read_b32 v34, a178
    v_mfma_f32_16x16x32_bf16 a[188:191], a[140:143], v[64:67], a[188:191]
    s_barrier
    v_mfma_f32_16x16x32_bf16 a[196:199], a[140:143], v[72:75], a[196:199]
    s_waitcnt lgkmcnt(4)
    ds_read_b128 v[64:67], v13 offset:16384
    s_add_u32 m0, s22, 49152
    v_mfma_f32_16x16x32_bf16 a[196:199], a[148:151], v[76:79], a[196:199]
    s_add_u32 s16, s16, 16384
    v_accvgpr_read_b32 v35, a179
    v_accvgpr_read_b32 v36, a180
    v_mfma_f32_16x16x32_bf16 a[192:195], a[144:147], v[76:79], a[192:195]
    s_waitcnt lgkmcnt(4)
    ds_read_b128 v[68:71], v13 offset:18432
    v_accvgpr_read_b32 v37, a181
    v_mfma_f32_16x16x32_bf16 a[192:195], a[136:139], v[72:75], a[192:195]
    buffer_load_dwordx4 v4, s[12:15], s16 offen offset:0 lds
    v_mfma_f32_16x16x32_bf16 a[192:195], a[152:155], v[80:83], a[192:195]
    s_waitcnt lgkmcnt(4)
    ds_read_b128 v[72:75], v13 offset:16640
    v_accvgpr_read_b32 v38, a182
    v_mfma_f32_16x16x32_bf16 a[192:195], a[160:163], v[84:87], a[192:195]
    v_accvgpr_read_b32 v39, a183
    v_cvt_pk_bf16_f32 v44, v32, v33
    v_mfma_f32_16x16x32_bf16 a[196:199], a[164:167], v[84:87], a[196:199]
    s_waitcnt lgkmcnt(4)
    ds_read_b128 v[76:79], v13 offset:18688
    v_cvt_pk_bf16_f32 v45, v34, v35
    v_mfma_f32_16x16x32_bf16 a[196:199], a[156:159], v[80:83], a[196:199]
    buffer_load_dwordx4 v4, s[12:15], s16 offen offset:1024 lds
    v_mfma_f32_16x16x32_bf16 a[188:191], a[156:159], v[88:91], a[188:191]
    s_waitcnt lgkmcnt(4)
    ds_read_b128 v[80:83], v13 offset:20736
    v_cvt_pk_bf16_f32 v46, v36, v37
    v_mfma_f32_16x16x32_bf16 a[188:191], a[164:167], v[92:95], a[188:191]
    v_cvt_pk_bf16_f32 v47, v38, v39
    v_mfma_f32_16x16x32_bf16 a[184:187], a[160:163], v[92:95], a[184:187]
    s_waitcnt lgkmcnt(4)
    ds_read_b128 v[84:87], v13 offset:22784
    v_mfma_f32_16x16x32_bf16 a[184:187], a[152:155], v[88:91], a[184:187]
    buffer_store_dwordx4 v[44:47], v4, s[12:15], s24 offen offset:1024 sc1
    v_mfma_f32_16x16x32_bf16 a[200:203], a[104:107], v[64:67], a[200:203]
    s_waitcnt lgkmcnt(4)
    ds_read_b128 v[88:91], v13 offset:20480
    s_nop 0
    v_mfma_f32_16x16x32_bf16 a[200:203], a[112:115], v[68:71], a[200:203]
    v_mfma_f32_16x16x32_bf16 a[204:207], a[116:119], v[68:71], a[204:207]
    s_waitcnt lgkmcnt(4)
    ds_read_b128 v[92:95], v13 offset:22528
    v_mfma_f32_16x16x32_bf16 a[204:207], a[108:111], v[64:67], a[204:207]
    buffer_load_dwordx4 v4, s[12:15], s16 offen offset:2048 lds
    v_mfma_f32_16x16x32_bf16 a[212:215], a[108:111], v[72:75], a[212:215]
    s_waitcnt lgkmcnt(4)
    ds_read_b128 v[64:67], v13 offset:24576
    v_mfma_f32_16x16x32_bf16 a[212:215], a[116:119], v[76:79], a[212:215]
    v_mfma_f32_16x16x32_bf16 a[208:211], a[112:115], v[76:79], a[208:211]
    s_waitcnt lgkmcnt(4)
    ds_read_b128 v[68:71], v13 offset:26624
    v_mfma_f32_16x16x32_bf16 a[208:211], a[104:107], v[72:75], a[208:211]
    buffer_load_dwordx4 v4, s[12:15], s16 offen offset:3072 lds
    v_mfma_f32_16x16x32_bf16 a[208:211], a[120:123], v[80:83], a[208:211]
    s_waitcnt lgkmcnt(4)
    ds_read_b128 v[72:75], v13 offset:24832
    v_accvgpr_read_b32 v24, a184
    v_mfma_f32_16x16x32_bf16 a[208:211], a[128:131], v[84:87], a[208:211]
    v_accvgpr_read_b32 v25, a185
    v_accvgpr_read_b32 v26, a186
    v_mfma_f32_16x16x32_bf16 a[212:215], a[132:135], v[84:87], a[212:215]
    s_waitcnt lgkmcnt(4)
    ds_read_b128 v[76:79], v13 offset:26880
    v_accvgpr_read_b32 v27, a187
    v_mfma_f32_16x16x32_bf16 a[212:215], a[124:127], v[80:83], a[212:215]
    v_accvgpr_read_b32 v28, a188
    v_accvgpr_read_b32 v29, a189
    v_mfma_f32_16x16x32_bf16 a[204:207], a[124:127], v[88:91], a[204:207]
    s_waitcnt lgkmcnt(4)
    ds_read_b128 v[80:83], v13 offset:28928
    v_accvgpr_read_b32 v30, a190
    v_mfma_f32_16x16x32_bf16 a[204:207], a[132:135], v[92:95], a[204:207]
    v_accvgpr_read_b32 v31, a191
    v_cvt_pk_bf16_f32 v48, v24, v25
    v_mfma_f32_16x16x32_bf16 a[200:203], a[128:131], v[92:95], a[200:203]
    s_waitcnt lgkmcnt(4)
    ds_read_b128 v[84:87], v13 offset:30976
    v_cvt_pk_bf16_f32 v49, v26, v27
    v_mfma_f32_16x16x32_bf16 a[200:203], a[120:123], v[88:91], a[200:203]
    v_cvt_pk_bf16_f32 v50, v28, v29
    v_cvt_pk_bf16_f32 v51, v30, v31
    v_mfma_f32_16x16x32_bf16 a[200:203], a[136:139], v[64:67], a[200:203]
    s_waitcnt lgkmcnt(4)
    ds_read_b128 v[88:91], v13 offset:28672
    v_accvgpr_read_b32 v32, a192
    v_mfma_f32_16x16x32_bf16 a[200:203], a[144:147], v[68:71], a[200:203]
    buffer_store_dwordx4 v[48:51], v4, s[12:15], s24 offen offset:2048 sc1
    v_mfma_f32_16x16x32_bf16 a[204:207], a[148:151], v[68:71], a[204:207]
    s_waitcnt lgkmcnt(4)
    ds_read_b128 v[92:95], v13 offset:30720
    s_nop 0
    v_mfma_f32_16x16x32_bf16 a[204:207], a[140:143], v[64:67], a[204:207]
    s_barrier
    v_mfma_f32_16x16x32_bf16 a[212:215], a[140:143], v[72:75], a[212:215]
    s_waitcnt lgkmcnt(4)
    ds_read_b128 v[64:67], v13 offset:32768
    s_add_u32 m0, s22, 65536
    v_mfma_f32_16x16x32_bf16 a[212:215], a[148:151], v[76:79], a[212:215]
    s_add_u32 s16, s16, 16384
    v_accvgpr_read_b32 v33, a193
    v_accvgpr_read_b32 v34, a194
    v_mfma_f32_16x16x32_bf16 a[208:211], a[144:147], v[76:79], a[208:211]
    s_waitcnt lgkmcnt(4)
    ds_read_b128 v[68:71], v13 offset:34816
    v_accvgpr_read_b32 v35, a195
    v_mfma_f32_16x16x32_bf16 a[208:211], a[136:139], v[72:75], a[208:211]
    buffer_load_dwordx4 v4, s[12:15], s16 offen offset:0 lds
    v_mfma_f32_16x16x32_bf16 a[208:211], a[152:155], v[80:83], a[208:211]
    s_waitcnt lgkmcnt(4)
    ds_read_b128 v[72:75], v13 offset:33024
    v_accvgpr_read_b32 v36, a196
    v_mfma_f32_16x16x32_bf16 a[208:211], a[160:163], v[84:87], a[208:211]
    v_accvgpr_read_b32 v37, a197
    v_accvgpr_read_b32 v38, a198
    v_mfma_f32_16x16x32_bf16 a[212:215], a[164:167], v[84:87], a[212:215]
    s_waitcnt lgkmcnt(4)
    ds_read_b128 v[76:79], v13 offset:35072
    v_accvgpr_read_b32 v39, a199
    v_mfma_f32_16x16x32_bf16 a[212:215], a[156:159], v[80:83], a[212:215]
    buffer_load_dwordx4 v4, s[12:15], s16 offen offset:1024 lds
    v_mfma_f32_16x16x32_bf16 a[204:207], a[156:159], v[88:91], a[204:207]
    s_waitcnt lgkmcnt(4)
    ds_read_b128 v[80:83], v13 offset:37120
    v_cvt_pk_bf16_f32 v52, v32, v33
    v_mfma_f32_16x16x32_bf16 a[204:207], a[164:167], v[92:95], a[204:207]
    v_cvt_pk_bf16_f32 v53, v34, v35
    v_cvt_pk_bf16_f32 v54, v36, v37
    v_mfma_f32_16x16x32_bf16 a[200:203], a[160:163], v[92:95], a[200:203]
    s_waitcnt lgkmcnt(4)
    ds_read_b128 v[84:87], v13 offset:39168
    v_cvt_pk_bf16_f32 v55, v38, v39
    v_mfma_f32_16x16x32_bf16 a[200:203], a[152:155], v[88:91], a[200:203]
    buffer_store_dwordx4 v[52:55], v4, s[12:15], s24 offen offset:3072 sc1
    v_mfma_f32_16x16x32_bf16 a[216:219], a[104:107], v[64:67], a[216:219]
    s_waitcnt lgkmcnt(4)
    ds_read_b128 v[88:91], v13 offset:36864
    s_nop 0
    v_mfma_f32_16x16x32_bf16 a[216:219], a[112:115], v[68:71], a[216:219]
    v_mfma_f32_16x16x32_bf16 a[220:223], a[116:119], v[68:71], a[220:223]
    s_waitcnt lgkmcnt(4)
    ds_read_b128 v[92:95], v13 offset:38912
    v_mfma_f32_16x16x32_bf16 a[220:223], a[108:111], v[64:67], a[220:223]
    buffer_load_dwordx4 v4, s[12:15], s16 offen offset:2048 lds
    v_mfma_f32_16x16x32_bf16 a[228:231], a[108:111], v[72:75], a[228:231]
    s_waitcnt lgkmcnt(4)
    ds_read_b128 v[64:67], v13 offset:40960
    v_mfma_f32_16x16x32_bf16 a[228:231], a[116:119], v[76:79], a[228:231]
    v_mfma_f32_16x16x32_bf16 a[224:227], a[112:115], v[76:79], a[224:227]
    s_waitcnt lgkmcnt(4)
    ds_read_b128 v[68:71], v13 offset:43008
    v_mfma_f32_16x16x32_bf16 a[224:227], a[104:107], v[72:75], a[224:227]
    buffer_load_dwordx4 v4, s[12:15], s16 offen offset:3072 lds
    v_mfma_f32_16x16x32_bf16 a[224:227], a[120:123], v[80:83], a[224:227]
    s_waitcnt lgkmcnt(4)
    ds_read_b128 v[72:75], v13 offset:41216
    v_accvgpr_read_b32 v24, a200
    v_mfma_f32_16x16x32_bf16 a[224:227], a[128:131], v[84:87], a[224:227]
    v_accvgpr_read_b32 v25, a201
    v_accvgpr_read_b32 v26, a202
    v_mfma_f32_16x16x32_bf16 a[228:231], a[132:135], v[84:87], a[228:231]
    s_waitcnt lgkmcnt(4)
    ds_read_b128 v[76:79], v13 offset:43264
    v_accvgpr_read_b32 v27, a203
    v_mfma_f32_16x16x32_bf16 a[228:231], a[124:127], v[80:83], a[228:231]
    v_accvgpr_read_b32 v28, a204
    v_accvgpr_read_b32 v29, a205
    v_mfma_f32_16x16x32_bf16 a[220:223], a[124:127], v[88:91], a[220:223]
    s_waitcnt lgkmcnt(4)
    ds_read_b128 v[80:83], v13 offset:45312
    v_accvgpr_read_b32 v30, a206
    v_mfma_f32_16x16x32_bf16 a[220:223], a[132:135], v[92:95], a[220:223]
    v_accvgpr_read_b32 v31, a207
    v_cvt_pk_bf16_f32 v40, v24, v25
    v_mfma_f32_16x16x32_bf16 a[216:219], a[128:131], v[92:95], a[216:219]
    s_waitcnt lgkmcnt(4)
    ds_read_b128 v[84:87], v13 offset:47360
    v_cvt_pk_bf16_f32 v41, v26, v27
    v_mfma_f32_16x16x32_bf16 a[216:219], a[120:123], v[88:91], a[216:219]
    v_cvt_pk_bf16_f32 v42, v28, v29
    v_cvt_pk_bf16_f32 v43, v30, v31
    v_mfma_f32_16x16x32_bf16 a[216:219], a[136:139], v[64:67], a[216:219]
    s_waitcnt lgkmcnt(4)
    ds_read_b128 v[88:91], v13 offset:45056
    v_accvgpr_read_b32 v32, a208
    v_mfma_f32_16x16x32_bf16 a[216:219], a[144:147], v[68:71], a[216:219]
    buffer_store_dwordx4 v[40:43], v4, s[12:15], s29 offen offset:0 sc1
    v_mfma_f32_16x16x32_bf16 a[220:223], a[148:151], v[68:71], a[220:223]
    s_waitcnt lgkmcnt(4)
    ds_read_b128 v[92:95], v13 offset:47104
    s_nop 0
    v_mfma_f32_16x16x32_bf16 a[220:223], a[140:143], v[64:67], a[220:223]
    s_waitcnt vmcnt(26)
    s_barrier
    v_mfma_f32_16x16x32_bf16 a[228:231], a[140:143], v[72:75], a[228:231]
    s_waitcnt lgkmcnt(4)
    ds_read_b128 v[64:67], v13 offset:49152
    s_add_u32 m0, s22, 81920
    v_mfma_f32_16x16x32_bf16 a[228:231], a[148:151], v[76:79], a[228:231]
    s_add_u32 s16, s16, 16384
    v_accvgpr_read_b32 v33, a209
    v_accvgpr_read_b32 v34, a210
    v_mfma_f32_16x16x32_bf16 a[224:227], a[144:147], v[76:79], a[224:227]
    s_waitcnt lgkmcnt(4)
    ds_read_b128 v[68:71], v13 offset:51200
    v_accvgpr_read_b32 v35, a211
    v_mfma_f32_16x16x32_bf16 a[224:227], a[136:139], v[72:75], a[224:227]
    buffer_load_dwordx4 v4, s[12:15], s16 offen offset:0 lds
    v_mfma_f32_16x16x32_bf16 a[224:227], a[152:155], v[80:83], a[224:227]
    s_waitcnt lgkmcnt(4)
    ds_read_b128 v[72:75], v13 offset:49408
    v_accvgpr_read_b32 v36, a212
    v_mfma_f32_16x16x32_bf16 a[224:227], a[160:163], v[84:87], a[224:227]
    v_accvgpr_read_b32 v37, a213
    v_accvgpr_read_b32 v38, a214
    v_mfma_f32_16x16x32_bf16 a[228:231], a[164:167], v[84:87], a[228:231]
    s_waitcnt lgkmcnt(4)
    ds_read_b128 v[76:79], v13 offset:51456
    v_accvgpr_read_b32 v39, a215
    v_mfma_f32_16x16x32_bf16 a[228:231], a[156:159], v[80:83], a[228:231]
    buffer_load_dwordx4 v4, s[12:15], s16 offen offset:1024 lds
    v_mfma_f32_16x16x32_bf16 a[220:223], a[156:159], v[88:91], a[220:223]
    s_waitcnt lgkmcnt(4)
    ds_read_b128 v[80:83], v13 offset:53504
    v_cvt_pk_bf16_f32 v44, v32, v33
    v_mfma_f32_16x16x32_bf16 a[220:223], a[164:167], v[92:95], a[220:223]
    v_cvt_pk_bf16_f32 v45, v34, v35
    v_cvt_pk_bf16_f32 v46, v36, v37
    v_mfma_f32_16x16x32_bf16 a[216:219], a[160:163], v[92:95], a[216:219]
    s_waitcnt lgkmcnt(4)
    ds_read_b128 v[84:87], v13 offset:55552
    v_cvt_pk_bf16_f32 v47, v38, v39
    v_mfma_f32_16x16x32_bf16 a[216:219], a[152:155], v[88:91], a[216:219]
    buffer_store_dwordx4 v[44:47], v4, s[12:15], s29 offen offset:1024 sc1
    v_mfma_f32_16x16x32_bf16 a[232:235], a[104:107], v[64:67], a[232:235]
    s_waitcnt lgkmcnt(4)
    ds_read_b128 v[88:91], v13 offset:53248
    s_nop 0
    v_mfma_f32_16x16x32_bf16 a[232:235], a[112:115], v[68:71], a[232:235]
    v_mfma_f32_16x16x32_bf16 a[236:239], a[116:119], v[68:71], a[236:239]
    s_waitcnt lgkmcnt(4)
    ds_read_b128 v[92:95], v13 offset:55296
    v_mfma_f32_16x16x32_bf16 a[236:239], a[108:111], v[64:67], a[236:239]
    buffer_load_dwordx4 v4, s[12:15], s16 offen offset:2048 lds
    v_mfma_f32_16x16x32_bf16 a[244:247], a[108:111], v[72:75], a[244:247]
    s_waitcnt lgkmcnt(4)
    ds_read_b128 v[64:67], v13 offset:57344
    v_mfma_f32_16x16x32_bf16 a[244:247], a[116:119], v[76:79], a[244:247]
    v_mfma_f32_16x16x32_bf16 a[240:243], a[112:115], v[76:79], a[240:243]
    s_waitcnt lgkmcnt(4)
    ds_read_b128 v[68:71], v13 offset:59392
    v_mfma_f32_16x16x32_bf16 a[240:243], a[104:107], v[72:75], a[240:243]
    buffer_load_dwordx4 v4, s[12:15], s16 offen offset:3072 lds
    v_mfma_f32_16x16x32_bf16 a[240:243], a[120:123], v[80:83], a[240:243]
    s_waitcnt lgkmcnt(4)
    ds_read_b128 v[72:75], v13 offset:57600
    v_accvgpr_read_b32 v24, a216
    v_mfma_f32_16x16x32_bf16 a[240:243], a[128:131], v[84:87], a[240:243]
    v_accvgpr_read_b32 v25, a217
    v_accvgpr_read_b32 v26, a218
    v_mfma_f32_16x16x32_bf16 a[244:247], a[132:135], v[84:87], a[244:247]
    s_waitcnt lgkmcnt(4)
    ds_read_b128 v[76:79], v13 offset:59648
    v_accvgpr_read_b32 v27, a219
    v_mfma_f32_16x16x32_bf16 a[244:247], a[124:127], v[80:83], a[244:247]
    v_accvgpr_read_b32 v28, a220
    v_accvgpr_read_b32 v29, a221
    v_mfma_f32_16x16x32_bf16 a[236:239], a[124:127], v[88:91], a[236:239]
    s_waitcnt lgkmcnt(4)
    ds_read_b128 v[80:83], v13 offset:61696
    v_accvgpr_read_b32 v30, a222
    v_mfma_f32_16x16x32_bf16 a[236:239], a[132:135], v[92:95], a[236:239]
    v_accvgpr_read_b32 v31, a223
    v_cvt_pk_bf16_f32 v48, v24, v25
    v_mfma_f32_16x16x32_bf16 a[232:235], a[128:131], v[92:95], a[232:235]
    s_waitcnt lgkmcnt(4)
    ds_read_b128 v[84:87], v13 offset:63744
    v_cvt_pk_bf16_f32 v49, v26, v27
    v_mfma_f32_16x16x32_bf16 a[232:235], a[120:123], v[88:91], a[232:235]
    v_cvt_pk_bf16_f32 v50, v28, v29
    v_cvt_pk_bf16_f32 v51, v30, v31
    v_mfma_f32_16x16x32_bf16 a[232:235], a[136:139], v[64:67], a[232:235]
    s_waitcnt lgkmcnt(4)
    ds_read_b128 v[88:91], v13 offset:61440
    v_accvgpr_read_b32 v32, a224
    v_mfma_f32_16x16x32_bf16 a[232:235], a[144:147], v[68:71], a[232:235]
    buffer_store_dwordx4 v[48:51], v4, s[12:15], s29 offen offset:2048 sc1
    v_mfma_f32_16x16x32_bf16 a[236:239], a[148:151], v[68:71], a[236:239]
    s_waitcnt lgkmcnt(4)
    ds_read_b128 v[92:95], v13 offset:63488
    s_nop 0
    v_mfma_f32_16x16x32_bf16 a[236:239], a[140:143], v[64:67], a[236:239]
    s_waitcnt vmcnt(27)
    s_barrier
    v_mfma_f32_16x16x32_bf16 a[244:247], a[140:143], v[72:75], a[244:247]
    s_waitcnt lgkmcnt(4)
    ds_read_b128 v[64:67], v12 offset:0
    s_add_u32 m0, s22, 98304
    v_mfma_f32_16x16x32_bf16 a[244:247], a[148:151], v[76:79], a[244:247]
    s_add_u32 s16, s16, 16384
    v_accvgpr_read_b32 v33, a225
    v_accvgpr_read_b32 v34, a226
    v_mfma_f32_16x16x32_bf16 a[240:243], a[144:147], v[76:79], a[240:243]
    s_waitcnt lgkmcnt(4)
    ds_read_b128 v[68:71], v12 offset:2048
    v_accvgpr_read_b32 v35, a227
    v_mfma_f32_16x16x32_bf16 a[240:243], a[136:139], v[72:75], a[240:243]
    buffer_load_dwordx4 v4, s[12:15], s16 offen offset:0 lds
    v_mfma_f32_16x16x32_bf16 a[240:243], a[152:155], v[80:83], a[240:243]
    s_waitcnt lgkmcnt(4)
    ds_read_b128 v[72:75], v12 offset:256
    v_accvgpr_read_b32 v36, a228
    v_mfma_f32_16x16x32_bf16 a[240:243], a[160:163], v[84:87], a[240:243]
    s_waitcnt vmcnt(10)
    buffer_store_dword v60, v59, s[12:15], s26 offen sc1
    v_mfma_f32_16x16x32_bf16 a[244:247], a[164:167], v[84:87], a[244:247]
    s_waitcnt lgkmcnt(4)
    ds_read_b128 v[76:79], v12 offset:2304
    v_mov_b32 v60, 9
    v_mfma_f32_16x16x32_bf16 a[244:247], a[156:159], v[80:83], a[244:247]
    v_accvgpr_read_b32 v37, a229
    v_accvgpr_read_b32 v38, a230
    v_mfma_f32_16x16x32_bf16 a[236:239], a[156:159], v[88:91], a[236:239]
    s_waitcnt lgkmcnt(4)
    ds_read_b128 v[80:83], v12 offset:4352
    v_accvgpr_read_b32 v39, a231
    v_mfma_f32_16x16x32_bf16 a[236:239], a[164:167], v[92:95], a[236:239]
    buffer_load_dwordx4 v4, s[12:15], s16 offen offset:1024 lds
    v_mfma_f32_16x16x32_bf16 a[232:235], a[160:163], v[92:95], a[232:235]
    s_waitcnt lgkmcnt(4)
    ds_read_b128 v[84:87], v12 offset:6400
    v_cvt_pk_bf16_f32 v52, v32, v33
    v_mfma_f32_16x16x32_bf16 a[232:235], a[152:155], v[88:91], a[232:235]
    v_cvt_pk_bf16_f32 v53, v34, v35
    v_cvt_pk_bf16_f32 v54, v36, v37
    v_mfma_f32_16x16x32_bf16 v[208:211], a[104:107], v[64:67], v[208:211]
    s_waitcnt lgkmcnt(4)
    ds_read_b128 v[88:91], v12 offset:4096
    v_cvt_pk_bf16_f32 v55, v38, v39
    v_mfma_f32_16x16x32_bf16 v[208:211], a[112:115], v[68:71], v[208:211]
    buffer_store_dwordx4 v[52:55], v4, s[12:15], s29 offen offset:3072 sc1
    v_mfma_f32_16x16x32_bf16 v[212:215], a[116:119], v[68:71], v[212:215]
    s_waitcnt lgkmcnt(4)
    ds_read_b128 v[92:95], v12 offset:6144
    s_nop 0
    v_mfma_f32_16x16x32_bf16 v[212:215], a[108:111], v[64:67], v[212:215]
    v_mfma_f32_16x16x32_bf16 v[220:223], a[108:111], v[72:75], v[220:223]
    s_waitcnt lgkmcnt(4)
    ds_read_b128 v[64:67], v12 offset:8192
    v_mfma_f32_16x16x32_bf16 v[220:223], a[116:119], v[76:79], v[220:223]
    buffer_load_dwordx4 v4, s[12:15], s16 offen offset:2048 lds
    v_mfma_f32_16x16x32_bf16 v[216:219], a[112:115], v[76:79], v[216:219]
    s_waitcnt lgkmcnt(4)
    ds_read_b128 v[68:71], v12 offset:10240
    v_mfma_f32_16x16x32_bf16 v[216:219], a[104:107], v[72:75], v[216:219]
    v_accvgpr_read_b32 v24, a232
    v_accvgpr_read_b32 v25, a233
    v_mfma_f32_16x16x32_bf16 v[216:219], a[120:123], v[80:83], v[216:219]
    s_waitcnt lgkmcnt(4)
    ds_read_b128 v[72:75], v12 offset:8448
    v_accvgpr_read_b32 v26, a234
    v_mfma_f32_16x16x32_bf16 v[216:219], a[128:131], v[84:87], v[216:219]
    buffer_load_dwordx4 v4, s[12:15], s16 offen offset:3072 lds
    v_mfma_f32_16x16x32_bf16 v[220:223], a[132:135], v[84:87], v[220:223]
    s_waitcnt lgkmcnt(4)
    ds_read_b128 v[76:79], v12 offset:10496
    v_accvgpr_read_b32 v27, a235
    v_mfma_f32_16x16x32_bf16 v[220:223], a[124:127], v[80:83], v[220:223]
    v_accvgpr_read_b32 v28, a236
    v_accvgpr_read_b32 v29, a237
    v_mfma_f32_16x16x32_bf16 v[212:215], a[124:127], v[88:91], v[212:215]
    s_waitcnt lgkmcnt(4)
    ds_read_b128 v[80:83], v12 offset:12544
    v_accvgpr_read_b32 v30, a238
    v_mfma_f32_16x16x32_bf16 v[212:215], a[132:135], v[92:95], v[212:215]
    v_accvgpr_read_b32 v31, a239
    v_cvt_pk_bf16_f32 v40, v24, v25
    v_mfma_f32_16x16x32_bf16 v[208:211], a[128:131], v[92:95], v[208:211]
    s_waitcnt lgkmcnt(4)
    ds_read_b128 v[84:87], v12 offset:14592
    v_cvt_pk_bf16_f32 v41, v26, v27
    v_mfma_f32_16x16x32_bf16 v[208:211], a[120:123], v[88:91], v[208:211]
    v_cvt_pk_bf16_f32 v42, v28, v29
    v_cvt_pk_bf16_f32 v43, v30, v31
    v_mfma_f32_16x16x32_bf16 v[208:211], a[136:139], v[64:67], v[208:211]
    s_waitcnt lgkmcnt(4)
    ds_read_b128 v[88:91], v12 offset:12288
    v_accvgpr_read_b32 v32, a240
    v_mfma_f32_16x16x32_bf16 v[208:211], a[144:147], v[68:71], v[208:211]
    buffer_store_dwordx4 v[40:43], v4, s[12:15], s44 offen offset:0 sc1
    v_mfma_f32_16x16x32_bf16 v[212:215], a[148:151], v[68:71], v[212:215]
    s_waitcnt lgkmcnt(4)
    ds_read_b128 v[92:95], v12 offset:14336
    s_nop 0
    v_mfma_f32_16x16x32_bf16 v[212:215], a[140:143], v[64:67], v[212:215]
    s_barrier
    v_mfma_f32_16x16x32_bf16 v[220:223], a[140:143], v[72:75], v[220:223]
    s_waitcnt lgkmcnt(4)
    ds_read_b128 v[64:67], v12 offset:16384
    s_add_u32 m0, s22, 114688
    v_mfma_f32_16x16x32_bf16 v[220:223], a[148:151], v[76:79], v[220:223]
    s_add_u32 s16, s16, 16384
    v_accvgpr_read_b32 v33, a241
    v_accvgpr_read_b32 v34, a242
    v_mfma_f32_16x16x32_bf16 v[216:219], a[144:147], v[76:79], v[216:219]
    s_waitcnt lgkmcnt(4)
    ds_read_b128 v[68:71], v12 offset:18432
    v_accvgpr_read_b32 v35, a243
    v_mfma_f32_16x16x32_bf16 v[216:219], a[136:139], v[72:75], v[216:219]
    buffer_load_dwordx4 v4, s[12:15], s16 offen offset:0 lds
    v_mfma_f32_16x16x32_bf16 v[216:219], a[152:155], v[80:83], v[216:219]
    s_waitcnt lgkmcnt(4)
    ds_read_b128 v[72:75], v12 offset:16640
    v_accvgpr_read_b32 v36, a244
    v_mfma_f32_16x16x32_bf16 v[216:219], a[160:163], v[84:87], v[216:219]
    v_accvgpr_read_b32 v37, a245
    v_accvgpr_read_b32 v38, a246
    v_mfma_f32_16x16x32_bf16 v[220:223], a[164:167], v[84:87], v[220:223]
    s_waitcnt lgkmcnt(4)
    ds_read_b128 v[76:79], v12 offset:18688
    v_accvgpr_read_b32 v39, a247
    v_mfma_f32_16x16x32_bf16 v[220:223], a[156:159], v[80:83], v[220:223]
    buffer_load_dwordx4 v4, s[12:15], s16 offen offset:1024 lds
    v_mfma_f32_16x16x32_bf16 v[212:215], a[156:159], v[88:91], v[212:215]
    s_waitcnt lgkmcnt(4)
    ds_read_b128 v[80:83], v12 offset:20736
    v_cvt_pk_bf16_f32 v44, v32, v33
    v_mfma_f32_16x16x32_bf16 v[212:215], a[164:167], v[92:95], v[212:215]
    v_cvt_pk_bf16_f32 v45, v34, v35
    v_cvt_pk_bf16_f32 v46, v36, v37
    v_mfma_f32_16x16x32_bf16 v[208:211], a[160:163], v[92:95], v[208:211]
    s_waitcnt lgkmcnt(4)
    ds_read_b128 v[84:87], v12 offset:22784
    v_cvt_pk_bf16_f32 v47, v38, v39
    v_mfma_f32_16x16x32_bf16 v[208:211], a[152:155], v[88:91], v[208:211]
    buffer_store_dwordx4 v[44:47], v4, s[12:15], s44 offen offset:1024 sc1
    v_mfma_f32_16x16x32_bf16 v[240:243], v[136:139], v[18:21], 0
    v_mfma_f32_16x16x32_bf16 v[244:247], v[140:143], v[18:21], 0
    v_mfma_f32_16x16x32_bf16 v[248:251], v[136:139], v[16:19], 0
    v_mfma_f32_16x16x32_bf16 v[252:255], v[140:143], v[16:19], 0
    v_mfma_f32_16x16x32_bf16 v[224:227], v[120:123], v[18:21], 0
    v_mfma_f32_16x16x32_bf16 v[228:231], v[124:127], v[18:21], 0
    v_mfma_f32_16x16x32_bf16 v[232:235], v[120:123], v[16:19], 0
    v_mfma_f32_16x16x32_bf16 v[236:239], v[124:127], v[16:19], 0
    v_mfma_f32_16x16x32_bf16 v[224:227], v[96:99], v[64:67], v[224:227]
    s_waitcnt lgkmcnt(4)
    ds_read_b128 v[88:91], v12 offset:20480
    s_nop 0
    v_mfma_f32_16x16x32_bf16 v[224:227], v[112:115], v[68:71], v[224:227]
    buffer_load_dwordx4 v4, s[12:15], s16 offen offset:2048 lds
    v_mfma_f32_16x16x32_bf16 v[228:231], v[116:119], v[68:71], v[228:231]
    s_waitcnt lgkmcnt(4)
    ds_read_b128 v[92:95], v12 offset:22528
    v_cvt_pk_bf16_f32 v48, v208, v209
    v_mfma_f32_16x16x32_bf16 v[228:231], v[100:103], v[64:67], v[228:231]
    v_cvt_pk_bf16_f32 v49, v210, v211
    v_cvt_pk_bf16_f32 v50, v212, v213
    v_mfma_f32_16x16x32_bf16 v[236:239], v[100:103], v[72:75], v[236:239]
    s_waitcnt lgkmcnt(4)
    ds_read_b128 v[64:67], v12 offset:24576
    v_cvt_pk_bf16_f32 v51, v214, v215
    v_mfma_f32_16x16x32_bf16 v[236:239], v[116:119], v[76:79], v[236:239]
    buffer_store_dwordx4 v[48:51], v4, s[12:15], s44 offen offset:2048 sc1
    v_mfma_f32_16x16x32_bf16 v[232:235], v[112:115], v[76:79], v[232:235]
    s_waitcnt lgkmcnt(4)
    ds_read_b128 v[68:71], v12 offset:26624
    s_nop 0
    v_mfma_f32_16x16x32_bf16 v[232:235], v[96:99], v[72:75], v[232:235]
    v_cvt_pk_bf16_f32 v52, v216, v217
    v_cvt_pk_bf16_f32 v53, v218, v219
    v_mfma_f32_16x16x32_bf16 v[232:235], v[128:131], v[80:83], v[232:235]
    s_waitcnt lgkmcnt(4)
    ds_read_b128 v[72:75], v12 offset:24832
    v_cvt_pk_bf16_f32 v54, v220, v221
    v_mfma_f32_16x16x32_bf16 v[232:235], a[0:3], v[84:87], v[232:235]
    buffer_load_dwordx4 v4, s[12:15], s16 offen offset:3072 lds
    v_mfma_f32_16x16x32_bf16 v[236:239], a[4:7], v[84:87], v[236:239]
    s_waitcnt lgkmcnt(4)
    ds_read_b128 v[76:79], v12 offset:26880
    v_cvt_pk_bf16_f32 v55, v222, v223
    v_mfma_f32_16x16x32_bf16 v[236:239], v[132:135], v[80:83], v[236:239]
    buffer_store_dwordx4 v[52:55], v4, s[12:15], s44 offen offset:3072 sc1
    v_mfma_f32_16x16x32_bf16 v[228:231], v[132:135], v[88:91], v[228:231]
    s_waitcnt lgkmcnt(4)
    ds_read_b128 v[80:83], v12 offset:28928
    s_nop 0
    v_mfma_f32_16x16x32_bf16 v[228:231], a[4:7], v[92:95], v[228:231]
    buffer_load_dword v110, off, s[12:15], s17 sc1
    v_mfma_f32_16x16x32_bf16 v[224:227], a[0:3], v[92:95], v[224:227]
    s_waitcnt lgkmcnt(4)
    ds_read_b128 v[84:87], v12 offset:30976
    v_mfma_f32_16x16x32_bf16 v[224:227], v[128:131], v[88:91], v[224:227]
    v_mfma_f32_16x16x32_bf16 v[224:227], a[8:11], v[64:67], v[224:227]
    s_waitcnt lgkmcnt(4)
    ds_read_b128 v[88:91], v12 offset:28672
    v_mfma_f32_16x16x32_bf16 v[224:227], a[16:19], v[68:71], v[224:227]
    s_waitcnt vmcnt(11)
    buffer_store_dword v60, v59, s[12:15], s26 offen sc1
    v_mfma_f32_16x16x32_bf16 v[228:231], a[20:23], v[68:71], v[228:231]
    s_waitcnt lgkmcnt(4)
    ds_read_b128 v[92:95], v12 offset:30720
    v_mov_b32 v60, 10
    v_mfma_f32_16x16x32_bf16 v[228:231], a[12:15], v[64:67], v[228:231]
    s_barrier
    v_mfma_f32_16x16x32_bf16 v[236:239], a[12:15], v[72:75], v[236:239]
    s_waitcnt lgkmcnt(4)
    ds_read_b128 v[64:67], v12 offset:32768
    v_mfma_f32_16x16x32_bf16 v[236:239], a[20:23], v[76:79], v[236:239]
    v_mfma_f32_16x16x32_bf16 v[232:235], a[16:19], v[76:79], v[232:235]
    s_waitcnt lgkmcnt(4)
    ds_read_b128 v[68:71], v12 offset:34816
    v_mfma_f32_16x16x32_bf16 v[232:235], a[8:11], v[72:75], v[232:235]
    v_mfma_f32_16x16x32_bf16 v[232:235], v[144:147], v[80:83], v[232:235]
    s_waitcnt lgkmcnt(4)
    ds_read_b128 v[72:75], v12 offset:33024
    v_mfma_f32_16x16x32_bf16 v[232:235], a[24:27], v[84:87], v[232:235]
    v_mfma_f32_16x16x32_bf16 v[236:239], a[28:31], v[84:87], v[236:239]
    s_waitcnt lgkmcnt(4)
    ds_read_b128 v[76:79], v12 offset:35072
    v_mfma_f32_16x16x32_bf16 v[236:239], v[148:151], v[80:83], v[236:239]
    v_mfma_f32_16x16x32_bf16 v[228:231], v[148:151], v[88:91], v[228:231]
    s_waitcnt lgkmcnt(4)
    ds_read_b128 v[80:83], v12 offset:37120
    v_mfma_f32_16x16x32_bf16 v[228:231], a[28:31], v[92:95], v[228:231]
    v_mfma_f32_16x16x32_bf16 v[224:227], a[24:27], v[92:95], v[224:227]
    s_waitcnt lgkmcnt(4)
    ds_read_b128 v[84:87], v12 offset:39168
    v_mfma_f32_16x16x32_bf16 v[224:227], v[144:147], v[88:91], v[224:227]
    v_mfma_f32_16x16x32_bf16 v[224:227], a[32:35], v[64:67], v[224:227]
    s_waitcnt lgkmcnt(4)
    ds_read_b128 v[88:91], v12 offset:36864
    v_mfma_f32_16x16x32_bf16 v[224:227], a[40:43], v[68:71], v[224:227]
    v_mfma_f32_16x16x32_bf16 v[228:231], a[44:47], v[68:71], v[228:231]
    s_waitcnt lgkmcnt(4)
    ds_read_b128 v[92:95], v12 offset:38912
    v_mfma_f32_16x16x32_bf16 v[228:231], a[36:39], v[64:67], v[228:231]
    v_mfma_f32_16x16x32_bf16 v[236:239], a[36:39], v[72:75], v[236:239]
    s_waitcnt lgkmcnt(4)
    ds_read_b128 v[64:67], v12 offset:40960
    v_mfma_f32_16x16x32_bf16 v[236:239], a[44:47], v[76:79], v[236:239]
    v_mfma_f32_16x16x32_bf16 v[232:235], a[40:43], v[76:79], v[232:235]
    s_waitcnt lgkmcnt(4)
    ds_read_b128 v[68:71], v12 offset:43008
    v_mfma_f32_16x16x32_bf16 v[232:235], a[32:35], v[72:75], v[232:235]
    v_mfma_f32_16x16x32_bf16 v[232:235], v[160:163], v[80:83], v[232:235]
    s_waitcnt lgkmcnt(4)
    ds_read_b128 v[72:75], v12 offset:41216
    v_mfma_f32_16x16x32_bf16 v[232:235], a[48:51], v[84:87], v[232:235]
    v_mfma_f32_16x16x32_bf16 v[236:239], a[52:55], v[84:87], v[236:239]
    s_waitcnt lgkmcnt(4)
    ds_read_b128 v[76:79], v12 offset:43264
    v_mfma_f32_16x16x32_bf16 v[236:239], v[164:167], v[80:83], v[236:239]
    v_mfma_f32_16x16x32_bf16 v[228:231], v[164:167], v[88:91], v[228:231]
    s_waitcnt lgkmcnt(4)
    ds_read_b128 v[80:83], v12 offset:45312
    v_mfma_f32_16x16x32_bf16 v[228:231], a[52:55], v[92:95], v[228:231]
    v_mfma_f32_16x16x32_bf16 v[224:227], a[48:51], v[92:95], v[224:227]
    s_waitcnt lgkmcnt(4)
    ds_read_b128 v[84:87], v12 offset:47360
    v_mfma_f32_16x16x32_bf16 v[224:227], v[160:163], v[88:91], v[224:227]
    v_mfma_f32_16x16x32_bf16 v[224:227], a[56:59], v[64:67], v[224:227]
    s_waitcnt lgkmcnt(4)
    ds_read_b128 v[88:91], v12 offset:45056
    v_mfma_f32_16x16x32_bf16 v[224:227], a[64:67], v[68:71], v[224:227]
    v_mfma_f32_16x16x32_bf16 v[228:231], a[68:71], v[68:71], v[228:231]
    s_waitcnt lgkmcnt(4)
    ds_read_b128 v[92:95], v12 offset:47104
    v_mfma_f32_16x16x32_bf16 v[228:231], a[60:63], v[64:67], v[228:231]
    s_barrier
    v_mfma_f32_16x16x32_bf16 v[236:239], a[60:63], v[72:75], v[236:239]
    s_waitcnt lgkmcnt(4)
    ds_read_b128 v[64:67], v12 offset:49152
    v_mfma_f32_16x16x32_bf16 v[236:239], a[68:71], v[76:79], v[236:239]
    v_mfma_f32_16x16x32_bf16 v[232:235], a[64:67], v[76:79], v[232:235]
    s_waitcnt lgkmcnt(4)
    ds_read_b128 v[68:71], v12 offset:51200
    v_mfma_f32_16x16x32_bf16 v[232:235], a[56:59], v[72:75], v[232:235]
    v_mfma_f32_16x16x32_bf16 v[232:235], v[176:179], v[80:83], v[232:235]
    s_waitcnt lgkmcnt(4)
    ds_read_b128 v[72:75], v12 offset:49408
    v_mfma_f32_16x16x32_bf16 v[232:235], a[72:75], v[84:87], v[232:235]
    v_mfma_f32_16x16x32_bf16 v[236:239], a[76:79], v[84:87], v[236:239]
    s_waitcnt lgkmcnt(4)
    ds_read_b128 v[76:79], v12 offset:51456
    v_mfma_f32_16x16x32_bf16 v[236:239], v[180:183], v[80:83], v[236:239]
    v_mfma_f32_16x16x32_bf16 v[228:231], v[180:183], v[88:91], v[228:231]
    s_waitcnt lgkmcnt(4)
    ds_read_b128 v[80:83], v12 offset:53504
    v_mfma_f32_16x16x32_bf16 v[228:231], a[76:79], v[92:95], v[228:231]
    v_mfma_f32_16x16x32_bf16 v[224:227], a[72:75], v[92:95], v[224:227]
    s_waitcnt lgkmcnt(4)
    ds_read_b128 v[84:87], v12 offset:55552
    v_mfma_f32_16x16x32_bf16 v[224:227], v[176:179], v[88:91], v[224:227]
    buffer_load_dword v111, off, s[12:15], s18 sc1
    v_mfma_f32_16x16x32_bf16 v[224:227], a[80:83], v[64:67], v[224:227]
    s_waitcnt lgkmcnt(4)
    ds_read_b128 v[88:91], v12 offset:53248
    v_mfma_f32_16x16x32_bf16 v[224:227], a[88:91], v[68:71], v[224:227]
    s_waitcnt vmcnt(2)
    v_cmp_gt_u32 vcc, 8, v110
    v_mfma_f32_16x16x32_bf16 v[228:231], a[92:95], v[68:71], v[228:231]
    s_waitcnt lgkmcnt(4)
    ds_read_b128 v[92:95], v12 offset:55296
    s_cmp_lg_u64 vcc, 0
    s_cselect_b32 s20, 0x40000000, 0
    v_mfma_f32_16x16x32_bf16 v[228:231], a[84:87], v[64:67], v[228:231]
    buffer_store_dword v60, v59, s[12:15], s26 offen sc1
    v_mfma_f32_16x16x32_bf16 v[236:239], a[84:87], v[72:75], v[236:239]
    s_waitcnt lgkmcnt(4)
    ds_read_b128 v[64:67], v12 offset:57344
    v_mov_b32 v60, 11
    v_mfma_f32_16x16x32_bf16 v[236:239], a[92:95], v[76:79], v[236:239]
    v_or_b32 v106, s20, v4
    v_mfma_f32_16x16x32_bf16 v[232:235], a[88:91], v[76:79], v[232:235]
    s_waitcnt lgkmcnt(4)
    ds_read_b128 v[68:71], v12 offset:59392
    s_nop 0
    v_mfma_f32_16x16x32_bf16 v[232:235], a[80:83], v[72:75], v[232:235]
    buffer_load_dwordx4 a[168:171], v106, s[12:15], s50 offen offset:0 sc1
    v_mfma_f32_16x16x32_bf16 v[232:235], v[192:195], v[80:83], v[232:235]
    s_waitcnt lgkmcnt(4)
    ds_read_b128 v[72:75], v12 offset:57600
    v_mfma_f32_16x16x32_bf16 v[232:235], a[96:99], v[84:87], v[232:235]
    buffer_load_dwordx4 a[172:175], v106, s[12:15], s50 offen offset:1024 sc1
    v_mfma_f32_16x16x32_bf16 v[236:239], a[100:103], v[84:87], v[236:239]
    s_waitcnt lgkmcnt(4)
    ds_read_b128 v[76:79], v12 offset:59648
    v_mfma_f32_16x16x32_bf16 v[236:239], v[196:199], v[80:83], v[236:239]
    buffer_load_dwordx4 a[176:179], v106, s[12:15], s50 offen offset:2048 sc1
    v_mfma_f32_16x16x32_bf16 v[228:231], v[196:199], v[88:91], v[228:231]
    s_waitcnt lgkmcnt(4)
    ds_read_b128 v[80:83], v12 offset:61696
    v_mfma_f32_16x16x32_bf16 v[228:231], a[100:103], v[92:95], v[228:231]
    buffer_load_dwordx4 a[180:183], v106, s[12:15], s50 offen offset:3072 sc1
    v_mfma_f32_16x16x32_bf16 v[224:227], a[96:99], v[92:95], v[224:227]
    s_waitcnt lgkmcnt(4)
    ds_read_b128 v[84:87], v12 offset:63744
    v_mfma_f32_16x16x32_bf16 v[224:227], v[192:195], v[88:91], v[224:227]
    v_mfma_f32_16x16x32_bf16 v[224:227], a[104:107], v[64:67], v[224:227]
    s_waitcnt lgkmcnt(4)
    ds_read_b128 v[88:91], v12 offset:61440
    v_mfma_f32_16x16x32_bf16 v[224:227], a[112:115], v[68:71], v[224:227]
    v_mfma_f32_16x16x32_bf16 v[228:231], a[116:119], v[68:71], v[228:231]
    s_waitcnt lgkmcnt(4)
    ds_read_b128 v[92:95], v12 offset:63488
    v_mfma_f32_16x16x32_bf16 v[228:231], a[108:111], v[64:67], v[228:231]
    s_barrier
    v_mfma_f32_16x16x32_bf16 v[236:239], a[108:111], v[72:75], v[236:239]
    s_waitcnt lgkmcnt(4)
    ds_read_b128 v[64:67], v13 offset:0
    v_mfma_f32_16x16x32_bf16 v[236:239], a[116:119], v[76:79], v[236:239]
    v_mfma_f32_16x16x32_bf16 v[232:235], a[112:115], v[76:79], v[232:235]
    s_waitcnt lgkmcnt(4)
    ds_read_b128 v[68:71], v13 offset:2048
    v_mfma_f32_16x16x32_bf16 v[232:235], a[104:107], v[72:75], v[232:235]
    v_mfma_f32_16x16x32_bf16 v[232:235], a[120:123], v[80:83], v[232:235]
    s_waitcnt lgkmcnt(4)
    ds_read_b128 v[72:75], v13 offset:256
    v_mfma_f32_16x16x32_bf16 v[232:235], a[128:131], v[84:87], v[232:235]
    v_mfma_f32_16x16x32_bf16 v[236:239], a[132:135], v[84:87], v[236:239]
    s_waitcnt lgkmcnt(4)
    ds_read_b128 v[76:79], v13 offset:2304
    v_mfma_f32_16x16x32_bf16 v[236:239], a[124:127], v[80:83], v[236:239]
    v_mfma_f32_16x16x32_bf16 v[228:231], a[124:127], v[88:91], v[228:231]
    s_waitcnt lgkmcnt(4)
    ds_read_b128 v[80:83], v13 offset:4352
    v_mfma_f32_16x16x32_bf16 v[228:231], a[132:135], v[92:95], v[228:231]
    v_mfma_f32_16x16x32_bf16 v[224:227], a[128:131], v[92:95], v[224:227]
    s_waitcnt lgkmcnt(4)
    ds_read_b128 v[84:87], v13 offset:6400
    v_mfma_f32_16x16x32_bf16 v[224:227], a[120:123], v[88:91], v[224:227]
    v_mfma_f32_16x16x32_bf16 v[224:227], a[136:139], v[64:67], v[224:227]
    s_waitcnt lgkmcnt(4)
    ds_read_b128 v[88:91], v13 offset:4096
    v_mfma_f32_16x16x32_bf16 v[224:227], a[144:147], v[68:71], v[224:227]
    v_mfma_f32_16x16x32_bf16 v[228:231], a[148:151], v[68:71], v[228:231]
    s_waitcnt lgkmcnt(4)
    ds_read_b128 v[92:95], v13 offset:6144
    v_mfma_f32_16x16x32_bf16 v[228:231], a[140:143], v[64:67], v[228:231]
    v_mfma_f32_16x16x32_bf16 v[236:239], a[140:143], v[72:75], v[236:239]
    s_waitcnt lgkmcnt(4)
    ds_read_b128 v[64:67], v13 offset:8192
    v_mfma_f32_16x16x32_bf16 v[236:239], a[148:151], v[76:79], v[236:239]
    v_mfma_f32_16x16x32_bf16 v[232:235], a[144:147], v[76:79], v[232:235]
    s_waitcnt lgkmcnt(4)
    ds_read_b128 v[68:71], v13 offset:10240
    v_mfma_f32_16x16x32_bf16 v[232:235], a[136:139], v[72:75], v[232:235]
    v_mfma_f32_16x16x32_bf16 v[232:235], a[152:155], v[80:83], v[232:235]
    s_waitcnt lgkmcnt(4)
    ds_read_b128 v[72:75], v13 offset:8448
    v_mfma_f32_16x16x32_bf16 v[232:235], a[160:163], v[84:87], v[232:235]
    v_mfma_f32_16x16x32_bf16 v[236:239], a[164:167], v[84:87], v[236:239]
    s_waitcnt lgkmcnt(4)
    ds_read_b128 v[76:79], v13 offset:10496
    v_mfma_f32_16x16x32_bf16 v[236:239], a[156:159], v[80:83], v[236:239]
    v_mfma_f32_16x16x32_bf16 v[228:231], a[156:159], v[88:91], v[228:231]
    s_waitcnt lgkmcnt(4)
    ds_read_b128 v[80:83], v13 offset:12544
    v_mfma_f32_16x16x32_bf16 v[228:231], a[164:167], v[92:95], v[228:231]
    v_mfma_f32_16x16x32_bf16 v[224:227], a[160:163], v[92:95], v[224:227]
    s_waitcnt lgkmcnt(4)
    ds_read_b128 v[84:87], v13 offset:14592
    v_mfma_f32_16x16x32_bf16 v[224:227], a[152:155], v[88:91], v[224:227]
    v_mfma_f32_16x16x32_bf16 v[240:243], v[96:99], v[64:67], v[240:243]
    s_waitcnt lgkmcnt(4)
    ds_read_b128 v[88:91], v13 offset:12288
    v_mfma_f32_16x16x32_bf16 v[240:243], v[112:115], v[68:71], v[240:243]
    s_waitcnt vmcnt(5)
    v_cmp_gt_u32 vcc, 9, v111
    v_mfma_f32_16x16x32_bf16 v[244:247], v[116:119], v[68:71], v[244:247]
    s_waitcnt lgkmcnt(4)
    ds_read_b128 v[92:95], v13 offset:14336
    s_cmp_lg_u64 vcc, 0
    s_cselect_b32 s21, 0x40000000, 0
    v_mfma_f32_16x16x32_bf16 v[244:247], v[100:103], v[64:67], v[244:247]
    s_barrier
    v_mfma_f32_16x16x32_bf16 v[252:255], v[100:103], v[72:75], v[252:255]
    s_waitcnt lgkmcnt(4)
    ds_read_b128 v[64:67], v13 offset:16384
    v_or_b32 v107, s21, v4
    v_mfma_f32_16x16x32_bf16 v[252:255], v[116:119], v[76:79], v[252:255]
    s_nop 0
    v_mfma_f32_16x16x32_bf16 v[248:251], v[112:115], v[76:79], v[248:251]
    s_waitcnt lgkmcnt(4)
    ds_read_b128 v[68:71], v13 offset:18432
    v_mfma_f32_16x16x32_bf16 v[248:251], v[96:99], v[72:75], v[248:251]
    buffer_load_dword v61, v108, s[12:15], s26 offen sc1
    v_mfma_f32_16x16x32_bf16 v[248:251], v[128:131], v[80:83], v[248:251]
    s_waitcnt lgkmcnt(4)
    ds_read_b128 v[72:75], v13 offset:16640
    s_lshr_b32 s6, s20, 30
    s_lshr_b32 s7, s21, 29
    v_mfma_f32_16x16x32_bf16 v[248:251], a[0:3], v[84:87], v[248:251]
    buffer_load_dwordx4 a[184:187], v107, s[12:15], s51 offen offset:0 sc1
    v_mfma_f32_16x16x32_bf16 v[252:255], a[4:7], v[84:87], v[252:255]
    s_waitcnt lgkmcnt(4)
    ds_read_b128 v[76:79], v13 offset:18688
    s_or_b32 s6, s6, s7
    s_or_b32 s6, s6, 4
    v_mfma_f32_16x16x32_bf16 v[252:255], v[132:135], v[80:83], v[252:255]
    buffer_load_dwordx4 a[188:191], v107, s[12:15], s51 offen offset:1024 sc1
    v_mfma_f32_16x16x32_bf16 v[244:247], v[132:135], v[88:91], v[244:247]
    s_waitcnt lgkmcnt(4)
    ds_read_b128 v[80:83], v13 offset:20736
    v_mfma_f32_16x16x32_bf16 v[244:247], a[4:7], v[92:95], v[244:247]
    buffer_load_dwordx4 a[192:195], v107, s[12:15], s51 offen offset:2048 sc1
    v_mfma_f32_16x16x32_bf16 v[240:243], a[0:3], v[92:95], v[240:243]
    s_waitcnt lgkmcnt(4)
    ds_read_b128 v[84:87], v13 offset:22784
    v_mfma_f32_16x16x32_bf16 v[240:243], v[128:131], v[88:91], v[240:243]
    buffer_load_dwordx4 a[196:199], v107, s[12:15], s51 offen offset:3072 sc1
    v_mfma_f32_16x16x32_bf16 v[240:243], a[8:11], v[64:67], v[240:243]
    s_waitcnt lgkmcnt(4)
    ds_read_b128 v[88:91], v13 offset:20480
    v_mfma_f32_16x16x32_bf16 v[240:243], a[16:19], v[68:71], v[240:243]
    v_mfma_f32_16x16x32_bf16 v[244:247], a[20:23], v[68:71], v[244:247]
    s_waitcnt lgkmcnt(4)
    ds_read_b128 v[92:95], v13 offset:22528
    v_mfma_f32_16x16x32_bf16 v[244:247], a[12:15], v[64:67], v[244:247]
    v_mfma_f32_16x16x32_bf16 v[252:255], a[12:15], v[72:75], v[252:255]
    s_waitcnt lgkmcnt(4)
    ds_read_b128 v[64:67], v13 offset:24576
    v_mfma_f32_16x16x32_bf16 v[252:255], a[20:23], v[76:79], v[252:255]
    v_mfma_f32_16x16x32_bf16 v[248:251], a[16:19], v[76:79], v[248:251]
    s_waitcnt lgkmcnt(4)
    ds_read_b128 v[68:71], v13 offset:26624
    v_mfma_f32_16x16x32_bf16 v[248:251], a[8:11], v[72:75], v[248:251]
    v_mfma_f32_16x16x32_bf16 v[248:251], v[144:147], v[80:83], v[248:251]
    s_waitcnt lgkmcnt(4)
    ds_read_b128 v[72:75], v13 offset:24832
    v_mfma_f32_16x16x32_bf16 v[248:251], a[24:27], v[84:87], v[248:251]
    v_mfma_f32_16x16x32_bf16 v[252:255], a[28:31], v[84:87], v[252:255]
    s_waitcnt lgkmcnt(4)
    ds_read_b128 v[76:79], v13 offset:26880
    v_mfma_f32_16x16x32_bf16 v[252:255], v[148:151], v[80:83], v[252:255]
    v_mfma_f32_16x16x32_bf16 v[244:247], v[148:151], v[88:91], v[244:247]
    s_waitcnt lgkmcnt(4)
    ds_read_b128 v[80:83], v13 offset:28928
    v_mfma_f32_16x16x32_bf16 v[244:247], a[28:31], v[92:95], v[244:247]
    v_mfma_f32_16x16x32_bf16 v[240:243], a[24:27], v[92:95], v[240:243]
    s_waitcnt lgkmcnt(4)
    ds_read_b128 v[84:87], v13 offset:30976
    v_mfma_f32_16x16x32_bf16 v[240:243], v[144:147], v[88:91], v[240:243]
    v_mfma_f32_16x16x32_bf16 v[240:243], a[32:35], v[64:67], v[240:243]
    s_waitcnt lgkmcnt(4)
    ds_read_b128 v[88:91], v13 offset:28672
    v_mfma_f32_16x16x32_bf16 v[240:243], a[40:43], v[68:71], v[240:243]
    v_mfma_f32_16x16x32_bf16 v[244:247], a[44:47], v[68:71], v[244:247]
    s_waitcnt lgkmcnt(4)
    ds_read_b128 v[92:95], v13 offset:30720
    v_mfma_f32_16x16x32_bf16 v[244:247], a[36:39], v[64:67], v[244:247]
    s_barrier
    v_mfma_f32_16x16x32_bf16 v[252:255], a[36:39], v[72:75], v[252:255]
    s_waitcnt lgkmcnt(4)
    ds_read_b128 v[64:67], v13 offset:32768
    v_mfma_f32_16x16x32_bf16 v[252:255], a[44:47], v[76:79], v[252:255]
    v_mfma_f32_16x16x32_bf16 v[248:251], a[40:43], v[76:79], v[248:251]
    s_waitcnt lgkmcnt(4)
    ds_read_b128 v[68:71], v13 offset:34816
    v_mfma_f32_16x16x32_bf16 v[248:251], a[32:35], v[72:75], v[248:251]
    v_mfma_f32_16x16x32_bf16 v[248:251], v[160:163], v[80:83], v[248:251]
    s_waitcnt lgkmcnt(4)
    ds_read_b128 v[72:75], v13 offset:33024
    v_mfma_f32_16x16x32_bf16 v[248:251], a[48:51], v[84:87], v[248:251]
    v_mfma_f32_16x16x32_bf16 v[252:255], a[52:55], v[84:87], v[252:255]
    s_waitcnt lgkmcnt(4)
    ds_read_b128 v[76:79], v13 offset:35072
    v_mfma_f32_16x16x32_bf16 v[252:255], v[164:167], v[80:83], v[252:255]
    v_mfma_f32_16x16x32_bf16 v[244:247], v[164:167], v[88:91], v[244:247]
    s_waitcnt lgkmcnt(4)
    ds_read_b128 v[80:83], v13 offset:37120
    v_mfma_f32_16x16x32_bf16 v[244:247], a[52:55], v[92:95], v[244:247]
    v_mfma_f32_16x16x32_bf16 v[240:243], a[48:51], v[92:95], v[240:243]
    s_waitcnt lgkmcnt(4)
    ds_read_b128 v[84:87], v13 offset:39168
    v_mfma_f32_16x16x32_bf16 v[240:243], v[160:163], v[88:91], v[240:243]
    v_mfma_f32_16x16x32_bf16 v[240:243], a[56:59], v[64:67], v[240:243]
    s_waitcnt lgkmcnt(4)
    ds_read_b128 v[88:91], v13 offset:36864
    v_mfma_f32_16x16x32_bf16 v[240:243], a[64:67], v[68:71], v[240:243]
    v_mfma_f32_16x16x32_bf16 v[244:247], a[68:71], v[68:71], v[244:247]
    s_waitcnt lgkmcnt(4)
    ds_read_b128 v[92:95], v13 offset:38912
    v_mfma_f32_16x16x32_bf16 v[244:247], a[60:63], v[64:67], v[244:247]
    v_mfma_f32_16x16x32_bf16 v[252:255], a[60:63], v[72:75], v[252:255]
    s_waitcnt lgkmcnt(4)
    ds_read_b128 v[64:67], v13 offset:40960
    v_mfma_f32_16x16x32_bf16 v[252:255], a[68:71], v[76:79], v[252:255]
    v_mfma_f32_16x16x32_bf16 v[248:251], a[64:67], v[76:79], v[248:251]
    s_waitcnt lgkmcnt(4)
    ds_read_b128 v[68:71], v13 offset:43008
    v_mfma_f32_16x16x32_bf16 v[248:251], a[56:59], v[72:75], v[248:251]
    v_mfma_f32_16x16x32_bf16 v[248:251], v[176:179], v[80:83], v[248:251]
    s_waitcnt lgkmcnt(4)
    ds_read_b128 v[72:75], v13 offset:41216
    v_mfma_f32_16x16x32_bf16 v[248:251], a[72:75], v[84:87], v[248:251]
    s_waitcnt vmcnt(4)
    v_cmp_gt_u32 vcc, v104, v61
    v_mfma_f32_16x16x32_bf16 v[252:255], a[76:79], v[84:87], v[252:255]
    s_waitcnt lgkmcnt(4)
    ds_read_b128 v[76:79], v13 offset:43264
    s_andn2_b32 s7, s6, vcc_lo
    s_and_b32 s6, s6, vcc_lo
    s_bitcmp0_b32 s7, 2
    s_cbranch_scc1 T2_ff_kernel
    buffer_load_dwordx4 a[200:203], v4, s[12:15], s53 offen offset:0 sc1
    buffer_load_dwordx4 a[204:207], v4, s[12:15], s53 offen offset:1024 sc1
    buffer_load_dwordx4 a[208:211], v4, s[12:15], s53 offen offset:2048 sc1
    buffer_load_dwordx4 a[212:215], v4, s[12:15], s53 offen offset:3072 sc1
T2_ff_kernel:
    s_bitcmp0_b32 s7, 1
    s_cbranch_scc1 T1_ff_kernel
    buffer_load_dwordx4 a[184:187], v4, s[12:15], s51 offen offset:0 sc1
    buffer_load_dwordx4 a[188:191], v4, s[12:15], s51 offen offset:1024 sc1
    buffer_load_dwordx4 a[192:195], v4, s[12:15], s51 offen offset:2048 sc1
    buffer_load_dwordx4 a[196:199], v4, s[12:15], s51 offen offset:3072 sc1
T1_ff_kernel:
    s_bitcmp0_b32 s7, 0
    s_cbranch_scc1 T0_ff_kernel
    buffer_load_dwordx4 a[168:171], v4, s[12:15], s50 offen offset:0 sc1
    buffer_load_dwordx4 a[172:175], v4, s[12:15], s50 offen offset:1024 sc1
    buffer_load_dwordx4 a[176:179], v4, s[12:15], s50 offen offset:2048 sc1
    buffer_load_dwordx4 a[180:183], v4, s[12:15], s50 offen offset:3072 sc1
T0_ff_kernel:
    v_mfma_f32_16x16x32_bf16 v[252:255], v[180:183], v[80:83], v[252:255]
    v_mfma_f32_16x16x32_bf16 v[244:247], v[180:183], v[88:91], v[244:247]
    s_waitcnt lgkmcnt(4)
    ds_read_b128 v[80:83], v13 offset:45312
    v_mfma_f32_16x16x32_bf16 v[244:247], a[76:79], v[92:95], v[244:247]
    v_mfma_f32_16x16x32_bf16 v[240:243], a[72:75], v[92:95], v[240:243]
    s_waitcnt lgkmcnt(4)
    ds_read_b128 v[84:87], v13 offset:47360
    v_mfma_f32_16x16x32_bf16 v[240:243], v[176:179], v[88:91], v[240:243]
    v_mfma_f32_16x16x32_bf16 v[240:243], a[80:83], v[64:67], v[240:243]
    s_waitcnt lgkmcnt(4)
    ds_read_b128 v[88:91], v13 offset:45056
    v_mfma_f32_16x16x32_bf16 v[240:243], a[88:91], v[68:71], v[240:243]
    v_mfma_f32_16x16x32_bf16 v[244:247], a[92:95], v[68:71], v[244:247]
    s_waitcnt lgkmcnt(4)
    ds_read_b128 v[92:95], v13 offset:47104
    v_mfma_f32_16x16x32_bf16 v[244:247], a[84:87], v[64:67], v[244:247]
    s_barrier
    v_mfma_f32_16x16x32_bf16 v[252:255], a[84:87], v[72:75], v[252:255]
    s_waitcnt lgkmcnt(4)
    ds_read_b128 v[64:67], v13 offset:49152
    v_mfma_f32_16x16x32_bf16 v[252:255], a[92:95], v[76:79], v[252:255]
    buffer_load_dword v62, v108, s[12:15], s26 offen sc1
    v_mfma_f32_16x16x32_bf16 v[248:251], a[88:91], v[76:79], v[248:251]
    s_waitcnt lgkmcnt(4)
    ds_read_b128 v[68:71], v13 offset:51200
    v_mfma_f32_16x16x32_bf16 v[248:251], a[80:83], v[72:75], v[248:251]
    v_mfma_f32_16x16x32_bf16 v[248:251], v[192:195], v[80:83], v[248:251]
    s_waitcnt lgkmcnt(4)
    ds_read_b128 v[72:75], v13 offset:49408
    v_mfma_f32_16x16x32_bf16 v[248:251], a[96:99], v[84:87], v[248:251]
    v_mfma_f32_16x16x32_bf16 v[252:255], a[100:103], v[84:87], v[252:255]
    s_waitcnt lgkmcnt(4)
    ds_read_b128 v[76:79], v13 offset:51456
    v_mfma_f32_16x16x32_bf16 v[252:255], v[196:199], v[80:83], v[252:255]
    v_mfma_f32_16x16x32_bf16 v[244:247], v[196:199], v[88:91], v[244:247]
    s_waitcnt lgkmcnt(4)
    ds_read_b128 v[80:83], v13 offset:53504
    v_mfma_f32_16x16x32_bf16 v[244:247], a[100:103], v[92:95], v[244:247]
    v_mfma_f32_16x16x32_bf16 v[240:243], a[96:99], v[92:95], v[240:243]
    s_waitcnt lgkmcnt(4)
    ds_read_b128 v[84:87], v13 offset:55552
    v_mfma_f32_16x16x32_bf16 v[240:243], v[192:195], v[88:91], v[240:243]
    v_mfma_f32_16x16x32_bf16 v[240:243], a[104:107], v[64:67], v[240:243]
    s_waitcnt lgkmcnt(4)
    ds_read_b128 v[88:91], v13 offset:53248
    v_mfma_f32_16x16x32_bf16 v[240:243], a[112:115], v[68:71], v[240:243]
    v_mfma_f32_16x16x32_bf16 v[244:247], a[116:119], v[68:71], v[244:247]
    s_waitcnt lgkmcnt(4)
    ds_read_b128 v[92:95], v13 offset:55296
    v_mfma_f32_16x16x32_bf16 v[244:247], a[108:111], v[64:67], v[244:247]
    v_mfma_f32_16x16x32_bf16 v[252:255], a[108:111], v[72:75], v[252:255]
    s_waitcnt lgkmcnt(4)
    ds_read_b128 v[64:67], v13 offset:57344
    v_mfma_f32_16x16x32_bf16 v[252:255], a[116:119], v[76:79], v[252:255]
    v_mfma_f32_16x16x32_bf16 v[248:251], a[112:115], v[76:79], v[248:251]
    s_waitcnt lgkmcnt(4)
    ds_read_b128 v[68:71], v13 offset:59392
    v_mfma_f32_16x16x32_bf16 v[248:251], a[104:107], v[72:75], v[248:251]
    v_mfma_f32_16x16x32_bf16 v[248:251], a[120:123], v[80:83], v[248:251]
    s_waitcnt lgkmcnt(4)
    ds_read_b128 v[72:75], v13 offset:57600
    v_mfma_f32_16x16x32_bf16 v[248:251], a[128:131], v[84:87], v[248:251]
    v_mfma_f32_16x16x32_bf16 v[252:255], a[132:135], v[84:87], v[252:255]
    s_waitcnt lgkmcnt(4)
    ds_read_b128 v[76:79], v13 offset:59648
    v_mfma_f32_16x16x32_bf16 v[252:255], a[124:127], v[80:83], v[252:255]
    v_mfma_f32_16x16x32_bf16 v[244:247], a[124:127], v[88:91], v[244:247]
    s_waitcnt lgkmcnt(4)
    ds_read_b128 v[80:83], v13 offset:61696
    v_mfma_f32_16x16x32_bf16 v[244:247], a[132:135], v[92:95], v[244:247]
    v_mfma_f32_16x16x32_bf16 v[240:243], a[128:131], v[92:95], v[240:243]
    s_waitcnt lgkmcnt(4)
    ds_read_b128 v[84:87], v13 offset:63744
    v_mfma_f32_16x16x32_bf16 v[240:243], a[120:123], v[88:91], v[240:243]
    v_mfma_f32_16x16x32_bf16 v[240:243], a[136:139], v[64:67], v[240:243]
    s_waitcnt lgkmcnt(4)
    ds_read_b128 v[88:91], v13 offset:61440
    v_mfma_f32_16x16x32_bf16 v[240:243], a[144:147], v[68:71], v[240:243]
    v_mfma_f32_16x16x32_bf16 v[244:247], a[148:151], v[68:71], v[244:247]
    s_waitcnt lgkmcnt(4)
    ds_read_b128 v[92:95], v13 offset:63488
    v_mfma_f32_16x16x32_bf16 v[244:247], a[140:143], v[64:67], v[244:247]
    v_mfma_f32_16x16x32_bf16 v[252:255], a[140:143], v[72:75], v[252:255]
    s_waitcnt lgkmcnt(4)
    v_mfma_f32_16x16x32_bf16 v[252:255], a[148:151], v[76:79], v[252:255]
    v_mfma_f32_16x16x32_bf16 v[248:251], a[144:147], v[76:79], v[248:251]
    s_waitcnt lgkmcnt(3)
    v_mfma_f32_16x16x32_bf16 v[248:251], a[136:139], v[72:75], v[248:251]
    v_mfma_f32_16x16x32_bf16 v[248:251], a[152:155], v[80:83], v[248:251]
    s_waitcnt lgkmcnt(2)
    v_mfma_f32_16x16x32_bf16 v[248:251], a[160:163], v[84:87], v[248:251]
    v_mfma_f32_16x16x32_bf16 v[252:255], a[164:167], v[84:87], v[252:255]
    s_waitcnt lgkmcnt(1)
    v_mfma_f32_16x16x32_bf16 v[252:255], a[156:159], v[80:83], v[252:255]
    v_mfma_f32_16x16x32_bf16 v[244:247], a[156:159], v[88:91], v[244:247]
    s_waitcnt lgkmcnt(0)
    v_mfma_f32_16x16x32_bf16 v[244:247], a[164:167], v[92:95], v[244:247]
    v_mfma_f32_16x16x32_bf16 v[240:243], a[160:163], v[92:95], v[240:243]
    v_mfma_f32_16x16x32_bf16 v[240:243], a[152:155], v[88:91], v[240:243]
    s_cmp_lg_u32 s6, 0
    s_cbranch_scc1 FB_ff_kernel
FBACK_ff_kernel:
    s_waitcnt vmcnt(0)
    v_mfma_f32_16x16x32_bf16 v[224:227], v[18:21], a[168:171], v[224:227]
    v_mfma_f32_16x16x32_bf16 v[228:231], v[16:19], a[168:171], v[228:231]
    v_mfma_f32_16x16x32_bf16 v[232:235], v[18:21], a[172:175], v[232:235]
    v_mfma_f32_16x16x32_bf16 v[236:239], v[16:19], a[172:175], v[236:239]
    v_mfma_f32_16x16x32_bf16 v[240:243], v[18:21], a[176:179], v[240:243]
    v_mfma_f32_16x16x32_bf16 v[244:247], v[16:19], a[176:179], v[244:247]
    v_mfma_f32_16x16x32_bf16 v[248:251], v[18:21], a[180:183], v[248:251]
    v_mfma_f32_16x16x32_bf16 v[252:255], v[16:19], a[180:183], v[252:255]
    v_mfma_f32_16x16x32_bf16 v[224:227], v[18:21], a[184:187], v[224:227]
    v_mfma_f32_16x16x32_bf16 v[228:231], v[16:19], a[184:187], v[228:231]
    v_mfma_f32_16x16x32_bf16 v[232:235], v[18:21], a[188:191], v[232:235]
    v_mfma_f32_16x16x32_bf16 v[236:239], v[16:19], a[188:191], v[236:239]
    v_mfma_f32_16x16x32_bf16 v[240:243], v[18:21], a[192:195], v[240:243]
    v_mfma_f32_16x16x32_bf16 v[244:247], v[16:19], a[192:195], v[244:247]
    v_mfma_f32_16x16x32_bf16 v[248:251], v[18:21], a[196:199], v[248:251]
    v_mfma_f32_16x16x32_bf16 v[252:255], v[16:19], a[196:199], v[252:255]
    v_mfma_f32_16x16x32_bf16 v[224:227], v[18:21], a[200:203], v[224:227]
    v_mfma_f32_16x16x32_bf16 v[228:231], v[16:19], a[200:203], v[228:231]
    v_mfma_f32_16x16x32_bf16 v[232:235], v[18:21], a[204:207], v[232:235]
    v_mfma_f32_16x16x32_bf16 v[236:239], v[16:19], a[204:207], v[236:239]
    v_mfma_f32_16x16x32_bf16 v[240:243], v[18:21], a[208:211], v[240:243]
    v_mfma_f32_16x16x32_bf16 v[244:247], v[16:19], a[208:211], v[244:247]
    v_mfma_f32_16x16x32_bf16 v[248:251], v[18:21], a[212:215], v[248:251]
    v_mfma_f32_16x16x32_bf16 v[252:255], v[16:19], a[212:215], v[252:255]
    s_nop 7
    buffer_store_dwordx4 v[224:227], v10, s[12:15], s33 offen offset:0 sc1
    buffer_store_dwordx4 v[228:231], v10, s[12:15], s33 offen offset:16 sc1
    v_mul_f32 v168, v224, v11
    v_mul_f32 v169, v225, v11
    v_mul_f32 v170, v226, v11
    v_mul_f32 v171, v227, v11
    v_mul_f32 v172, v228, v11
    v_mul_f32 v173, v229, v11
    v_mul_f32 v174, v230, v11
    v_mul_f32 v175, v231, v11
    v_cvt_pk_bf16_f32 v40, v168, v169
    v_cvt_pk_bf16_f32 v41, v170, v171
    v_cvt_pk_bf16_f32 v42, v172, v173
    v_cvt_pk_bf16_f32 v43, v174, v175
    buffer_store_dwordx4 v[40:43], v8, s[12:15], s32 offen offset:0 sc1
    v_cvt_pk_bf16_f32 v44, v232, v233
    v_cvt_pk_bf16_f32 v45, v234, v235
    v_cvt_pk_bf16_f32 v46, v236, v237
    v_cvt_pk_bf16_f32 v47, v238, v239
    buffer_store_dwordx4 v[44:47], v8, s[12:15], s32 offen offset:256 sc1
    v_cvt_pk_bf16_f32 v48, v240, v241
    v_cvt_pk_bf16_f32 v49, v242, v243
    v_cvt_pk_bf16_f32 v50, v244, v245
    v_cvt_pk_bf16_f32 v51, v246, v247
    buffer_store_dwordx4 v[48:51], v8, s[12:15], s32 offen offset:512 sc1
    v_cvt_pk_bf16_f32 v52, v248, v249
    v_cvt_pk_bf16_f32 v53, v250, v251
    v_cvt_pk_bf16_f32 v54, v252, v253
    v_cvt_pk_bf16_f32 v55, v254, v255
    buffer_store_dwordx4 v[52:55], v8, s[12:15], s32 offen offset:768 sc1
    v_pk_mul_f32 v[184:185], v[168:169], v[168:169]
    v_pk_mul_f32 v[186:187], v[170:171], v[170:171]
    v_pk_mul_f32 v[188:189], v[172:173], v[172:173]
    v_pk_mul_f32 v[190:191], v[174:175], v[174:175]
    v_pk_fma_f32 v[184:185], v[232:233], v[232:233], v[184:185]
    v_pk_fma_f32 v[186:187], v[234:235], v[234:235], v[186:187]
    v_pk_fma_f32 v[188:189], v[236:237], v[236:237], v[188:189]
    v_pk_fma_f32 v[190:191], v[238:239], v[238:239], v[190:191]
    v_pk_fma_f32 v[184:185], v[240:241], v[240:241], v[184:185]
    v_pk_fma_f32 v[186:187], v[242:243], v[242:243], v[186:187]
    v_pk_fma_f32 v[188:189], v[244:245], v[244:245], v[188:189]
    v_pk_fma_f32 v[190:191], v[246:247], v[246:247], v[190:191]
    v_pk_fma_f32 v[184:185], v[248:249], v[248:249], v[184:185]
    v_pk_fma_f32 v[186:187], v[250:251], v[250:251], v[186:187]
    v_pk_fma_f32 v[188:189], v[252:253], v[252:253], v[188:189]
    v_pk_fma_f32 v[190:191], v[254:255], v[254:255], v[190:191]
    s_nop 1
    v_add_f32_dpp v24, v184, v184 row_ror:8 row_mask:0xf bank_mask:0x3
    v_add_f32_dpp v24, v188, v188 row_ror:8 row_mask:0xf bank_mask:0xc
    v_add_f32_dpp v25, v185, v185 row_ror:8 row_mask:0xf bank_mask:0x3
    v_add_f32_dpp v25, v189, v189 row_ror:8 row_mask:0xf bank_mask:0xc
    v_add_f32_dpp v26, v186, v186 row_ror:8 row_mask:0xf bank_mask:0x3
    v_add_f32_dpp v26, v190, v190 row_ror:8 row_mask:0xf bank_mask:0xc
    v_add_f32_dpp v27, v187, v187 row_ror:8 row_mask:0xf bank_mask:0x3
    v_add_f32_dpp v27, v191, v191 row_ror:8 row_mask:0xf bank_mask:0xc
    s_nop 1
    v_add_f32_dpp v184, v24, v24 row_half_mirror row_mask:0xf bank_mask:0x5
    v_add_f32_dpp v184, v26, v26 row_half_mirror row_mask:0xf bank_mask:0xa
    v_add_f32_dpp v185, v25, v25 row_half_mirror row_mask:0xf bank_mask:0x5
    v_add_f32_dpp v185, v27, v27 row_half_mirror row_mask:0xf bank_mask:0xa
    v_and_b32 v2, 1, v5
    v_cmp_eq_u32 vcc, 0, v2
    v_add_f32_dpp v184, v184, v184 quad_perm:[2,3,0,1] row_mask:0xf bank_mask:0xf
    v_add_f32_dpp v185, v185, v185 quad_perm:[2,3,0,1] row_mask:0xf bank_mask:0xf
    s_nop 0
    v_add_f32_dpp v184, v184, v184 quad_perm:[1,0,3,2] row_mask:0xf bank_mask:0xf
    v_add_f32_dpp v185, v185, v185 quad_perm:[1,0,3,2] row_mask:0xf bank_mask:0xf
    v_cndmask_b32 v184, v185, v184, vcc
    buffer_atomic_add_f32 v184, v9, s[12:15], s33 offen
    s_getpc_b64 s[60:61]
PF_ff_kernel_3:
    v_lshlrev_b32 v152, 0, v0
    v_min_u32 v152, END_k2_kernel-BODY_k2_kernel-4, v152
    v_add_u32 v152, BODY_k2_kernel-PF_ff_kernel_3, v152
    v_ashrrev_i32 v153, 31, v152
    v_lshl_add_u64 v[152:153], v[152:153], 0, s[60:61]
    global_load_dword v63, v[152:153], off
END_ff_kernel:
    s_endpgm
FB_ff_kernel:
    s_waitcnt vmcnt(0)
    v_cmp_gt_u32 vcc, v104, v62
    s_nop 2
    s_add_u32 s52, s52, 1
    s_cmp_gt_u32 s52, 200000
    s_cselect_b32 s28, 0, vcc_lo
    s_andn2_b32 s5, s6, s28
    s_bitcmp0_b32 s5, 2
    s_cbranch_scc1 U2_ff_kernel
    buffer_load_dwordx4 a[200:203], v4, s[12:15], s53 offen offset:0 sc1
    buffer_load_dwordx4 a[204:207], v4, s[12:15], s53 offen offset:1024 sc1
    buffer_load_dwordx4 a[208:211], v4, s[12:15], s53 offen offset:2048 sc1
    buffer_load_dwordx4 a[212:215], v4, s[12:15], s53 offen offset:3072 sc1
U2_ff_kernel:
    s_bitcmp0_b32 s5, 1
    s_cbranch_scc1 U1_ff_kernel
    buffer_load_dwordx4 a[184:187], v4, s[12:15], s51 offen offset:0 sc1
    buffer_load_dwordx4 a[188:191], v4, s[12:15], s51 offen offset:1024 sc1
    buffer_load_dwordx4 a[192:195], v4, s[12:15], s51 offen offset:2048 sc1
    buffer_load_dwordx4 a[196:199], v4, s[12:15], s51 offen offset:3072 sc1
U1_ff_kernel:
    s_bitcmp0_b32 s5, 0
    s_cbranch_scc1 U0_ff_kernel
    buffer_load_dwordx4 a[168:171], v4, s[12:15], s50 offen offset:0 sc1
    buffer_load_dwordx4 a[172:175], v4, s[12:15], s50 offen offset:1024 sc1
    buffer_load_dwordx4 a[176:179], v4, s[12:15], s50 offen offset:2048 sc1
    buffer_load_dwordx4 a[180:183], v4, s[12:15], s50 offen offset:3072 sc1
U0_ff_kernel:
    s_and_b32 s6, s6, s28
    s_cbranch_scc0 FBACK_ff_kernel
    buffer_load_dword v62, v108, s[12:15], s26 offen sc1
    s_branch FB_ff_kernel
SLOW0_ff_kernel:
    s_add_u32 s52, s52, 1
    s_cmp_gt_u32 s52, 200000
    s_cbranch_scc1 BACK0_ff_kernel
    buffer_load_dword v61, v58, s[12:15], s26 offen sc1
    s_waitcnt vmcnt(0)
    v_cmp_gt_u32 vcc, 1, v61
    s_nop 4
    s_cbranch_vccnz SLOW0_ff_kernel
    s_branch BACK0_ff_kernel
SLOW1_ff_kernel:
    s_add_u32 s52, s52, 1
    s_cmp_gt_u32 s52, 200000
    s_cbranch_scc1 BACK1_ff_kernel
    buffer_load_dword v62, v58, s[12:15], s26 offen sc1
    s_waitcnt vmcnt(0)
    v_cmp_gt_u32 vcc, 2, v62
    s_nop 4
    s_cbranch_vccnz SLOW1_ff_kernel
    s_branch BACK1_ff_kernel
SLOW2_ff_kernel:
    s_add_u32 s52, s52, 1
    s_cmp_gt_u32 s52, 200000
    s_cbranch_scc1 BACK2_ff_kernel
    buffer_load_dword v61, v58, s[12:15], s26 offen sc1
    s_waitcnt vmcnt(0)
    v_cmp_gt_u32 vcc, 3, v61
    s_nop 4
    s_cbranch_vccnz SLOW2_ff_kernel
    s_branch BACK2_ff_kernel
SLOW3_ff_kernel:
    s_add_u32 s52, s52, 1
    s_cmp_gt_u32 s52, 200000
    s_cbranch_scc1 BACK3_ff_kernel
    buffer_load_dword v62, v58, s[12:15], s26 offen sc1
    s_waitcnt vmcnt(0)
    v_cmp_gt_u32 vcc, 4, v62
    s_nop 4
    s_cbranch_vccnz SLOW3_ff_kernel
    s_branch BACK3_ff_kernel
SLOW4_ff_kernel:
    s_add_u32 s52, s52, 1
    s_cmp_gt_u32 s52, 200000
    s_cbranch_scc1 BACK4_ff_kernel
    buffer_load_dword v61, v58, s[12:15], s26 offen sc1
    s_waitcnt vmcnt(0)
    v_cmp_gt_u32 vcc, 5, v61
    s_nop 4
    s_cbranch_vccnz SLOW4_ff_kernel
    s_branch BACK4_ff_kernel
SLOW5_ff_kernel:
    s_add_u32 s52, s52, 1
    s_cmp_gt_u32 s52, 200000
    s_cbranch_scc1 BACK5_ff_kernel
    buffer_load_dword v62, v58, s[12:15], s26 offen sc1
    s_waitcnt vmcnt(0)
    v_cmp_gt_u32 vcc, 6, v62
    s_nop 4
    s_cbranch_vccnz SLOW5_ff_kernel
    s_branch BACK5_ff_kernel
SLOW6_ff_kernel:
    s_add_u32 s52, s52, 1
    s_cmp_gt_u32 s52, 200000
    s_cbranch_scc1 BACK6_ff_kernel
    buffer_load_dword v61, v58, s[12:15], s26 offen sc1
    s_waitcnt vmcnt(0)
    v_cmp_gt_u32 vcc, 7, v61
    s_nop 4
    s_cbranch_vccnz SLOW6_ff_kernel
    s_branch BACK6_ff_kernel
LAST_ff_kernel:

.globl ffb_kernel
.p2align 8
.type ffb_kernel,@function
ffb_kernel:
    s_cmp_ge_u32 s2, 256
    s_cbranch_scc1 END_ffb_kernel
    s_mov_b32 s52, 0
    s_load_dwordx2 s[4:5], s[0:1], 64
    s_load_dwordx2 s[30:31], s[0:1], 48
    s_getpc_b64 s[60:61]
PF_ffb_kernel_1:
    v_lshlrev_b32 v2, 7, v0
    v_min_u32 v2, MID_ffb_kernel-PF_ffb_kernel_1-4, v2
    v_mov_b32 v3, 0
    v_lshl_add_u64 v[2:3], v[2:3], 0, s[60:61]
    global_load_dword v63, v[2:3], off
    s_and_b32 s6, s2, 7
    s_lshr_b32 s7, s2, 3
    s_lshr_b32 s8, s6, 1
    s_and_b32 s9, s6, 1
    s_lshl_b32 s9, s9, 3
    s_lshr_b32 s10, s7, 2
    s_add_u32 s9, s9, s10
    s_and_b32 s10, s7, 3
    v_lshrrev_b32 v1, 6, v0
    v_and_b32 v5, 63, v0
    v_readfirstlane_b32 s11, v1
    v_lshlrev_b32 v4, 4, v5
    v_lshrrev_b32 v7, 4, v5
    v_lshlrev_b32 v1, 9, v7
    v_and_b32 v6, 15, v5
    v_lshl_add_u32 v1, v6, 4, v1
    s_lshl_b32 s19, s9, 2
    s_add_u32 s19, s19, s11
    s_lshl_b32 s16, s8, 2
    s_add_u32 s23, s16, s10
    s_mul_i32 s16, s23, 458752
    s_add_u32 s16, s16, 41943040
    s_lshl_b32 s22, s11, 12
    s_lshl_b32 s25, s11, 10
    s_add_u32 s17, s16, s25
    s_add_u32 s16, s16, s22
    s_nop 0
    s_mul_i32 s18, s19, 65536
    s_add_u32 s18, s18, 71303168
    v_lshlrev_b32 v0, 7, v0
    v_and_b32 v224, 3, v5
    v_bfe_u32 v2, v5, 3, 1
    v_lshl_add_u32 v224, v2, 2, v224
    v_lshlrev_b32 v224, 4, v224
    v_bfe_u32 v2, v5, 2, 1
    v_lshl_add_u32 v224, v2, 10, v224
    v_bfe_u32 v2, v5, 4, 1
    v_lshl_add_u32 v224, v2, 9, v224
    v_lshrrev_b32 v66, 5, v5
    v_lshl_add_u32 v224, v66, 15, v224
    v_add_u32 v225, 16384, v224
    s_lshr_b32 s21, s23, 2
    s_lshl2_add_u32 s28, s9, s21
    s_mul_i32 s28, s28, 65536
    s_and_b32 s27, s23, 3
    s_lshl_b32 s45, s27, 14
    s_add_u32 s45, s45, s28
    s_add_u32 s45, s45, s22
    s_add_u32 s45, s45, 109051904
    s_lshl_b32 s27, s27, 7
    s_add_u32 s28, s28, s27
    s_add_u32 s28, s28, s22
    s_add_u32 s28, s28, 71303168
    s_lshl4_add_u32 s27, s9, s21
    s_and_b32 s21, s23, 1
    s_lshl3_add_u32 s27, s21, s27
    s_lshr_b32 s21, s11, 1
    s_lshl2_add_u32 s27, s21, s27
    s_lshl_b32 s27, s27, 5
    s_and_b32 s21, s23, 2
    s_lshl3_add_u32 s27, s21, s27
    s_and_b32 s21, s11, 1
    s_lshl3_add_u32 s27, s21, s27
    s_add_u32 s27, s27, 63971328
    v_lshrrev_b32 v2, 1, v6
    v_xor_b32 v2, v2, v7
    v_lshlrev_b32 v2, 4, v2
    v_lshl_add_u32 v8, v6, 7, v2
    v_xor_b32 v10, 64, v8
    v_add_u32 v9, 0x10000, v8
    v_add_u32 v11, 0x10000, v10
    v_mov_b32 v12, v1
    v_add_u32 v13, 0x10000, v1
    v_and_b32 v14, 0x23, v5
    v_and_b32 v2, 12, v5
    v_lshl_or_b32 v14, v2, 1, v14
    v_and_b32 v2, 16, v5
    v_lshrrev_b32 v2, 2, v2
    v_or_b32 v14, v14, v2
    v_lshlrev_b32 v14, 4, v14
    s_mul_i32 s20, s19, 224
    s_mul_i32 s21, s8, 56
    s_add_u32 s20, s20, s21
    s_lshl_b32 s20, s20, 10
    s_add_u32 s20, s20, 75497472
    s_add_u32 s21, s10, 0
    s_and_b32 s21, s21, 3
    s_mul_i32 s21, s21, 14336
    s_add_u32 s40, s20, s21
    s_add_u32 s21, s10, 1
    s_and_b32 s21, s21, 3
    s_mul_i32 s21, s21, 14336
    s_add_u32 s41, s20, s21
    s_add_u32 s21, s10, 2
    s_and_b32 s21, s21, 3
    s_mul_i32 s21, s21, 14336
    s_add_u32 s42, s20, s21
    s_add_u32 s21, s10, 3
    s_and_b32 s21, s21, 3
    s_mul_i32 s21, s21, 14336
    s_add_u32 s43, s20, s21
    s_lshl2_add_u32 s20, s19, s10
    s_mul_i32 s20, s20, 49152
    s_add_u32 s20, s20, 91226112
    s_add_u32 s21, s8, 1
    s_and_b32 s21, s21, 3
    s_mul_i32 s21, s21, 12288
    s_add_u32 s21, s21, 0
    s_add_u32 s24, s20, s21
    s_add_u32 s21, s8, 2
    s_and_b32 s21, s21, 3
    s_mul_i32 s21, s21, 12288
    s_add_u32 s21, s21, 4096
    s_add_u32 s29, s20, s21
    s_add_u32 s21, s8, 3
    s_and_b32 s21, s21, 3
    s_mul_i32 s21, s21, 12288
    s_add_u32 s21, s21, 8192
    s_add_u32 s44, s20, s21
    s_mul_i32 s21, s8, 12288
    s_add_u32 s50, s20, s21
    s_add_u32 s51, s50, 4096
    s_add_u32 s53, s50, 8192
    s_lshl_b32 s26, s19, 11
    s_add_u32 s26, s26, 132120576
    v_min_u32 v2, 2, v5
    v_add_u32 v2, 1, v2
    v_add_u32 v58, s10, v2
    v_and_b32 v58, 3, v58
    v_lshlrev_b32 v58, 7, v58
    s_lshl_b32 s20, s8, 9
    v_add_u32 v58, s20, v58
    v_and_b32 v15, 3, v5
    s_lshl_b32 s21, s11, 9
    v_lshl_add_u32 v15, v15, 7, s21
    s_lshl_b32 s21, s10, 7
    v_cmp_eq_u32 vcc, 0, v5
    v_bfrev_b32 v59, -2
    s_add_u32 s21, s21, s20
    v_mov_b32 v2, s21
    v_cndmask_b32 v59, v59, v2, vcc
    v_mov_b32 v60, 1
    s_lshl2_add_u32 s21, s10, s8
    s_lshr_b32 s20, s9, 2
    s_lshl_b32 s32, s20, 9
    s_and_b32 s20, s9, 2
    s_lshl_b32 s20, s20, 6
    s_add_u32 s32, s32, s20
    s_and_b32 s20, s9, 1
    s_lshl4_add_u32 s32, s20, s32
    s_add_u32 s32, s32, s11
    s_lshl_b32 s32, s32, 11
    s_lshl_b32 s20, s21, 7
    s_add_u32 s32, s32, s20
    s_add_u32 s33, s32, 0x80000
    s_mul_i32 s3, s19, 65536
    s_add_u32 s3, s3, s20
    s_add_u32 s3, s3, 109051904
    v_lshrrev_b32 v2, 2, v6
    v_cmp_eq_u32 vcc, v2, v7
    v_and_b32 v2, 1, v5
    v_lshlrev_b32 v2, 4, v2
    v_mov_b32 v3, 0x3f80
    v_lshlrev_b32 v2, v2, v3
    v_mov_b32 v16, 0
    v_cndmask_b32 v2, v16, v2, vcc
    v_and_b32 v3, 2, v5
    v_cmp_eq_u32 vcc, 0, v3
    v_mov_b32 v17, 0
    v_mov_b32 v20, 0
    v_mov_b32 v21, 0
    v_cndmask_b32 v18, v16, v2, vcc
    v_cndmask_b32 v19, v2, v16, vcc
    v_and_b32 v67, 4, v5
    v_lshlrev_b32 v67, 2, v67
    v_bfe_u32 v2, v5, 3, 2
    v_lshl_add_u32 v67, v2, 2, v67
    v_and_b32 v2, 3, v5
    v_add_u32 v67, v67, v2
    v_cvt_f32_u32 v67, v67
    v_cvt_f32_u32 v68, v66
    v_mul_f32 v69, 0x3d000000, v67
    v_mul_f32 v70, v69, v68
    v_mul_f32 v70, 0x41000000, v70
    s_waitcnt lgkmcnt(0)
    s_mov_b32 s12, s4
    s_mov_b32 s13, s5
    s_mov_b32 s14, 268435456
    s_mov_b32 s15, 0x00020000
    s_buffer_load_dwordx2 s[96:97], s[12:15], s27
    s_add_u32 s27, s27, 67108864
    s_buffer_load_dwordx2 s[98:99], s[12:15], s27
    s_mov_b32 s5, s45
    s_add_u32 m0, s25, 0
    s_nop 0
    buffer_load_dwordx4 v4, s[12:15], s17 offen lds
    buffer_load_dwordx4 a[0:3], v1, s[12:15], s18 offen offset:0
    buffer_load_dwordx4 a[4:7], v1, s[12:15], s18 offen offset:256
    buffer_load_dwordx4 a[8:11], v1, s[12:15], s18 offen offset:2048
    buffer_load_dwordx4 a[12:15], v1, s[12:15], s18 offen offset:2304
    s_add_u32 m0, s25, 4096
    s_add_u32 s17, s17, 4096
    buffer_load_dwordx4 v4, s[12:15], s17 offen lds
    s_add_u32 m0, s25, 8192
    s_add_u32 s17, s17, 4096
    buffer_load_dwordx4 v4, s[12:15], s17 offen lds
    s_add_u32 m0, s25, 12288
    s_add_u32 s17, s17, 4096
    buffer_load_dwordx4 v4, s[12:15], s17 offen lds
    s_add_u32 s18, s18, 4096
    buffer_load_dwordx4 a[16:19], v1, s[12:15], s18 offen offset:0
    v_mul_f32 v73, 0x40000000, v69
    v_fmamk_f32 v160, v69, 0x00000000, v70
    v_fmamk_f32 v161, v69, 0x00000000, v70
    v_fmamk_f32 v162, v69, 0x3f800000, v70
    v_fmamk_f32 v163, v69, 0x3f800000, v70
    v_add_f32 v161, 0x3e800000, v161
    v_add_f32 v163, 0x3e800000, v163
    v_cos_f32 v72, v73
    v_sin_f32 v73, v73
    v_cos_f32 v144, v160
    v_cos_f32 v145, v161
    v_cos_f32 v146, v162
    v_cos_f32 v147, v163
    v_sin_f32 v160, v160
    v_sin_f32 v161, v161
    v_sin_f32 v162, v162
    v_sin_f32 v163, v163
    v_pk_mul_f32 v[148:149], v[144:145], v[72:73] op_sel:[0,0] op_sel_hi:[1,0]
    v_pk_mul_f32 v[164:165], v[160:161], v[72:73] op_sel:[0,0] op_sel_hi:[1,0]
    v_pk_mul_f32 v[150:151], v[146:147], v[72:73] op_sel:[0,0] op_sel_hi:[1,0]
    v_pk_mul_f32 v[166:167], v[162:163], v[72:73] op_sel:[0,0] op_sel_hi:[1,0]
    v_pk_fma_f32 v[148:149], v[160:161], v[72:73], v[148:149] op_sel:[0,1,0] op_sel_hi:[1,1,1] neg_lo:[1,0,0] neg_hi:[1,0,0]
    buffer_load_dwordx4 a[20:23], v1, s[12:15], s18 offen offset:256
    v_pk_fma_f32 v[164:165], v[144:145], v[72:73], v[164:165] op_sel:[0,1,0] op_sel_hi:[1,1,1]
    v_pk_fma_f32 v[150:151], v[162:163], v[72:73], v[150:151] op_sel:[0,1,0] op_sel_hi:[1,1,1] neg_lo:[1,0,0] neg_hi:[1,0,0]
    v_pk_fma_f32 v[166:167], v[146:147], v[72:73], v[166:167] op_sel:[0,1,0] op_sel_hi:[1,1,1]
    v_pk_mul_f32 v[152:153], v[148:149], v[72:73] op_sel:[0,0] op_sel_hi:[1,0]
    v_pk_mul_f32 v[168:169], v[164:165], v[72:73] op_sel:[0,0] op_sel_hi:[1,0]
    v_pk_mul_f32 v[154:155], v[150:151], v[72:73] op_sel:[0,0] op_sel_hi:[1,0]
    v_pk_mul_f32 v[170:171], v[166:167], v[72:73] op_sel:[0,0] op_sel_hi:[1,0]
    v_pk_fma_f32 v[152:153], v[164:165], v[72:73], v[152:153] op_sel:[0,1,0] op_sel_hi:[1,1,1] neg_lo:[1,0,0] neg_hi:[1,0,0]
    v_pk_fma_f32 v[168:169], v[148:149], v[72:73], v[168:169] op_sel:[0,1,0] op_sel_hi:[1,1,1]
    v_pk_fma_f32 v[154:155], v[166:167], v[72:73], v[154:155] op_sel:[0,1,0] op_sel_hi:[1,1,1] neg_lo:[1,0,0] neg_hi:[1,0,0]
    v_pk_fma_f32 v[170:171], v[150:151], v[72:73], v[170:171] op_sel:[0,1,0] op_sel_hi:[1,1,1]
    v_pk_mul_f32 v[156:157], v[152:153], v[72:73] op_sel:[0,0] op_sel_hi:[1,0]
    v_pk_mul_f32 v[172:173], v[168:169], v[72:73] op_sel:[0,0] op_sel_hi:[1,0]
    v_pk_mul_f32 v[158:159], v[154:155], v[72:73] op_sel:[0,0] op_sel_hi:[1,0]
    v_pk_mul_f32 v[174:175], v[170:171], v[72:73] op_sel:[0,0] op_sel_hi:[1,0]
    v_pk_fma_f32 v[156:157], v[168:169], v[72:73], v[156:157] op_sel:[0,1,0] op_sel_hi:[1,1,1] neg_lo:[1,0,0] neg_hi:[1,0,0]
    v_pk_fma_f32 v[172:173], v[152:153], v[72:73], v[172:173] op_sel:[0,1,0] op_sel_hi:[1,1,1]
    v_pk_fma_f32 v[158:159], v[170:171], v[72:73], v[158:159] op_sel:[0,1,0] op_sel_hi:[1,1,1] neg_lo:[1,0,0] neg_hi:[1,0,0]
    v_pk_fma_f32 v[174:175], v[154:155], v[72:73], v[174:175] op_sel:[0,1,0] op_sel_hi:[1,1,1]
    v_cvt_pk_bf16_f32 v144, v144, v145
    v_cvt_pk_bf16_f32 v146, v146, v147
    v_cvt_pk_bf16_f32 v148, v148, v149
    buffer_load_dwordx4 a[24:27], v1, s[12:15], s18 offen offset:2048
    v_cvt_pk_bf16_f32 v150, v150, v151
    v_cvt_pk_bf16_f32 v152, v152, v153
    v_cvt_pk_bf16_f32 v154, v154, v155
    v_cvt_pk_bf16_f32 v156, v156, v157
    v_cvt_pk_bf16_f32 v158, v158, v159
    v_cvt_pk_bf16_f32 v160, v160, v161
    v_cvt_pk_bf16_f32 v162, v162, v163
    v_cvt_pk_bf16_f32 v164, v164, v165
    v_cvt_pk_bf16_f32 v166, v166, v167
    v_cvt_pk_bf16_f32 v168, v168, v169
    v_cvt_pk_bf16_f32 v170, v170, v171
    v_cvt_pk_bf16_f32 v172, v172, v173
    v_cvt_pk_bf16_f32 v174, v174, v175
    v_accvgpr_write_b32 a224, v144
    v_accvgpr_write_b32 a225, v146
    v_accvgpr_write_b32 a226, v148
    v_accvgpr_write_b32 a227, v150
    v_accvgpr_write_b32 a228, v152
    v_accvgpr_write_b32 a229, v154
    v_accvgpr_write_b32 a230, v156
    v_accvgpr_write_b32 a231, v158
    v_accvgpr_write_b32 a232, v160
    buffer_load_dwordx4 a[28:31], v1, s[12:15], s18 offen offset:2304
    v_accvgpr_write_b32 a233, v162
    v_accvgpr_write_b32 a234, v164
    v_accvgpr_write_b32 a235, v166
    v_accvgpr_write_b32 a236, v168
    v_accvgpr_write_b32 a237, v170
    v_accvgpr_write_b32 a238, v172
    v_accvgpr_write_b32 a239, v174
    v_lshlrev_b32 v2, 31, v5
    v_xor_b32 v2, 1.0, v2
    v_mov_b32 v3, 0
    v_cmp_gt_u32 vcc, 32, v5
    v_accvgpr_write_b32 a209, v3
    v_accvgpr_write_b32 a210, v3
    v_cndmask_b32 v2, v3, v2, vcc
    v_accvgpr_write_b32 a211, v3
    v_accvgpr_write_b32 a208, v2
    v_cmp_gt_u32 vcc, 0x1000, v0
    v_mov_b32 v2, 0x3f3504f3
    s_lshl_b32 s21, s11, 3
    v_cndmask_b32 v29, v3, v2, vcc
    v_lshl_add_u32 v70, v66, 1, s21
    v_cvt_f32_u32 v70, v70
    s_add_u32 m0, s22, 16384
    s_add_u32 s16, s16, 16384
    buffer_load_dwordx4 v4, s[12:15], s16 offen offset:0 lds
    v_mul_f32 v69, 0x3a800000, v67
    v_mul_f32 v70, v69, v70
    v_fmamk_f32 v33, v69, 0x00000000, v70
    v_fmamk_f32 v35, v69, 0x3f800000, v70
    v_fmamk_f32 v37, v69, 0x40800000, v70
    v_fmamk_f32 v39, v69, 0x40a00000, v70
    v_cos_f32 v32, v33
    v_cos_f32 v34, v35
    v_cos_f32 v36, v37
    v_cos_f32 v38, v39
    v_sin_f32 v33, v33
    v_sin_f32 v35, v35
    v_sin_f32 v37, v37
    v_sin_f32 v39, v39
    s_lshr_b32 s21, s11, 1
    s_lshl_b32 s21, s21, 10
    s_and_b32 s20, s11, 1
    s_lshl3_add_u32 s21, s20, s21
    s_add_u32 s21, s21, 131072
    v_add_u32 v24, s21, v4
    s_lshl_b32 s21, s11, 13
    s_add_u32 s21, s21, 131072
    buffer_load_dwordx4 v4, s[12:15], s16 offen offset:1024 lds
    v_add_u32 v25, s21, v4
    v_and_b32 v26, 31, v5
    v_cvt_f32_u32 v226, v26
    v_lshlrev_b32 v26, 2, v26
    v_lshl_add_u32 v26, v66, 1, v26
    v_bfe_u32 v2, v5, 1, 3
    v_xor_b32 v26, v26, v2
    v_lshl_add_u32 v26, v26, 4, s21
    v_xor_b32 v27, 16, v26
    v_lshrrev_b32 v28, 3, v5
    v_xor_b32 v28, v28, v5
    v_lshl_add_u32 v28, v28, 4, s21
    v_mul_f32 v226, 0xbd000000, v226
    v_mul_f32 v227, v226, v68
    v_add_f32 v227, v227, v227
    v_mul_f32 v32, 0x3d3504f3, v32
    v_mul_f32 v33, 0x3d3504f3, v33
    v_mul_f32 v34, 0x3d3504f3, v34
    v_mul_f32 v35, 0x3d3504f3, v35
    v_mul_f32 v36, 0x3d3504f3, v36
    v_mul_f32 v37, 0x3d3504f3, v37
    v_mul_f32 v38, 0x3d3504f3, v38
    buffer_load_dwordx4 v4, s[12:15], s16 offen offset:2048 lds
    v_mul_f32 v39, 0x3d3504f3, v39
    v_mul_f32 v73, 0x41000000, v226
    v_fmamk_f32 v192, v226, 0x00000000, v227
    v_fmamk_f32 v193, v226, 0x3f800000, v227
    v_fmamk_f32 v194, v226, 0x40800000, v227
    v_fmamk_f32 v195, v226, 0x40a00000, v227
    v_cos_f32 v72, v73
    v_sin_f32 v73, v73
    v_cos_f32 v176, v192
    v_cos_f32 v177, v193
    v_cos_f32 v178, v194
    v_cos_f32 v179, v195
    v_sin_f32 v192, v192
    v_sin_f32 v193, v193
    v_sin_f32 v194, v194
    v_sin_f32 v195, v195
    v_pk_mul_f32 v[180:181], v[176:177], v[72:73] op_sel:[0,0] op_sel_hi:[1,0]
    v_pk_mul_f32 v[196:197], v[192:193], v[72:73] op_sel:[0,0] op_sel_hi:[1,0]
    v_pk_mul_f32 v[182:183], v[178:179], v[72:73] op_sel:[0,0] op_sel_hi:[1,0]
    v_pk_mul_f32 v[198:199], v[194:195], v[72:73] op_sel:[0,0] op_sel_hi:[1,0]
    v_pk_fma_f32 v[180:181], v[192:193], v[72:73], v[180:181] op_sel:[0,1,0] op_sel_hi:[1,1,1] neg_lo:[1,0,0] neg_hi:[1,0,0]
    v_pk_fma_f32 v[196:197], v[176:177], v[72:73], v[196:197] op_sel:[0,1,0] op_sel_hi:[1,1,1]
    buffer_load_dwordx4 v4, s[12:15], s16 offen offset:3072 lds
    v_pk_fma_f32 v[182:183], v[194:195], v[72:73], v[182:183] op_sel:[0,1,0] op_sel_hi:[1,1,1] neg_lo:[1,0,0] neg_hi:[1,0,0]
    v_pk_fma_f32 v[198:199], v[178:179], v[72:73], v[198:199] op_sel:[0,1,0] op_sel_hi:[1,1,1]
    v_pk_mul_f32 v[184:185], v[180:181], v[72:73] op_sel:[0,0] op_sel_hi:[1,0]
    v_pk_mul_f32 v[200:201], v[196:197], v[72:73] op_sel:[0,0] op_sel_hi:[1,0]
    v_pk_mul_f32 v[186:187], v[182:183], v[72:73] op_sel:[0,0] op_sel_hi:[1,0]
    v_pk_mul_f32 v[202:203], v[198:199], v[72:73] op_sel:[0,0] op_sel_hi:[1,0]
    v_pk_fma_f32 v[184:185], v[196:197], v[72:73], v[184:185] op_sel:[0,1,0] op_sel_hi:[1,1,1] neg_lo:[1,0,0] neg_hi:[1,0,0]
    v_pk_fma_f32 v[200:201], v[180:181], v[72:73], v[200:201] op_sel:[0,1,0] op_sel_hi:[1,1,1]
    v_pk_fma_f32 v[186:187], v[198:199], v[72:73], v[186:187] op_sel:[0,1,0] op_sel_hi:[1,1,1] neg_lo:[1,0,0] neg_hi:[1,0,0]
    v_pk_fma_f32 v[202:203], v[182:183], v[72:73], v[202:203] op_sel:[0,1,0] op_sel_hi:[1,1,1]
    v_pk_mul_f32 v[188:189], v[184:185], v[72:73] op_sel:[0,0] op_sel_hi:[1,0]
    v_pk_mul_f32 v[204:205], v[200:201], v[72:73] op_sel:[0,0] op_sel_hi:[1,0]
    v_pk_mul_f32 v[190:191], v[186:187], v[72:73] op_sel:[0,0] op_sel_hi:[1,0]
    v_pk_mul_f32 v[206:207], v[202:203], v[72:73] op_sel:[0,0] op_sel_hi:[1,0]
    v_pk_fma_f32 v[188:189], v[200:201], v[72:73], v[188:189] op_sel:[0,1,0] op_sel_hi:[1,1,1] neg_lo:[1,0,0] neg_hi:[1,0,0]
    v_pk_fma_f32 v[204:205], v[184:185], v[72:73], v[204:205] op_sel:[0,1,0] op_sel_hi:[1,1,1]
    v_pk_fma_f32 v[190:191], v[202:203], v[72:73], v[190:191] op_sel:[0,1,0] op_sel_hi:[1,1,1] neg_lo:[1,0,0] neg_hi:[1,0,0]
    v_pk_fma_f32 v[206:207], v[186:187], v[72:73], v[206:207] op_sel:[0,1,0] op_sel_hi:[1,1,1]
    s_waitcnt lgkmcnt(0)
    v_mov_b32 v30, s98
    v_mul_f32 v30, 0x3d3504f3, v30
    v_add_f32 v30, s96, v30
    v_mov_b32 v31, s99
    v_mul_f32 v31, 0x3d3504f3, v31
    v_add_f32 v31, s97, v31
    s_mov_b32 s8, s30
    s_mov_b32 s9, s31
    s_mov_b32 s10, 4194304
    s_mov_b32 s11, 0x00020000
    s_mov_b32 s96, 0x22222222
    s_mov_b32 s97, 0x22222222
    s_mov_b32 s98, 0x44444444
    s_mov_b32 s99, 0x44444444
    s_mov_b32 s100, 0x88888888
    s_mov_b32 s101, 0x88888888
    s_waitcnt vmcnt(15)
    s_barrier
    ds_read_b128 v[64:67], v8 offset:0
    ds_read_b128 v[68:71], v10 offset:0
    ds_read_b128 v[72:75], v8 offset:2048
    ds_read_b128 v[76:79], v10 offset:2048
    s_waitcnt vmcnt(14) lgkmcnt(3)
    v_mfma_f32_16x16x32_bf16 v[96:99], v[64:67], a[0:3], 0
    s_waitcnt vmcnt(12) lgkmcnt(2)
    s_add_u32 s18, s18, 4096
    v_mfma_f32_16x16x32_bf16 v[96:99], v[68:71], a[8:11], v[96:99]
    s_waitcnt vmcnt(11)
    s_waitcnt vmcnt(10)
    s_barrier
    v_mfma_f32_16x16x32_bf16 v[100:103], v[68:71], a[12:15], 0
    s_waitcnt lgkmcnt(1)
    ds_read_b128 v[80:83], v8 offset:4096
    ds_read_b128 v[84:87], v10 offset:4096
    v_mfma_f32_16x16x32_bf16 v[100:103], v[64:67], a[4:7], v[100:103]
    buffer_load_dwordx4 a[32:35], v1, s[12:15], s18 offen offset:0
    v_mfma_f32_16x16x32_bf16 v[108:111], v[72:75], a[4:7], 0
    s_waitcnt lgkmcnt(2)
    ds_read_b128 v[88:91], v8 offset:6144
    ds_read_b128 v[92:95], v10 offset:6144
    v_mfma_f32_16x16x32_bf16 v[108:111], v[76:79], a[12:15], v[108:111]
    s_waitcnt vmcnt(9)
    s_barrier
    v_mfma_f32_16x16x32_bf16 v[104:107], v[76:79], a[8:11], 0
    s_waitcnt lgkmcnt(3)
    ds_read_b128 v[64:67], v8 offset:8192
    ds_read_b128 v[68:71], v10 offset:8192
    v_mfma_f32_16x16x32_bf16 v[104:107], v[72:75], a[0:3], v[104:107]
    buffer_load_dwordx4 a[36:39], v1, s[12:15], s18 offen offset:256
    v_mfma_f32_16x16x32_bf16 v[112:115], v[80:83], a[0:3], 0
    s_waitcnt lgkmcnt(4)
    ds_read_b128 v[72:75], v8 offset:10240
    v_cvt_pk_bf16_f32 v176, v176, v177
    v_cvt_pk_bf16_f32 v178, v178, v179
    v_mfma_f32_16x16x32_bf16 v[112:115], v[84:87], a[8:11], v[112:115]
    buffer_load_dwordx4 a[40:43], v1, s[12:15], s18 offen offset:2048
    v_mfma_f32_4x4x4_16b_bf16 v[40:43], a[0:1], a[0:1], 0
    v_mfma_f32_4x4x4_16b_bf16 v[44:47], a[2:3], a[2:3], 0
    v_mfma_f32_4x4x4_16b_bf16 v[48:51], a[4:5], a[4:5], 0
    v_mfma_f32_4x4x4_16b_bf16 v[52:55], a[6:7], a[6:7], 0
    v_mfma_f32_4x4x4_16b_bf16 v[40:43], a[8:9], a[8:9], v[40:43]
    v_mfma_f32_4x4x4_16b_bf16 v[44:47], a[10:11], a[10:11], v[44:47]
    v_mfma_f32_4x4x4_16b_bf16 v[48:51], a[12:13], a[12:13], v[48:51]
    v_mfma_f32_4x4x4_16b_bf16 v[52:55], a[14:15], a[14:15], v[52:55]
    v_mfma_f32_16x16x32_bf16 v[116:119], v[84:87], a[12:15], 0
    s_waitcnt lgkmcnt(4)
    ds_read_b128 v[76:79], v10 offset:10240
    v_cvt_pk_bf16_f32 v180, v180, v181
    v_cvt_pk_bf16_f32 v182, v182, v183
    v_mfma_f32_16x16x32_bf16 v[116:119], v[80:83], a[4:7], v[116:119]
    buffer_load_dwordx4 a[192:195], v224, s[12:15], s28 offen offset:0
    v_mfma_f32_16x16x32_bf16 v[124:127], v[88:91], a[4:7], 0
    s_waitcnt lgkmcnt(4)
    ds_read_b128 v[80:83], v8 offset:12288
    v_cvt_pk_bf16_f32 v184, v184, v185
    v_cvt_pk_bf16_f32 v186, v186, v187
    v_mfma_f32_16x16x32_bf16 v[124:127], v[92:95], a[12:15], v[124:127]
    buffer_load_dwordx4 a[44:47], v1, s[12:15], s18 offen offset:2304
    v_mfma_f32_16x16x32_bf16 v[120:123], v[92:95], a[8:11], 0
    s_waitcnt lgkmcnt(4)
    ds_read_b128 v[84:87], v10 offset:12288
    s_add_u32 m0, s22, 32768
    v_mfma_f32_16x16x32_bf16 v[120:123], v[88:91], a[0:3], v[120:123]
    s_add_u32 s16, s16, 16384
    v_cvt_pk_bf16_f32 v188, v188, v189
    v_cvt_pk_bf16_f32 v190, v190, v191
    v_cvt_pk_bf16_f32 v192, v192, v193
    v_cvt_pk_bf16_f32 v194, v194, v195
    v_mfma_f32_16x16x32_bf16 v[128:131], v[64:67], a[0:3], 0
    s_waitcnt lgkmcnt(4)
    ds_read_b128 v[88:91], v8 offset:14336
    v_cvt_pk_bf16_f32 v196, v196, v197
    v_cvt_pk_bf16_f32 v198, v198, v199
    v_mfma_f32_16x16x32_bf16 v[128:131], v[68:71], a[8:11], v[128:131]
    buffer_load_dwordx4 v4, s[12:15], s16 offen offset:0 lds
    v_mfma_f32_16x16x32_bf16 v[132:135], v[68:71], a[12:15], 0
    s_waitcnt lgkmcnt(4)
    ds_read_b128 v[92:95], v10 offset:14336
    v_cvt_pk_bf16_f32 v200, v200, v201
    v_cvt_pk_bf16_f32 v202, v202, v203
    v_mfma_f32_16x16x32_bf16 v[132:135], v[64:67], a[4:7], v[132:135]
    s_waitcnt vmcnt(6)
    s_barrier
    v_mfma_f32_16x16x32_bf16 v[140:143], v[72:75], a[4:7], 0
    s_waitcnt lgkmcnt(4)
    ds_read_b128 v[64:67], v8 offset:16384
    v_cvt_pk_bf16_f32 v204, v204, v205
    v_cvt_pk_bf16_f32 v206, v206, v207
    v_mfma_f32_16x16x32_bf16 v[140:143], v[76:79], a[12:15], v[140:143]
    buffer_load_dwordx4 v4, s[12:15], s16 offen offset:1024 lds
    v_mfma_f32_16x16x32_bf16 v[136:139], v[76:79], a[8:11], 0
    s_waitcnt lgkmcnt(4)
    ds_read_b128 v[68:71], v10 offset:16384
    v_accvgpr_write_b32 a240, v176
    v_accvgpr_write_b32 a241, v178
    v_mfma_f32_16x16x32_bf16 v[136:139], v[72:75], a[0:3], v[136:139]
    buffer_load_dwordx4 a[196:199], v225, s[12:15], s28 offen offset:0
    v_mfma_f32_16x16x32_bf16 v[96:99], v[80:83], a[16:19], v[96:99]
    s_waitcnt lgkmcnt(4)
    ds_read_b128 v[72:75], v8 offset:18432
    v_accvgpr_write_b32 a242, v180
    v_accvgpr_write_b32 a243, v182
    v_mfma_f32_16x16x32_bf16 v[96:99], v[84:87], a[24:27], v[96:99]
    buffer_load_dwordx4 v4, s[12:15], s16 offen offset:2048 lds
    v_mfma_f32_16x16x32_bf16 v[100:103], v[84:87], a[28:31], v[100:103]
    s_waitcnt lgkmcnt(4)
    ds_read_b128 v[76:79], v10 offset:18432
    v_accvgpr_write_b32 a244, v184
    v_accvgpr_write_b32 a245, v186
    v_mfma_f32_16x16x32_bf16 v[100:103], v[80:83], a[20:23], v[100:103]
    buffer_load_dwordx4 v4, s[12:15], s16 offen offset:3072 lds
    v_mfma_f32_16x16x32_bf16 v[108:111], v[88:91], a[20:23], v[108:111]
    s_waitcnt lgkmcnt(4)
    ds_read_b128 v[80:83], v8 offset:20480
    s_add_u32 s18, s18, 4096
    v_mfma_f32_16x16x32_bf16 v[108:111], v[92:95], a[28:31], v[108:111]
    buffer_load_dwordx4 a[48:51], v1, s[12:15], s18 offen offset:0
    v_mfma_f32_16x16x32_bf16 v[104:107], v[92:95], a[24:27], v[104:107]
    s_waitcnt lgkmcnt(4)
    ds_read_b128 v[84:87], v10 offset:20480
    v_accvgpr_write_b32 a246, v188
    v_accvgpr_write_b32 a247, v190
    v_mfma_f32_16x16x32_bf16 v[104:107], v[88:91], a[16:19], v[104:107]
    buffer_load_dwordx4 a[52:55], v1, s[12:15], s18 offen offset:256
    v_mfma_f32_16x16x32_bf16 v[112:115], v[64:67], a[16:19], v[112:115]
    s_waitcnt lgkmcnt(4)
    ds_read_b128 v[88:91], v8 offset:22528
    v_accvgpr_write_b32 a248, v192
    v_accvgpr_write_b32 a249, v194
    v_mfma_f32_16x16x32_bf16 v[112:115], v[68:71], a[24:27], v[112:115]
    buffer_load_dwordx4 a[56:59], v1, s[12:15], s18 offen offset:2048
    v_mfma_f32_4x4x4_16b_bf16 v[40:43], a[16:17], a[16:17], v[40:43]
    v_mfma_f32_4x4x4_16b_bf16 v[44:47], a[18:19], a[18:19], v[44:47]
    v_mfma_f32_4x4x4_16b_bf16 v[48:51], a[20:21], a[20:21], v[48:51]
    v_mfma_f32_4x4x4_16b_bf16 v[52:55], a[22:23], a[22:23], v[52:55]
    v_mfma_f32_4x4x4_16b_bf16 v[40:43], a[24:25], a[24:25], v[40:43]
    v_mfma_f32_4x4x4_16b_bf16 v[44:47], a[26:27], a[26:27], v[44:47]
    v_mfma_f32_4x4x4_16b_bf16 v[48:51], a[28:29], a[28:29], v[48:51]
    v_mfma_f32_4x4x4_16b_bf16 v[52:55], a[30:31], a[30:31], v[52:55]
    v_mfma_f32_16x16x32_bf16 v[116:119], v[68:71], a[28:31], v[116:119]
    s_waitcnt lgkmcnt(4)
    ds_read_b128 v[92:95], v10 offset:22528
    v_accvgpr_write_b32 a250, v196
    v_accvgpr_write_b32 a251, v198
    v_mfma_f32_16x16x32_bf16 v[116:119], v[64:67], a[20:23], v[116:119]
    buffer_load_dwordx4 a[200:203], v224, s[12:15], s28 offen offset:2048
    v_mfma_f32_16x16x32_bf16 v[124:127], v[72:75], a[20:23], v[124:127]
    s_waitcnt lgkmcnt(4)
    ds_read_b128 v[64:67], v8 offset:24576
    v_accvgpr_write_b32 a252, v200
    v_accvgpr_write_b32 a253, v202
    v_mfma_f32_16x16x32_bf16 v[124:127], v[76:79], a[28:31], v[124:127]
    buffer_load_dwordx4 a[60:63], v1, s[12:15], s18 offen offset:2304
    v_mfma_f32_16x16x32_bf16 v[120:123], v[76:79], a[24:27], v[120:123]
    s_waitcnt lgkmcnt(4)
    ds_read_b128 v[68:71], v10 offset:24576
    s_add_u32 m0, s22, 49152
    v_mfma_f32_16x16x32_bf16 v[120:123], v[72:75], a[16:19], v[120:123]
    s_add_u32 s16, s16, 16384
    v_accvgpr_write_b32 a254, v204
    v_accvgpr_write_b32 a255, v206
    v_mfma_f32_16x16x32_bf16 v[128:131], v[80:83], a[16:19], v[128:131]
    s_waitcnt lgkmcnt(4)
    ds_read_b128 v[72:75], v8 offset:26624
    v_mfma_f32_16x16x32_bf16 v[128:131], v[84:87], a[24:27], v[128:131]
    buffer_load_dwordx4 v4, s[12:15], s16 offen offset:0 lds
    v_mfma_f32_16x16x32_bf16 v[132:135], v[84:87], a[28:31], v[132:135]
    s_waitcnt lgkmcnt(4)
    ds_read_b128 v[76:79], v10 offset:26624
    v_mfma_f32_16x16x32_bf16 v[132:135], v[80:83], a[20:23], v[132:135]
    buffer_load_dwordx4 v4, s[12:15], s16 offen offset:1024 lds
    v_mfma_f32_16x16x32_bf16 v[140:143], v[88:91], a[20:23], v[140:143]
    s_waitcnt lgkmcnt(4)
    ds_read_b128 v[80:83], v8 offset:28672
    v_mfma_f32_16x16x32_bf16 v[140:143], v[92:95], a[28:31], v[140:143]
    buffer_load_dwordx4 v4, s[12:15], s16 offen offset:2048 lds
    v_mfma_f32_16x16x32_bf16 v[136:139], v[92:95], a[24:27], v[136:139]
    s_waitcnt lgkmcnt(4)
    ds_read_b128 v[84:87], v10 offset:28672
    v_mfma_f32_16x16x32_bf16 v[136:139], v[88:91], a[16:19], v[136:139]
    s_waitcnt vmcnt(17)
    buffer_load_dwordx4 v4, s[12:15], s16 offen offset:3072 lds
    v_mfma_f32_16x16x32_bf16 v[96:99], v[64:67], a[32:35], v[96:99]
    s_waitcnt vmcnt(16) lgkmcnt(4)
    ds_read_b128 v[88:91], v8 offset:30720
    v_mfma_f32_16x16x32_bf16 v[96:99], v[68:71], a[40:43], v[96:99]
    s_waitcnt vmcnt(14)
    buffer_load_dwordx4 a[204:207], v225, s[12:15], s28 offen offset:2048
    v_mfma_f32_16x16x32_bf16 v[100:103], v[68:71], a[44:47], v[100:103]
    s_waitcnt lgkmcnt(4)
    ds_read_b128 v[92:95], v10 offset:30720
    s_add_u32 s18, s18, 4096
    v_mfma_f32_16x16x32_bf16 v[100:103], v[64:67], a[36:39], v[100:103]
    s_waitcnt vmcnt(10)
    s_barrier
    v_mfma_f32_16x16x32_bf16 v[108:111], v[72:75], a[36:39], v[108:111]
    s_waitcnt lgkmcnt(4)
    ds_read_b128 v[64:67], v8 offset:32768
    v_mfma_f32_16x16x32_bf16 v[108:111], v[76:79], a[44:47], v[108:111]
    buffer_load_dwordx4 a[64:67], v1, s[12:15], s18 offen offset:0
    v_mfma_f32_16x16x32_bf16 v[104:107], v[76:79], a[40:43], v[104:107]
    s_waitcnt lgkmcnt(4)
    ds_read_b128 v[68:71], v10 offset:32768
    v_mfma_f32_16x16x32_bf16 v[104:107], v[72:75], a[32:35], v[104:107]
    buffer_load_dwordx4 a[68:71], v1, s[12:15], s18 offen offset:256
    v_mfma_f32_16x16x32_bf16 v[112:115], v[80:83], a[32:35], v[112:115]
    s_waitcnt lgkmcnt(4)
    ds_read_b128 v[72:75], v8 offset:34816
    v_mfma_f32_16x16x32_bf16 v[112:115], v[84:87], a[40:43], v[112:115]
    buffer_load_dwordx4 a[72:75], v1, s[12:15], s18 offen offset:2048
    v_mfma_f32_4x4x4_16b_bf16 v[40:43], a[32:33], a[32:33], v[40:43]
    v_mfma_f32_4x4x4_16b_bf16 v[44:47], a[34:35], a[34:35], v[44:47]
    v_mfma_f32_4x4x4_16b_bf16 v[48:51], a[36:37], a[36:37], v[48:51]
    v_mfma_f32_4x4x4_16b_bf16 v[52:55], a[38:39], a[38:39], v[52:55]
    v_mfma_f32_4x4x4_16b_bf16 v[40:43], a[40:41], a[40:41], v[40:43]
    v_mfma_f32_4x4x4_16b_bf16 v[44:47], a[42:43], a[42:43], v[44:47]
    v_mfma_f32_4x4x4_16b_bf16 v[48:51], a[44:45], a[44:45], v[48:51]
    v_mfma_f32_4x4x4_16b_bf16 v[52:55], a[46:47], a[46:47], v[52:55]
    v_mfma_f32_16x16x32_bf16 v[116:119], v[84:87], a[44:47], v[116:119]
    s_waitcnt lgkmcnt(4)
    ds_read_b128 v[76:79], v10 offset:34816
    v_mfma_f32_16x16x32_bf16 v[116:119], v[80:83], a[36:39], v[116:119]
    buffer_load_dwordx4 a[76:79], v1, s[12:15], s18 offen offset:2304
    v_mfma_f32_16x16x32_bf16 v[124:127], v[88:91], a[36:39], v[124:127]
    s_waitcnt lgkmcnt(4)
    ds_read_b128 v[80:83], v8 offset:36864
    s_add_u32 s18, s18, 4096
    v_mfma_f32_16x16x32_bf16 v[124:127], v[92:95], a[44:47], v[124:127]
    buffer_load_dwordx4 a[80:83], v1, s[12:15], s18 offen offset:0
    v_mfma_f32_16x16x32_bf16 v[120:123], v[92:95], a[40:43], v[120:123]
    s_waitcnt lgkmcnt(4)
    ds_read_b128 v[84:87], v10 offset:36864
    v_mfma_f32_16x16x32_bf16 v[120:123], v[88:91], a[32:35], v[120:123]
    buffer_load_dwordx4 a[84:87], v1, s[12:15], s18 offen offset:256
    v_mfma_f32_16x16x32_bf16 v[128:131], v[64:67], a[32:35], v[128:131]
    s_waitcnt lgkmcnt(4)
    ds_read_b128 v[88:91], v8 offset:38912
    v_mfma_f32_16x16x32_bf16 v[128:131], v[68:71], a[40:43], v[128:131]
    buffer_load_dwordx4 a[88:91], v1, s[12:15], s18 offen offset:2048
    v_mfma_f32_16x16x32_bf16 v[132:135], v[68:71], a[44:47], v[132:135]
    s_waitcnt lgkmcnt(4)
    ds_read_b128 v[92:95], v10 offset:38912
    v_mfma_f32_16x16x32_bf16 v[132:135], v[64:67], a[36:39], v[132:135]
    buffer_load_dwordx4 a[92:95], v1, s[12:15], s18 offen offset:2304
    v_mfma_f32_16x16x32_bf16 v[140:143], v[72:75], a[36:39], v[140:143]
    s_waitcnt lgkmcnt(4)
    ds_read_b128 v[64:67], v8 offset:40960
    v_mfma_f32_16x16x32_bf16 v[140:143], v[76:79], a[44:47], v[140:143]
    v_mfma_f32_16x16x32_bf16 v[136:139], v[76:79], a[40:43], v[136:139]
    s_waitcnt lgkmcnt(4)
    ds_read_b128 v[68:71], v10 offset:40960
    s_add_u32 m0, s22, 65536
    v_mfma_f32_16x16x32_bf16 v[136:139], v[72:75], a[32:35], v[136:139]
    s_waitcnt vmcnt(17)
    s_add_u32 s16, s16, 16384
    v_mfma_f32_16x16x32_bf16 v[96:99], v[80:83], a[48:51], v[96:99]
    s_waitcnt vmcnt(15) lgkmcnt(4)
    ds_read_b128 v[72:75], v8 offset:43008
    v_mfma_f32_16x16x32_bf16 v[96:99], v[84:87], a[56:59], v[96:99]
    s_waitcnt vmcnt(13)
    buffer_load_dwordx4 v4, s[12:15], s16 offen offset:0 lds
    v_mfma_f32_16x16x32_bf16 v[100:103], v[84:87], a[60:63], v[100:103]
    s_waitcnt lgkmcnt(4)
    ds_read_b128 v[76:79], v10 offset:43008
    v_mfma_f32_16x16x32_bf16 v[100:103], v[80:83], a[52:55], v[100:103]
    buffer_load_dwordx4 v4, s[12:15], s16 offen offset:1024 lds
    v_mfma_f32_16x16x32_bf16 v[108:111], v[88:91], a[52:55], v[108:111]
    s_waitcnt lgkmcnt(4)
    ds_read_b128 v[80:83], v8 offset:45056
    v_mfma_f32_16x16x32_bf16 v[108:111], v[92:95], a[60:63], v[108:111]
    buffer_load_dwordx4 v4, s[12:15], s16 offen offset:2048 lds
    v_mfma_f32_16x16x32_bf16 v[104:107], v[92:95], a[56:59], v[104:107]
    s_waitcnt lgkmcnt(4)
    ds_read_b128 v[84:87], v10 offset:45056
    v_mfma_f32_16x16x32_bf16 v[104:107], v[88:91], a[48:51], v[104:107]
    v_mfma_f32_16x16x32_bf16 v[112:115], v[64:67], a[48:51], v[112:115]
    s_waitcnt lgkmcnt(4)
    ds_read_b128 v[88:91], v8 offset:47104
    v_mfma_f32_16x16x32_bf16 v[112:115], v[68:71], a[56:59], v[112:115]
    buffer_load_dwordx4 v4, s[12:15], s16 offen offset:3072 lds
    v_mfma_f32_4x4x4_16b_bf16 v[40:43], a[48:49], a[48:49], v[40:43]
    v_mfma_f32_4x4x4_16b_bf16 v[44:47], a[50:51], a[50:51], v[44:47]
    v_mfma_f32_4x4x4_16b_bf16 v[48:51], a[52:53], a[52:53], v[48:51]
    v_mfma_f32_4x4x4_16b_bf16 v[52:55], a[54:55], a[54:55], v[52:55]
    v_mfma_f32_4x4x4_16b_bf16 v[40:43], a[56:57], a[56:57], v[40:43]
    v_mfma_f32_4x4x4_16b_bf16 v[44:47], a[58:59], a[58:59], v[44:47]
    v_mfma_f32_4x4x4_16b_bf16 v[48:51], a[60:61], a[60:61], v[48:51]
    v_mfma_f32_4x4x4_16b_bf16 v[52:55], a[62:63], a[62:63], v[52:55]
    v_mfma_f32_16x16x32_bf16 v[116:119], v[68:71], a[60:63], v[116:119]
    s_waitcnt lgkmcnt(4)
    ds_read_b128 v[92:95], v10 offset:47104
    v_mfma_f32_16x16x32_bf16 v[116:119], v[64:67], a[52:55], v[116:119]
    s_waitcnt vmcnt(13)
    s_barrier
    v_mfma_f32_16x16x32_bf16 v[124:127], v[72:75], a[52:55], v[124:127]
    s_waitcnt lgkmcnt(4)
    ds_read_b128 v[64:67], v8 offset:49152
    s_add_u32 s18, s18, 4096
    v_mfma_f32_16x16x32_bf16 v[124:127], v[76:79], a[60:63], v[124:127]
    buffer_load_dwordx4 a[96:99], v1, s[12:15], s18 offen offset:0
    v_mfma_f32_16x16x32_bf16 v[120:123], v[76:79], a[56:59], v[120:123]
    s_waitcnt lgkmcnt(4)
    ds_read_b128 v[68:71], v10 offset:49152
    v_mfma_f32_16x16x32_bf16 v[120:123], v[72:75], a[48:51], v[120:123]
    buffer_load_dwordx4 a[100:103], v1, s[12:15], s18 offen offset:256
    v_mfma_f32_16x16x32_bf16 v[128:131], v[80:83], a[48:51], v[128:131]
    s_waitcnt lgkmcnt(4)
    ds_read_b128 v[72:75], v8 offset:51200
    v_mfma_f32_16x16x32_bf16 v[128:131], v[84:87], a[56:59], v[128:131]
    v_mfma_f32_32x32x16_bf16 v[144:159], a[192:195], a[224:227], 0
    v_mfma_f32_16x16x32_bf16 v[132:135], v[84:87], a[60:63], v[132:135]
    s_waitcnt lgkmcnt(4)
    ds_read_b128 v[76:79], v10 offset:51200
    v_mfma_f32_16x16x32_bf16 v[132:135], v[80:83], a[52:55], v[132:135]
    buffer_load_dwordx4 a[104:107], v1, s[12:15], s18 offen offset:2048
    v_mfma_f32_32x32x16_bf16 v[160:175], a[192:195], a[232:235], 0
    v_mfma_f32_16x16x32_bf16 v[140:143], v[88:91], a[52:55], v[140:143]
    s_waitcnt lgkmcnt(4)
    ds_read_b128 v[80:83], v8 offset:53248
    v_mfma_f32_16x16x32_bf16 v[140:143], v[92:95], a[60:63], v[140:143]
    v_mfma_f32_32x32x16_bf16 v[208:223], a[192:195], a[208:211], 0
    v_mfma_f32_16x16x32_bf16 v[136:139], v[92:95], a[56:59], v[136:139]
    s_waitcnt lgkmcnt(4)
    ds_read_b128 v[84:87], v10 offset:53248
    v_mfma_f32_16x16x32_bf16 v[136:139], v[88:91], a[48:51], v[136:139]
    s_waitcnt vmcnt(14)
    buffer_load_dwordx4 a[108:111], v1, s[12:15], s18 offen offset:2304
    v_mfma_f32_32x32x16_bf16 v[144:159], a[196:199], a[228:231], v[144:159]
    v_mfma_f32_16x16x32_bf16 v[96:99], v[64:67], a[64:67], v[96:99]
    s_waitcnt vmcnt(13) lgkmcnt(4)
    ds_read_b128 v[88:91], v8 offset:55296
    v_mfma_f32_16x16x32_bf16 v[96:99], v[68:71], a[72:75], v[96:99]
    s_waitcnt vmcnt(12)
    v_mfma_f32_32x32x16_bf16 v[160:175], a[196:199], a[236:239], v[160:175]
    v_mfma_f32_16x16x32_bf16 v[100:103], v[68:71], a[76:79], v[100:103]
    s_waitcnt lgkmcnt(4)
    ds_read_b128 v[92:95], v10 offset:55296
    s_add_u32 m0, s22, 81920
    v_mfma_f32_16x16x32_bf16 v[100:103], v[64:67], a[68:71], v[100:103]
    s_add_u32 s16, s16, 16384
    v_mfma_f32_32x32x16_bf16 v[176:191], a[200:203], a[224:227], 0
    v_mfma_f32_16x16x32_bf16 v[108:111], v[72:75], a[68:71], v[108:111]
    s_waitcnt lgkmcnt(4)
    ds_read_b128 v[64:67], v8 offset:57344
    v_mfma_f32_16x16x32_bf16 v[108:111], v[76:79], a[76:79], v[108:111]
    buffer_load_dwordx4 v4, s[12:15], s16 offen offset:0 lds
    v_mfma_f32_32x32x16_bf16 v[192:207], a[200:203], a[232:235], 0
    v_mfma_f32_16x16x32_bf16 v[104:107], v[76:79], a[72:75], v[104:107]
    s_waitcnt lgkmcnt(4)
    ds_read_b128 v[68:71], v10 offset:57344
    v_mfma_f32_16x16x32_bf16 v[104:107], v[72:75], a[64:67], v[104:107]
    buffer_load_dwordx4 v4, s[12:15], s16 offen offset:1024 lds
    v_mfma_f32_32x32x16_bf16 v[176:191], a[204:207], a[228:231], v[176:191]
    v_mfma_f32_16x16x32_bf16 v[112:115], v[80:83], a[64:67], v[112:115]
    s_waitcnt lgkmcnt(4)
    ds_read_b128 v[72:75], v8 offset:59392
    v_mfma_f32_16x16x32_bf16 v[112:115], v[84:87], a[72:75], v[112:115]
    buffer_load_dwordx4 v4, s[12:15], s16 offen offset:2048 lds
    v_mfma_f32_4x4x4_16b_bf16 v[40:43], a[64:65], a[64:65], v[40:43]
    v_mfma_f32_4x4x4_16b_bf16 v[44:47], a[66:67], a[66:67], v[44:47]
    v_mfma_f32_4x4x4_16b_bf16 v[48:51], a[68:69], a[68:69], v[48:51]
    v_mfma_f32_4x4x4_16b_bf16 v[52:55], a[70:71], a[70:71], v[52:55]
    v_mfma_f32_4x4x4_16b_bf16 v[40:43], a[72:73], a[72:73], v[40:43]
    v_mfma_f32_4x4x4_16b_bf16 v[44:47], a[74:75], a[74:75], v[44:47]
    v_mfma_f32_4x4x4_16b_bf16 v[48:51], a[76:77], a[76:77], v[48:51]
    v_mfma_f32_4x4x4_16b_bf16 v[52:55], a[78:79], a[78:79], v[52:55]
    v_mfma_f32_32x32x16_bf16 v[192:207], a[204:207], a[236:239], v[192:207]
    v_mfma_f32_16x16x32_bf16 v[116:119], v[84:87], a[76:79], v[116:119]
    s_waitcnt lgkmcnt(4)
    ds_read_b128 v[76:79], v10 offset:59392
    v_mfma_f32_16x16x32_bf16 v[116:119], v[80:83], a[68:71], v[116:119]
    v_mfma_f32_16x16x32_bf16 v[124:127], v[88:91], a[68:71], v[124:127]
    s_waitcnt lgkmcnt(4)
    ds_read_b128 v[80:83], v8 offset:61440
    v_mfma_f32_16x16x32_bf16 v[124:127], v[92:95], a[76:79], v[124:127]
    buffer_load_dwordx4 v4, s[12:15], s16 offen offset:3072 lds
    v_mfma_f32_16x16x32_bf16 v[120:123], v[92:95], a[72:75], v[120:123]
    s_waitcnt lgkmcnt(4)
    ds_read_b128 v[84:87], v10 offset:61440
    s_add_u32 s18, s18, 4096
    v_mfma_f32_16x16x32_bf16 v[120:123], v[88:91], a[64:67], v[120:123]
    buffer_load_dwordx4 a[112:115], v1, s[12:15], s18 offen offset:0
    v_mfma_f32_16x16x32_bf16 v[128:131], v[64:67], a[64:67], v[128:131]
    s_waitcnt lgkmcnt(4)
    ds_read_b128 v[88:91], v8 offset:63488
    v_mfma_f32_16x16x32_bf16 v[128:131], v[68:71], a[72:75], v[128:131]
    v_mfma_f32_16x16x32_bf16 v[132:135], v[68:71], a[76:79], v[132:135]
    s_waitcnt lgkmcnt(4)
    ds_read_b128 v[92:95], v10 offset:63488
    v_mfma_f32_16x16x32_bf16 v[132:135], v[64:67], a[68:71], v[132:135]
    s_waitcnt vmcnt(9)
    s_barrier
    v_mfma_f32_16x16x32_bf16 v[140:143], v[72:75], a[68:71], v[140:143]
    s_waitcnt lgkmcnt(4)
    ds_read_b128 v[64:67], v9 offset:0
    v_mfma_f32_16x16x32_bf16 v[140:143], v[76:79], a[76:79], v[140:143]
    buffer_load_dwordx4 a[116:119], v1, s[12:15], s18 offen offset:256
    v_mfma_f32_16x16x32_bf16 v[136:139], v[76:79], a[72:75], v[136:139]
    s_waitcnt lgkmcnt(4)
    ds_read_b128 v[68:71], v11 offset:0
    v_fmac_f32 v144, v208, v29
    v_fmac_f32 v145, v209, v29
    v_mfma_f32_16x16x32_bf16 v[136:139], v[72:75], a[64:67], v[136:139]
    buffer_load_dwordx4 a[120:123], v1, s[12:15], s18 offen offset:2048
    v_mfma_f32_16x16x32_bf16 v[96:99], v[80:83], a[80:83], v[96:99]
    s_waitcnt lgkmcnt(4)
    ds_read_b128 v[72:75], v9 offset:2048
    v_fmac_f32 v146, v210, v29
    v_fmac_f32 v147, v211, v29
    v_mfma_f32_16x16x32_bf16 v[96:99], v[84:87], a[88:91], v[96:99]
    v_fmac_f32 v148, v212, v29
    v_fmac_f32 v149, v213, v29
    v_fmac_f32 v150, v214, v29
    v_fmac_f32 v151, v215, v29
    v_mfma_f32_16x16x32_bf16 v[100:103], v[84:87], a[92:95], v[100:103]
    s_waitcnt lgkmcnt(4)
    ds_read_b128 v[76:79], v11 offset:2048
    v_mul_f32 v216, v160, v33
    v_mul_f32 v217, v161, v33
    v_mfma_f32_16x16x32_bf16 v[100:103], v[80:83], a[84:87], v[100:103]
    buffer_load_dwordx4 a[124:127], v1, s[12:15], s18 offen offset:2304
    v_mfma_f32_16x16x32_bf16 v[108:111], v[88:91], a[84:87], v[108:111]
    s_waitcnt lgkmcnt(4)
    ds_read_b128 v[80:83], v9 offset:4096
    s_add_u32 m0, s22, 98304
    v_mfma_f32_16x16x32_bf16 v[108:111], v[92:95], a[92:95], v[108:111]
    s_add_u32 s16, s16, 16384
    v_mul_f32 v218, v162, v33
    v_mul_f32 v219, v163, v33
    v_mul_f32 v220, v164, v33
    v_mul_f32 v221, v165, v33
    v_mfma_f32_16x16x32_bf16 v[104:107], v[92:95], a[88:91], v[104:107]
    s_waitcnt lgkmcnt(4)
    ds_read_b128 v[84:87], v11 offset:4096
    v_mul_f32 v222, v166, v33
    v_mul_f32 v223, v167, v33
    v_mfma_f32_16x16x32_bf16 v[104:107], v[88:91], a[80:83], v[104:107]
    buffer_load_dwordx4 v4, s[12:15], s16 offen offset:0 lds
    v_mfma_f32_16x16x32_bf16 v[112:115], v[64:67], a[80:83], v[112:115]
    s_waitcnt lgkmcnt(4)
    ds_read_b128 v[88:91], v9 offset:6144
    v_mul_f32 v160, v160, v32
    v_mul_f32 v161, v161, v32
    v_mfma_f32_16x16x32_bf16 v[112:115], v[68:71], a[88:91], v[112:115]
    buffer_load_dwordx4 v4, s[12:15], s16 offen offset:1024 lds
    v_mfma_f32_4x4x4_16b_bf16 v[40:43], a[80:81], a[80:81], v[40:43]
    v_mfma_f32_4x4x4_16b_bf16 v[44:47], a[82:83], a[82:83], v[44:47]
    v_mfma_f32_4x4x4_16b_bf16 v[48:51], a[84:85], a[84:85], v[48:51]
    v_mfma_f32_4x4x4_16b_bf16 v[52:55], a[86:87], a[86:87], v[52:55]
    v_mfma_f32_4x4x4_16b_bf16 v[40:43], a[88:89], a[88:89], v[40:43]
    v_mfma_f32_4x4x4_16b_bf16 v[44:47], a[90:91], a[90:91], v[44:47]
    v_mfma_f32_4x4x4_16b_bf16 v[48:51], a[92:93], a[92:93], v[48:51]
    v_mfma_f32_4x4x4_16b_bf16 v[52:55], a[94:95], a[94:95], v[52:55]
    v_mfma_f32_16x16x32_bf16 v[116:119], v[68:71], a[92:95], v[116:119]
    s_waitcnt lgkmcnt(4)
    ds_read_b128 v[92:95], v11 offset:6144
    v_mul_f32 v162, v162, v32
    v_mul_f32 v163, v163, v32
    v_mfma_f32_16x16x32_bf16 v[116:119], v[64:67], a[84:87], v[116:119]
    v_mul_f32 v164, v164, v32
    v_mul_f32 v165, v165, v32
    v_mul_f32 v166, v166, v32
    v_mul_f32 v167, v167, v32
    v_mfma_f32_16x16x32_bf16 v[124:127], v[72:75], a[84:87], v[124:127]
    s_waitcnt lgkmcnt(4)
    ds_read_b128 v[64:67], v9 offset:8192
    v_fmac_f32 v160, v144, v33
    v_fmac_f32 v161, v145, v33
    v_mfma_f32_16x16x32_bf16 v[124:127], v[76:79], a[92:95], v[124:127]
    buffer_load_dwordx4 v4, s[12:15], s16 offen offset:2048 lds
    v_mfma_f32_16x16x32_bf16 v[120:123], v[76:79], a[88:91], v[120:123]
    s_waitcnt lgkmcnt(4)
    ds_read_b128 v[68:71], v11 offset:8192
    v_fmac_f32 v162, v146, v33
    v_fmac_f32 v163, v147, v33
    v_mfma_f32_16x16x32_bf16 v[120:123], v[72:75], a[80:83], v[120:123]
    buffer_load_dwordx4 v4, s[12:15], s16 offen offset:3072 lds
    v_mfma_f32_16x16x32_bf16 v[128:131], v[80:83], a[80:83], v[128:131]
    s_waitcnt lgkmcnt(4)
    ds_read_b128 v[72:75], v9 offset:10240
    v_fmac_f32 v164, v148, v33
    v_fmac_f32 v165, v149, v33
    v_mfma_f32_16x16x32_bf16 v[128:131], v[84:87], a[88:91], v[128:131]
    v_fmac_f32 v166, v150, v33
    v_fmac_f32 v167, v151, v33
    v_fma_f32 v144, v144, v32, -v216
    v_fma_f32 v145, v145, v32, -v217
    v_mfma_f32_16x16x32_bf16 v[132:135], v[84:87], a[92:95], v[132:135]
    s_waitcnt lgkmcnt(4)
    ds_read_b128 v[76:79], v11 offset:10240
    s_add_u32 s18, s18, 4096
    v_mfma_f32_16x16x32_bf16 v[132:135], v[80:83], a[84:87], v[132:135]
    buffer_load_dwordx4 a[128:131], v1, s[12:15], s18 offen offset:0
    v_mfma_f32_16x16x32_bf16 v[140:143], v[88:91], a[84:87], v[140:143]
    s_waitcnt lgkmcnt(4)
    ds_read_b128 v[80:83], v9 offset:12288
    v_fma_f32 v146, v146, v32, -v218
    v_fma_f32 v147, v147, v32, -v219
    v_mfma_f32_16x16x32_bf16 v[140:143], v[92:95], a[92:95], v[140:143]
    v_fma_f32 v148, v148, v32, -v220
    v_fma_f32 v149, v149, v32, -v221
    v_fma_f32 v150, v150, v32, -v222
    v_fma_f32 v151, v151, v32, -v223
    v_mfma_f32_16x16x32_bf16 v[136:139], v[92:95], a[88:91], v[136:139]
    s_waitcnt lgkmcnt(4)
    ds_read_b128 v[84:87], v11 offset:12288
    v_mul_f32 v216, v168, v35
    v_mul_f32 v217, v169, v35
    v_mfma_f32_16x16x32_bf16 v[136:139], v[88:91], a[80:83], v[136:139]
    s_waitcnt vmcnt(16)
    buffer_load_dwordx4 a[132:135], v1, s[12:15], s18 offen offset:256
    v_mfma_f32_16x16x32_bf16 v[96:99], v[64:67], a[96:99], v[96:99]
    s_waitcnt vmcnt(15) lgkmcnt(4)
    ds_read_b128 v[88:91], v9 offset:14336
    v_mul_f32 v218, v170, v35
    v_mul_f32 v219, v171, v35
    v_mfma_f32_16x16x32_bf16 v[96:99], v[68:71], a[104:107], v[96:99]
    s_waitcnt vmcnt(14)
    v_mul_f32 v220, v172, v35
    v_mul_f32 v221, v173, v35
    v_mul_f32 v222, v174, v35
    v_mul_f32 v223, v175, v35
    v_mfma_f32_16x16x32_bf16 v[100:103], v[68:71], a[108:111], v[100:103]
    s_waitcnt lgkmcnt(4)
    ds_read_b128 v[92:95], v11 offset:14336
    v_mul_f32 v168, v168, v34
    v_mul_f32 v169, v169, v34
    v_mfma_f32_16x16x32_bf16 v[100:103], v[64:67], a[100:103], v[100:103]
    s_waitcnt vmcnt(10)
    s_barrier
    v_mfma_f32_16x16x32_bf16 v[108:111], v[72:75], a[100:103], v[108:111]
    s_waitcnt lgkmcnt(4)
    ds_read_b128 v[64:67], v9 offset:16384
    v_mul_f32 v170, v170, v34
    v_mul_f32 v171, v171, v34
    v_mfma_f32_16x16x32_bf16 v[108:111], v[76:79], a[108:111], v[108:111]
    buffer_load_dwordx4 a[136:139], v1, s[12:15], s18 offen offset:2048
    v_mfma_f32_16x16x32_bf16 v[104:107], v[76:79], a[104:107], v[104:107]
    s_waitcnt lgkmcnt(4)
    ds_read_b128 v[68:71], v11 offset:16384
    v_mul_f32 v172, v172, v34
    v_mul_f32 v173, v173, v34
    v_mfma_f32_16x16x32_bf16 v[104:107], v[72:75], a[96:99], v[104:107]
    buffer_load_dwordx4 a[140:143], v1, s[12:15], s18 offen offset:2304
    v_mfma_f32_16x16x32_bf16 v[112:115], v[80:83], a[96:99], v[112:115]
    s_waitcnt lgkmcnt(4)
    ds_read_b128 v[72:75], v9 offset:18432
    s_add_u32 s18, s18, 4096
    v_mfma_f32_16x16x32_bf16 v[112:115], v[84:87], a[104:107], v[112:115]
    buffer_load_dwordx4 a[144:147], v1, s[12:15], s18 offen offset:0
    v_mfma_f32_4x4x4_16b_bf16 v[40:43], a[96:97], a[96:97], v[40:43]
    v_mfma_f32_4x4x4_16b_bf16 v[44:47], a[98:99], a[98:99], v[44:47]
    v_mfma_f32_4x4x4_16b_bf16 v[48:51], a[100:101], a[100:101], v[48:51]
    v_mfma_f32_4x4x4_16b_bf16 v[52:55], a[102:103], a[102:103], v[52:55]
    v_mfma_f32_4x4x4_16b_bf16 v[40:43], a[104:105], a[104:105], v[40:43]
    v_mfma_f32_4x4x4_16b_bf16 v[44:47], a[106:107], a[106:107], v[44:47]
    v_mfma_f32_4x4x4_16b_bf16 v[48:51], a[108:109], a[108:109], v[48:51]
    v_mfma_f32_4x4x4_16b_bf16 v[52:55], a[110:111], a[110:111], v[52:55]
    v_mfma_f32_16x16x32_bf16 v[116:119], v[84:87], a[108:111], v[116:119]
    s_waitcnt lgkmcnt(4)
    ds_read_b128 v[76:79], v11 offset:18432
    v_mul_f32 v174, v174, v34
    v_mul_f32 v175, v175, v34
    v_mfma_f32_16x16x32_bf16 v[116:119], v[80:83], a[100:103], v[116:119]
    v_fmac_f32 v168, v152, v35
    v_fmac_f32 v169, v153, v35
    v_fmac_f32 v170, v154, v35
    v_fmac_f32 v171, v155, v35
    v_mfma_f32_16x16x32_bf16 v[124:127], v[88:91], a[100:103], v[124:127]
    s_waitcnt lgkmcnt(4)
    ds_read_b128 v[80:83], v9 offset:20480
    v_fmac_f32 v172, v156, v35
    v_fmac_f32 v173, v157, v35
    v_mfma_f32_16x16x32_bf16 v[124:127], v[92:95], a[108:111], v[124:127]
    buffer_load_dwordx4 a[148:151], v1, s[12:15], s18 offen offset:256
    v_mfma_f32_16x16x32_bf16 v[120:123], v[92:95], a[104:107], v[120:123]
    s_waitcnt lgkmcnt(4)
    ds_read_b128 v[84:87], v11 offset:20480
    v_fmac_f32 v174, v158, v35
    v_fmac_f32 v175, v159, v35
    v_mfma_f32_16x16x32_bf16 v[120:123], v[88:91], a[96:99], v[120:123]
    buffer_load_dwordx4 a[152:155], v1, s[12:15], s18 offen offset:2048
    v_mfma_f32_16x16x32_bf16 v[128:131], v[64:67], a[96:99], v[128:131]
    s_waitcnt lgkmcnt(4)
    ds_read_b128 v[88:91], v9 offset:22528
    v_fma_f32 v152, v152, v34, -v216
    v_fma_f32 v153, v153, v34, -v217
    v_mfma_f32_16x16x32_bf16 v[128:131], v[68:71], a[104:107], v[128:131]
    v_fma_f32 v154, v154, v34, -v218
    v_fma_f32 v155, v155, v34, -v219
    v_fma_f32 v156, v156, v34, -v220
    v_fma_f32 v157, v157, v34, -v221
    v_mfma_f32_16x16x32_bf16 v[132:135], v[68:71], a[108:111], v[132:135]
    s_waitcnt lgkmcnt(4)
    ds_read_b128 v[92:95], v11 offset:22528
    v_fma_f32 v158, v158, v34, -v222
    v_fma_f32 v159, v159, v34, -v223
    v_mfma_f32_16x16x32_bf16 v[132:135], v[64:67], a[100:103], v[132:135]
    buffer_load_dwordx4 a[156:159], v1, s[12:15], s18 offen offset:2304
    v_mfma_f32_16x16x32_bf16 v[140:143], v[72:75], a[100:103], v[140:143]
    s_waitcnt lgkmcnt(4)
    ds_read_b128 v[64:67], v9 offset:24576
    v_mul_f32 v216, v192, v37
    v_mul_f32 v217, v193, v37
    v_mfma_f32_16x16x32_bf16 v[140:143], v[76:79], a[108:111], v[140:143]
    v_mul_f32 v218, v194, v37
    v_mul_f32 v219, v195, v37
    v_mul_f32 v220, v196, v37
    v_mul_f32 v221, v197, v37
    v_mfma_f32_16x16x32_bf16 v[136:139], v[76:79], a[104:107], v[136:139]
    s_waitcnt lgkmcnt(4)
    ds_read_b128 v[68:71], v11 offset:24576
    s_add_u32 m0, s22, 114688
    v_mfma_f32_16x16x32_bf16 v[136:139], v[72:75], a[96:99], v[136:139]
    s_waitcnt vmcnt(15)
    v_mul_f32 v222, v198, v37
    v_mul_f32 v223, v199, v37
    v_mul_f32 v192, v192, v36
    v_mul_f32 v193, v193, v36
    v_mfma_f32_16x16x32_bf16 v[96:99], v[80:83], a[112:115], v[96:99]
    s_waitcnt vmcnt(13) lgkmcnt(4)
    ds_read_b128 v[72:75], v9 offset:26624
    s_add_u32 s16, s16, 16384
    v_mfma_f32_16x16x32_bf16 v[96:99], v[84:87], a[120:123], v[96:99]
    s_waitcnt vmcnt(12)
    buffer_load_dwordx4 v4, s[12:15], s16 offen offset:0 lds
    v_mfma_f32_16x16x32_bf16 v[100:103], v[84:87], a[124:127], v[100:103]
    s_waitcnt lgkmcnt(4)
    ds_read_b128 v[76:79], v11 offset:26624
    v_mul_f32 v194, v194, v36
    v_mul_f32 v195, v195, v36
    v_mfma_f32_16x16x32_bf16 v[100:103], v[80:83], a[116:119], v[100:103]
    buffer_load_dwordx4 v4, s[12:15], s16 offen offset:1024 lds
    v_mfma_f32_16x16x32_bf16 v[108:111], v[88:91], a[116:119], v[108:111]
    s_waitcnt lgkmcnt(4)
    ds_read_b128 v[80:83], v9 offset:28672
    v_mul_f32 v196, v196, v36
    v_mul_f32 v197, v197, v36
    v_mfma_f32_16x16x32_bf16 v[108:111], v[92:95], a[124:127], v[108:111]
    buffer_load_dwordx4 v4, s[12:15], s16 offen offset:2048 lds
    v_mfma_f32_16x16x32_bf16 v[104:107], v[92:95], a[120:123], v[104:107]
    s_waitcnt lgkmcnt(4)
    ds_read_b128 v[84:87], v11 offset:28672
    v_mul_f32 v198, v198, v36
    v_mul_f32 v199, v199, v36
    v_mfma_f32_16x16x32_bf16 v[104:107], v[88:91], a[112:115], v[104:107]
    v_fmac_f32 v192, v176, v37
    v_fmac_f32 v193, v177, v37
    v_fmac_f32 v194, v178, v37
    v_fmac_f32 v195, v179, v37
    v_mfma_f32_16x16x32_bf16 v[112:115], v[64:67], a[112:115], v[112:115]
    s_waitcnt lgkmcnt(4)
    ds_read_b128 v[88:91], v9 offset:30720
    v_fmac_f32 v196, v180, v37
    v_fmac_f32 v197, v181, v37
    v_mfma_f32_16x16x32_bf16 v[112:115], v[68:71], a[120:123], v[112:115]
    buffer_load_dwordx4 v4, s[12:15], s16 offen offset:3072 lds
    v_mfma_f32_4x4x4_16b_bf16 v[40:43], a[112:113], a[112:113], v[40:43]
    v_mfma_f32_4x4x4_16b_bf16 v[44:47], a[114:115], a[114:115], v[44:47]
    v_mfma_f32_4x4x4_16b_bf16 v[48:51], a[116:117], a[116:117], v[48:51]
    v_mfma_f32_4x4x4_16b_bf16 v[52:55], a[118:119], a[118:119], v[52:55]
    v_mfma_f32_4x4x4_16b_bf16 v[40:43], a[120:121], a[120:121], v[40:43]
    v_mfma_f32_4x4x4_16b_bf16 v[44:47], a[122:123], a[122:123], v[44:47]
    v_mfma_f32_4x4x4_16b_bf16 v[48:51], a[124:125], a[124:125], v[48:51]
    v_mfma_f32_4x4x4_16b_bf16 v[52:55], a[126:127], a[126:127], v[52:55]
    v_mfma_f32_16x16x32_bf16 v[116:119], v[68:71], a[124:127], v[116:119]
    s_waitcnt lgkmcnt(4)
    ds_read_b128 v[92:95], v11 offset:30720
    v_fmac_f32 v198, v182, v37
    v_fmac_f32 v199, v183, v37
    v_mfma_f32_16x16x32_bf16 v[116:119], v[64:67], a[116:119], v[116:119]
    s_waitcnt vmcnt(12)
    s_barrier
    v_mfma_f32_16x16x32_bf16 v[124:127], v[72:75], a[116:119], v[124:127]
    s_waitcnt lgkmcnt(4)
    ds_read_b128 v[64:67], v9 offset:32768
    s_add_u32 s18, s18, 4096
    v_mfma_f32_16x16x32_bf16 v[124:127], v[76:79], a[124:127], v[124:127]
    buffer_load_dwordx4 a[160:163], v1, s[12:15], s18 offen offset:0
    v_mfma_f32_16x16x32_bf16 v[120:123], v[76:79], a[120:123], v[120:123]
    s_waitcnt lgkmcnt(4)
    ds_read_b128 v[68:71], v11 offset:32768
    v_fma_f32 v176, v176, v36, -v216
    v_fma_f32 v177, v177, v36, -v217
    v_mfma_f32_16x16x32_bf16 v[120:123], v[72:75], a[112:115], v[120:123]
    buffer_load_dwordx4 a[164:167], v1, s[12:15], s18 offen offset:256
    v_mfma_f32_16x16x32_bf16 v[128:131], v[80:83], a[112:115], v[128:131]
    s_waitcnt lgkmcnt(4)
    ds_read_b128 v[72:75], v9 offset:34816
    v_fma_f32 v178, v178, v36, -v218
    v_fma_f32 v179, v179, v36, -v219
    v_mfma_f32_16x16x32_bf16 v[128:131], v[84:87], a[120:123], v[128:131]
    v_fma_f32 v180, v180, v36, -v220
    v_fma_f32 v181, v181, v36, -v221
    v_fma_f32 v182, v182, v36, -v222
    v_fma_f32 v183, v183, v36, -v223
    v_mfma_f32_16x16x32_bf16 v[132:135], v[84:87], a[124:127], v[132:135]
    s_waitcnt lgkmcnt(4)
    ds_read_b128 v[76:79], v11 offset:34816
    v_mul_f32 v216, v200, v39
    v_mul_f32 v217, v201, v39
    v_mfma_f32_16x16x32_bf16 v[132:135], v[80:83], a[116:119], v[132:135]
    buffer_load_dwordx4 a[168:171], v1, s[12:15], s18 offen offset:2048
    v_mfma_f32_16x16x32_bf16 v[140:143], v[88:91], a[116:119], v[140:143]
    s_waitcnt lgkmcnt(4)
    ds_read_b128 v[80:83], v9 offset:36864
    v_mul_f32 v218, v202, v39
    v_mul_f32 v219, v203, v39
    v_mfma_f32_16x16x32_bf16 v[140:143], v[92:95], a[124:127], v[140:143]
    v_mul_f32 v220, v204, v39
    v_mul_f32 v221, v205, v39
    v_mul_f32 v222, v206, v39
    v_mul_f32 v223, v207, v39
    v_mfma_f32_16x16x32_bf16 v[136:139], v[92:95], a[120:123], v[136:139]
    s_waitcnt lgkmcnt(4)
    ds_read_b128 v[84:87], v11 offset:36864
    v_mul_f32 v200, v200, v38
    v_mul_f32 v201, v201, v38
    v_mfma_f32_16x16x32_bf16 v[136:139], v[88:91], a[112:115], v[136:139]
    s_waitcnt vmcnt(14)
    buffer_load_dwordx4 a[172:175], v1, s[12:15], s18 offen offset:2304
    v_mfma_f32_16x16x32_bf16 v[96:99], v[64:67], a[128:131], v[96:99]
    s_waitcnt vmcnt(13) lgkmcnt(4)
    ds_read_b128 v[88:91], v9 offset:38912
    v_mul_f32 v202, v202, v38
    v_mul_f32 v203, v203, v38
    v_mfma_f32_16x16x32_bf16 v[96:99], v[68:71], a[136:139], v[96:99]
    s_waitcnt vmcnt(12)
    v_mul_f32 v204, v204, v38
    v_mul_f32 v205, v205, v38
    v_mul_f32 v206, v206, v38
    v_mul_f32 v207, v207, v38
    v_mfma_f32_16x16x32_bf16 v[100:103], v[68:71], a[140:143], v[100:103]
    s_waitcnt lgkmcnt(4)
    ds_read_b128 v[92:95], v11 offset:38912
    s_add_u32 m0, s22, 0
    v_mfma_f32_16x16x32_bf16 v[100:103], v[64:67], a[132:135], v[100:103]
    s_add_u32 s16, s16, 16384
    v_fmac_f32 v200, v184, v39
    v_fmac_f32 v201, v185, v39
    v_fmac_f32 v202, v186, v39
    v_fmac_f32 v203, v187, v39
    v_mfma_f32_16x16x32_bf16 v[108:111], v[72:75], a[132:135], v[108:111]
    s_waitcnt lgkmcnt(4)
    ds_read_b128 v[64:67], v9 offset:40960
    v_fmac_f32 v204, v188, v39
    v_fmac_f32 v205, v189, v39
    v_mfma_f32_16x16x32_bf16 v[108:111], v[76:79], a[140:143], v[108:111]
    buffer_load_dwordx4 v4, s[12:15], s16 offen offset:0 lds
    v_mfma_f32_16x16x32_bf16 v[104:107], v[76:79], a[136:139], v[104:107]
    s_waitcnt lgkmcnt(4)
    ds_read_b128 v[68:71], v11 offset:40960
    v_fmac_f32 v206, v190, v39
    v_fmac_f32 v207, v191, v39
    v_mfma_f32_16x16x32_bf16 v[104:107], v[72:75], a[128:131], v[104:107]
    buffer_load_dwordx4 v4, s[12:15], s16 offen offset:1024 lds
    v_mfma_f32_16x16x32_bf16 v[112:115], v[80:83], a[128:131], v[112:115]
    s_waitcnt lgkmcnt(4)
    ds_read_b128 v[72:75], v9 offset:43008
    v_fma_f32 v184, v184, v38, -v216
    v_fma_f32 v185, v185, v38, -v217
    v_mfma_f32_16x16x32_bf16 v[112:115], v[84:87], a[136:139], v[112:115]
    buffer_load_dwordx4 v4, s[12:15], s16 offen offset:2048 lds
    v_mfma_f32_4x4x4_16b_bf16 v[40:43], a[128:129], a[128:129], v[40:43]
    v_mfma_f32_4x4x4_16b_bf16 v[44:47], a[130:131], a[130:131], v[44:47]
    v_mfma_f32_4x4x4_16b_bf16 v[48:51], a[132:133], a[132:133], v[48:51]
    v_mfma_f32_4x4x4_16b_bf16 v[52:55], a[134:135], a[134:135], v[52:55]
    v_mfma_f32_4x4x4_16b_bf16 v[40:43], a[136:137], a[136:137], v[40:43]
    v_mfma_f32_4x4x4_16b_bf16 v[44:47], a[138:139], a[138:139], v[44:47]
    v_mfma_f32_4x4x4_16b_bf16 v[48:51], a[140:141], a[140:141], v[48:51]
    v_mfma_f32_4x4x4_16b_bf16 v[52:55], a[142:143], a[142:143], v[52:55]
    v_mfma_f32_16x16x32_bf16 v[116:119], v[84:87], a[140:143], v[116:119]
    s_waitcnt lgkmcnt(4)
    ds_read_b128 v[76:79], v11 offset:43008
    v_fma_f32 v186, v186, v38, -v218
    v_fma_f32 v187, v187, v38, -v219
    v_mfma_f32_16x16x32_bf16 v[116:119], v[80:83], a[132:135], v[116:119]
    v_fma_f32 v188, v188, v38, -v220
    v_fma_f32 v189, v189, v38, -v221
    v_fma_f32 v190, v190, v38, -v222
    v_fma_f32 v191, v191, v38, -v223
    v_mfma_f32_16x16x32_bf16 v[124:127], v[88:91], a[132:135], v[124:127]
    s_waitcnt lgkmcnt(4)
    ds_read_b128 v[80:83], v9 offset:45056
    v_cvt_pk_bf16_f32 v224, v144, v152
    v_cvt_pk_bf16_f32 v225, v176, v184
    v_mfma_f32_16x16x32_bf16 v[124:127], v[92:95], a[140:143], v[124:127]
    buffer_load_dwordx4 v4, s[12:15], s16 offen offset:3072 lds
    v_mfma_f32_16x16x32_bf16 v[120:123], v[92:95], a[136:139], v[120:123]
    s_waitcnt lgkmcnt(4)
    ds_read_b128 v[84:87], v11 offset:45056
    s_add_u32 s18, s18, 4096
    v_mfma_f32_16x16x32_bf16 v[120:123], v[88:91], a[128:131], v[120:123]
    buffer_load_dwordx4 a[176:179], v1, s[12:15], s18 offen offset:0
    v_mfma_f32_16x16x32_bf16 v[128:131], v[64:67], a[128:131], v[128:131]
    s_waitcnt lgkmcnt(4)
    ds_read_b128 v[88:91], v9 offset:47104
    ds_write_b64 v24, v[224:225] offset:0
    v_cvt_pk_bf16_f32 v226, v160, v168
    v_mfma_f32_16x16x32_bf16 v[128:131], v[68:71], a[136:139], v[128:131]
    v_cvt_pk_bf16_f32 v227, v192, v200
    ds_write_b64 v24, v[226:227] offset:2048
    v_cvt_pk_bf16_f32 v228, v145, v153
    v_cvt_pk_bf16_f32 v229, v177, v185
    v_mfma_f32_16x16x32_bf16 v[132:135], v[68:71], a[140:143], v[132:135]
    s_waitcnt lgkmcnt(6)
    ds_read_b128 v[92:95], v11 offset:47104
    ds_write_b64 v24, v[228:229] offset:4096
    v_cvt_pk_bf16_f32 v230, v161, v169
    v_mfma_f32_16x16x32_bf16 v[132:135], v[64:67], a[132:135], v[132:135]
    s_waitcnt vmcnt(9)
    s_barrier
    v_mfma_f32_16x16x32_bf16 v[140:143], v[72:75], a[132:135], v[140:143]
    s_waitcnt lgkmcnt(7)
    ds_read_b128 v[64:67], v9 offset:49152
    v_cvt_pk_bf16_f32 v231, v193, v201
    ds_write_b64 v24, v[230:231] offset:6144
    v_mfma_f32_16x16x32_bf16 v[140:143], v[76:79], a[140:143], v[140:143]
    buffer_load_dwordx4 a[180:183], v1, s[12:15], s18 offen offset:256
    v_mfma_f32_16x16x32_bf16 v[136:139], v[76:79], a[136:139], v[136:139]
    s_waitcnt lgkmcnt(8)
    ds_read_b128 v[68:71], v11 offset:49152
    v_cvt_pk_bf16_f32 v232, v146, v154
    v_cvt_pk_bf16_f32 v233, v178, v186
    v_mfma_f32_16x16x32_bf16 v[136:139], v[72:75], a[128:131], v[136:139]
    buffer_load_dwordx4 a[184:187], v1, s[12:15], s18 offen offset:2048
    v_mfma_f32_16x16x32_bf16 v[96:99], v[80:83], a[144:147], v[96:99]
    s_waitcnt lgkmcnt(8)
    ds_read_b128 v[72:75], v9 offset:51200
    ds_write_b64 v24, v[232:233] offset:8192
    v_cvt_pk_bf16_f32 v234, v162, v170
    v_mfma_f32_16x16x32_bf16 v[96:99], v[84:87], a[152:155], v[96:99]
    v_cvt_pk_bf16_f32 v235, v194, v202
    ds_write_b64 v24, v[234:235] offset:10240
    v_cvt_pk_bf16_f32 v236, v147, v155
    v_cvt_pk_bf16_f32 v237, v179, v187
    v_mfma_f32_16x16x32_bf16 v[100:103], v[84:87], a[156:159], v[100:103]
    s_waitcnt lgkmcnt(10)
    ds_read_b128 v[76:79], v11 offset:51200
    ds_write_b64 v24, v[236:237] offset:12288
    v_cvt_pk_bf16_f32 v238, v163, v171
    v_mfma_f32_16x16x32_bf16 v[100:103], v[80:83], a[148:151], v[100:103]
    buffer_load_dwordx4 a[188:191], v1, s[12:15], s18 offen offset:2304
    v_mfma_f32_16x16x32_bf16 v[108:111], v[88:91], a[148:151], v[108:111]
    s_waitcnt lgkmcnt(9)
    ds_read_b128 v[80:83], v9 offset:53248
    s_add_u32 m0, s22, 16384
    v_mfma_f32_16x16x32_bf16 v[108:111], v[92:95], a[156:159], v[108:111]
    s_add_u32 s16, s16, 16384
    v_cvt_pk_bf16_f32 v239, v195, v203
    ds_write_b64 v24, v[238:239] offset:14336
    v_cvt_pk_bf16_f32 v240, v148, v156
    v_cvt_pk_bf16_f32 v241, v180, v188
    v_mfma_f32_16x16x32_bf16 v[104:107], v[92:95], a[152:155], v[104:107]
    s_waitcnt lgkmcnt(9)
    ds_read_b128 v[84:87], v11 offset:53248
    ds_write_b64 v24, v[240:241] offset:16384
    v_cvt_pk_bf16_f32 v242, v164, v172
    v_mfma_f32_16x16x32_bf16 v[104:107], v[88:91], a[144:147], v[104:107]
    buffer_load_dwordx4 v4, s[12:15], s16 offen offset:0 lds
    v_mfma_f32_16x16x32_bf16 v[112:115], v[64:67], a[144:147], v[112:115]
    s_waitcnt lgkmcnt(9)
    ds_read_b128 v[88:91], v9 offset:55296
    v_cvt_pk_bf16_f32 v243, v196, v204
    ds_write_b64 v24, v[242:243] offset:18432
    v_mfma_f32_16x16x32_bf16 v[112:115], v[68:71], a[152:155], v[112:115]
    buffer_load_dwordx4 v4, s[12:15], s16 offen offset:1024 lds
    v_mfma_f32_4x4x4_16b_bf16 v[40:43], a[144:145], a[144:145], v[40:43]
    v_mfma_f32_4x4x4_16b_bf16 v[44:47], a[146:147], a[146:147], v[44:47]
    v_mfma_f32_4x4x4_16b_bf16 v[48:51], a[148:149], a[148:149], v[48:51]
    v_mfma_f32_4x4x4_16b_bf16 v[52:55], a[150:151], a[150:151], v[52:55]
    v_mfma_f32_4x4x4_16b_bf16 v[40:43], a[152:153], a[152:153], v[40:43]
    v_mfma_f32_4x4x4_16b_bf16 v[44:47], a[154:155], a[154:155], v[44:47]
    v_mfma_f32_4x4x4_16b_bf16 v[48:51], a[156:157], a[156:157], v[48:51]
    v_mfma_f32_4x4x4_16b_bf16 v[52:55], a[158:159], a[158:159], v[52:55]
    v_mfma_f32_16x16x32_bf16 v[116:119], v[68:71], a[156:159], v[116:119]
    s_waitcnt lgkmcnt(10)
    ds_read_b128 v[92:95], v11 offset:55296
    v_cvt_pk_bf16_f32 v244, v149, v157
    v_cvt_pk_bf16_f32 v245, v181, v189
    v_mfma_f32_16x16x32_bf16 v[116:119], v[64:67], a[148:151], v[116:119]
    ds_write_b64 v24, v[244:245] offset:20480
    v_cvt_pk_bf16_f32 v246, v165, v173
    v_cvt_pk_bf16_f32 v247, v197, v205
    ds_write_b64 v24, v[246:247] offset:22528
    v_mfma_f32_16x16x32_bf16 v[124:127], v[72:75], a[148:151], v[124:127]
    s_waitcnt lgkmcnt(10)
    ds_read_b128 v[64:67], v9 offset:57344
    v_cvt_pk_bf16_f32 v248, v150, v158
    v_cvt_pk_bf16_f32 v249, v182, v190
    v_mfma_f32_16x16x32_bf16 v[124:127], v[76:79], a[156:159], v[124:127]
    buffer_load_dwordx4 v4, s[12:15], s16 offen offset:2048 lds
    v_mfma_f32_16x16x32_bf16 v[120:123], v[76:79], a[152:155], v[120:123]
    s_waitcnt lgkmcnt(9)
    ds_read_b128 v[68:71], v11 offset:57344
    ds_write_b64 v24, v[248:249] offset:24576
    v_cvt_pk_bf16_f32 v250, v166, v174
    v_mfma_f32_16x16x32_bf16 v[120:123], v[72:75], a[144:147], v[120:123]
    buffer_load_dwordx4 v4, s[12:15], s16 offen offset:3072 lds
    v_mfma_f32_16x16x32_bf16 v[128:131], v[80:83], a[144:147], v[128:131]
    s_waitcnt lgkmcnt(9)
    ds_read_b128 v[72:75], v9 offset:59392
    v_cvt_pk_bf16_f32 v251, v198, v206
    ds_write_b64 v24, v[250:251] offset:26624
    v_mfma_f32_16x16x32_bf16 v[128:131], v[84:87], a[152:155], v[128:131]
    v_cvt_pk_bf16_f32 v252, v151, v159
    v_cvt_pk_bf16_f32 v253, v183, v191
    ds_write_b64 v24, v[252:253] offset:28672
    v_cvt_pk_bf16_f32 v254, v167, v175
    v_mfma_f32_16x16x32_bf16 v[132:135], v[84:87], a[156:159], v[132:135]
    s_waitcnt lgkmcnt(10)
    ds_read_b128 v[76:79], v11 offset:59392
    s_add_u32 s18, s18, 4096
    v_mfma_f32_16x16x32_bf16 v[132:135], v[80:83], a[148:151], v[132:135]
    buffer_load_dwordx4 a[192:195], v1, s[12:15], s18 offen offset:0
    v_mfma_f32_16x16x32_bf16 v[140:143], v[88:91], a[148:151], v[140:143]
    s_waitcnt lgkmcnt(9)
    ds_read_b128 v[80:83], v9 offset:61440
    v_cvt_pk_bf16_f32 v255, v199, v207
    ds_write_b64 v24, v[254:255] offset:30720
    v_mfma_f32_16x16x32_bf16 v[140:143], v[92:95], a[156:159], v[140:143]
    v_mov_b32 v144, v30
    v_mov_b32 v145, v30
    v_mov_b32 v146, v30
    v_mov_b32 v147, v30
    v_mfma_f32_16x16x32_bf16 v[136:139], v[92:95], a[152:155], v[136:139]
    s_waitcnt lgkmcnt(8)
    ds_read_b128 v[84:87], v11 offset:61440
    v_mov_b32 v148, v30
    v_mov_b32 v149, v30
    v_mfma_f32_16x16x32_bf16 v[136:139], v[88:91], a[144:147], v[136:139]
    s_waitcnt vmcnt(16)
    buffer_load_dwordx4 a[196:199], v1, s[12:15], s18 offen offset:256
    v_mfma_f32_16x16x32_bf16 v[96:99], v[64:67], a[160:163], v[96:99]
    s_waitcnt vmcnt(15) lgkmcnt(8)
    ds_read_b128 v[88:91], v9 offset:63488
    v_mov_b32 v150, v30
    v_mov_b32 v151, v30
    v_mfma_f32_16x16x32_bf16 v[96:99], v[68:71], a[168:171], v[96:99]
    s_waitcnt vmcnt(14)
    v_mov_b32 v152, v30
    v_mov_b32 v153, v30
    v_mov_b32 v154, v30
    v_mov_b32 v155, v30
    v_mfma_f32_16x16x32_bf16 v[100:103], v[68:71], a[172:175], v[100:103]
    s_waitcnt lgkmcnt(7)
    ds_read_b128 v[92:95], v11 offset:63488
    v_mov_b32 v156, v30
    v_mov_b32 v157, v30
    v_mfma_f32_16x16x32_bf16 v[100:103], v[64:67], a[164:167], v[100:103]
    s_waitcnt vmcnt(10)
    s_barrier
    v_mfma_f32_16x16x32_bf16 v[108:111], v[72:75], a[164:167], v[108:111]
    s_waitcnt lgkmcnt(5)
    ds_read_b128 v[64:67], v8 offset:0
    v_mov_b32 v158, v30
    v_mov_b32 v159, v30
    v_mfma_f32_16x16x32_bf16 v[108:111], v[76:79], a[172:175], v[108:111]
    buffer_load_dwordx4 a[200:203], v1, s[12:15], s18 offen offset:2048
    v_mfma_f32_16x16x32_bf16 v[104:107], v[76:79], a[168:171], v[104:107]
    s_waitcnt lgkmcnt(5)
    ds_read_b128 v[68:71], v10 offset:0
    v_mov_b32 v160, v31
    v_mov_b32 v161, v31
    v_mfma_f32_16x16x32_bf16 v[104:107], v[72:75], a[160:163], v[104:107]
    buffer_load_dwordx4 a[204:207], v1, s[12:15], s18 offen offset:2304
    v_mfma_f32_16x16x32_bf16 v[112:115], v[80:83], a[160:163], v[112:115]
    s_waitcnt lgkmcnt(4)
    ds_read_b128 v[72:75], v8 offset:2048
    s_add_u32 s18, s18, 4096
    v_mfma_f32_16x16x32_bf16 v[112:115], v[84:87], a[168:171], v[112:115]
    buffer_load_dwordx4 a[208:211], v1, s[12:15], s18 offen offset:0
    v_mfma_f32_4x4x4_16b_bf16 v[40:43], a[160:161], a[160:161], v[40:43]
    v_mfma_f32_4x4x4_16b_bf16 v[44:47], a[162:163], a[162:163], v[44:47]
    v_mfma_f32_4x4x4_16b_bf16 v[48:51], a[164:165], a[164:165], v[48:51]
    v_mfma_f32_4x4x4_16b_bf16 v[52:55], a[166:167], a[166:167], v[52:55]
    v_mfma_f32_4x4x4_16b_bf16 v[40:43], a[168:169], a[168:169], v[40:43]
    v_mfma_f32_4x4x4_16b_bf16 v[44:47], a[170:171], a[170:171], v[44:47]
    v_mfma_f32_4x4x4_16b_bf16 v[48:51], a[172:173], a[172:173], v[48:51]
    v_mfma_f32_4x4x4_16b_bf16 v[52:55], a[174:175], a[174:175], v[52:55]
    v_mfma_f32_16x16x32_bf16 v[116:119], v[84:87], a[172:175], v[116:119]
    s_waitcnt lgkmcnt(4)
    ds_read_b128 v[76:79], v10 offset:2048
    v_mov_b32 v162, v31
    v_mov_b32 v163, v31
    v_mfma_f32_16x16x32_bf16 v[116:119], v[80:83], a[164:167], v[116:119]
    v_mov_b32 v164, v31
    v_mov_b32 v165, v31
    v_mov_b32 v166, v31
    v_mov_b32 v167, v31
    v_mfma_f32_16x16x32_bf16 v[124:127], v[88:91], a[164:167], v[124:127]
    s_waitcnt lgkmcnt(4)
    ds_read_b128 v[80:83], v8 offset:4096
    v_mov_b32 v168, v31
    v_mov_b32 v169, v31
    v_mfma_f32_16x16x32_bf16 v[124:127], v[92:95], a[172:175], v[124:127]
    buffer_load_dwordx4 a[212:215], v1, s[12:15], s18 offen offset:256
    v_mfma_f32_16x16x32_bf16 v[120:123], v[92:95], a[168:171], v[120:123]
    s_waitcnt lgkmcnt(4)
    ds_read_b128 v[84:87], v10 offset:4096
    v_mov_b32 v170, v31
    v_mov_b32 v171, v31
    v_mfma_f32_16x16x32_bf16 v[120:123], v[88:91], a[160:163], v[120:123]
    buffer_load_dwordx4 a[216:219], v1, s[12:15], s18 offen offset:2048
    v_mfma_f32_16x16x32_bf16 v[128:131], v[64:67], a[160:163], v[128:131]
    s_waitcnt lgkmcnt(4)
    ds_read_b128 v[88:91], v8 offset:6144
    v_mov_b32 v172, v31
    v_mov_b32 v173, v31
    v_mfma_f32_16x16x32_bf16 v[128:131], v[68:71], a[168:171], v[128:131]
    v_mov_b32 v174, v31
    v_mov_b32 v175, v31
    v_mfma_f32_16x16x32_bf16 v[132:135], v[68:71], a[172:175], v[132:135]
    s_waitcnt lgkmcnt(4)
    ds_read_b128 v[92:95], v10 offset:6144
    v_mfma_f32_16x16x32_bf16 v[132:135], v[64:67], a[164:167], v[132:135]
    buffer_load_dwordx4 a[220:223], v1, s[12:15], s18 offen offset:2304
    v_mfma_f32_16x16x32_bf16 v[140:143], v[72:75], a[164:167], v[140:143]
    s_waitcnt lgkmcnt(4)
    ds_read_b128 v[64:67], v8 offset:8192
    v_mfma_f32_16x16x32_bf16 v[140:143], v[76:79], a[172:175], v[140:143]
    v_mfma_f32_16x16x32_bf16 v[136:139], v[76:79], a[168:171], v[136:139]
    s_waitcnt lgkmcnt(4)
    ds_read_b128 v[68:71], v10 offset:8192
    s_add_u32 m0, s22, 32768
    v_mfma_f32_16x16x32_bf16 v[136:139], v[72:75], a[160:163], v[136:139]
    s_waitcnt vmcnt(15)
    s_add_u32 s16, s16, 16384
    v_mfma_f32_16x16x32_bf16 v[96:99], v[80:83], a[176:179], v[96:99]
    s_waitcnt vmcnt(13) lgkmcnt(4)
    ds_read_b128 v[72:75], v8 offset:10240
    v_mfma_f32_16x16x32_bf16 v[96:99], v[84:87], a[184:187], v[96:99]
    s_waitcnt vmcnt(12)
    buffer_load_dwordx4 v4, s[12:15], s16 offen offset:0 lds
    v_mfma_f32_16x16x32_bf16 v[100:103], v[84:87], a[188:191], v[100:103]
    s_waitcnt lgkmcnt(4)
    ds_read_b128 v[76:79], v10 offset:10240
    v_mfma_f32_16x16x32_bf16 v[100:103], v[80:83], a[180:183], v[100:103]
    buffer_load_dwordx4 v4, s[12:15], s16 offen offset:1024 lds
    v_mfma_f32_16x16x32_bf16 v[108:111], v[88:91], a[180:183], v[108:111]
    s_waitcnt lgkmcnt(4)
    ds_read_b128 v[80:83], v8 offset:12288
    v_mfma_f32_16x16x32_bf16 v[108:111], v[92:95], a[188:191], v[108:111]
    buffer_load_dwordx4 v4, s[12:15], s16 offen offset:2048 lds
    v_mfma_f32_16x16x32_bf16 v[104:107], v[92:95], a[184:187], v[104:107]
    s_waitcnt lgkmcnt(4)
    ds_read_b128 v[84:87], v10 offset:12288
    v_mfma_f32_16x16x32_bf16 v[104:107], v[88:91], a[176:179], v[104:107]
    v_mfma_f32_16x16x32_bf16 v[112:115], v[64:67], a[176:179], v[112:115]
    s_waitcnt lgkmcnt(4)
    ds_read_b128 v[88:91], v8 offset:14336
    v_mfma_f32_16x16x32_bf16 v[112:115], v[68:71], a[184:187], v[112:115]
    buffer_load_dwordx4 v4, s[12:15], s16 offen offset:3072 lds
    v_mfma_f32_4x4x4_16b_bf16 v[40:43], a[176:177], a[176:177], v[40:43]
    v_mfma_f32_4x4x4_16b_bf16 v[44:47], a[178:179], a[178:179], v[44:47]
    v_mfma_f32_4x4x4_16b_bf16 v[48:51], a[180:181], a[180:181], v[48:51]
    v_mfma_f32_4x4x4_16b_bf16 v[52:55], a[182:183], a[182:183], v[52:55]
    v_mfma_f32_4x4x4_16b_bf16 v[40:43], a[184:185], a[184:185], v[40:43]
    v_mfma_f32_4x4x4_16b_bf16 v[44:47], a[186:187], a[186:187], v[44:47]
    v_mfma_f32_4x4x4_16b_bf16 v[48:51], a[188:189], a[188:189], v[48:51]
    v_mfma_f32_4x4x4_16b_bf16 v[52:55], a[190:191], a[190:191], v[52:55]
    v_mfma_f32_16x16x32_bf16 v[116:119], v[68:71], a[188:191], v[116:119]
    s_waitcnt lgkmcnt(4)
    ds_read_b128 v[92:95], v10 offset:14336
    v_mfma_f32_16x16x32_bf16 v[116:119], v[64:67], a[180:183], v[116:119]
    s_waitcnt vmcnt(12)
    s_barrier
    v_mfma_f32_16x16x32_bf16 v[124:127], v[72:75], a[180:183], v[124:127]
    s_waitcnt lgkmcnt(4)
    ds_read_b128 v[64:67], v8 offset:16384
    s_add_u32 s18, s18, 4096
    v_mfma_f32_16x16x32_bf16 v[124:127], v[76:79], a[188:191], v[124:127]
    buffer_load_dwordx4 a[224:227], v1, s[12:15], s18 offen offset:0
    v_mfma_f32_16x16x32_bf16 v[120:123], v[76:79], a[184:187], v[120:123]
    s_waitcnt lgkmcnt(4)
    ds_read_b128 v[68:71], v10 offset:16384
    ds_read_b128 v[176:179], v25 offset:0
    ds_read_b128 v[192:195], v25 offset:4096
    v_mfma_f32_16x16x32_bf16 v[120:123], v[72:75], a[176:179], v[120:123]
    buffer_load_dwordx4 a[228:231], v1, s[12:15], s18 offen offset:256
    v_mfma_f32_16x16x32_bf16 v[128:131], v[80:83], a[176:179], v[128:131]
    s_waitcnt lgkmcnt(6)
    ds_read_b128 v[72:75], v8 offset:18432
    ds_read_b128 v[180:183], v25 offset:1024
    ds_read_b128 v[196:199], v25 offset:5120
    v_mfma_f32_16x16x32_bf16 v[128:131], v[84:87], a[184:187], v[128:131]
    ds_read_b128 v[184:187], v25 offset:2048
    ds_read_b128 v[200:203], v25 offset:6144
    ds_read_b128 v[188:191], v25 offset:3072
    ds_read_b128 v[204:207], v25 offset:7168
    v_mfma_f32_16x16x32_bf16 v[132:135], v[84:87], a[188:191], v[132:135]
    s_waitcnt lgkmcnt(12)
    ds_read_b128 v[76:79], v10 offset:18432
    v_mfma_f32_16x16x32_bf16 v[132:135], v[80:83], a[180:183], v[132:135]
    buffer_load_dwordx4 a[232:235], v1, s[12:15], s18 offen offset:2048
    v_mfma_f32_16x16x32_bf16 v[140:143], v[88:91], a[180:183], v[140:143]
    s_waitcnt lgkmcnt(12)
    ds_read_b128 v[80:83], v8 offset:20480
    v_mfma_f32_16x16x32_bf16 v[140:143], v[92:95], a[188:191], v[140:143]
    s_waitcnt lgkmcnt(10)
    v_mfma_f32_32x32x16_bf16 v[144:159], v[176:179], a[240:243], v[144:159]
    s_waitcnt lgkmcnt(9)
    v_mfma_f32_16x16x32_bf16 v[136:139], v[92:95], a[184:187], v[136:139]
    ds_read_b128 v[84:87], v10 offset:20480
    v_mfma_f32_16x16x32_bf16 v[136:139], v[88:91], a[176:179], v[136:139]
    s_waitcnt vmcnt(14)
    buffer_load_dwordx4 a[236:239], v1, s[12:15], s18 offen offset:2304
    v_mfma_f32_32x32x16_bf16 v[160:175], v[192:195], a[240:243], v[160:175]
    s_waitcnt lgkmcnt(8)
    v_mfma_f32_16x16x32_bf16 v[96:99], v[64:67], a[192:195], v[96:99]
    s_waitcnt vmcnt(13)
    ds_read_b128 v[88:91], v8 offset:22528
    v_mfma_f32_16x16x32_bf16 v[96:99], v[68:71], a[200:203], v[96:99]
    s_waitcnt vmcnt(12)
    v_mfma_f32_32x32x16_bf16 v[144:159], v[180:183], a[244:247], v[144:159]
    s_waitcnt lgkmcnt(8)
    v_mfma_f32_16x16x32_bf16 v[100:103], v[68:71], a[204:207], v[100:103]
    ds_read_b128 v[92:95], v10 offset:22528
    s_add_u32 m0, s22, 49152
    v_mfma_f32_16x16x32_bf16 v[100:103], v[64:67], a[196:199], v[100:103]
    s_add_u32 s16, s16, 16384
    v_mfma_f32_32x32x16_bf16 v[160:175], v[196:199], a[244:247], v[160:175]
    s_waitcnt lgkmcnt(8)
    v_mfma_f32_16x16x32_bf16 v[108:111], v[72:75], a[196:199], v[108:111]
    s_waitcnt lgkmcnt(4)
    ds_read_b128 v[64:67], v8 offset:24576
    v_mfma_f32_16x16x32_bf16 v[108:111], v[76:79], a[204:207], v[108:111]
    buffer_load_dwordx4 v4, s[12:15], s16 offen offset:0 lds
    v_mfma_f32_32x32x16_bf16 v[144:159], v[184:187], a[248:251], v[144:159]
    v_mfma_f32_16x16x32_bf16 v[104:107], v[76:79], a[200:203], v[104:107]
    s_waitcnt lgkmcnt(4)
    ds_read_b128 v[68:71], v10 offset:24576
    v_mfma_f32_16x16x32_bf16 v[104:107], v[72:75], a[192:195], v[104:107]
    buffer_load_dwordx4 v4, s[12:15], s16 offen offset:1024 lds
    v_mfma_f32_32x32x16_bf16 v[160:175], v[200:203], a[248:251], v[160:175]
    v_mfma_f32_16x16x32_bf16 v[112:115], v[80:83], a[192:195], v[112:115]
    s_waitcnt lgkmcnt(4)
    ds_read_b128 v[72:75], v8 offset:26624
    v_mfma_f32_16x16x32_bf16 v[112:115], v[84:87], a[200:203], v[112:115]
    buffer_load_dwordx4 v4, s[12:15], s16 offen offset:2048 lds
    v_mfma_f32_4x4x4_16b_bf16 v[40:43], a[192:193], a[192:193], v[40:43]
    v_mfma_f32_4x4x4_16b_bf16 v[44:47], a[194:195], a[194:195], v[44:47]
    v_mfma_f32_4x4x4_16b_bf16 v[48:51], a[196:197], a[196:197], v[48:51]
    v_mfma_f32_4x4x4_16b_bf16 v[52:55], a[198:199], a[198:199], v[52:55]
    v_mfma_f32_4x4x4_16b_bf16 v[40:43], a[200:201], a[200:201], v[40:43]
    v_mfma_f32_4x4x4_16b_bf16 v[44:47], a[202:203], a[202:203], v[44:47]
    v_mfma_f32_4x4x4_16b_bf16 v[48:51], a[204:205], a[204:205], v[48:51]
    v_mfma_f32_4x4x4_16b_bf16 v[52:55], a[206:207], a[206:207], v[52:55]
    v_mfma_f32_32x32x16_bf16 v[144:159], v[188:191], a[252:255], v[144:159]
    v_mfma_f32_16x16x32_bf16 v[116:119], v[84:87], a[204:207], v[116:119]
    s_waitcnt lgkmcnt(4)
    ds_read_b128 v[76:79], v10 offset:26624
    v_mfma_f32_16x16x32_bf16 v[116:119], v[80:83], a[196:199], v[116:119]
    v_mfma_f32_32x32x16_bf16 v[160:175], v[204:207], a[252:255], v[160:175]
    v_mfma_f32_16x16x32_bf16 v[124:127], v[88:91], a[196:199], v[124:127]
    s_waitcnt lgkmcnt(4)
    ds_read_b128 v[80:83], v8 offset:28672
    v_mfma_f32_16x16x32_bf16 v[124:127], v[92:95], a[204:207], v[124:127]
    buffer_load_dwordx4 v4, s[12:15], s16 offen offset:3072 lds
    v_mfma_f32_16x16x32_bf16 v[120:123], v[92:95], a[200:203], v[120:123]
    s_waitcnt lgkmcnt(4)
    ds_read_b128 v[84:87], v10 offset:28672
    v_mfma_f32_16x16x32_bf16 v[120:123], v[88:91], a[192:195], v[120:123]
    v_mfma_f32_16x16x32_bf16 v[128:131], v[64:67], a[192:195], v[128:131]
    s_waitcnt lgkmcnt(4)
    ds_read_b128 v[88:91], v8 offset:30720
    v_mfma_f32_16x16x32_bf16 v[128:131], v[68:71], a[200:203], v[128:131]
    v_mfma_f32_16x16x32_bf16 v[132:135], v[68:71], a[204:207], v[132:135]
    s_waitcnt lgkmcnt(4)
    ds_read_b128 v[92:95], v10 offset:30720
    v_mfma_f32_16x16x32_bf16 v[132:135], v[64:67], a[196:199], v[132:135]
    s_waitcnt vmcnt(8)
    s_barrier
    v_mfma_f32_16x16x32_bf16 v[140:143], v[72:75], a[196:199], v[140:143]
    s_waitcnt lgkmcnt(4)
    ds_read_b128 v[64:67], v8 offset:32768
    v_mfma_f32_16x16x32_bf16 v[140:143], v[76:79], a[204:207], v[140:143]
    v_mfma_f32_16x16x32_bf16 v[136:139], v[76:79], a[200:203], v[136:139]
    s_waitcnt lgkmcnt(4)
    ds_read_b128 v[68:71], v10 offset:32768
    v_mfma_f32_16x16x32_bf16 v[136:139], v[72:75], a[192:195], v[136:139]
    v_cvt_pk_bf16_f32 v224, v144, v145
    v_cvt_pk_bf16_f32 v225, v146, v147
    v_cvt_pk_bf16_f32 v226, v148, v149
    v_cvt_pk_bf16_f32 v227, v150, v151
    v_mfma_f32_16x16x32_bf16 v[96:99], v[80:83], a[208:211], v[96:99]
    s_waitcnt lgkmcnt(4)
    ds_read_b128 v[72:75], v8 offset:34816
    s_add_u32 s18, s18, 4096
    v_mfma_f32_16x16x32_bf16 v[96:99], v[84:87], a[216:219], v[96:99]
    buffer_load_dwordx4 a[240:243], v1, s[12:15], s18 offen offset:0
    v_mfma_f32_16x16x32_bf16 v[100:103], v[84:87], a[220:223], v[100:103]
    s_waitcnt lgkmcnt(4)
    ds_read_b128 v[76:79], v10 offset:34816
    ds_write_b128 v26, v[224:227] offset:0
    v_cvt_pk_bf16_f32 v228, v152, v153
    v_mfma_f32_16x16x32_bf16 v[100:103], v[80:83], a[212:215], v[100:103]
    buffer_load_dwordx4 a[244:247], v1, s[12:15], s18 offen offset:256
    v_mfma_f32_16x16x32_bf16 v[108:111], v[88:91], a[212:215], v[108:111]
    s_waitcnt lgkmcnt(5)
    ds_read_b128 v[80:83], v8 offset:36864
    v_cvt_pk_bf16_f32 v229, v154, v155
    v_cvt_pk_bf16_f32 v230, v156, v157
    v_mfma_f32_16x16x32_bf16 v[108:111], v[92:95], a[220:223], v[108:111]
    buffer_load_dwordx4 a[248:251], v1, s[12:15], s18 offen offset:2048
    v_mfma_f32_16x16x32_bf16 v[104:107], v[92:95], a[216:219], v[104:107]
    s_waitcnt lgkmcnt(5)
    ds_read_b128 v[84:87], v10 offset:36864
    v_cvt_pk_bf16_f32 v231, v158, v159
    ds_write_b128 v27, v[228:231] offset:0
    v_mfma_f32_16x16x32_bf16 v[104:107], v[88:91], a[208:211], v[104:107]
    buffer_load_dwordx4 a[252:255], v1, s[12:15], s18 offen offset:2304
    v_mfma_f32_16x16x32_bf16 v[112:115], v[64:67], a[208:211], v[112:115]
    s_waitcnt lgkmcnt(6)
    ds_read_b128 v[88:91], v8 offset:38912
    s_add_u32 m0, s22, 65536
    v_mfma_f32_16x16x32_bf16 v[112:115], v[68:71], a[216:219], v[112:115]
    s_add_u32 s16, s16, 16384
    v_cvt_pk_bf16_f32 v232, v160, v161
    v_cvt_pk_bf16_f32 v233, v162, v163
    v_cvt_pk_bf16_f32 v234, v164, v165
    v_cvt_pk_bf16_f32 v235, v166, v167
    v_mfma_f32_4x4x4_16b_bf16 v[40:43], a[208:209], a[208:209], v[40:43]
    v_mfma_f32_4x4x4_16b_bf16 v[44:47], a[210:211], a[210:211], v[44:47]
    v_mfma_f32_4x4x4_16b_bf16 v[48:51], a[212:213], a[212:213], v[48:51]
    v_mfma_f32_4x4x4_16b_bf16 v[52:55], a[214:215], a[214:215], v[52:55]
    v_mfma_f32_4x4x4_16b_bf16 v[40:43], a[216:217], a[216:217], v[40:43]
    v_mfma_f32_4x4x4_16b_bf16 v[44:47], a[218:219], a[218:219], v[44:47]
    v_mfma_f32_4x4x4_16b_bf16 v[48:51], a[220:221], a[220:221], v[48:51]
    v_mfma_f32_4x4x4_16b_bf16 v[52:55], a[222:223], a[222:223], v[52:55]
    v_mfma_f32_16x16x32_bf16 v[116:119], v[68:71], a[220:223], v[116:119]
    s_waitcnt lgkmcnt(6)
    ds_read_b128 v[92:95], v10 offset:38912
    ds_write_b128 v26, v[232:235] offset:2048
    v_cvt_pk_bf16_f32 v236, v168, v169
    v_mfma_f32_16x16x32_bf16 v[116:119], v[64:67], a[212:215], v[116:119]
    buffer_load_dwordx4 v4, s[12:15], s16 offen offset:0 lds
    v_mfma_f32_16x16x32_bf16 v[124:127], v[72:75], a[212:215], v[124:127]
    s_waitcnt lgkmcnt(7)
    ds_read_b128 v[64:67], v8 offset:40960
    v_cvt_pk_bf16_f32 v237, v170, v171
    v_cvt_pk_bf16_f32 v238, v172, v173
    v_mfma_f32_16x16x32_bf16 v[124:127], v[76:79], a[220:223], v[124:127]
    buffer_load_dwordx4 v4, s[12:15], s16 offen offset:1024 lds
    v_mfma_f32_16x16x32_bf16 v[120:123], v[76:79], a[216:219], v[120:123]
    s_waitcnt lgkmcnt(6)
    ds_read_b128 v[68:71], v10 offset:40960
    v_cvt_pk_bf16_f32 v239, v174, v175
    ds_write_b128 v27, v[236:239] offset:2048
    v_mfma_f32_16x16x32_bf16 v[120:123], v[72:75], a[208:211], v[120:123]
    buffer_load_dwordx4 v4, s[12:15], s16 offen offset:2048 lds
    v_mfma_f32_16x16x32_bf16 v[128:131], v[80:83], a[208:211], v[128:131]
    s_waitcnt lgkmcnt(7)
    ds_read_b128 v[72:75], v8 offset:43008
    ds_read_b128 v[240:243], v28 offset:0
    ds_read_b128 v[244:247], v28 offset:1024
    v_mfma_f32_16x16x32_bf16 v[128:131], v[84:87], a[216:219], v[128:131]
    buffer_load_dwordx4 v4, s[12:15], s16 offen offset:3072 lds
    v_mfma_f32_16x16x32_bf16 v[132:135], v[84:87], a[220:223], v[132:135]
    s_waitcnt lgkmcnt(8)
    ds_read_b128 v[76:79], v10 offset:43008
    s_add_u32 m0, s22, 81920
    v_mfma_f32_16x16x32_bf16 v[132:135], v[80:83], a[212:215], v[132:135]
    s_add_u32 s16, s16, 16384
    ds_read_b128 v[248:251], v28 offset:2048
    ds_read_b128 v[252:255], v28 offset:3072
    v_mfma_f32_16x16x32_bf16 v[140:143], v[88:91], a[212:215], v[140:143]
    s_waitcnt lgkmcnt(10)
    ds_read_b128 v[80:83], v8 offset:45056
    v_mfma_f32_16x16x32_bf16 v[140:143], v[92:95], a[220:223], v[140:143]
    buffer_load_dwordx4 v4, s[12:15], s16 offen offset:0 lds
    v_mfma_f32_16x16x32_bf16 v[136:139], v[92:95], a[216:219], v[136:139]
    s_waitcnt lgkmcnt(9)
    ds_read_b128 v[84:87], v10 offset:45056
    v_mfma_f32_16x16x32_bf16 v[136:139], v[88:91], a[208:211], v[136:139]
    s_waitcnt vmcnt(16)
    buffer_load_dwordx4 v4, s[12:15], s16 offen offset:1024 lds
    v_mfma_f32_16x16x32_bf16 v[96:99], v[64:67], a[224:227], v[96:99]
    s_waitcnt vmcnt(15) lgkmcnt(9)
    ds_read_b128 v[88:91], v8 offset:47104
    v_mfma_f32_16x16x32_bf16 v[96:99], v[68:71], a[232:235], v[96:99]
    s_waitcnt vmcnt(14)
    v_mfma_f32_16x16x32_bf16 v[100:103], v[68:71], a[236:239], v[100:103]
    s_waitcnt lgkmcnt(8)
    ds_read_b128 v[92:95], v10 offset:47104
    v_mfma_f32_16x16x32_bf16 v[100:103], v[64:67], a[228:231], v[100:103]
    s_waitcnt vmcnt(10)
    s_barrier
    v_mfma_f32_16x16x32_bf16 v[108:111], v[72:75], a[228:231], v[108:111]
    s_waitcnt lgkmcnt(6)
    ds_read_b128 v[64:67], v8 offset:49152
    v_mfma_f32_16x16x32_bf16 v[108:111], v[76:79], a[236:239], v[108:111]
    buffer_load_dwordx4 v4, s[12:15], s16 offen offset:2048 lds
    v_mfma_f32_16x16x32_bf16 v[104:107], v[76:79], a[232:235], v[104:107]
    s_waitcnt lgkmcnt(4)
    ds_read_b128 v[68:71], v10 offset:49152
    v_mfma_f32_16x16x32_bf16 v[104:107], v[72:75], a[224:227], v[104:107]
    buffer_load_dwordx4 v4, s[12:15], s16 offen offset:3072 lds
    v_mfma_f32_16x16x32_bf16 v[112:115], v[80:83], a[224:227], v[112:115]
    s_waitcnt lgkmcnt(4)
    ds_read_b128 v[72:75], v8 offset:51200
    s_add_u32 m0, s22, 98304
    v_mfma_f32_16x16x32_bf16 v[112:115], v[84:87], a[232:235], v[112:115]
    s_add_u32 s16, s16, 16384
    v_mfma_f32_4x4x4_16b_bf16 v[40:43], a[224:225], a[224:225], v[40:43]
    v_mfma_f32_4x4x4_16b_bf16 v[44:47], a[226:227], a[226:227], v[44:47]
    v_mfma_f32_4x4x4_16b_bf16 v[48:51], a[228:229], a[228:229], v[48:51]
    v_mfma_f32_4x4x4_16b_bf16 v[52:55], a[230:231], a[230:231], v[52:55]
    v_mfma_f32_4x4x4_16b_bf16 v[40:43], a[232:233], a[232:233], v[40:43]
    v_mfma_f32_4x4x4_16b_bf16 v[44:47], a[234:235], a[234:235], v[44:47]
    v_mfma_f32_4x4x4_16b_bf16 v[48:51], a[236:237], a[236:237], v[48:51]
    v_mfma_f32_4x4x4_16b_bf16 v[52:55], a[238:239], a[238:239], v[52:55]
    v_mfma_f32_16x16x32_bf16 v[116:119], v[84:87], a[236:239], v[116:119]
    s_waitcnt lgkmcnt(4)
    ds_read_b128 v[76:79], v10 offset:51200
    v_mfma_f32_16x16x32_bf16 v[116:119], v[80:83], a[228:231], v[116:119]
    buffer_load_dwordx4 v4, s[12:15], s16 offen offset:0 lds
    v_mfma_f32_16x16x32_bf16 v[124:127], v[88:91], a[228:231], v[124:127]
    s_waitcnt lgkmcnt(4)
    ds_read_b128 v[80:83], v8 offset:53248
    v_mfma_f32_16x16x32_bf16 v[124:127], v[92:95], a[236:239], v[124:127]
    buffer_load_dwordx4 v4, s[12:15], s16 offen offset:1024 lds
    v_mfma_f32_16x16x32_bf16 v[120:123], v[92:95], a[232:235], v[120:123]
    s_waitcnt lgkmcnt(4)
    ds_read_b128 v[84:87], v10 offset:53248
    v_mfma_f32_16x16x32_bf16 v[120:123], v[88:91], a[224:227], v[120:123]
    buffer_load_dwordx4 v4, s[12:15], s16 offen offset:2048 lds
    v_mfma_f32_16x16x32_bf16 v[128:131], v[64:67], a[224:227], v[128:131]
    s_waitcnt lgkmcnt(4)
    ds_read_b128 v[88:91], v8 offset:55296
    v_mfma_f32_16x16x32_bf16 v[128:131], v[68:71], a[232:235], v[128:131]
    v_mfma_f32_16x16x32_bf16 v[132:135], v[68:71], a[236:239], v[132:135]
    s_waitcnt lgkmcnt(4)
    ds_read_b128 v[92:95], v10 offset:55296
    v_mfma_f32_16x16x32_bf16 v[132:135], v[64:67], a[228:231], v[132:135]
    buffer_load_dwordx4 v4, s[12:15], s16 offen offset:3072 lds
    v_mfma_f32_16x16x32_bf16 v[140:143], v[72:75], a[228:231], v[140:143]
    s_waitcnt lgkmcnt(4)
    ds_read_b128 v[64:67], v8 offset:57344
    v_mfma_f32_16x16x32_bf16 v[140:143], v[76:79], a[236:239], v[140:143]
    v_mfma_f32_16x16x32_bf16 v[136:139], v[76:79], a[232:235], v[136:139]
    s_waitcnt lgkmcnt(4)
    ds_read_b128 v[68:71], v10 offset:57344
    s_add_u32 m0, s22, 114688
    v_mfma_f32_16x16x32_bf16 v[136:139], v[72:75], a[224:227], v[136:139]
    s_waitcnt vmcnt(15)
    s_add_u32 s16, s16, 16384
    v_mfma_f32_16x16x32_bf16 v[96:99], v[80:83], a[240:243], v[96:99]
    s_waitcnt vmcnt(13) lgkmcnt(4)
    ds_read_b128 v[72:75], v8 offset:59392
    v_mfma_f32_16x16x32_bf16 v[96:99], v[84:87], a[248:251], v[96:99]
    s_waitcnt vmcnt(12)
    buffer_load_dwordx4 v4, s[12:15], s16 offen offset:0 lds
    v_mfma_f32_16x16x32_bf16 v[100:103], v[84:87], a[252:255], v[100:103]
    s_waitcnt lgkmcnt(4)
    ds_read_b128 v[76:79], v10 offset:59392
    v_mfma_f32_16x16x32_bf16 v[100:103], v[80:83], a[244:247], v[100:103]
    buffer_load_dwordx4 v4, s[12:15], s16 offen offset:1024 lds
    v_mfma_f32_16x16x32_bf16 v[108:111], v[88:91], a[244:247], v[108:111]
    s_waitcnt lgkmcnt(4)
    ds_read_b128 v[80:83], v8 offset:61440
    v_mfma_f32_16x16x32_bf16 v[108:111], v[92:95], a[252:255], v[108:111]
    buffer_load_dwordx4 v4, s[12:15], s16 offen offset:2048 lds
    v_mfma_f32_16x16x32_bf16 v[104:107], v[92:95], a[248:251], v[104:107]
    s_waitcnt lgkmcnt(4)
    ds_read_b128 v[84:87], v10 offset:61440
    v_mfma_f32_16x16x32_bf16 v[104:107], v[88:91], a[240:243], v[104:107]
    buffer_load_dwordx4 v4, s[12:15], s16 offen offset:3072 lds
    v_mfma_f32_16x16x32_bf16 v[112:115], v[64:67], a[240:243], v[112:115]
    s_waitcnt lgkmcnt(4)
    ds_read_b128 v[88:91], v8 offset:63488
    s_add_u32 m0, s22, 0
    v_mfma_f32_16x16x32_bf16 v[112:115], v[68:71], a[248:251], v[112:115]
    s_add_u32 s16, s16, 16384
    v_mfma_f32_4x4x4_16b_bf16 v[40:43], a[240:241], a[240:241], v[40:43]
    v_mfma_f32_4x4x4_16b_bf16 v[44:47], a[242:243], a[242:243], v[44:47]
    v_mfma_f32_4x4x4_16b_bf16 v[48:51], a[244:245], a[244:245], v[48:51]
    v_mfma_f32_4x4x4_16b_bf16 v[52:55], a[246:247], a[246:247], v[52:55]
    v_mfma_f32_4x4x4_16b_bf16 v[40:43], a[248:249], a[248:249], v[40:43]
    v_mfma_f32_4x4x4_16b_bf16 v[44:47], a[250:251], a[250:251], v[44:47]
    v_mfma_f32_4x4x4_16b_bf16 v[48:51], a[252:253], a[252:253], v[48:51]
    v_mfma_f32_4x4x4_16b_bf16 v[52:55], a[254:255], a[254:255], v[52:55]
    v_mfma_f32_16x16x32_bf16 v[116:119], v[68:71], a[252:255], v[116:119]
    s_waitcnt lgkmcnt(4)
    ds_read_b128 v[92:95], v10 offset:63488
    v_mov_b32 v3, 0x3727c5ac
    v_mfma_f32_16x16x32_bf16 v[116:119], v[64:67], a[244:247], v[116:119]
    s_waitcnt vmcnt(12)
    s_barrier
    v_mfma_f32_16x16x32_bf16 v[124:127], v[72:75], a[244:247], v[124:127]
    s_waitcnt lgkmcnt(4)
    ds_read_b128 v[64:67], v9 offset:0
    v_mfma_f32_16x16x32_bf16 v[124:127], v[76:79], a[252:255], v[124:127]
    buffer_load_dwordx4 v4, s[12:15], s16 offen offset:0 lds
    v_mfma_f32_16x16x32_bf16 v[120:123], v[76:79], a[248:251], v[120:123]
    s_waitcnt lgkmcnt(4)
    ds_read_b128 v[68:71], v11 offset:0
    v_add_f32 v40, v40, v44
    v_mfma_f32_16x16x32_bf16 v[120:123], v[72:75], a[240:243], v[120:123]
    buffer_load_dwordx4 v4, s[12:15], s16 offen offset:1024 lds
    v_mfma_f32_16x16x32_bf16 v[128:131], v[80:83], a[240:243], v[128:131]
    s_waitcnt lgkmcnt(4)
    ds_read_b128 v[72:75], v9 offset:2048
    s_add_u32 s27, s40, 0
    v_mfma_f32_16x16x32_bf16 v[128:131], v[84:87], a[248:251], v[128:131]
    buffer_load_dwordx4 v4, s[12:15], s16 offen offset:2048 lds
    v_mfma_f32_16x16x32_bf16 v[132:135], v[84:87], a[252:255], v[132:135]
    s_waitcnt lgkmcnt(4)
    ds_read_b128 v[76:79], v11 offset:2048
    v_add_f32 v41, v41, v45
    v_mfma_f32_16x16x32_bf16 v[132:135], v[80:83], a[244:247], v[132:135]
    buffer_load_dwordx4 v4, s[12:15], s16 offen offset:3072 lds
    v_mfma_f32_16x16x32_bf16 v[140:143], v[88:91], a[244:247], v[140:143]
    s_waitcnt lgkmcnt(4)
    ds_read_b128 v[80:83], v9 offset:6144
    s_add_u32 m0, s22, 16384
    v_mfma_f32_16x16x32_bf16 v[140:143], v[92:95], a[252:255], v[140:143]
    s_add_u32 s16, s16, 16384
    v_add_f32 v42, v42, v46
    v_add_f32 v43, v43, v47
    v_mfma_f32_16x16x32_bf16 v[136:139], v[92:95], a[248:251], v[136:139]
    s_waitcnt lgkmcnt(4)
    ds_read_b128 v[84:87], v11 offset:6144
    v_cndmask_b32 v40, v40, v41, s[96:97]
    v_mfma_f32_16x16x32_bf16 v[136:139], v[88:91], a[240:243], v[136:139]
    buffer_load_dwordx4 v4, s[12:15], s16 offen offset:0 lds
    v_mfma_f32_16x16x32_bf16 v[144:147], v[64:67], a[0:3], 0
    s_waitcnt lgkmcnt(4)
    ds_read_b128 v[88:91], v9 offset:4096
    s_add_u32 s45, s40, 2048
    v_mfma_f32_16x16x32_bf16 v[144:147], v[68:71], a[8:11], v[144:147]
    v_cndmask_b32 v40, v40, v42, s[98:99]
    v_add_f32 v48, v48, v52
    v_mfma_f32_16x16x32_bf16 v[148:151], v[68:71], a[12:15], 0
    s_waitcnt lgkmcnt(4)
    ds_read_b128 v[92:95], v11 offset:4096
    v_cndmask_b32 v40, v40, v43, s[100:101]
    v_mfma_f32_16x16x32_bf16 v[148:151], v[64:67], a[4:7], v[148:151]
    buffer_load_dwordx4 v4, s[12:15], s16 offen offset:1024 lds
    v_mfma_f32_16x16x32_bf16 v[156:159], v[72:75], a[4:7], 0
    s_waitcnt lgkmcnt(4)
    ds_read_b128 v[64:67], v9 offset:8192
    v_mov_b32 v41, v40
    v_mfma_f32_16x16x32_bf16 v[156:159], v[76:79], a[12:15], v[156:159]
    s_nop 0
    v_add_f32 v49, v49, v53
    v_add_f32 v50, v50, v54
    v_mfma_f32_16x16x32_bf16 v[152:155], v[76:79], a[8:11], 0
    s_waitcnt lgkmcnt(4)
    ds_read_b128 v[68:71], v11 offset:8192
    v_permlane32_swap_b32 v40, v41
    v_mfma_f32_16x16x32_bf16 v[152:155], v[72:75], a[0:3], v[152:155]
    buffer_load_dwordx4 v4, s[12:15], s16 offen offset:2048 lds
    v_mfma_f32_16x16x32_bf16 v[152:155], v[80:83], a[16:19], v[152:155]
    s_waitcnt lgkmcnt(4)
    ds_read_b128 v[72:75], v9 offset:10240
    v_add_f32 v40, v40, v41
    v_mfma_f32_16x16x32_bf16 v[152:155], v[84:87], a[24:27], v[152:155]
    v_mov_b32 v41, v40
    v_add_f32 v51, v51, v55
    v_mfma_f32_16x16x32_bf16 v[156:159], v[84:87], a[28:31], v[156:159]
    s_waitcnt lgkmcnt(4)
    ds_read_b128 v[76:79], v11 offset:10240
    s_nop 0
    v_mfma_f32_16x16x32_bf16 v[156:159], v[80:83], a[20:23], v[156:159]
    buffer_load_dwordx4 v4, s[12:15], s16 offen offset:3072 lds
    v_mfma_f32_16x16x32_bf16 v[148:151], v[88:91], a[20:23], v[148:151]
    s_waitcnt lgkmcnt(4)
    ds_read_b128 v[80:83], v9 offset:14336
    s_add_u32 m0, s22, 32768
    v_mfma_f32_16x16x32_bf16 v[148:151], v[92:95], a[28:31], v[148:151]
    s_add_u32 s16, s16, 16384
    v_permlane16_swap_b32 v40, v41
    v_mfma_f32_16x16x32_bf16 v[144:147], v[92:95], a[24:27], v[144:147]
    s_waitcnt lgkmcnt(4)
    ds_read_b128 v[84:87], v11 offset:14336
    v_add_f32 v40, v40, v41
    v_mfma_f32_16x16x32_bf16 v[144:147], v[88:91], a[16:19], v[144:147]
    buffer_load_dwordx4 v4, s[12:15], s16 offen offset:0 lds
    v_mfma_f32_16x16x32_bf16 v[144:147], v[64:67], a[32:35], v[144:147]
    s_waitcnt lgkmcnt(4)
    ds_read_b128 v[88:91], v9 offset:12288
    v_fmamk_f32 v40, v40, 0x3a800000, v3
    v_mfma_f32_16x16x32_bf16 v[144:147], v[68:71], a[40:43], v[144:147]
    v_rsq_f32 v22, v40
    v_mfma_f32_16x16x32_bf16 v[148:151], v[68:71], a[44:47], v[148:151]
    s_waitcnt lgkmcnt(4)
    ds_read_b128 v[92:95], v11 offset:12288
    v_sqrt_f32 v23, v40
    v_mfma_f32_16x16x32_bf16 v[148:151], v[64:67], a[36:39], v[148:151]
    s_waitcnt vmcnt(17)
    s_barrier
    v_mfma_f32_16x16x32_bf16 v[156:159], v[72:75], a[36:39], v[156:159]
    s_waitcnt lgkmcnt(4)
    ds_read_b128 v[64:67], v9 offset:16384
    v_mul_f32 v22, 0xbfb8aa3b, v22
    v_mfma_f32_16x16x32_bf16 v[156:159], v[76:79], a[44:47], v[156:159]
    buffer_load_dwordx4 v4, s[12:15], s16 offen offset:1024 lds
    v_mfma_f32_16x16x32_bf16 v[152:155], v[76:79], a[40:43], v[152:155]
    s_waitcnt lgkmcnt(4)
    ds_read_b128 v[68:71], v11 offset:16384
    v_cndmask_b32 v48, v48, v49, s[96:97]
    v_mfma_f32_16x16x32_bf16 v[152:155], v[72:75], a[32:35], v[152:155]
    v_cndmask_b32 v48, v48, v50, s[98:99]
    v_mfma_f32_16x16x32_bf16 v[152:155], v[80:83], a[48:51], v[152:155]
    s_waitcnt lgkmcnt(4)
    ds_read_b128 v[72:75], v9 offset:18432
    v_cndmask_b32 v48, v48, v51, s[100:101]
    v_mfma_f32_16x16x32_bf16 v[152:155], v[84:87], a[56:59], v[152:155]
    buffer_load_dwordx4 v4, s[12:15], s16 offen offset:2048 lds
    v_mfma_f32_16x16x32_bf16 v[156:159], v[84:87], a[60:63], v[156:159]
    s_waitcnt lgkmcnt(4)
    ds_read_b128 v[76:79], v11 offset:18432
    v_mov_b32 v49, v48
    v_mfma_f32_16x16x32_bf16 v[156:159], v[80:83], a[52:55], v[156:159]
    s_nop 0
    v_mfma_f32_16x16x32_bf16 v[148:151], v[88:91], a[52:55], v[148:151]
    s_waitcnt lgkmcnt(4)
    ds_read_b128 v[80:83], v9 offset:22528
    v_permlane32_swap_b32 v48, v49
    v_mfma_f32_16x16x32_bf16 v[148:151], v[92:95], a[60:63], v[148:151]
    buffer_load_dwordx4 v4, s[12:15], s16 offen offset:3072 lds
    v_mfma_f32_16x16x32_bf16 v[144:147], v[92:95], a[56:59], v[144:147]
    s_waitcnt lgkmcnt(4)
    ds_read_b128 v[84:87], v11 offset:22528
    s_add_u32 m0, s22, 49152
    v_mfma_f32_16x16x32_bf16 v[144:147], v[88:91], a[48:51], v[144:147]
    s_add_u32 s16, s16, 16384
    v_add_f32 v48, v48, v49
    v_mfma_f32_16x16x32_bf16 v[144:147], v[64:67], a[64:67], v[144:147]
    s_waitcnt lgkmcnt(4)
    ds_read_b128 v[88:91], v9 offset:20480
    v_mov_b32 v49, v48
    v_mfma_f32_16x16x32_bf16 v[144:147], v[68:71], a[72:75], v[144:147]
    buffer_load_dwordx4 v4, s[12:15], s16 offen offset:0 lds
    v_mfma_f32_16x16x32_bf16 v[148:151], v[68:71], a[76:79], v[148:151]
    s_waitcnt lgkmcnt(4)
    ds_read_b128 v[92:95], v11 offset:20480
    s_nop 0
    v_mfma_f32_16x16x32_bf16 v[148:151], v[64:67], a[68:71], v[148:151]
    v_permlane16_swap_b32 v48, v49
    v_mfma_f32_16x16x32_bf16 v[156:159], v[72:75], a[68:71], v[156:159]
    s_waitcnt lgkmcnt(4)
    ds_read_b128 v[64:67], v9 offset:24576
    v_add_f32 v48, v48, v49
    v_mfma_f32_16x16x32_bf16 v[156:159], v[76:79], a[76:79], v[156:159]
    buffer_load_dwordx4 v4, s[12:15], s16 offen offset:1024 lds
    v_mfma_f32_16x16x32_bf16 v[152:155], v[76:79], a[72:75], v[152:155]
    s_waitcnt lgkmcnt(4)
    ds_read_b128 v[68:71], v11 offset:24576
    v_fmamk_f32 v48, v48, 0x3a800000, v3
    v_mfma_f32_16x16x32_bf16 v[152:155], v[72:75], a[64:67], v[152:155]
    v_rsq_f32 v56, v48
    v_mfma_f32_16x16x32_bf16 v[152:155], v[80:83], a[80:83], v[152:155]
    s_waitcnt lgkmcnt(4)
    ds_read_b128 v[72:75], v9 offset:26624
    v_sqrt_f32 v57, v48
    v_mfma_f32_16x16x32_bf16 v[152:155], v[84:87], a[88:91], v[152:155]
    buffer_store_dwordx4 v[240:243], v4, s[12:15], s5 offen offset:0 sc1
    v_mfma_f32_16x16x32_bf16 v[156:159], v[84:87], a[92:95], v[156:159]
    s_waitcnt lgkmcnt(4)
    ds_read_b128 v[76:79], v11 offset:26624
    v_mul_f32 v56, 0xbfb8aa3b, v56
    v_mfma_f32_16x16x32_bf16 v[156:159], v[80:83], a[84:87], v[156:159]
    s_nop 0
    v_mfma_f32_16x16x32_bf16 v[148:151], v[88:91], a[84:87], v[148:151]
    s_waitcnt lgkmcnt(4)
    ds_read_b128 v[80:83], v9 offset:30720
    v_mul_f32 v24, v96, v22
    v_mfma_f32_16x16x32_bf16 v[148:151], v[92:95], a[92:95], v[148:151]
    buffer_load_dwordx4 v4, s[12:15], s16 offen offset:2048 lds
    v_mfma_f32_16x16x32_bf16 v[144:147], v[92:95], a[88:91], v[144:147]
    s_waitcnt lgkmcnt(4)
    ds_read_b128 v[84:87], v11 offset:30720
    v_exp_f32 v24, v24
    v_mfma_f32_16x16x32_bf16 v[144:147], v[88:91], a[80:83], v[144:147]
    v_fma_f32 v24, v24, v23, v23
    v_mul_f32 v25, v97, v22
    v_mfma_f32_16x16x32_bf16 v[144:147], v[64:67], a[96:99], v[144:147]
    s_waitcnt lgkmcnt(4)
    ds_read_b128 v[88:91], v9 offset:28672
    v_rcp_f32 v24, v24
    v_mfma_f32_16x16x32_bf16 v[144:147], v[68:71], a[104:107], v[144:147]
    buffer_load_dwordx4 v4, s[12:15], s16 offen offset:3072 lds
    v_mfma_f32_16x16x32_bf16 v[148:151], v[68:71], a[108:111], v[148:151]
    s_waitcnt lgkmcnt(4)
    ds_read_b128 v[92:95], v11 offset:28672
    v_exp_f32 v25, v25
    v_mfma_f32_16x16x32_bf16 v[148:151], v[64:67], a[100:103], v[148:151]
    s_waitcnt vmcnt(21)
    s_barrier
    v_mfma_f32_16x16x32_bf16 v[156:159], v[72:75], a[100:103], v[156:159]
    s_waitcnt lgkmcnt(4)
    ds_read_b128 v[64:67], v9 offset:32768
    s_add_u32 m0, s22, 65536
    v_mfma_f32_16x16x32_bf16 v[156:159], v[76:79], a[108:111], v[156:159]
    s_add_u32 s16, s16, 16384
    v_mul_f32 v24, v24, v96
    v_fma_f32 v25, v25, v23, v23
    v_mfma_f32_16x16x32_bf16 v[152:155], v[76:79], a[104:107], v[152:155]
    s_waitcnt lgkmcnt(4)
    ds_read_b128 v[68:71], v11 offset:32768
    v_rcp_f32 v25, v25
    v_mfma_f32_16x16x32_bf16 v[152:155], v[72:75], a[96:99], v[152:155]
    buffer_load_dwordx4 v4, s[12:15], s16 offen offset:0 lds
    v_mfma_f32_16x16x32_bf16 v[152:155], v[80:83], a[112:115], v[152:155]
    s_waitcnt lgkmcnt(4)
    ds_read_b128 v[72:75], v9 offset:34816
    v_mul_f32 v25, v25, v97
    v_mfma_f32_16x16x32_bf16 v[152:155], v[84:87], a[120:123], v[152:155]
    v_mul_f32 v26, v98, v22
    v_mul_f32 v27, v99, v22
    v_mfma_f32_16x16x32_bf16 v[156:159], v[84:87], a[124:127], v[156:159]
    s_waitcnt lgkmcnt(4)
    ds_read_b128 v[76:79], v11 offset:34816
    v_exp_f32 v26, v26
    v_mfma_f32_16x16x32_bf16 v[156:159], v[80:83], a[116:119], v[156:159]
    buffer_load_dwordx4 v4, s[12:15], s16 offen offset:1024 lds
    v_mfma_f32_16x16x32_bf16 v[148:151], v[88:91], a[116:119], v[148:151]
    s_waitcnt lgkmcnt(4)
    ds_read_b128 v[80:83], v9 offset:38912
    v_exp_f32 v27, v27
    v_mfma_f32_16x16x32_bf16 v[148:151], v[92:95], a[124:127], v[148:151]
    v_fma_f32 v26, v26, v23, v23
    v_fma_f32 v27, v27, v23, v23
    v_mfma_f32_16x16x32_bf16 v[144:147], v[92:95], a[120:123], v[144:147]
    s_waitcnt lgkmcnt(4)
    ds_read_b128 v[84:87], v11 offset:38912
    v_rcp_f32 v26, v26
    v_mfma_f32_16x16x32_bf16 v[144:147], v[88:91], a[112:115], v[144:147]
    buffer_load_dwordx4 v4, s[12:15], s16 offen offset:2048 lds
    v_mfma_f32_16x16x32_bf16 v[144:147], v[64:67], a[128:131], v[144:147]
    s_waitcnt lgkmcnt(4)
    ds_read_b128 v[88:91], v9 offset:36864
    v_rcp_f32 v27, v27
    v_mfma_f32_16x16x32_bf16 v[144:147], v[68:71], a[136:139], v[144:147]
    v_mul_f32 v26, v26, v98
    v_mul_f32 v27, v27, v99
    v_mfma_f32_16x16x32_bf16 v[148:151], v[68:71], a[140:143], v[148:151]
    s_waitcnt lgkmcnt(4)
    ds_read_b128 v[92:95], v11 offset:36864
    v_mul_f32 v28, v104, v22
    v_mfma_f32_16x16x32_bf16 v[148:151], v[64:67], a[132:135], v[148:151]
    buffer_load_dwordx4 v4, s[12:15], s16 offen offset:3072 lds
    v_mfma_f32_16x16x32_bf16 v[156:159], v[72:75], a[132:135], v[156:159]
    s_waitcnt lgkmcnt(4)
    ds_read_b128 v[64:67], v9 offset:40960
    v_exp_f32 v28, v28
    v_mfma_f32_16x16x32_bf16 v[156:159], v[76:79], a[140:143], v[156:159]
    v_fma_f32 v28, v28, v23, v23
    v_mul_f32 v29, v105, v22
    v_mfma_f32_16x16x32_bf16 v[152:155], v[76:79], a[136:139], v[152:155]
    s_waitcnt lgkmcnt(4)
    ds_read_b128 v[68:71], v11 offset:40960
    v_rcp_f32 v28, v28
    v_mfma_f32_16x16x32_bf16 v[152:155], v[72:75], a[128:131], v[152:155]
    v_mul_f32 v28, v28, v104
    v_mul_f32 v30, v106, v22
    v_mfma_f32_16x16x32_bf16 v[152:155], v[80:83], a[144:147], v[152:155]
    s_waitcnt lgkmcnt(4)
    ds_read_b128 v[72:75], v9 offset:43008
    v_exp_f32 v29, v29
    v_mfma_f32_16x16x32_bf16 v[152:155], v[84:87], a[152:155], v[152:155]
    v_fma_f32 v29, v29, v23, v23
    v_mul_f32 v31, v107, v22
    v_mfma_f32_16x16x32_bf16 v[156:159], v[84:87], a[156:159], v[156:159]
    s_waitcnt lgkmcnt(4)
    ds_read_b128 v[76:79], v11 offset:43008
    v_rcp_f32 v29, v29
    v_mfma_f32_16x16x32_bf16 v[156:159], v[80:83], a[148:151], v[156:159]
    v_mul_f32 v29, v29, v105
    v_cvt_pk_bf16_f32 v96, v24, v25
    v_mfma_f32_16x16x32_bf16 v[148:151], v[88:91], a[148:151], v[148:151]
    s_waitcnt lgkmcnt(4)
    ds_read_b128 v[80:83], v9 offset:47104
    v_exp_f32 v30, v30
    v_mfma_f32_16x16x32_bf16 v[148:151], v[92:95], a[156:159], v[148:151]
    v_fma_f32 v30, v30, v23, v23
    v_cvt_pk_bf16_f32 v97, v26, v27
    v_mfma_f32_16x16x32_bf16 v[144:147], v[92:95], a[152:155], v[144:147]
    s_waitcnt lgkmcnt(4)
    ds_read_b128 v[84:87], v11 offset:47104
    v_rcp_f32 v30, v30
    v_mfma_f32_16x16x32_bf16 v[144:147], v[88:91], a[144:147], v[144:147]
    v_mul_f32 v30, v30, v106
    v_cvt_pk_bf16_f32 v98, v28, v29
    v_mfma_f32_16x16x32_bf16 v[144:147], v[64:67], a[160:163], v[144:147]
    s_waitcnt lgkmcnt(4)
    ds_read_b128 v[88:91], v9 offset:45056
    v_exp_f32 v31, v31
    v_mfma_f32_16x16x32_bf16 v[144:147], v[68:71], a[168:171], v[144:147]
    v_fma_f32 v31, v31, v23, v23
    v_mul_f32 v32, v100, v56
    v_mfma_f32_16x16x32_bf16 v[148:151], v[68:71], a[172:175], v[148:151]
    s_waitcnt lgkmcnt(4)
    ds_read_b128 v[92:95], v11 offset:45056
    v_rcp_f32 v31, v31
    v_mfma_f32_16x16x32_bf16 v[148:151], v[64:67], a[164:167], v[148:151]
    s_waitcnt vmcnt(21)
    s_barrier
    v_mfma_f32_16x16x32_bf16 v[156:159], v[72:75], a[164:167], v[156:159]
    s_waitcnt lgkmcnt(4)
    ds_read_b128 v[64:67], v9 offset:49152
    s_add_u32 m0, s22, 81920
    v_mfma_f32_16x16x32_bf16 v[156:159], v[76:79], a[172:175], v[156:159]
    s_add_u32 s16, s16, 16384
    v_mul_f32 v31, v31, v107
    v_mul_f32 v33, v101, v56
    v_mfma_f32_16x16x32_bf16 v[152:155], v[76:79], a[168:171], v[152:155]
    s_waitcnt lgkmcnt(4)
    ds_read_b128 v[68:71], v11 offset:49152
    v_exp_f32 v32, v32
    v_mfma_f32_16x16x32_bf16 v[152:155], v[72:75], a[160:163], v[152:155]
    buffer_load_dwordx4 v4, s[12:15], s16 offen offset:0 lds
    v_mfma_f32_16x16x32_bf16 v[152:155], v[80:83], a[176:179], v[152:155]
    s_waitcnt lgkmcnt(4)
    ds_read_b128 v[72:75], v9 offset:51200
    v_exp_f32 v33, v33
    v_mfma_f32_16x16x32_bf16 v[152:155], v[84:87], a[184:187], v[152:155]
    v_cvt_pk_bf16_f32 v99, v30, v31
    v_fma_f32 v32, v32, v57, v57
    v_mfma_f32_16x16x32_bf16 v[156:159], v[84:87], a[188:191], v[156:159]
    s_waitcnt lgkmcnt(4)
    ds_read_b128 v[76:79], v11 offset:51200
    v_rcp_f32 v32, v32
    v_mfma_f32_16x16x32_bf16 v[156:159], v[80:83], a[180:183], v[156:159]
    buffer_store_dwordx4 v[96:99], v1, s[12:15], s27 offen offset:0 sc1
    v_mfma_f32_16x16x32_bf16 v[148:151], v[88:91], a[180:183], v[148:151]
    s_waitcnt lgkmcnt(4)
    ds_read_b128 v[80:83], v9 offset:55296
    v_mul_f32 v32, v32, v100
    v_mfma_f32_16x16x32_bf16 v[148:151], v[92:95], a[188:191], v[148:151]
    v_fma_f32 v33, v33, v57, v57
    v_mul_f32 v34, v102, v56
    v_mfma_f32_16x16x32_bf16 v[144:147], v[92:95], a[184:187], v[144:147]
    s_waitcnt lgkmcnt(4)
    ds_read_b128 v[84:87], v11 offset:55296
    v_rcp_f32 v33, v33
    v_mfma_f32_16x16x32_bf16 v[144:147], v[88:91], a[176:179], v[144:147]
    buffer_load_dwordx4 v4, s[12:15], s16 offen offset:1024 lds
    v_mfma_f32_16x16x32_bf16 v[144:147], v[64:67], a[192:195], v[144:147]
    s_waitcnt lgkmcnt(4)
    ds_read_b128 v[88:91], v9 offset:53248
    v_exp_f32 v34, v34
    v_mfma_f32_16x16x32_bf16 v[144:147], v[68:71], a[200:203], v[144:147]
    v_mul_f32 v33, v33, v101
    v_fma_f32 v34, v34, v57, v57
    v_mfma_f32_16x16x32_bf16 v[148:151], v[68:71], a[204:207], v[148:151]
    s_waitcnt lgkmcnt(4)
    ds_read_b128 v[92:95], v11 offset:53248
    v_rcp_f32 v34, v34
    v_mfma_f32_16x16x32_bf16 v[148:151], v[64:67], a[196:199], v[148:151]
    buffer_load_dwordx4 v4, s[12:15], s16 offen offset:2048 lds
    v_mfma_f32_16x16x32_bf16 v[156:159], v[72:75], a[196:199], v[156:159]
    s_waitcnt lgkmcnt(4)
    ds_read_b128 v[64:67], v9 offset:57344
    v_mul_f32 v34, v34, v102
    v_mfma_f32_16x16x32_bf16 v[156:159], v[76:79], a[204:207], v[156:159]
    v_mul_f32 v35, v103, v56
    v_mul_f32 v36, v108, v56
    v_mfma_f32_16x16x32_bf16 v[152:155], v[76:79], a[200:203], v[152:155]
    s_waitcnt lgkmcnt(4)
    ds_read_b128 v[68:71], v11 offset:57344
    v_exp_f32 v35, v35
    v_mfma_f32_16x16x32_bf16 v[152:155], v[72:75], a[192:195], v[152:155]
    buffer_store_dwordx4 v[244:247], v4, s[12:15], s5 offen offset:1024 sc1
    v_mfma_f32_16x16x32_bf16 v[152:155], v[80:83], a[208:211], v[152:155]
    s_waitcnt lgkmcnt(4)
    ds_read_b128 v[72:75], v9 offset:59392
    v_exp_f32 v36, v36
    v_mfma_f32_16x16x32_bf16 v[152:155], v[84:87], a[216:219], v[152:155]
    v_fma_f32 v35, v35, v57, v57
    v_fma_f32 v36, v36, v57, v57
    v_mfma_f32_16x16x32_bf16 v[156:159], v[84:87], a[220:223], v[156:159]
    s_waitcnt lgkmcnt(4)
    ds_read_b128 v[76:79], v11 offset:59392
    v_rcp_f32 v35, v35
    v_mfma_f32_16x16x32_bf16 v[156:159], v[80:83], a[212:215], v[156:159]
    buffer_load_dwordx4 v4, s[12:15], s16 offen offset:3072 lds
    v_mfma_f32_16x16x32_bf16 v[148:151], v[88:91], a[212:215], v[148:151]
    s_waitcnt lgkmcnt(4)
    ds_read_b128 v[80:83], v9 offset:63488
    v_rcp_f32 v36, v36
    v_mfma_f32_16x16x32_bf16 v[148:151], v[92:95], a[220:223], v[148:151]
    v_mul_f32 v35, v35, v103
    v_mul_f32 v36, v36, v108
    v_mfma_f32_16x16x32_bf16 v[144:147], v[92:95], a[216:219], v[144:147]
    s_waitcnt lgkmcnt(4)
    ds_read_b128 v[84:87], v11 offset:63488
    v_mul_f32 v37, v109, v56
    v_mfma_f32_16x16x32_bf16 v[144:147], v[88:91], a[208:211], v[144:147]
    v_exp_f32 v37, v37
    v_mfma_f32_16x16x32_bf16 v[144:147], v[64:67], a[224:227], v[144:147]
    s_waitcnt lgkmcnt(4)
    ds_read_b128 v[88:91], v9 offset:61440
    v_fma_f32 v37, v37, v57, v57
    v_mfma_f32_16x16x32_bf16 v[144:147], v[68:71], a[232:235], v[144:147]
    v_rcp_f32 v37, v37
    v_mfma_f32_16x16x32_bf16 v[148:151], v[68:71], a[236:239], v[148:151]
    s_waitcnt lgkmcnt(4)
    ds_read_b128 v[92:95], v11 offset:61440
    v_mul_f32 v37, v37, v109
    v_mfma_f32_16x16x32_bf16 v[148:151], v[64:67], a[228:231], v[148:151]
    s_waitcnt vmcnt(23)
    s_barrier
    v_mfma_f32_16x16x32_bf16 v[156:159], v[72:75], a[228:231], v[156:159]
    s_waitcnt lgkmcnt(4)
    ds_read_b128 v[64:67], v8 offset:0
    s_add_u32 m0, s22, 98304
    v_mfma_f32_16x16x32_bf16 v[156:159], v[76:79], a[236:239], v[156:159]
    s_add_u32 s16, s16, 16384
    v_mul_f32 v38, v110, v56
    v_mul_f32 v39, v111, v56
    v_mfma_f32_16x16x32_bf16 v[152:155], v[76:79], a[232:235], v[152:155]
    s_waitcnt lgkmcnt(4)
    ds_read_b128 v[68:71], v10 offset:0
    v_exp_f32 v38, v38
    v_mfma_f32_16x16x32_bf16 v[152:155], v[72:75], a[224:227], v[152:155]
    buffer_load_dwordx4 v4, s[12:15], s16 offen offset:0 lds
    v_mfma_f32_16x16x32_bf16 v[152:155], v[80:83], a[240:243], v[152:155]
    s_waitcnt lgkmcnt(4)
    ds_read_b128 v[72:75], v8 offset:2048
    v_exp_f32 v39, v39
    v_mfma_f32_16x16x32_bf16 v[152:155], v[84:87], a[248:251], v[152:155]
    v_fma_f32 v38, v38, v57, v57
    v_fma_f32 v39, v39, v57, v57
    v_mfma_f32_16x16x32_bf16 v[156:159], v[84:87], a[252:255], v[156:159]
    s_waitcnt lgkmcnt(4)
    ds_read_b128 v[76:79], v10 offset:2048
    v_rcp_f32 v38, v38
    v_mfma_f32_16x16x32_bf16 v[156:159], v[80:83], a[244:247], v[156:159]
    buffer_load_dwordx4 v4, s[12:15], s16 offen offset:1024 lds
    v_mfma_f32_16x16x32_bf16 v[148:151], v[88:91], a[244:247], v[148:151]
    s_waitcnt lgkmcnt(4)
    ds_read_b128 v[80:83], v8 offset:6144
    v_rcp_f32 v39, v39
    v_mfma_f32_16x16x32_bf16 v[148:151], v[92:95], a[252:255], v[148:151]
    v_mul_f32 v38, v38, v110
    v_mul_f32 v39, v39, v111
    v_mfma_f32_16x16x32_bf16 v[144:147], v[92:95], a[248:251], v[144:147]
    s_waitcnt lgkmcnt(4)
    ds_read_b128 v[84:87], v10 offset:6144
    v_cvt_pk_bf16_f32 v100, v32, v33
    v_mfma_f32_16x16x32_bf16 v[144:147], v[88:91], a[240:243], v[144:147]
    buffer_load_dwordx4 v4, s[12:15], s16 offen offset:2048 lds
    v_mfma_f32_16x16x32_bf16 v[160:163], v[64:67], a[0:3], 0
    s_waitcnt lgkmcnt(4)
    ds_read_b128 v[88:91], v8 offset:4096
    v_cvt_pk_bf16_f32 v101, v34, v35
    v_mfma_f32_16x16x32_bf16 v[160:163], v[68:71], a[8:11], v[160:163]
    v_cvt_pk_bf16_f32 v102, v36, v37
    v_cvt_pk_bf16_f32 v103, v38, v39
    v_mfma_f32_16x16x32_bf16 v[164:167], v[68:71], a[12:15], 0
    s_waitcnt lgkmcnt(4)
    ds_read_b128 v[92:95], v10 offset:4096
    v_mul_f32 v24, v112, v22
    v_mfma_f32_16x16x32_bf16 v[164:167], v[64:67], a[4:7], v[164:167]
    buffer_store_dwordx4 v[100:103], v1, s[12:15], s27 offen offset:256 sc1
    v_mfma_f32_16x16x32_bf16 v[172:175], v[72:75], a[4:7], 0
    s_waitcnt lgkmcnt(4)
    ds_read_b128 v[64:67], v8 offset:8192
    s_add_u32 s27, s40, 4096
    v_mfma_f32_16x16x32_bf16 v[172:175], v[76:79], a[12:15], v[172:175]
    v_lshlrev_b32 v105, 5, v5
    v_mul_f32 v25, v113, v22
    v_mfma_f32_16x16x32_bf16 v[168:171], v[76:79], a[8:11], 0
    s_waitcnt lgkmcnt(4)
    ds_read_b128 v[68:71], v10 offset:8192
    v_exp_f32 v24, v24
    v_mfma_f32_16x16x32_bf16 v[168:171], v[72:75], a[0:3], v[168:171]
    buffer_load_dwordx4 v4, s[12:15], s16 offen offset:3072 lds
    v_mfma_f32_16x16x32_bf16 v[168:171], v[80:83], a[16:19], v[168:171]
    s_waitcnt lgkmcnt(4)
    ds_read_b128 v[72:75], v8 offset:10240
    v_exp_f32 v25, v25
    v_mfma_f32_16x16x32_bf16 v[168:171], v[84:87], a[24:27], v[168:171]
    v_fma_f32 v24, v24, v23, v23
    v_fma_f32 v25, v25, v23, v23
    v_mfma_f32_16x16x32_bf16 v[172:175], v[84:87], a[28:31], v[172:175]
    s_waitcnt lgkmcnt(4)
    ds_read_b128 v[76:79], v10 offset:10240
    v_rcp_f32 v24, v24
    v_mfma_f32_16x16x32_bf16 v[172:175], v[80:83], a[20:23], v[172:175]
    v_mul_f32 v24, v24, v112
    v_mul_f32 v26, v114, v22
    v_mfma_f32_16x16x32_bf16 v[164:167], v[88:91], a[20:23], v[164:167]
    s_waitcnt lgkmcnt(4)
    ds_read_b128 v[80:83], v8 offset:14336
    v_rcp_f32 v25, v25
    v_mfma_f32_16x16x32_bf16 v[164:167], v[92:95], a[28:31], v[164:167]
    v_mul_f32 v25, v25, v113
    v_mul_f32 v27, v115, v22
    v_mfma_f32_16x16x32_bf16 v[160:163], v[92:95], a[24:27], v[160:163]
    s_waitcnt lgkmcnt(4)
    ds_read_b128 v[84:87], v10 offset:14336
    v_exp_f32 v26, v26
    v_mfma_f32_16x16x32_bf16 v[160:163], v[88:91], a[16:19], v[160:163]
    v_fma_f32 v26, v26, v23, v23
    v_mul_f32 v28, v120, v22
    v_mfma_f32_16x16x32_bf16 v[160:163], v[64:67], a[32:35], v[160:163]
    s_waitcnt lgkmcnt(4)
    ds_read_b128 v[88:91], v8 offset:12288
    v_rcp_f32 v26, v26
    v_mfma_f32_16x16x32_bf16 v[160:163], v[68:71], a[40:43], v[160:163]
    v_mul_f32 v26, v26, v114
    v_mul_f32 v29, v121, v22
    v_mfma_f32_16x16x32_bf16 v[164:167], v[68:71], a[44:47], v[164:167]
    s_waitcnt lgkmcnt(4)
    ds_read_b128 v[92:95], v10 offset:12288
    v_exp_f32 v27, v27
    v_mfma_f32_16x16x32_bf16 v[164:167], v[64:67], a[36:39], v[164:167]
    s_waitcnt vmcnt(24)
    s_barrier
    v_mfma_f32_16x16x32_bf16 v[172:175], v[72:75], a[36:39], v[172:175]
    s_waitcnt lgkmcnt(4)
    ds_read_b128 v[64:67], v8 offset:16384
    s_add_u32 m0, s22, 114688
    v_mfma_f32_16x16x32_bf16 v[172:175], v[76:79], a[44:47], v[172:175]
    s_add_u32 s16, s16, 16384
    v_fma_f32 v27, v27, v23, v23
    v_mul_f32 v30, v122, v22
    v_mfma_f32_16x16x32_bf16 v[168:171], v[76:79], a[40:43], v[168:171]
    s_waitcnt lgkmcnt(4)
    ds_read_b128 v[68:71], v10 offset:16384
    v_rcp_f32 v27, v27
    v_mfma_f32_16x16x32_bf16 v[168:171], v[72:75], a[32:35], v[168:171]
    buffer_load_dwordx4 v4, s[12:15], s16 offen offset:0 lds
    v_mfma_f32_16x16x32_bf16 v[168:171], v[80:83], a[48:51], v[168:171]
    s_waitcnt lgkmcnt(4)
    ds_read_b128 v[72:75], v8 offset:18432
    v_exp_f32 v28, v28
    v_mfma_f32_16x16x32_bf16 v[168:171], v[84:87], a[56:59], v[168:171]
    v_mul_f32 v27, v27, v115
    v_fma_f32 v28, v28, v23, v23
    v_mfma_f32_16x16x32_bf16 v[172:175], v[84:87], a[60:63], v[172:175]
    s_waitcnt lgkmcnt(4)
    ds_read_b128 v[76:79], v10 offset:18432
    v_rcp_f32 v28, v28
    v_mfma_f32_16x16x32_bf16 v[172:175], v[80:83], a[52:55], v[172:175]
    buffer_load_dwordx4 v4, s[12:15], s16 offen offset:1024 lds
    v_mfma_f32_16x16x32_bf16 v[164:167], v[88:91], a[52:55], v[164:167]
    s_waitcnt lgkmcnt(4)
    ds_read_b128 v[80:83], v8 offset:22528
    v_exp_f32 v29, v29
    v_mfma_f32_16x16x32_bf16 v[164:167], v[92:95], a[60:63], v[164:167]
    v_mul_f32 v28, v28, v120
    v_fma_f32 v29, v29, v23, v23
    v_mfma_f32_16x16x32_bf16 v[160:163], v[92:95], a[56:59], v[160:163]
    s_waitcnt lgkmcnt(4)
    ds_read_b128 v[84:87], v10 offset:22528
    v_rcp_f32 v29, v29
    v_mfma_f32_16x16x32_bf16 v[160:163], v[88:91], a[48:51], v[160:163]
    buffer_load_dwordx4 v4, s[12:15], s16 offen offset:2048 lds
    v_mfma_f32_16x16x32_bf16 v[160:163], v[64:67], a[64:67], v[160:163]
    s_waitcnt lgkmcnt(4)
    ds_read_b128 v[88:91], v8 offset:20480
    v_exp_f32 v30, v30
    v_mfma_f32_16x16x32_bf16 v[160:163], v[68:71], a[72:75], v[160:163]
    v_mul_f32 v29, v29, v121
    v_fma_f32 v30, v30, v23, v23
    v_mfma_f32_16x16x32_bf16 v[164:167], v[68:71], a[76:79], v[164:167]
    s_waitcnt lgkmcnt(4)
    ds_read_b128 v[92:95], v10 offset:20480
    v_rcp_f32 v30, v30
    v_mfma_f32_16x16x32_bf16 v[164:167], v[64:67], a[68:71], v[164:167]
    buffer_store_dwordx4 v[248:251], v4, s[12:15], s5 offen offset:2048 sc1
    v_mfma_f32_16x16x32_bf16 v[172:175], v[72:75], a[68:71], v[172:175]
    s_waitcnt lgkmcnt(4)
    ds_read_b128 v[64:67], v8 offset:24576
    v_mul_f32 v30, v30, v122
    v_mfma_f32_16x16x32_bf16 v[172:175], v[76:79], a[76:79], v[172:175]
    v_mul_f32 v31, v123, v22
    v_cvt_pk_bf16_f32 v112, v24, v25
    v_mfma_f32_16x16x32_bf16 v[168:171], v[76:79], a[72:75], v[168:171]
    s_waitcnt lgkmcnt(4)
    ds_read_b128 v[68:71], v10 offset:24576
    v_exp_f32 v31, v31
    v_mfma_f32_16x16x32_bf16 v[168:171], v[72:75], a[64:67], v[168:171]
    buffer_load_dwordx4 v4, s[12:15], s16 offen offset:3072 lds
    v_mfma_f32_16x16x32_bf16 v[168:171], v[80:83], a[80:83], v[168:171]
    s_waitcnt lgkmcnt(4)
    ds_read_b128 v[72:75], v8 offset:26624
    v_fma_f32 v31, v31, v23, v23
    v_mfma_f32_16x16x32_bf16 v[168:171], v[84:87], a[88:91], v[168:171]
    v_rcp_f32 v31, v31
    v_mfma_f32_16x16x32_bf16 v[172:175], v[84:87], a[92:95], v[172:175]
    s_waitcnt lgkmcnt(4)
    ds_read_b128 v[76:79], v10 offset:26624
    v_mul_f32 v31, v31, v123
    v_mfma_f32_16x16x32_bf16 v[172:175], v[80:83], a[84:87], v[172:175]
    v_cvt_pk_bf16_f32 v113, v26, v27
    v_cvt_pk_bf16_f32 v114, v28, v29
    v_mfma_f32_16x16x32_bf16 v[164:167], v[88:91], a[84:87], v[164:167]
    s_waitcnt lgkmcnt(4)
    ds_read_b128 v[80:83], v8 offset:30720
    v_cvt_pk_bf16_f32 v115, v30, v31
    v_mfma_f32_16x16x32_bf16 v[164:167], v[92:95], a[92:95], v[164:167]
    buffer_store_dwordx4 v[112:115], v1, s[12:15], s45 offen offset:0 sc1
    v_mfma_f32_16x16x32_bf16 v[160:163], v[92:95], a[88:91], v[160:163]
    s_waitcnt lgkmcnt(4)
    ds_read_b128 v[84:87], v10 offset:30720
    v_mul_f32 v32, v116, v56
    v_mfma_f32_16x16x32_bf16 v[160:163], v[88:91], a[80:83], v[160:163]
    v_exp_f32 v32, v32
    v_mfma_f32_16x16x32_bf16 v[160:163], v[64:67], a[96:99], v[160:163]
    s_waitcnt lgkmcnt(4)
    ds_read_b128 v[88:91], v8 offset:28672
    v_fma_f32 v32, v32, v57, v57
    v_mfma_f32_16x16x32_bf16 v[160:163], v[68:71], a[104:107], v[160:163]
    v_rcp_f32 v32, v32
    v_mfma_f32_16x16x32_bf16 v[164:167], v[68:71], a[108:111], v[164:167]
    s_waitcnt lgkmcnt(4)
    ds_read_b128 v[92:95], v10 offset:28672
    v_mul_f32 v32, v32, v116
    v_mfma_f32_16x16x32_bf16 v[164:167], v[64:67], a[100:103], v[164:167]
    s_waitcnt vmcnt(26)
    s_barrier
    v_mfma_f32_16x16x32_bf16 v[172:175], v[72:75], a[100:103], v[172:175]
    s_waitcnt lgkmcnt(4)
    ds_read_b128 v[64:67], v8 offset:32768
    s_add_u32 m0, s22, 0
    v_mfma_f32_16x16x32_bf16 v[172:175], v[76:79], a[108:111], v[172:175]
    s_add_u32 s16, s16, 16384
    v_mul_f32 v33, v117, v56
    v_mul_f32 v34, v118, v56
    v_mfma_f32_16x16x32_bf16 v[168:171], v[76:79], a[104:107], v[168:171]
    s_waitcnt lgkmcnt(4)
    ds_read_b128 v[68:71], v10 offset:32768
    v_exp_f32 v33, v33
    v_mfma_f32_16x16x32_bf16 v[168:171], v[72:75], a[96:99], v[168:171]
    buffer_load_dwordx4 v4, s[12:15], s16 offen offset:0 lds
    v_mfma_f32_16x16x32_bf16 v[168:171], v[80:83], a[112:115], v[168:171]
    s_waitcnt lgkmcnt(4)
    ds_read_b128 v[72:75], v8 offset:34816
    v_exp_f32 v34, v34
    v_mfma_f32_16x16x32_bf16 v[168:171], v[84:87], a[120:123], v[168:171]
    v_fma_f32 v33, v33, v57, v57
    v_fma_f32 v34, v34, v57, v57
    v_mfma_f32_16x16x32_bf16 v[172:175], v[84:87], a[124:127], v[172:175]
    s_waitcnt lgkmcnt(4)
    ds_read_b128 v[76:79], v10 offset:34816
    v_rcp_f32 v33, v33
    v_mfma_f32_16x16x32_bf16 v[172:175], v[80:83], a[116:119], v[172:175]
    buffer_load_dwordx4 v4, s[12:15], s16 offen offset:1024 lds
    v_mfma_f32_16x16x32_bf16 v[164:167], v[88:91], a[116:119], v[164:167]
    s_waitcnt lgkmcnt(4)
    ds_read_b128 v[80:83], v8 offset:38912
    v_rcp_f32 v34, v34
    v_mfma_f32_16x16x32_bf16 v[164:167], v[92:95], a[124:127], v[164:167]
    v_mul_f32 v33, v33, v117
    v_mul_f32 v34, v34, v118
    v_mfma_f32_16x16x32_bf16 v[160:163], v[92:95], a[120:123], v[160:163]
    s_waitcnt lgkmcnt(4)
    ds_read_b128 v[84:87], v10 offset:38912
    v_mul_f32 v35, v119, v56
    v_mfma_f32_16x16x32_bf16 v[160:163], v[88:91], a[112:115], v[160:163]
    buffer_load_dwordx4 v4, s[12:15], s16 offen offset:2048 lds
    v_mfma_f32_16x16x32_bf16 v[160:163], v[64:67], a[128:131], v[160:163]
    s_waitcnt lgkmcnt(4)
    ds_read_b128 v[88:91], v8 offset:36864
    v_exp_f32 v35, v35
    v_mfma_f32_16x16x32_bf16 v[160:163], v[68:71], a[136:139], v[160:163]
    s_waitcnt vmcnt(10)
    buffer_store_dword v60, v59, s[12:15], s26 offen sc1
    v_mfma_f32_16x16x32_bf16 v[164:167], v[68:71], a[140:143], v[164:167]
    s_waitcnt lgkmcnt(4)
    ds_read_b128 v[92:95], v10 offset:36864
    v_mov_b32 v60, 2
    v_mfma_f32_16x16x32_bf16 v[164:167], v[64:67], a[132:135], v[164:167]
    v_fma_f32 v35, v35, v57, v57
    v_mul_f32 v36, v124, v56
    v_mfma_f32_16x16x32_bf16 v[172:175], v[72:75], a[132:135], v[172:175]
    s_waitcnt lgkmcnt(4)
    ds_read_b128 v[64:67], v8 offset:40960
    v_rcp_f32 v35, v35
    v_mfma_f32_16x16x32_bf16 v[172:175], v[76:79], a[140:143], v[172:175]
    buffer_load_dwordx4 v4, s[12:15], s16 offen offset:3072 lds
    v_mfma_f32_16x16x32_bf16 v[168:171], v[76:79], a[136:139], v[168:171]
    s_waitcnt lgkmcnt(4)
    ds_read_b128 v[68:71], v10 offset:40960
    v_exp_f32 v36, v36
    v_mfma_f32_16x16x32_bf16 v[168:171], v[72:75], a[128:131], v[168:171]
    v_mul_f32 v35, v35, v119
    v_fma_f32 v36, v36, v57, v57
    v_mfma_f32_16x16x32_bf16 v[168:171], v[80:83], a[144:147], v[168:171]
    s_waitcnt lgkmcnt(4)
    ds_read_b128 v[72:75], v8 offset:43008
    v_rcp_f32 v36, v36
    v_mfma_f32_16x16x32_bf16 v[168:171], v[84:87], a[152:155], v[168:171]
    v_mul_f32 v36, v36, v124
    v_mul_f32 v37, v125, v56
    v_mfma_f32_16x16x32_bf16 v[172:175], v[84:87], a[156:159], v[172:175]
    s_waitcnt lgkmcnt(4)
    ds_read_b128 v[76:79], v10 offset:43008
    v_exp_f32 v37, v37
    v_mfma_f32_16x16x32_bf16 v[172:175], v[80:83], a[148:151], v[172:175]
    v_fma_f32 v37, v37, v57, v57
    v_mul_f32 v38, v126, v56
    v_mfma_f32_16x16x32_bf16 v[164:167], v[88:91], a[148:151], v[164:167]
    s_waitcnt lgkmcnt(4)
    ds_read_b128 v[80:83], v8 offset:47104
    v_rcp_f32 v37, v37
    v_mfma_f32_16x16x32_bf16 v[164:167], v[92:95], a[156:159], v[164:167]
    v_mul_f32 v37, v37, v125
    v_mul_f32 v39, v127, v56
    v_mfma_f32_16x16x32_bf16 v[160:163], v[92:95], a[152:155], v[160:163]
    s_waitcnt lgkmcnt(4)
    ds_read_b128 v[84:87], v10 offset:47104
    v_exp_f32 v38, v38
    v_mfma_f32_16x16x32_bf16 v[160:163], v[88:91], a[144:147], v[160:163]
    v_fma_f32 v38, v38, v57, v57
    v_cvt_pk_bf16_f32 v116, v32, v33
    v_mfma_f32_16x16x32_bf16 v[160:163], v[64:67], a[160:163], v[160:163]
    s_waitcnt lgkmcnt(4)
    ds_read_b128 v[88:91], v8 offset:45056
    v_rcp_f32 v38, v38
    v_mfma_f32_16x16x32_bf16 v[160:163], v[68:71], a[168:171], v[160:163]
    v_mul_f32 v38, v38, v126
    v_cvt_pk_bf16_f32 v117, v34, v35
    v_mfma_f32_16x16x32_bf16 v[164:167], v[68:71], a[172:175], v[164:167]
    s_waitcnt lgkmcnt(4)
    ds_read_b128 v[92:95], v10 offset:45056
    v_exp_f32 v39, v39
    v_mfma_f32_16x16x32_bf16 v[164:167], v[64:67], a[164:167], v[164:167]
    s_barrier
    v_mfma_f32_16x16x32_bf16 v[172:175], v[72:75], a[164:167], v[172:175]
    s_waitcnt lgkmcnt(4)
    ds_read_b128 v[64:67], v8 offset:49152
    s_add_u32 m0, s22, 16384
    v_mfma_f32_16x16x32_bf16 v[172:175], v[76:79], a[172:175], v[172:175]
    s_add_u32 s16, s16, 16384
    v_fma_f32 v39, v39, v57, v57
    v_cvt_pk_bf16_f32 v118, v36, v37
    v_mfma_f32_16x16x32_bf16 v[168:171], v[76:79], a[168:171], v[168:171]
    s_waitcnt lgkmcnt(4)
    ds_read_b128 v[68:71], v10 offset:49152
    v_rcp_f32 v39, v39
    v_mfma_f32_16x16x32_bf16 v[168:171], v[72:75], a[160:163], v[168:171]
    buffer_load_dwordx4 v4, s[12:15], s16 offen offset:0 lds
    v_mfma_f32_16x16x32_bf16 v[168:171], v[80:83], a[176:179], v[168:171]
    s_waitcnt lgkmcnt(4)
    ds_read_b128 v[72:75], v8 offset:51200
    v_mul_f32 v39, v39, v127
    v_mfma_f32_16x16x32_bf16 v[168:171], v[84:87], a[184:187], v[168:171]
    v_cvt_pk_bf16_f32 v119, v38, v39
    v_mul_f32 v24, v128, v22
    v_mfma_f32_16x16x32_bf16 v[172:175], v[84:87], a[188:191], v[172:175]
    s_waitcnt lgkmcnt(4)
    ds_read_b128 v[76:79], v10 offset:51200
    v_exp_f32 v24, v24
    v_mfma_f32_16x16x32_bf16 v[172:175], v[80:83], a[180:183], v[172:175]
    buffer_store_dwordx4 v[116:119], v1, s[12:15], s45 offen offset:256 sc1
    v_mfma_f32_16x16x32_bf16 v[164:167], v[88:91], a[180:183], v[164:167]
    s_waitcnt lgkmcnt(4)
    ds_read_b128 v[80:83], v8 offset:55296
    s_add_u32 s45, s40, 6144
    v_mfma_f32_16x16x32_bf16 v[164:167], v[92:95], a[188:191], v[164:167]
    v_fma_f32 v24, v24, v23, v23
    v_mul_f32 v25, v129, v22
    v_mfma_f32_16x16x32_bf16 v[160:163], v[92:95], a[184:187], v[160:163]
    s_waitcnt lgkmcnt(4)
    ds_read_b128 v[84:87], v10 offset:55296
    v_rcp_f32 v24, v24
    v_mfma_f32_16x16x32_bf16 v[160:163], v[88:91], a[176:179], v[160:163]
    buffer_load_dwordx4 v4, s[12:15], s16 offen offset:1024 lds
    v_mfma_f32_16x16x32_bf16 v[160:163], v[64:67], a[192:195], v[160:163]
    s_waitcnt lgkmcnt(4)
    ds_read_b128 v[88:91], v8 offset:53248
    v_exp_f32 v25, v25
    v_mfma_f32_16x16x32_bf16 v[160:163], v[68:71], a[200:203], v[160:163]
    v_mul_f32 v24, v24, v128
    v_fma_f32 v25, v25, v23, v23
    v_mfma_f32_16x16x32_bf16 v[164:167], v[68:71], a[204:207], v[164:167]
    s_waitcnt lgkmcnt(4)
    ds_read_b128 v[92:95], v10 offset:53248
    v_rcp_f32 v25, v25
    v_mfma_f32_16x16x32_bf16 v[164:167], v[64:67], a[196:199], v[164:167]
    buffer_store_dwordx4 v[252:255], v4, s[12:15], s5 offen offset:3072 sc1
    v_mfma_f32_16x16x32_bf16 v[172:175], v[72:75], a[196:199], v[172:175]
    s_waitcnt lgkmcnt(4)
    ds_read_b128 v[64:67], v8 offset:57344
    v_mul_f32 v25, v25, v129
    v_mfma_f32_16x16x32_bf16 v[172:175], v[76:79], a[204:207], v[172:175]
    buffer_load_dword v61, v58, s[12:15], s26 offen sc1
    v_mfma_f32_16x16x32_bf16 v[168:171], v[76:79], a[200:203], v[168:171]
    s_waitcnt lgkmcnt(4)
    ds_read_b128 v[68:71], v10 offset:57344
    v_mul_f32 v26, v130, v22
    v_mfma_f32_16x16x32_bf16 v[168:171], v[72:75], a[192:195], v[168:171]
    v_exp_f32 v26, v26
    v_mfma_f32_16x16x32_bf16 v[168:171], v[80:83], a[208:211], v[168:171]
    s_waitcnt lgkmcnt(4)
    ds_read_b128 v[72:75], v8 offset:59392
    v_fma_f32 v26, v26, v23, v23
    v_mfma_f32_16x16x32_bf16 v[168:171], v[84:87], a[216:219], v[168:171]
    buffer_load_dwordx4 v4, s[12:15], s16 offen offset:2048 lds
    v_mfma_f32_16x16x32_bf16 v[172:175], v[84:87], a[220:223], v[172:175]
    s_waitcnt lgkmcnt(4)
    ds_read_b128 v[76:79], v10 offset:59392
    v_rcp_f32 v26, v26
    v_mfma_f32_16x16x32_bf16 v[172:175], v[80:83], a[212:215], v[172:175]
    v_mul_f32 v26, v26, v130
    v_mul_f32 v27, v131, v22
    v_mfma_f32_16x16x32_bf16 v[164:167], v[88:91], a[212:215], v[164:167]
    s_waitcnt lgkmcnt(4)
    ds_read_b128 v[80:83], v8 offset:63488
    v_exp_f32 v27, v27
    v_mfma_f32_16x16x32_bf16 v[164:167], v[92:95], a[220:223], v[164:167]
    buffer_load_dwordx4 v4, s[12:15], s16 offen offset:3072 lds
    v_mfma_f32_16x16x32_bf16 v[160:163], v[92:95], a[216:219], v[160:163]
    s_waitcnt lgkmcnt(4)
    ds_read_b128 v[84:87], v10 offset:63488
    v_fma_f32 v27, v27, v23, v23
    v_mfma_f32_16x16x32_bf16 v[160:163], v[88:91], a[208:211], v[160:163]
    v_rcp_f32 v27, v27
    v_mfma_f32_16x16x32_bf16 v[160:163], v[64:67], a[224:227], v[160:163]
    s_waitcnt lgkmcnt(4)
    ds_read_b128 v[88:91], v8 offset:61440
    v_mul_f32 v27, v27, v131
    v_mfma_f32_16x16x32_bf16 v[160:163], v[68:71], a[232:235], v[160:163]
    v_mul_f32 v28, v136, v22
    v_mul_f32 v29, v137, v22
    v_mfma_f32_16x16x32_bf16 v[164:167], v[68:71], a[236:239], v[164:167]
    s_waitcnt lgkmcnt(4)
    ds_read_b128 v[92:95], v10 offset:61440
    v_exp_f32 v28, v28
    v_mfma_f32_16x16x32_bf16 v[164:167], v[64:67], a[228:231], v[164:167]
    s_barrier
    v_mfma_f32_16x16x32_bf16 v[172:175], v[72:75], a[228:231], v[172:175]
    s_waitcnt lgkmcnt(4)
    ds_read_b128 v[64:67], v9 offset:0
    s_add_u32 m0, s22, 32768
    v_mfma_f32_16x16x32_bf16 v[172:175], v[76:79], a[236:239], v[172:175]
    s_add_u32 s16, s16, 16384
    v_fma_f32 v28, v28, v23, v23
    v_mul_f32 v30, v138, v22
    v_mfma_f32_16x16x32_bf16 v[168:171], v[76:79], a[232:235], v[168:171]
    s_waitcnt lgkmcnt(4)
    ds_read_b128 v[68:71], v11 offset:0
    v_rcp_f32 v28, v28
    v_mfma_f32_16x16x32_bf16 v[168:171], v[72:75], a[224:227], v[168:171]
    buffer_load_dwordx4 v4, s[12:15], s16 offen offset:0 lds
    v_mfma_f32_16x16x32_bf16 v[168:171], v[80:83], a[240:243], v[168:171]
    s_waitcnt lgkmcnt(4)
    ds_read_b128 v[72:75], v9 offset:2048
    v_exp_f32 v29, v29
    v_mfma_f32_16x16x32_bf16 v[168:171], v[84:87], a[248:251], v[168:171]
    v_mul_f32 v28, v28, v136
    v_fma_f32 v29, v29, v23, v23
    v_mfma_f32_16x16x32_bf16 v[172:175], v[84:87], a[252:255], v[172:175]
    s_waitcnt lgkmcnt(4)
    ds_read_b128 v[76:79], v11 offset:2048
    v_rcp_f32 v29, v29
    v_mfma_f32_16x16x32_bf16 v[172:175], v[80:83], a[244:247], v[172:175]
    buffer_load_dwordx4 v4, s[12:15], s16 offen offset:1024 lds
    v_mfma_f32_16x16x32_bf16 v[164:167], v[88:91], a[244:247], v[164:167]
    s_waitcnt lgkmcnt(4)
    ds_read_b128 v[80:83], v9 offset:6144
    v_exp_f32 v30, v30
    v_mfma_f32_16x16x32_bf16 v[164:167], v[92:95], a[252:255], v[164:167]
    v_mul_f32 v29, v29, v137
    v_fma_f32 v30, v30, v23, v23
    v_mfma_f32_16x16x32_bf16 v[160:163], v[92:95], a[248:251], v[160:163]
    s_waitcnt lgkmcnt(4)
    ds_read_b128 v[84:87], v11 offset:6144
    v_rcp_f32 v30, v30
    v_mfma_f32_16x16x32_bf16 v[160:163], v[88:91], a[240:243], v[160:163]
    buffer_load_dwordx4 v4, s[12:15], s16 offen offset:2048 lds
    v_mfma_f32_16x16x32_bf16 v[176:179], v[64:67], a[0:3], 0
    s_waitcnt lgkmcnt(4)
    ds_read_b128 v[88:91], v9 offset:4096
    v_mul_f32 v30, v30, v138
    v_mfma_f32_16x16x32_bf16 v[176:179], v[68:71], a[8:11], v[176:179]
    v_mul_f32 v31, v139, v22
    v_cvt_pk_bf16_f32 v128, v24, v25
    v_mfma_f32_16x16x32_bf16 v[180:183], v[68:71], a[12:15], 0
    s_waitcnt lgkmcnt(4)
    ds_read_b128 v[92:95], v11 offset:4096
    v_exp_f32 v31, v31
    v_mfma_f32_16x16x32_bf16 v[180:183], v[64:67], a[4:7], v[180:183]
    buffer_load_dwordx4 v4, s[12:15], s16 offen offset:3072 lds
    v_mfma_f32_16x16x32_bf16 v[188:191], v[72:75], a[4:7], 0
    s_waitcnt lgkmcnt(4)
    ds_read_b128 v[64:67], v9 offset:8192
    v_fma_f32 v31, v31, v23, v23
    v_mfma_f32_16x16x32_bf16 v[188:191], v[76:79], a[12:15], v[188:191]
    v_rcp_f32 v31, v31
    v_mfma_f32_16x16x32_bf16 v[184:187], v[76:79], a[8:11], 0
    s_waitcnt lgkmcnt(4)
    ds_read_b128 v[68:71], v11 offset:8192
    v_mul_f32 v31, v31, v139
    v_mfma_f32_16x16x32_bf16 v[184:187], v[72:75], a[0:3], v[184:187]
    v_cvt_pk_bf16_f32 v129, v26, v27
    v_cvt_pk_bf16_f32 v130, v28, v29
    v_mfma_f32_16x16x32_bf16 v[184:187], v[80:83], a[16:19], v[184:187]
    s_waitcnt lgkmcnt(4)
    ds_read_b128 v[72:75], v9 offset:10240
    v_cvt_pk_bf16_f32 v131, v30, v31
    v_mfma_f32_16x16x32_bf16 v[184:187], v[84:87], a[24:27], v[184:187]
    buffer_store_dwordx4 v[128:131], v1, s[12:15], s27 offen offset:0 sc1
    v_mfma_f32_16x16x32_bf16 v[188:191], v[84:87], a[28:31], v[188:191]
    s_waitcnt lgkmcnt(4)
    ds_read_b128 v[76:79], v11 offset:10240
    v_mul_f32 v32, v132, v56
    v_mfma_f32_16x16x32_bf16 v[188:191], v[80:83], a[20:23], v[188:191]
    v_exp_f32 v32, v32
    v_mfma_f32_16x16x32_bf16 v[180:183], v[88:91], a[20:23], v[180:183]
    s_waitcnt lgkmcnt(4)
    ds_read_b128 v[80:83], v9 offset:14336
    v_fma_f32 v32, v32, v57, v57
    v_mfma_f32_16x16x32_bf16 v[180:183], v[92:95], a[28:31], v[180:183]
    v_rcp_f32 v32, v32
    v_mfma_f32_16x16x32_bf16 v[176:179], v[92:95], a[24:27], v[176:179]
    s_waitcnt lgkmcnt(4)
    ds_read_b128 v[84:87], v11 offset:14336
    v_mul_f32 v32, v32, v132
    v_mfma_f32_16x16x32_bf16 v[176:179], v[88:91], a[16:19], v[176:179]
    v_mul_f32 v33, v133, v56
    v_mul_f32 v34, v134, v56
    v_mfma_f32_16x16x32_bf16 v[176:179], v[64:67], a[32:35], v[176:179]
    s_waitcnt lgkmcnt(4)
    ds_read_b128 v[88:91], v9 offset:12288
    v_exp_f32 v33, v33
    v_mfma_f32_16x16x32_bf16 v[176:179], v[68:71], a[40:43], v[176:179]
    v_fma_f32 v33, v33, v57, v57
    v_mul_f32 v35, v135, v56
    v_mfma_f32_16x16x32_bf16 v[180:183], v[68:71], a[44:47], v[180:183]
    s_waitcnt lgkmcnt(4)
    ds_read_b128 v[92:95], v11 offset:12288
    v_rcp_f32 v33, v33
    v_mfma_f32_16x16x32_bf16 v[180:183], v[64:67], a[36:39], v[180:183]
    s_barrier
    v_mfma_f32_16x16x32_bf16 v[188:191], v[72:75], a[36:39], v[188:191]
    s_waitcnt lgkmcnt(4)
    ds_read_b128 v[64:67], v9 offset:16384
    s_add_u32 m0, s22, 49152
    v_mfma_f32_16x16x32_bf16 v[188:191], v[76:79], a[44:47], v[188:191]
    s_add_u32 s16, s16, 16384
    v_mul_f32 v33, v33, v133
    v_mul_f32 v36, v140, v56
    v_mfma_f32_16x16x32_bf16 v[184:187], v[76:79], a[40:43], v[184:187]
    s_waitcnt lgkmcnt(4)
    ds_read_b128 v[68:71], v11 offset:16384
    v_exp_f32 v34, v34
    v_mfma_f32_16x16x32_bf16 v[184:187], v[72:75], a[32:35], v[184:187]
    buffer_load_dwordx4 v4, s[12:15], s16 offen offset:0 lds
    v_mfma_f32_16x16x32_bf16 v[184:187], v[80:83], a[48:51], v[184:187]
    s_waitcnt lgkmcnt(4)
    ds_read_b128 v[72:75], v9 offset:18432
    v_exp_f32 v35, v35
    v_mfma_f32_16x16x32_bf16 v[184:187], v[84:87], a[56:59], v[184:187]
    s_waitcnt vmcnt(11)
    buffer_store_dword v60, v59, s[12:15], s26 offen sc1
    v_mfma_f32_16x16x32_bf16 v[188:191], v[84:87], a[60:63], v[188:191]
    s_waitcnt lgkmcnt(4)
    ds_read_b128 v[76:79], v11 offset:18432
    v_exp_f32 v36, v36
    v_mfma_f32_16x16x32_bf16 v[188:191], v[80:83], a[52:55], v[188:191]
    v_mov_b32 v60, 3
    v_fma_f32 v34, v34, v57, v57
    v_mfma_f32_16x16x32_bf16 v[180:183], v[88:91], a[52:55], v[180:183]
    s_waitcnt lgkmcnt(4)
    ds_read_b128 v[80:83], v9 offset:22528
    v_rcp_f32 v34, v34
    v_mfma_f32_16x16x32_bf16 v[180:183], v[92:95], a[60:63], v[180:183]
    buffer_load_dwordx4 v4, s[12:15], s16 offen offset:1024 lds
    v_mfma_f32_16x16x32_bf16 v[176:179], v[92:95], a[56:59], v[176:179]
    s_waitcnt lgkmcnt(4)
    ds_read_b128 v[84:87], v11 offset:22528
    v_mul_f32 v34, v34, v134
    v_mfma_f32_16x16x32_bf16 v[176:179], v[88:91], a[48:51], v[176:179]
    v_fma_f32 v35, v35, v57, v57
    v_fma_f32 v36, v36, v57, v57
    v_mfma_f32_16x16x32_bf16 v[176:179], v[64:67], a[64:67], v[176:179]
    s_waitcnt lgkmcnt(4)
    ds_read_b128 v[88:91], v9 offset:20480
    v_rcp_f32 v35, v35
    v_mfma_f32_16x16x32_bf16 v[176:179], v[68:71], a[72:75], v[176:179]
    buffer_load_dwordx4 v4, s[12:15], s16 offen offset:2048 lds
    v_mfma_f32_16x16x32_bf16 v[180:183], v[68:71], a[76:79], v[180:183]
    s_waitcnt lgkmcnt(4)
    ds_read_b128 v[92:95], v11 offset:20480
    v_rcp_f32 v36, v36
    v_mfma_f32_16x16x32_bf16 v[180:183], v[64:67], a[68:71], v[180:183]
    v_mul_f32 v35, v35, v135
    v_mul_f32 v36, v36, v140
    v_mfma_f32_16x16x32_bf16 v[188:191], v[72:75], a[68:71], v[188:191]
    s_waitcnt lgkmcnt(4)
    ds_read_b128 v[64:67], v9 offset:24576
    v_mul_f32 v37, v141, v56
    v_mfma_f32_16x16x32_bf16 v[188:191], v[76:79], a[76:79], v[188:191]
    buffer_load_dwordx4 v4, s[12:15], s16 offen offset:3072 lds
    v_mfma_f32_16x16x32_bf16 v[184:187], v[76:79], a[72:75], v[184:187]
    s_waitcnt lgkmcnt(4)
    ds_read_b128 v[68:71], v11 offset:24576
    v_exp_f32 v37, v37
    v_mfma_f32_16x16x32_bf16 v[184:187], v[72:75], a[64:67], v[184:187]
    s_waitcnt vmcnt(12)
    v_cmp_gt_u32 vcc, 1, v61
    v_fma_f32 v37, v37, v57, v57
    v_mfma_f32_16x16x32_bf16 v[184:187], v[80:83], a[80:83], v[184:187]
    s_waitcnt lgkmcnt(4)
    ds_read_b128 v[72:75], v9 offset:26624
    s_cbranch_vccnz SLOW0_ffb_kernel
BACK0_ffb_kernel:
    v_mfma_f32_16x16x32_bf16 v[184:187], v[84:87], a[88:91], v[184:187]
    v_rcp_f32 v37, v37
    v_mfma_f32_16x16x32_bf16 v[188:191], v[84:87], a[92:95], v[188:191]
    s_waitcnt lgkmcnt(4)
    ds_read_b128 v[76:79], v11 offset:26624
    v_mul_f32 v37, v37, v141
    v_mfma_f32_16x16x32_bf16 v[188:191], v[80:83], a[84:87], v[188:191]
    v_mul_f32 v38, v142, v56
    v_mul_f32 v39, v143, v56
    v_mfma_f32_16x16x32_bf16 v[180:183], v[88:91], a[84:87], v[180:183]
    s_waitcnt lgkmcnt(4)
    ds_read_b128 v[80:83], v9 offset:30720
    v_exp_f32 v38, v38
    v_mfma_f32_16x16x32_bf16 v[180:183], v[92:95], a[92:95], v[180:183]
    v_fma_f32 v38, v38, v57, v57
    v_cvt_pk_bf16_f32 v132, v32, v33
    v_mfma_f32_16x16x32_bf16 v[176:179], v[92:95], a[88:91], v[176:179]
    s_waitcnt lgkmcnt(4)
    ds_read_b128 v[84:87], v11 offset:30720
    v_rcp_f32 v38, v38
    v_mfma_f32_16x16x32_bf16 v[176:179], v[88:91], a[80:83], v[176:179]
    v_mul_f32 v38, v38, v142
    v_cvt_pk_bf16_f32 v133, v34, v35
    v_mfma_f32_16x16x32_bf16 v[176:179], v[64:67], a[96:99], v[176:179]
    s_waitcnt lgkmcnt(4)
    ds_read_b128 v[88:91], v9 offset:28672
    v_exp_f32 v39, v39
    v_mfma_f32_16x16x32_bf16 v[176:179], v[68:71], a[104:107], v[176:179]
    v_fma_f32 v39, v39, v57, v57
    v_cvt_pk_bf16_f32 v134, v36, v37
    v_mfma_f32_16x16x32_bf16 v[180:183], v[68:71], a[108:111], v[180:183]
    s_waitcnt lgkmcnt(4)
    ds_read_b128 v[92:95], v11 offset:28672
    v_rcp_f32 v39, v39
    v_mfma_f32_16x16x32_bf16 v[180:183], v[64:67], a[100:103], v[180:183]
    s_barrier
    v_mfma_f32_16x16x32_bf16 v[188:191], v[72:75], a[100:103], v[188:191]
    s_waitcnt lgkmcnt(4)
    ds_read_b128 v[64:67], v9 offset:32768
    s_add_u32 m0, s22, 65536
    v_mfma_f32_16x16x32_bf16 v[188:191], v[76:79], a[108:111], v[188:191]
    s_add_u32 s16, s16, 75055104
    v_mul_f32 v39, v39, v143
    v_mul_f32 v24, v144, v22
    v_mfma_f32_16x16x32_bf16 v[184:187], v[76:79], a[104:107], v[184:187]
    s_waitcnt lgkmcnt(4)
    ds_read_b128 v[68:71], v11 offset:32768
    v_exp_f32 v24, v24
    v_mfma_f32_16x16x32_bf16 v[184:187], v[72:75], a[96:99], v[184:187]
    buffer_load_dwordx4 v14, s[12:15], s16 offen offset:0 lds
    v_mfma_f32_16x16x32_bf16 v[184:187], v[80:83], a[112:115], v[184:187]
    s_waitcnt lgkmcnt(4)
    ds_read_b128 v[72:75], v9 offset:34816
    v_cvt_pk_bf16_f32 v135, v38, v39
    v_mfma_f32_16x16x32_bf16 v[184:187], v[84:87], a[120:123], v[184:187]
    buffer_store_dwordx4 v[132:135], v1, s[12:15], s27 offen offset:256 sc1
    v_mfma_f32_16x16x32_bf16 v[188:191], v[84:87], a[124:127], v[188:191]
    s_waitcnt lgkmcnt(4)
    ds_read_b128 v[76:79], v11 offset:34816
    s_add_u32 s27, s40, 8192
    v_mfma_f32_16x16x32_bf16 v[188:191], v[80:83], a[116:119], v[188:191]
    buffer_load_dword v62, v58, s[12:15], s26 offen sc1
    v_mfma_f32_16x16x32_bf16 v[180:183], v[88:91], a[116:119], v[180:183]
    s_waitcnt lgkmcnt(4)
    ds_read_b128 v[80:83], v9 offset:38912
    v_fma_f32 v24, v24, v23, v23
    v_mfma_f32_16x16x32_bf16 v[180:183], v[92:95], a[124:127], v[180:183]
    v_rcp_f32 v24, v24
    v_mfma_f32_16x16x32_bf16 v[176:179], v[92:95], a[120:123], v[176:179]
    s_waitcnt lgkmcnt(4)
    ds_read_b128 v[84:87], v11 offset:38912
    v_mul_f32 v24, v24, v144
    v_mfma_f32_16x16x32_bf16 v[176:179], v[88:91], a[112:115], v[176:179]
    buffer_load_dwordx4 v14, s[12:15], s16 offen offset:1024 lds
    v_mfma_f32_16x16x32_bf16 v[176:179], v[64:67], a[128:131], v[176:179]
    s_waitcnt lgkmcnt(4)
    ds_read_b128 v[88:91], v9 offset:36864
    v_mul_f32 v25, v145, v22
    v_mfma_f32_16x16x32_bf16 v[176:179], v[68:71], a[136:139], v[176:179]
    v_exp_f32 v25, v25
    v_mfma_f32_16x16x32_bf16 v[180:183], v[68:71], a[140:143], v[180:183]
    s_waitcnt lgkmcnt(4)
    ds_read_b128 v[92:95], v11 offset:36864
    v_fma_f32 v25, v25, v23, v23
    v_mfma_f32_16x16x32_bf16 v[180:183], v[64:67], a[132:135], v[180:183]
    buffer_load_dwordx4 v14, s[12:15], s16 offen offset:2048 lds
    v_mfma_f32_16x16x32_bf16 v[188:191], v[72:75], a[132:135], v[188:191]
    s_waitcnt lgkmcnt(4)
    ds_read_b128 v[64:67], v9 offset:40960
    v_rcp_f32 v25, v25
    v_mfma_f32_16x16x32_bf16 v[188:191], v[76:79], a[140:143], v[188:191]
    v_mul_f32 v25, v25, v145
    v_mul_f32 v26, v146, v22
    v_mfma_f32_16x16x32_bf16 v[184:187], v[76:79], a[136:139], v[184:187]
    s_waitcnt lgkmcnt(4)
    ds_read_b128 v[68:71], v11 offset:40960
    v_exp_f32 v26, v26
    v_mfma_f32_16x16x32_bf16 v[184:187], v[72:75], a[128:131], v[184:187]
    buffer_load_dwordx4 v14, s[12:15], s16 offen offset:3072 lds
    v_mfma_f32_16x16x32_bf16 v[184:187], v[80:83], a[144:147], v[184:187]
    s_waitcnt lgkmcnt(4)
    ds_read_b128 v[72:75], v9 offset:43008
    v_fma_f32 v26, v26, v23, v23
    v_mfma_f32_16x16x32_bf16 v[184:187], v[84:87], a[152:155], v[184:187]
    v_rcp_f32 v26, v26
    v_mfma_f32_16x16x32_bf16 v[188:191], v[84:87], a[156:159], v[188:191]
    s_waitcnt lgkmcnt(4)
    ds_read_b128 v[76:79], v11 offset:43008
    v_mul_f32 v26, v26, v146
    v_mfma_f32_16x16x32_bf16 v[188:191], v[80:83], a[148:151], v[188:191]
    v_mul_f32 v27, v147, v22
    v_mul_f32 v28, v152, v22
    v_mfma_f32_16x16x32_bf16 v[180:183], v[88:91], a[148:151], v[180:183]
    s_waitcnt lgkmcnt(4)
    ds_read_b128 v[80:83], v9 offset:47104
    v_exp_f32 v27, v27
    v_mfma_f32_16x16x32_bf16 v[180:183], v[92:95], a[156:159], v[180:183]
    v_fma_f32 v27, v27, v23, v23
    v_mul_f32 v29, v153, v22
    v_mfma_f32_16x16x32_bf16 v[176:179], v[92:95], a[152:155], v[176:179]
    s_waitcnt lgkmcnt(4)
    ds_read_b128 v[84:87], v11 offset:47104
    v_rcp_f32 v27, v27
    v_mfma_f32_16x16x32_bf16 v[176:179], v[88:91], a[144:147], v[176:179]
    v_mul_f32 v27, v27, v147
    v_mul_f32 v30, v154, v22
    v_mfma_f32_16x16x32_bf16 v[176:179], v[64:67], a[160:163], v[176:179]
    s_waitcnt lgkmcnt(4)
    ds_read_b128 v[88:91], v9 offset:45056
    v_exp_f32 v28, v28
    v_mfma_f32_16x16x32_bf16 v[176:179], v[68:71], a[168:171], v[176:179]
    v_fma_f32 v28, v28, v23, v23
    v_mul_f32 v31, v155, v22
    v_mfma_f32_16x16x32_bf16 v[180:183], v[68:71], a[172:175], v[180:183]
    s_waitcnt lgkmcnt(4)
    ds_read_b128 v[92:95], v11 offset:45056
    v_rcp_f32 v28, v28
    v_mfma_f32_16x16x32_bf16 v[180:183], v[64:67], a[164:167], v[180:183]
    s_barrier
    v_mfma_f32_16x16x32_bf16 v[188:191], v[72:75], a[164:167], v[188:191]
    s_waitcnt lgkmcnt(4)
    ds_read_b128 v[64:67], v9 offset:49152
    s_add_u32 m0, s22, 81920
    v_mfma_f32_16x16x32_bf16 v[188:191], v[76:79], a[172:175], v[188:191]
    s_add_u32 s16, s16, 16384
    v_mul_f32 v28, v28, v152
    v_cvt_pk_bf16_f32 v144, v24, v25
    v_mfma_f32_16x16x32_bf16 v[184:187], v[76:79], a[168:171], v[184:187]
    s_waitcnt lgkmcnt(4)
    ds_read_b128 v[68:71], v11 offset:49152
    v_exp_f32 v29, v29
    v_mfma_f32_16x16x32_bf16 v[184:187], v[72:75], a[160:163], v[184:187]
    buffer_load_dwordx4 v14, s[12:15], s16 offen offset:0 lds
    v_mfma_f32_16x16x32_bf16 v[184:187], v[80:83], a[176:179], v[184:187]
    s_waitcnt lgkmcnt(4)
    ds_read_b128 v[72:75], v9 offset:51200
    v_exp_f32 v30, v30
    v_mfma_f32_16x16x32_bf16 v[184:187], v[84:87], a[184:187], v[184:187]
    v_fma_f32 v29, v29, v23, v23
    v_fma_f32 v30, v30, v23, v23
    v_mfma_f32_16x16x32_bf16 v[188:191], v[84:87], a[188:191], v[188:191]
    s_waitcnt lgkmcnt(4)
    ds_read_b128 v[76:79], v11 offset:51200
    v_rcp_f32 v29, v29
    v_mfma_f32_16x16x32_bf16 v[188:191], v[80:83], a[180:183], v[188:191]
    buffer_load_dwordx4 v14, s[12:15], s16 offen offset:1024 lds
    v_mfma_f32_16x16x32_bf16 v[180:183], v[88:91], a[180:183], v[180:183]
    s_waitcnt lgkmcnt(4)
    ds_read_b128 v[80:83], v9 offset:55296
    v_rcp_f32 v30, v30
    v_mfma_f32_16x16x32_bf16 v[180:183], v[92:95], a[188:191], v[180:183]
    v_mul_f32 v29, v29, v153
    v_mul_f32 v30, v30, v154
    v_mfma_f32_16x16x32_bf16 v[176:179], v[92:95], a[184:187], v[176:179]
    s_waitcnt lgkmcnt(4)
    ds_read_b128 v[84:87], v11 offset:55296
    v_exp_f32 v31, v31
    v_mfma_f32_16x16x32_bf16 v[176:179], v[88:91], a[176:179], v[176:179]
    buffer_load_dwordx4 v14, s[12:15], s16 offen offset:2048 lds
    v_mfma_f32_16x16x32_bf16 v[176:179], v[64:67], a[192:195], v[176:179]
    s_waitcnt lgkmcnt(4)
    ds_read_b128 v[88:91], v9 offset:53248
    v_fma_f32 v31, v31, v23, v23
    v_mfma_f32_16x16x32_bf16 v[176:179], v[68:71], a[200:203], v[176:179]
    v_rcp_f32 v31, v31
    v_mfma_f32_16x16x32_bf16 v[180:183], v[68:71], a[204:207], v[180:183]
    s_waitcnt lgkmcnt(4)
    ds_read_b128 v[92:95], v11 offset:53248
    v_mul_f32 v31, v31, v155
    v_mfma_f32_16x16x32_bf16 v[180:183], v[64:67], a[196:199], v[180:183]
    buffer_load_dwordx4 v14, s[12:15], s16 offen offset:3072 lds
    v_mfma_f32_16x16x32_bf16 v[188:191], v[72:75], a[196:199], v[188:191]
    s_waitcnt lgkmcnt(4)
    ds_read_b128 v[64:67], v9 offset:57344
    v_cvt_pk_bf16_f32 v145, v26, v27
    v_mfma_f32_16x16x32_bf16 v[188:191], v[76:79], a[204:207], v[188:191]
    v_cvt_pk_bf16_f32 v146, v28, v29
    v_cvt_pk_bf16_f32 v147, v30, v31
    v_mfma_f32_16x16x32_bf16 v[184:187], v[76:79], a[200:203], v[184:187]
    s_waitcnt lgkmcnt(4)
    ds_read_b128 v[68:71], v11 offset:57344
    v_mul_f32 v32, v148, v56
    v_mfma_f32_16x16x32_bf16 v[184:187], v[72:75], a[192:195], v[184:187]
    buffer_store_dwordx4 v[144:147], v1, s[12:15], s45 offen offset:0 sc1
    v_mfma_f32_16x16x32_bf16 v[184:187], v[80:83], a[208:211], v[184:187]
    s_waitcnt lgkmcnt(4)
    ds_read_b128 v[72:75], v9 offset:59392
    v_exp_f32 v32, v32
    v_mfma_f32_16x16x32_bf16 v[184:187], v[84:87], a[216:219], v[184:187]
    v_fma_f32 v32, v32, v57, v57
    v_mul_f32 v33, v149, v56
    v_mfma_f32_16x16x32_bf16 v[188:191], v[84:87], a[220:223], v[188:191]
    s_waitcnt lgkmcnt(4)
    ds_read_b128 v[76:79], v11 offset:59392
    v_rcp_f32 v32, v32
    v_mfma_f32_16x16x32_bf16 v[188:191], v[80:83], a[212:215], v[188:191]
    v_mul_f32 v32, v32, v148
    v_mul_f32 v34, v150, v56
    v_mfma_f32_16x16x32_bf16 v[180:183], v[88:91], a[212:215], v[180:183]
    s_waitcnt lgkmcnt(4)
    ds_read_b128 v[80:83], v9 offset:63488
    v_exp_f32 v33, v33
    v_mfma_f32_16x16x32_bf16 v[180:183], v[92:95], a[220:223], v[180:183]
    v_fma_f32 v33, v33, v57, v57
    v_mul_f32 v35, v151, v56
    v_mfma_f32_16x16x32_bf16 v[176:179], v[92:95], a[216:219], v[176:179]
    s_waitcnt lgkmcnt(4)
    ds_read_b128 v[84:87], v11 offset:63488
    v_rcp_f32 v33, v33
    v_mfma_f32_16x16x32_bf16 v[176:179], v[88:91], a[208:211], v[176:179]
    v_mul_f32 v33, v33, v149
    v_mul_f32 v36, v156, v56
    v_mfma_f32_16x16x32_bf16 v[176:179], v[64:67], a[224:227], v[176:179]
    s_waitcnt lgkmcnt(4)
    ds_read_b128 v[88:91], v9 offset:61440
    v_exp_f32 v34, v34
    v_mfma_f32_16x16x32_bf16 v[176:179], v[68:71], a[232:235], v[176:179]
    v_fma_f32 v34, v34, v57, v57
    v_mul_f32 v37, v157, v56
    v_mfma_f32_16x16x32_bf16 v[180:183], v[68:71], a[236:239], v[180:183]
    s_waitcnt lgkmcnt(4)
    ds_read_b128 v[92:95], v11 offset:61440
    v_rcp_f32 v34, v34
    v_mfma_f32_16x16x32_bf16 v[180:183], v[64:67], a[228:231], v[180:183]
    s_barrier
    v_mfma_f32_16x16x32_bf16 v[188:191], v[72:75], a[228:231], v[188:191]
    s_waitcnt lgkmcnt(4)
    ds_read_b128 v[64:67], v8 offset:0
    s_add_u32 m0, s22, 98304
    v_mfma_f32_16x16x32_bf16 v[188:191], v[76:79], a[236:239], v[188:191]
    s_add_u32 s16, s16, 16384
    v_mul_f32 v34, v34, v150
    v_mul_f32 v38, v158, v56
    v_mfma_f32_16x16x32_bf16 v[184:187], v[76:79], a[232:235], v[184:187]
    s_waitcnt lgkmcnt(4)
    ds_read_b128 v[68:71], v10 offset:0
    v_exp_f32 v35, v35
    v_mfma_f32_16x16x32_bf16 v[184:187], v[72:75], a[224:227], v[184:187]
    buffer_load_dwordx4 v14, s[12:15], s16 offen offset:0 lds
    v_mfma_f32_16x16x32_bf16 v[184:187], v[80:83], a[240:243], v[184:187]
    s_waitcnt lgkmcnt(4)
    ds_read_b128 v[72:75], v8 offset:2048
    v_exp_f32 v36, v36
    v_mfma_f32_16x16x32_bf16 v[184:187], v[84:87], a[248:251], v[184:187]
    s_waitcnt vmcnt(10)
    buffer_store_dword v60, v59, s[12:15], s26 offen sc1
    v_mfma_f32_16x16x32_bf16 v[188:191], v[84:87], a[252:255], v[188:191]
    s_waitcnt lgkmcnt(4)
    ds_read_b128 v[76:79], v10 offset:2048
    v_exp_f32 v37, v37
    v_mfma_f32_16x16x32_bf16 v[188:191], v[80:83], a[244:247], v[188:191]
    s_waitcnt vmcnt(10)
    v_cmp_gt_u32 vcc, 2, v62
    v_mov_b32 v60, 4
    v_mfma_f32_16x16x32_bf16 v[180:183], v[88:91], a[244:247], v[180:183]
    s_waitcnt lgkmcnt(4)
    ds_read_b128 v[80:83], v8 offset:6144
    s_cbranch_vccnz SLOW1_ffb_kernel
BACK1_ffb_kernel:
    v_mfma_f32_16x16x32_bf16 v[180:183], v[92:95], a[252:255], v[180:183]
    buffer_load_dwordx4 v14, s[12:15], s16 offen offset:1024 lds
    v_mfma_f32_16x16x32_bf16 v[176:179], v[92:95], a[248:251], v[176:179]
    s_waitcnt lgkmcnt(4)
    ds_read_b128 v[84:87], v10 offset:6144
    v_exp_f32 v38, v38
    v_mfma_f32_16x16x32_bf16 v[176:179], v[88:91], a[240:243], v[176:179]
    v_fma_f32 v35, v35, v57, v57
    v_fma_f32 v36, v36, v57, v57
    v_mfma_f32_16x16x32_bf16 v[192:195], v[64:67], a[0:3], 0
    s_waitcnt lgkmcnt(4)
    ds_read_b128 v[88:91], v8 offset:4096
    v_rcp_f32 v35, v35
    v_mfma_f32_16x16x32_bf16 v[192:195], v[68:71], a[8:11], v[192:195]
    buffer_load_dwordx4 v14, s[12:15], s16 offen offset:2048 lds
    v_mfma_f32_16x16x32_bf16 v[196:199], v[68:71], a[12:15], 0
    s_waitcnt lgkmcnt(4)
    ds_read_b128 v[92:95], v10 offset:4096
    v_rcp_f32 v36, v36
    v_mfma_f32_16x16x32_bf16 v[196:199], v[64:67], a[4:7], v[196:199]
    v_mul_f32 v35, v35, v151
    v_mul_f32 v36, v36, v156
    v_mfma_f32_16x16x32_bf16 v[204:207], v[72:75], a[4:7], 0
    s_waitcnt lgkmcnt(4)
    ds_read_b128 v[64:67], v8 offset:8192
    v_fma_f32 v37, v37, v57, v57
    v_mfma_f32_16x16x32_bf16 v[204:207], v[76:79], a[12:15], v[204:207]
    buffer_load_dwordx4 v14, s[12:15], s16 offen offset:3072 lds
    v_mfma_f32_16x16x32_bf16 v[200:203], v[76:79], a[8:11], 0
    s_waitcnt lgkmcnt(4)
    ds_read_b128 v[68:71], v10 offset:8192
    v_rcp_f32 v37, v37
    v_mfma_f32_16x16x32_bf16 v[200:203], v[72:75], a[0:3], v[200:203]
    s_add_u32 s28, s41, 0
    v_mul_f32 v37, v37, v157
    v_fma_f32 v38, v38, v57, v57
    v_mfma_f32_16x16x32_bf16 v[200:203], v[80:83], a[16:19], v[200:203]
    s_waitcnt lgkmcnt(4)
    ds_read_b128 v[72:75], v8 offset:10240
    v_rcp_f32 v38, v38
    v_mfma_f32_16x16x32_bf16 v[200:203], v[84:87], a[24:27], v[200:203]
    buffer_load_dwordx4 a[0:3], v1, s[12:15], s28 offen offset:0 sc1
    v_mfma_f32_16x16x32_bf16 v[204:207], v[84:87], a[28:31], v[204:207]
    s_waitcnt lgkmcnt(4)
    ds_read_b128 v[76:79], v10 offset:10240
    v_mul_f32 v38, v38, v158
    v_mfma_f32_16x16x32_bf16 v[204:207], v[80:83], a[20:23], v[204:207]
    v_mul_f32 v39, v159, v56
    v_cvt_pk_bf16_f32 v148, v32, v33
    v_mfma_f32_16x16x32_bf16 v[196:199], v[88:91], a[20:23], v[196:199]
    s_waitcnt lgkmcnt(4)
    ds_read_b128 v[80:83], v8 offset:14336
    v_exp_f32 v39, v39
    v_mfma_f32_16x16x32_bf16 v[196:199], v[92:95], a[28:31], v[196:199]
    buffer_load_dwordx4 a[4:7], v1, s[12:15], s28 offen offset:256 sc1
    v_mfma_f32_16x16x32_bf16 v[192:195], v[92:95], a[24:27], v[192:195]
    s_waitcnt lgkmcnt(4)
    ds_read_b128 v[84:87], v10 offset:14336
    s_add_u32 s28, s42, 0
    v_mfma_f32_16x16x32_bf16 v[192:195], v[88:91], a[16:19], v[192:195]
    v_fma_f32 v39, v39, v57, v57
    v_cvt_pk_bf16_f32 v149, v34, v35
    v_mfma_f32_16x16x32_bf16 v[192:195], v[64:67], a[32:35], v[192:195]
    s_waitcnt lgkmcnt(4)
    ds_read_b128 v[88:91], v8 offset:12288
    v_rcp_f32 v39, v39
    v_mfma_f32_16x16x32_bf16 v[192:195], v[68:71], a[40:43], v[192:195]
    buffer_load_dwordx4 a[8:11], v1, s[12:15], s28 offen offset:0 sc1
    v_mfma_f32_16x16x32_bf16 v[196:199], v[68:71], a[44:47], v[196:199]
    s_waitcnt lgkmcnt(4)
    ds_read_b128 v[92:95], v10 offset:12288
    v_mul_f32 v39, v39, v159
    v_mfma_f32_16x16x32_bf16 v[196:199], v[64:67], a[36:39], v[196:199]
    s_barrier
    v_mfma_f32_16x16x32_bf16 v[204:207], v[72:75], a[36:39], v[204:207]
    s_waitcnt lgkmcnt(4)
    ds_read_b128 v[64:67], v8 offset:16384
    v_cvt_pk_bf16_f32 v150, v36, v37
    v_mfma_f32_16x16x32_bf16 v[204:207], v[76:79], a[44:47], v[204:207]
    buffer_load_dwordx4 a[12:15], v1, s[12:15], s28 offen offset:256 sc1
    v_mfma_f32_16x16x32_bf16 v[200:203], v[76:79], a[40:43], v[200:203]
    s_waitcnt lgkmcnt(4)
    ds_read_b128 v[68:71], v10 offset:16384
    s_add_u32 s28, s43, 0
    v_mfma_f32_16x16x32_bf16 v[200:203], v[72:75], a[32:35], v[200:203]
    v_cvt_pk_bf16_f32 v151, v38, v39
    v_mul_f32 v24, v160, v22
    v_mfma_f32_16x16x32_bf16 v[200:203], v[80:83], a[48:51], v[200:203]
    s_waitcnt lgkmcnt(4)
    ds_read_b128 v[72:75], v8 offset:18432
    v_exp_f32 v24, v24
    v_mfma_f32_16x16x32_bf16 v[200:203], v[84:87], a[56:59], v[200:203]
    buffer_store_dwordx4 v[148:151], v1, s[12:15], s45 offen offset:256 sc1
    v_mfma_f32_16x16x32_bf16 v[204:207], v[84:87], a[60:63], v[204:207]
    s_waitcnt lgkmcnt(4)
    ds_read_b128 v[76:79], v10 offset:18432
    s_add_u32 s45, s40, 10240
    v_mfma_f32_16x16x32_bf16 v[204:207], v[80:83], a[52:55], v[204:207]
    v_fma_f32 v24, v24, v23, v23
    v_mul_f32 v25, v161, v22
    v_mfma_f32_16x16x32_bf16 v[196:199], v[88:91], a[52:55], v[196:199]
    s_waitcnt lgkmcnt(4)
    ds_read_b128 v[80:83], v8 offset:22528
    v_rcp_f32 v24, v24
    v_mfma_f32_16x16x32_bf16 v[196:199], v[92:95], a[60:63], v[196:199]
    buffer_load_dwordx4 a[16:19], v1, s[12:15], s28 offen offset:0 sc1
    v_mfma_f32_16x16x32_bf16 v[192:195], v[92:95], a[56:59], v[192:195]
    s_waitcnt lgkmcnt(4)
    ds_read_b128 v[84:87], v10 offset:22528
    v_exp_f32 v25, v25
    v_mfma_f32_16x16x32_bf16 v[192:195], v[88:91], a[48:51], v[192:195]
    v_mul_f32 v24, v24, v160
    v_fma_f32 v25, v25, v23, v23
    v_mfma_f32_16x16x32_bf16 v[192:195], v[64:67], a[64:67], v[192:195]
    s_waitcnt lgkmcnt(4)
    ds_read_b128 v[88:91], v8 offset:20480
    v_rcp_f32 v25, v25
    v_mfma_f32_16x16x32_bf16 v[192:195], v[68:71], a[72:75], v[192:195]
    buffer_load_dwordx4 a[20:23], v1, s[12:15], s28 offen offset:256 sc1
    v_mfma_f32_16x16x32_bf16 v[196:199], v[68:71], a[76:79], v[196:199]
    s_waitcnt lgkmcnt(4)
    ds_read_b128 v[92:95], v10 offset:20480
    v_mul_f32 v25, v25, v161
    v_mfma_f32_16x16x32_bf16 v[196:199], v[64:67], a[68:71], v[196:199]
    buffer_load_dword v61, v58, s[12:15], s26 offen sc1
    v_mfma_f32_16x16x32_bf16 v[204:207], v[72:75], a[68:71], v[204:207]
    s_waitcnt lgkmcnt(4)
    ds_read_b128 v[64:67], v8 offset:24576
    s_add_u32 s28, s41, 2048
    v_mfma_f32_16x16x32_bf16 v[204:207], v[76:79], a[76:79], v[204:207]
    v_mul_f32 v26, v162, v22
    v_mul_f32 v27, v163, v22
    v_mfma_f32_16x16x32_bf16 v[200:203], v[76:79], a[72:75], v[200:203]
    s_waitcnt lgkmcnt(4)
    ds_read_b128 v[68:71], v10 offset:24576
    v_exp_f32 v26, v26
    v_mfma_f32_16x16x32_bf16 v[200:203], v[72:75], a[64:67], v[200:203]
    buffer_load_dwordx4 a[24:27], v1, s[12:15], s28 offen offset:0 sc1
    v_mfma_f32_16x16x32_bf16 v[200:203], v[80:83], a[80:83], v[200:203]
    s_waitcnt lgkmcnt(4)
    ds_read_b128 v[72:75], v8 offset:26624
    v_exp_f32 v27, v27
    v_mfma_f32_16x16x32_bf16 v[200:203], v[84:87], a[88:91], v[200:203]
    v_fma_f32 v26, v26, v23, v23
    v_fma_f32 v27, v27, v23, v23
    v_mfma_f32_16x16x32_bf16 v[204:207], v[84:87], a[92:95], v[204:207]
    s_waitcnt lgkmcnt(4)
    ds_read_b128 v[76:79], v10 offset:26624
    v_rcp_f32 v26, v26
    v_mfma_f32_16x16x32_bf16 v[204:207], v[80:83], a[84:87], v[204:207]
    buffer_load_dwordx4 a[28:31], v1, s[12:15], s28 offen offset:256 sc1
    v_mfma_f32_16x16x32_bf16 v[196:199], v[88:91], a[84:87], v[196:199]
    s_waitcnt lgkmcnt(4)
    ds_read_b128 v[80:83], v8 offset:30720
    s_add_u32 s28, s42, 2048
    v_mfma_f32_16x16x32_bf16 v[196:199], v[92:95], a[92:95], v[196:199]
    v_mul_f32 v26, v26, v162
    v_mul_f32 v28, v168, v22
    v_mfma_f32_16x16x32_bf16 v[192:195], v[92:95], a[88:91], v[192:195]
    s_waitcnt lgkmcnt(4)
    ds_read_b128 v[84:87], v10 offset:30720
    v_rcp_f32 v27, v27
    v_mfma_f32_16x16x32_bf16 v[192:195], v[88:91], a[80:83], v[192:195]
    buffer_load_dwordx4 a[32:35], v1, s[12:15], s28 offen offset:0 sc1
    v_mfma_f32_16x16x32_bf16 v[192:195], v[64:67], a[96:99], v[192:195]
    s_waitcnt lgkmcnt(4)
    ds_read_b128 v[88:91], v8 offset:28672
    v_exp_f32 v28, v28
    v_mfma_f32_16x16x32_bf16 v[192:195], v[68:71], a[104:107], v[192:195]
    v_mul_f32 v27, v27, v163
    v_fma_f32 v28, v28, v23, v23
    v_mfma_f32_16x16x32_bf16 v[196:199], v[68:71], a[108:111], v[196:199]
    s_waitcnt lgkmcnt(4)
    ds_read_b128 v[92:95], v10 offset:28672
    v_rcp_f32 v28, v28
    v_mfma_f32_16x16x32_bf16 v[196:199], v[64:67], a[100:103], v[196:199]
    s_barrier
    v_mfma_f32_16x16x32_bf16 v[204:207], v[72:75], a[100:103], v[204:207]
    s_waitcnt lgkmcnt(4)
    ds_read_b128 v[64:67], v8 offset:32768
    v_mul_f32 v28, v28, v168
    v_mfma_f32_16x16x32_bf16 v[204:207], v[76:79], a[108:111], v[204:207]
    buffer_load_dwordx4 a[36:39], v1, s[12:15], s28 offen offset:256 sc1
    v_mfma_f32_16x16x32_bf16 v[200:203], v[76:79], a[104:107], v[200:203]
    s_waitcnt lgkmcnt(4)
    ds_read_b128 v[68:71], v10 offset:32768
    s_add_u32 s28, s43, 2048
    v_mfma_f32_16x16x32_bf16 v[200:203], v[72:75], a[96:99], v[200:203]
    v_mul_f32 v29, v169, v22
    v_mul_f32 v30, v170, v22
    v_mfma_f32_16x16x32_bf16 v[200:203], v[80:83], a[112:115], v[200:203]
    s_waitcnt lgkmcnt(4)
    ds_read_b128 v[72:75], v8 offset:34816
    v_exp_f32 v29, v29
    v_mfma_f32_16x16x32_bf16 v[200:203], v[84:87], a[120:123], v[200:203]
    buffer_load_dwordx4 a[40:43], v1, s[12:15], s28 offen offset:0 sc1
    v_mfma_f32_16x16x32_bf16 v[204:207], v[84:87], a[124:127], v[204:207]
    s_waitcnt lgkmcnt(4)
    ds_read_b128 v[76:79], v10 offset:34816
    v_exp_f32 v30, v30
    v_mfma_f32_16x16x32_bf16 v[204:207], v[80:83], a[116:119], v[204:207]
    v_fma_f32 v29, v29, v23, v23
    v_fma_f32 v30, v30, v23, v23
    v_mfma_f32_16x16x32_bf16 v[196:199], v[88:91], a[116:119], v[196:199]
    s_waitcnt lgkmcnt(4)
    ds_read_b128 v[80:83], v8 offset:38912
    v_rcp_f32 v29, v29
    v_mfma_f32_16x16x32_bf16 v[196:199], v[92:95], a[124:127], v[196:199]
    buffer_load_dwordx4 a[44:47], v1, s[12:15], s28 offen offset:256 sc1
    v_mfma_f32_16x16x32_bf16 v[192:195], v[92:95], a[120:123], v[192:195]
    s_waitcnt lgkmcnt(4)
    ds_read_b128 v[84:87], v10 offset:38912
    s_add_u32 m0, s22, 114688
    v_mfma_f32_16x16x32_bf16 v[192:195], v[88:91], a[112:115], v[192:195]
    s_add_u32 s16, s16, 16384
    v_mul_f32 v29, v29, v169
    v_mul_f32 v31, v171, v22
    v_mfma_f32_16x16x32_bf16 v[192:195], v[64:67], a[128:131], v[192:195]
    s_waitcnt lgkmcnt(4)
    ds_read_b128 v[88:91], v8 offset:36864
    v_rcp_f32 v30, v30
    v_mfma_f32_16x16x32_bf16 v[192:195], v[68:71], a[136:139], v[192:195]
    buffer_load_dwordx4 v14, s[12:15], s16 offen offset:0 lds
    v_mfma_f32_16x16x32_bf16 v[196:199], v[68:71], a[140:143], v[196:199]
    s_waitcnt lgkmcnt(4)
    ds_read_b128 v[92:95], v10 offset:36864
    v_exp_f32 v31, v31
    v_mfma_f32_16x16x32_bf16 v[196:199], v[64:67], a[132:135], v[196:199]
    v_mul_f32 v30, v30, v170
    v_fma_f32 v31, v31, v23, v23
    v_mfma_f32_16x16x32_bf16 v[204:207], v[72:75], a[132:135], v[204:207]
    s_waitcnt lgkmcnt(4)
    ds_read_b128 v[64:67], v8 offset:40960
    v_rcp_f32 v31, v31
    v_mfma_f32_16x16x32_bf16 v[204:207], v[76:79], a[140:143], v[204:207]
    buffer_load_dwordx4 v14, s[12:15], s16 offen offset:1024 lds
    v_mfma_f32_16x16x32_bf16 v[200:203], v[76:79], a[136:139], v[200:203]
    s_waitcnt lgkmcnt(4)
    ds_read_b128 v[68:71], v10 offset:40960
    v_mul_f32 v31, v31, v171
    v_mfma_f32_16x16x32_bf16 v[200:203], v[72:75], a[128:131], v[200:203]
    v_cvt_pk_bf16_f32 v160, v24, v25
    v_cvt_pk_bf16_f32 v161, v26, v27
    v_mfma_f32_16x16x32_bf16 v[200:203], v[80:83], a[144:147], v[200:203]
    s_waitcnt lgkmcnt(4)
    ds_read_b128 v[72:75], v8 offset:43008
    v_cvt_pk_bf16_f32 v162, v28, v29
    v_mfma_f32_16x16x32_bf16 v[200:203], v[84:87], a[152:155], v[200:203]
    buffer_load_dwordx4 v14, s[12:15], s16 offen offset:2048 lds
    v_mfma_f32_16x16x32_bf16 v[204:207], v[84:87], a[156:159], v[204:207]
    s_waitcnt lgkmcnt(4)
    ds_read_b128 v[76:79], v10 offset:43008
    v_cvt_pk_bf16_f32 v163, v30, v31
    v_mfma_f32_16x16x32_bf16 v[204:207], v[80:83], a[148:151], v[204:207]
    buffer_store_dwordx4 v[160:163], v1, s[12:15], s27 offen offset:0 sc1
    v_mfma_f32_16x16x32_bf16 v[196:199], v[88:91], a[148:151], v[196:199]
    s_waitcnt lgkmcnt(4)
    ds_read_b128 v[80:83], v8 offset:47104
    v_mul_f32 v32, v164, v56
    v_mfma_f32_16x16x32_bf16 v[196:199], v[92:95], a[156:159], v[196:199]
    v_exp_f32 v32, v32
    v_mfma_f32_16x16x32_bf16 v[192:195], v[92:95], a[152:155], v[192:195]
    s_waitcnt lgkmcnt(4)
    ds_read_b128 v[84:87], v10 offset:47104
    v_fma_f32 v32, v32, v57, v57
    v_mfma_f32_16x16x32_bf16 v[192:195], v[88:91], a[144:147], v[192:195]
    buffer_load_dwordx4 v14, s[12:15], s16 offen offset:3072 lds
    v_mfma_f32_16x16x32_bf16 v[192:195], v[64:67], a[160:163], v[192:195]
    s_waitcnt lgkmcnt(4)
    ds_read_b128 v[88:91], v8 offset:45056
    s_add_u32 m0, s22, 0
    v_mfma_f32_16x16x32_bf16 v[192:195], v[68:71], a[168:171], v[192:195]
    s_add_u32 s16, s16, 16384
    v_rcp_f32 v32, v32
    v_mfma_f32_16x16x32_bf16 v[196:199], v[68:71], a[172:175], v[196:199]
    s_waitcnt lgkmcnt(4)
    ds_read_b128 v[92:95], v10 offset:45056
    v_mul_f32 v32, v32, v164
    v_mfma_f32_16x16x32_bf16 v[196:199], v[64:67], a[164:167], v[196:199]
    s_barrier
    v_mfma_f32_16x16x32_bf16 v[204:207], v[72:75], a[164:167], v[204:207]
    s_waitcnt lgkmcnt(4)
    ds_read_b128 v[64:67], v8 offset:49152
    v_mul_f32 v33, v165, v56
    v_mfma_f32_16x16x32_bf16 v[204:207], v[76:79], a[172:175], v[204:207]
    buffer_load_dwordx4 v14, s[12:15], s16 offen offset:0 lds
    v_mfma_f32_16x16x32_bf16 v[200:203], v[76:79], a[168:171], v[200:203]
    s_waitcnt lgkmcnt(4)
    ds_read_b128 v[68:71], v10 offset:49152
    v_exp_f32 v33, v33
    v_mfma_f32_16x16x32_bf16 v[200:203], v[72:75], a[160:163], v[200:203]
    s_waitcnt vmcnt(15)
    buffer_store_dword v60, v59, s[12:15], s26 offen sc1
    v_mfma_f32_16x16x32_bf16 v[200:203], v[80:83], a[176:179], v[200:203]
    s_waitcnt lgkmcnt(4)
    ds_read_b128 v[72:75], v8 offset:51200
    v_mov_b32 v60, 5
    v_mfma_f32_16x16x32_bf16 v[200:203], v[84:87], a[184:187], v[200:203]
    v_fma_f32 v33, v33, v57, v57
    v_mul_f32 v34, v166, v56
    v_mfma_f32_16x16x32_bf16 v[204:207], v[84:87], a[188:191], v[204:207]
    s_waitcnt lgkmcnt(4)
    ds_read_b128 v[76:79], v10 offset:51200
    v_rcp_f32 v33, v33
    v_mfma_f32_16x16x32_bf16 v[204:207], v[80:83], a[180:183], v[204:207]
    buffer_load_dwordx4 v14, s[12:15], s16 offen offset:1024 lds
    v_mfma_f32_16x16x32_bf16 v[196:199], v[88:91], a[180:183], v[196:199]
    s_waitcnt lgkmcnt(4)
    ds_read_b128 v[80:83], v8 offset:55296
    v_exp_f32 v34, v34
    v_mfma_f32_16x16x32_bf16 v[196:199], v[92:95], a[188:191], v[196:199]
    v_mul_f32 v33, v33, v165
    v_fma_f32 v34, v34, v57, v57
    v_mfma_f32_16x16x32_bf16 v[192:195], v[92:95], a[184:187], v[192:195]
    s_waitcnt lgkmcnt(4)
    ds_read_b128 v[84:87], v10 offset:55296
    v_rcp_f32 v34, v34
    v_mfma_f32_16x16x32_bf16 v[192:195], v[88:91], a[176:179], v[192:195]
    buffer_load_dwordx4 v14, s[12:15], s16 offen offset:2048 lds
    v_mfma_f32_16x16x32_bf16 v[192:195], v[64:67], a[192:195], v[192:195]
    s_waitcnt lgkmcnt(4)
    ds_read_b128 v[88:91], v8 offset:53248
    v_mul_f32 v34, v34, v166
    v_mfma_f32_16x16x32_bf16 v[192:195], v[68:71], a[200:203], v[192:195]
    v_mul_f32 v35, v167, v56
    v_mul_f32 v36, v172, v56
    v_mfma_f32_16x16x32_bf16 v[196:199], v[68:71], a[204:207], v[196:199]
    s_waitcnt lgkmcnt(4)
    ds_read_b128 v[92:95], v10 offset:53248
    v_exp_f32 v35, v35
    v_mfma_f32_16x16x32_bf16 v[196:199], v[64:67], a[196:199], v[196:199]
    buffer_load_dwordx4 v14, s[12:15], s16 offen offset:3072 lds
    v_mfma_f32_16x16x32_bf16 v[204:207], v[72:75], a[196:199], v[204:207]
    s_waitcnt lgkmcnt(4)
    ds_read_b128 v[64:67], v8 offset:57344
    s_add_u32 m0, s22, 16384
    v_mfma_f32_16x16x32_bf16 v[204:207], v[76:79], a[204:207], v[204:207]
    s_waitcnt vmcnt(16)
    v_cmp_gt_u32 vcc, 3, v61
    v_fma_f32 v35, v35, v57, v57
    v_mfma_f32_16x16x32_bf16 v[200:203], v[76:79], a[200:203], v[200:203]
    s_waitcnt lgkmcnt(4)
    ds_read_b128 v[68:71], v10 offset:57344
    s_add_u32 s16, s16, 16384
    v_mfma_f32_16x16x32_bf16 v[200:203], v[72:75], a[192:195], v[200:203]
    buffer_load_dwordx4 v14, s[12:15], s16 offen offset:0 lds
    v_mfma_f32_16x16x32_bf16 v[200:203], v[80:83], a[208:211], v[200:203]
    s_waitcnt lgkmcnt(4)
    ds_read_b128 v[72:75], v8 offset:59392
    s_cbranch_vccnz SLOW2_ffb_kernel
BACK2_ffb_kernel:
    v_mfma_f32_16x16x32_bf16 v[200:203], v[84:87], a[216:219], v[200:203]
    v_rcp_f32 v35, v35
    v_mfma_f32_16x16x32_bf16 v[204:207], v[84:87], a[220:223], v[204:207]
    s_waitcnt lgkmcnt(4)
    ds_read_b128 v[76:79], v10 offset:59392
    v_exp_f32 v36, v36
    v_mfma_f32_16x16x32_bf16 v[204:207], v[80:83], a[212:215], v[204:207]
    buffer_load_dwordx4 v14, s[12:15], s16 offen offset:1024 lds
    v_mfma_f32_16x16x32_bf16 v[196:199], v[88:91], a[212:215], v[196:199]
    s_waitcnt lgkmcnt(4)
    ds_read_b128 v[80:83], v8 offset:63488
    s_add_u32 s28, s41, 4096
    v_mfma_f32_16x16x32_bf16 v[196:199], v[92:95], a[220:223], v[196:199]
    v_mul_f32 v35, v35, v167
    v_fma_f32 v36, v36, v57, v57
    v_mfma_f32_16x16x32_bf16 v[192:195], v[92:95], a[216:219], v[192:195]
    s_waitcnt lgkmcnt(4)
    ds_read_b128 v[84:87], v10 offset:63488
    v_rcp_f32 v36, v36
    v_mfma_f32_16x16x32_bf16 v[192:195], v[88:91], a[208:211], v[192:195]
    buffer_load_dwordx4 a[48:51], v1, s[12:15], s28 offen offset:0 sc1
    v_mfma_f32_16x16x32_bf16 v[192:195], v[64:67], a[224:227], v[192:195]
    s_waitcnt lgkmcnt(4)
    ds_read_b128 v[88:91], v8 offset:61440
    v_mul_f32 v36, v36, v172
    v_mfma_f32_16x16x32_bf16 v[192:195], v[68:71], a[232:235], v[192:195]
MID_ffb_kernel:
    s_getpc_b64 s[60:61]
PF_ffb_kernel_2:
    v_lshlrev_b32 v2, 0, v0
    v_min_u32 v2, END_ffb_kernel-PF_ffb_kernel_2-4, v2
    v_mov_b32 v3, 0
    v_lshl_add_u64 v[2:3], v[2:3], 0, s[60:61]
    global_load_dword v63, v[2:3], off
    v_mul_f32 v37, v173, v56
    v_mul_f32 v38, v174, v56
    v_mfma_f32_16x16x32_bf16 v[196:199], v[68:71], a[236:239], v[196:199]
    s_waitcnt lgkmcnt(4)
    ds_read_b128 v[92:95], v10 offset:61440
    v_exp_f32 v37, v37
    v_mfma_f32_16x16x32_bf16 v[196:199], v[64:67], a[228:231], v[196:199]
    s_barrier
    v_mfma_f32_16x16x32_bf16 v[204:207], v[72:75], a[228:231], v[204:207]
    s_waitcnt lgkmcnt(4)
    ds_read_b128 v[64:67], v13 offset:0
    v_exp_f32 v38, v38
    v_mfma_f32_16x16x32_bf16 v[204:207], v[76:79], a[236:239], v[204:207]
    buffer_load_dwordx4 a[52:55], v1, s[12:15], s28 offen offset:256 sc1
    v_mfma_f32_16x16x32_bf16 v[200:203], v[76:79], a[232:235], v[200:203]
    s_waitcnt lgkmcnt(4)
    ds_read_b128 v[68:71], v13 offset:2048
    v_fma_f32 v37, v37, v57, v57
    v_mfma_f32_16x16x32_bf16 v[200:203], v[72:75], a[224:227], v[200:203]
    buffer_load_dword v62, v58, s[12:15], s26 offen sc1
    v_mfma_f32_16x16x32_bf16 v[200:203], v[80:83], a[240:243], v[200:203]
    s_waitcnt lgkmcnt(4)
    ds_read_b128 v[72:75], v13 offset:256
    s_add_u32 s28, s42, 4096
    v_mfma_f32_16x16x32_bf16 v[200:203], v[84:87], a[248:251], v[200:203]
    v_rcp_f32 v37, v37
    v_mfma_f32_16x16x32_bf16 v[204:207], v[84:87], a[252:255], v[204:207]
    s_waitcnt lgkmcnt(4)
    ds_read_b128 v[76:79], v13 offset:2304
    v_mul_f32 v37, v37, v173
    v_mfma_f32_16x16x32_bf16 v[204:207], v[80:83], a[244:247], v[204:207]
    buffer_load_dwordx4 a[56:59], v1, s[12:15], s28 offen offset:0 sc1
    v_mfma_f32_16x16x32_bf16 v[196:199], v[88:91], a[244:247], v[196:199]
    s_waitcnt lgkmcnt(4)
    ds_read_b128 v[80:83], v13 offset:4096
    v_fma_f32 v38, v38, v57, v57
    v_mfma_f32_16x16x32_bf16 v[196:199], v[92:95], a[252:255], v[196:199]
    v_rcp_f32 v38, v38
    v_mfma_f32_16x16x32_bf16 v[192:195], v[92:95], a[248:251], v[192:195]
    s_waitcnt lgkmcnt(4)
    ds_read_b128 v[84:87], v13 offset:6144
    v_mul_f32 v38, v38, v174
    v_mfma_f32_16x16x32_bf16 v[192:195], v[88:91], a[240:243], v[192:195]
    buffer_load_dwordx4 a[60:63], v1, s[12:15], s28 offen offset:256 sc1
    v_mfma_f32_16x16x32_bf16 a[168:171], v[64:67], v[96:99], 0
    s_waitcnt lgkmcnt(4)
    ds_read_b128 v[88:91], v13 offset:4352
    s_add_u32 s28, s43, 4096
    v_mfma_f32_16x16x32_bf16 a[168:171], v[68:71], v[112:115], a[168:171]
    v_mul_f32 v39, v175, v56
    v_cvt_pk_bf16_f32 v164, v32, v33
    v_mfma_f32_16x16x32_bf16 a[172:175], v[68:71], v[116:119], 0
    s_waitcnt lgkmcnt(4)
    ds_read_b128 v[92:95], v13 offset:6400
    v_exp_f32 v39, v39
    v_mfma_f32_16x16x32_bf16 a[172:175], v[64:67], v[100:103], a[172:175]
    buffer_load_dwordx4 a[64:67], v1, s[12:15], s28 offen offset:0 sc1
    v_mfma_f32_16x16x32_bf16 a[180:183], v[72:75], v[100:103], 0
    s_waitcnt lgkmcnt(4)
    ds_read_b128 v[64:67], v13 offset:8192
    v_fma_f32 v39, v39, v57, v57
    v_mfma_f32_16x16x32_bf16 a[180:183], v[76:79], v[116:119], a[180:183]
    v_rcp_f32 v39, v39
    v_mfma_f32_16x16x32_bf16 a[176:179], v[76:79], v[112:115], 0
    s_waitcnt lgkmcnt(4)
    ds_read_b128 v[68:71], v13 offset:10240
    v_mul_f32 v39, v39, v175
    v_mfma_f32_16x16x32_bf16 a[176:179], v[72:75], v[96:99], a[176:179]
    buffer_load_dwordx4 a[68:71], v1, s[12:15], s28 offen offset:256 sc1
    v_mfma_f32_16x16x32_bf16 a[184:187], v[80:83], v[96:99], 0
    s_waitcnt lgkmcnt(4)
    ds_read_b128 v[72:75], v13 offset:8448
    v_cvt_pk_bf16_f32 v165, v34, v35
    v_mfma_f32_16x16x32_bf16 a[184:187], v[84:87], v[112:115], a[184:187]
    v_cvt_pk_bf16_f32 v166, v36, v37
    v_cvt_pk_bf16_f32 v167, v38, v39
    v_mfma_f32_16x16x32_bf16 a[188:191], v[84:87], v[116:119], 0
    s_waitcnt lgkmcnt(4)
    ds_read_b128 v[76:79], v13 offset:10496
    v_mul_f32 v24, v176, v22
    v_mfma_f32_16x16x32_bf16 a[188:191], v[80:83], v[100:103], a[188:191]
    buffer_store_dwordx4 v[164:167], v1, s[12:15], s27 offen offset:256 sc1
    v_mfma_f32_16x16x32_bf16 a[196:199], v[88:91], v[100:103], 0
    s_waitcnt lgkmcnt(4)
    ds_read_b128 v[80:83], v13 offset:12288
    s_add_u32 s27, s40, 12288
    v_mfma_f32_16x16x32_bf16 a[196:199], v[92:95], v[116:119], a[196:199]
    v_exp_f32 v24, v24
    v_mfma_f32_16x16x32_bf16 a[192:195], v[92:95], v[112:115], 0
    s_waitcnt lgkmcnt(4)
    ds_read_b128 v[84:87], v13 offset:14336
    v_fma_f32 v24, v24, v23, v23
    v_mfma_f32_16x16x32_bf16 a[192:195], v[88:91], v[96:99], a[192:195]
    buffer_load_dwordx4 v14, s[12:15], s16 offen offset:2048 lds
    v_mfma_f32_16x16x32_bf16 a[200:203], v[64:67], v[96:99], 0
    s_waitcnt lgkmcnt(4)
    ds_read_b128 v[88:91], v13 offset:12544
    v_rcp_f32 v24, v24
    v_mfma_f32_16x16x32_bf16 a[200:203], v[68:71], v[112:115], a[200:203]
    v_mul_f32 v24, v24, v176
    v_mul_f32 v25, v177, v22
    v_mfma_f32_16x16x32_bf16 a[204:207], v[68:71], v[116:119], 0
    s_waitcnt lgkmcnt(4)
    ds_read_b128 v[92:95], v13 offset:14592
    v_exp_f32 v25, v25
    v_mfma_f32_16x16x32_bf16 a[204:207], v[64:67], v[100:103], a[204:207]
    s_barrier
    v_mfma_f32_16x16x32_bf16 a[212:215], v[72:75], v[100:103], 0
    s_waitcnt lgkmcnt(4)
    ds_read_b128 v[64:67], v13 offset:16384
    v_fma_f32 v25, v25, v23, v23
    v_mfma_f32_16x16x32_bf16 a[212:215], v[76:79], v[116:119], a[212:215]
    buffer_load_dwordx4 v14, s[12:15], s16 offen offset:3072 lds
    v_mfma_f32_16x16x32_bf16 a[208:211], v[76:79], v[112:115], 0
    s_waitcnt lgkmcnt(4)
    ds_read_b128 v[68:71], v13 offset:18432
    s_add_u32 m0, s22, 32768
    v_mfma_f32_16x16x32_bf16 a[208:211], v[72:75], v[96:99], a[208:211]
    s_add_u32 s16, s16, 16384
    v_rcp_f32 v25, v25
    v_mfma_f32_16x16x32_bf16 a[216:219], v[80:83], v[96:99], 0
    s_waitcnt lgkmcnt(4)
    ds_read_b128 v[72:75], v13 offset:16640
    v_mul_f32 v25, v25, v177
    v_mfma_f32_16x16x32_bf16 a[216:219], v[84:87], v[112:115], a[216:219]
    buffer_load_dwordx4 v14, s[12:15], s16 offen offset:0 lds
    v_mfma_f32_16x16x32_bf16 a[220:223], v[84:87], v[116:119], 0
    s_waitcnt lgkmcnt(4)
    ds_read_b128 v[76:79], v13 offset:18688
    s_add_u32 s17, s23, 12
    v_mfma_f32_16x16x32_bf16 a[220:223], v[80:83], v[100:103], a[220:223]
    buffer_load_dword v109, v15, s[12:15], s26 offen sc1
    v_mfma_f32_16x16x32_bf16 a[228:231], v[88:91], v[100:103], 0
    s_waitcnt lgkmcnt(4)
    ds_read_b128 v[80:83], v13 offset:20480
    s_and_b32 s17, s17, 15
    v_mfma_f32_16x16x32_bf16 a[228:231], v[92:95], v[116:119], a[228:231]
    s_lshl_b32 s17, s17, 7
    v_lshlrev_b32 v9, 4, v7
    v_lshrrev_b32 v2, 2, v6
    v_mfma_f32_16x16x32_bf16 a[224:227], v[92:95], v[112:115], 0
    s_waitcnt lgkmcnt(4)
    ds_read_b128 v[84:87], v13 offset:22528
    s_add_u32 s17, s17, s26
    v_mfma_f32_16x16x32_bf16 a[224:227], v[88:91], v[96:99], a[224:227]
    buffer_load_dwordx4 v14, s[12:15], s16 offen offset:1024 lds
    v_mfma_f32_16x16x32_bf16 a[232:235], v[64:67], v[96:99], 0
    s_waitcnt lgkmcnt(4)
    ds_read_b128 v[88:91], v13 offset:20736
    s_add_u32 s18, s23, 8
    v_mfma_f32_16x16x32_bf16 a[232:235], v[68:71], v[112:115], a[232:235]
    s_and_b32 s18, s18, 15
    v_lshl_add_u32 v9, v6, 11, v9
    v_and_b32 v8, 3, v6
    v_mfma_f32_16x16x32_bf16 a[236:239], v[68:71], v[116:119], 0
    s_waitcnt lgkmcnt(4)
    ds_read_b128 v[92:95], v13 offset:22784
    s_lshl_b32 s18, s18, 7
    v_mfma_f32_16x16x32_bf16 a[236:239], v[64:67], v[100:103], a[236:239]
    buffer_load_dwordx4 v14, s[12:15], s16 offen offset:2048 lds
    v_mfma_f32_16x16x32_bf16 a[244:247], v[72:75], v[100:103], 0
    s_waitcnt lgkmcnt(4)
    ds_read_b128 v[64:67], v13 offset:24576
    s_add_u32 s18, s18, s26
    v_mfma_f32_16x16x32_bf16 a[244:247], v[76:79], v[116:119], a[244:247]
    v_add_u32 v10, 0x8000, v9
    v_lshlrev_b32 v8, 16, v8
    v_mfma_f32_16x16x32_bf16 a[240:243], v[76:79], v[112:115], 0
    s_waitcnt lgkmcnt(4)
    ds_read_b128 v[68:71], v13 offset:26624
    v_lshl_add_u32 v8, v7, 4, v8
    v_mfma_f32_16x16x32_bf16 a[240:243], v[72:75], v[96:99], a[240:243]
    buffer_load_dwordx4 v14, s[12:15], s16 offen offset:3072 lds
    v_mfma_f32_16x16x32_bf16 v[208:211], v[80:83], v[96:99], 0
    s_waitcnt lgkmcnt(4)
    ds_read_b128 v[72:75], v13 offset:24832
    s_add_u32 m0, s22, 49152
    v_mfma_f32_16x16x32_bf16 v[208:211], v[84:87], v[112:115], v[208:211]
    s_add_u32 s16, s16, 16384
    v_lshl_add_u32 v8, v2, 13, v8
    v_min_u32 v104, 2, v5
    v_mfma_f32_16x16x32_bf16 v[212:215], v[84:87], v[116:119], 0
    s_waitcnt lgkmcnt(4)
    ds_read_b128 v[76:79], v13 offset:26880
    v_sub_u32 v108, 3, v104
    v_mfma_f32_16x16x32_bf16 v[212:215], v[80:83], v[100:103], v[212:215]
    buffer_load_dwordx4 v14, s[12:15], s16 offen offset:0 lds
    v_mfma_f32_16x16x32_bf16 v[220:223], v[88:91], v[100:103], 0
    s_waitcnt lgkmcnt(4)
    ds_read_b128 v[80:83], v13 offset:28672
    v_lshl_add_u32 v108, v108, 2, s23
    v_mfma_f32_16x16x32_bf16 v[220:223], v[92:95], v[116:119], v[220:223]
    v_and_b32 v108, 15, v108
    v_add_u32 v104, 8, v104
    v_mfma_f32_16x16x32_bf16 v[216:219], v[92:95], v[112:115], 0
    s_waitcnt lgkmcnt(4)
    ds_read_b128 v[84:87], v13 offset:30720
    v_lshlrev_b32 v108, 7, v108
    v_mfma_f32_16x16x32_bf16 v[216:219], v[88:91], v[96:99], v[216:219]
    buffer_load_dwordx4 v14, s[12:15], s16 offen offset:1024 lds
    v_mfma_f32_16x16x32_bf16 a[168:171], v[64:67], v[128:131], a[168:171]
    s_waitcnt lgkmcnt(4)
    ds_read_b128 v[88:91], v13 offset:28928
    s_nop 0
    v_mfma_f32_16x16x32_bf16 a[168:171], v[68:71], a[0:3], a[168:171]
    v_mul_f32 v26, v178, v22
    v_mul_f32 v27, v179, v22
    v_mfma_f32_16x16x32_bf16 a[172:175], v[68:71], a[4:7], a[172:175]
    s_waitcnt lgkmcnt(4)
    ds_read_b128 v[92:95], v13 offset:30976
    v_exp_f32 v26, v26
    v_mfma_f32_16x16x32_bf16 a[172:175], v[64:67], v[132:135], a[172:175]
    s_barrier
    v_mfma_f32_16x16x32_bf16 a[180:183], v[72:75], v[132:135], a[180:183]
    s_waitcnt lgkmcnt(4)
    ds_read_b128 v[64:67], v13 offset:32768
    v_exp_f32 v27, v27
    v_mfma_f32_16x16x32_bf16 a[180:183], v[76:79], a[4:7], a[180:183]
    buffer_load_dwordx4 v14, s[12:15], s16 offen offset:2048 lds
    v_mfma_f32_16x16x32_bf16 a[176:179], v[76:79], a[0:3], a[176:179]
    s_waitcnt lgkmcnt(4)
    ds_read_b128 v[68:71], v13 offset:34816
    v_fma_f32 v26, v26, v23, v23
    v_mfma_f32_16x16x32_bf16 a[176:179], v[72:75], v[128:131], a[176:179]
    s_waitcnt vmcnt(15)
    v_cmp_gt_u32 vcc, 4, v62
    v_fma_f32 v27, v27, v23, v23
    v_mfma_f32_16x16x32_bf16 a[184:187], v[80:83], v[128:131], a[184:187]
    s_waitcnt lgkmcnt(4)
    ds_read_b128 v[72:75], v13 offset:33024
    s_cbranch_vccnz SLOW3_ffb_kernel
BACK3_ffb_kernel:
    v_mfma_f32_16x16x32_bf16 a[184:187], v[84:87], a[0:3], a[184:187]
    buffer_load_dwordx4 v14, s[12:15], s16 offen offset:3072 lds
    v_mfma_f32_16x16x32_bf16 a[188:191], v[84:87], a[4:7], a[188:191]
    s_waitcnt lgkmcnt(4)
    ds_read_b128 v[76:79], v13 offset:35072
    s_add_u32 s28, s41, 6144
    v_mfma_f32_16x16x32_bf16 a[188:191], v[80:83], v[132:135], a[188:191]
    v_rcp_f32 v26, v26
    v_mfma_f32_16x16x32_bf16 a[196:199], v[88:91], v[132:135], a[196:199]
    s_waitcnt lgkmcnt(4)
    ds_read_b128 v[80:83], v13 offset:36864
    v_rcp_f32 v27, v27
    v_mfma_f32_16x16x32_bf16 a[196:199], v[92:95], a[4:7], a[196:199]
    buffer_load_dwordx4 a[72:75], v1, s[12:15], s28 offen offset:0 sc1
    v_mfma_f32_16x16x32_bf16 a[192:195], v[92:95], a[0:3], a[192:195]
    s_waitcnt lgkmcnt(4)
    ds_read_b128 v[84:87], v13 offset:38912
    v_mul_f32 v26, v26, v178
    v_mfma_f32_16x16x32_bf16 a[192:195], v[88:91], v[128:131], a[192:195]
    v_mul_f32 v27, v27, v179
    v_mul_f32 v28, v184, v22
    v_mfma_f32_16x16x32_bf16 a[200:203], v[64:67], v[128:131], a[200:203]
    s_waitcnt lgkmcnt(4)
    ds_read_b128 v[88:91], v13 offset:37120
    v_exp_f32 v28, v28
    v_mfma_f32_16x16x32_bf16 a[200:203], v[68:71], a[0:3], a[200:203]
    buffer_load_dwordx4 a[76:79], v1, s[12:15], s28 offen offset:256 sc1
    v_mfma_f32_16x16x32_bf16 a[204:207], v[68:71], a[4:7], a[204:207]
    s_waitcnt lgkmcnt(4)
    ds_read_b128 v[92:95], v13 offset:39168
    s_add_u32 s28, s42, 6144
    v_mfma_f32_16x16x32_bf16 a[204:207], v[64:67], v[132:135], a[204:207]
    v_fma_f32 v28, v28, v23, v23
    v_mul_f32 v29, v185, v22
    v_mfma_f32_16x16x32_bf16 a[212:215], v[72:75], v[132:135], a[212:215]
    s_waitcnt lgkmcnt(4)
    ds_read_b128 v[64:67], v13 offset:40960
    v_rcp_f32 v28, v28
    v_mfma_f32_16x16x32_bf16 a[212:215], v[76:79], a[4:7], a[212:215]
    buffer_load_dwordx4 a[80:83], v1, s[12:15], s28 offen offset:0 sc1
    v_mfma_f32_16x16x32_bf16 a[208:211], v[76:79], a[0:3], a[208:211]
    s_waitcnt lgkmcnt(4)
    ds_read_b128 v[68:71], v13 offset:43008
    v_exp_f32 v29, v29
    v_mfma_f32_16x16x32_bf16 a[208:211], v[72:75], v[128:131], a[208:211]
    v_mul_f32 v28, v28, v184
    v_fma_f32 v29, v29, v23, v23
    v_mfma_f32_16x16x32_bf16 a[216:219], v[80:83], v[128:131], a[216:219]
    s_waitcnt lgkmcnt(4)
    ds_read_b128 v[72:75], v13 offset:41216
    v_rcp_f32 v29, v29
    v_mfma_f32_16x16x32_bf16 a[216:219], v[84:87], a[0:3], a[216:219]
    buffer_load_dwordx4 a[84:87], v1, s[12:15], s28 offen offset:256 sc1
    v_mfma_f32_16x16x32_bf16 a[220:223], v[84:87], a[4:7], a[220:223]
    s_waitcnt lgkmcnt(4)
    ds_read_b128 v[76:79], v13 offset:43264
    v_mul_f32 v29, v29, v185
    v_mfma_f32_16x16x32_bf16 a[220:223], v[80:83], v[132:135], a[220:223]
    s_waitcnt vmcnt(15)
    buffer_store_dword v60, v59, s[12:15], s26 offen sc1
    v_mfma_f32_16x16x32_bf16 a[228:231], v[88:91], v[132:135], a[228:231]
    s_waitcnt lgkmcnt(4)
    ds_read_b128 v[80:83], v13 offset:45056
    s_add_u32 s28, s43, 6144
    v_mfma_f32_16x16x32_bf16 a[228:231], v[92:95], a[4:7], a[228:231]
    v_mov_b32 v60, 6
    v_mul_f32 v30, v186, v22
    v_mfma_f32_16x16x32_bf16 a[224:227], v[92:95], a[0:3], a[224:227]
    s_waitcnt lgkmcnt(4)
    ds_read_b128 v[84:87], v13 offset:47104
    v_exp_f32 v30, v30
    v_mfma_f32_16x16x32_bf16 a[224:227], v[88:91], v[128:131], a[224:227]
    buffer_load_dwordx4 a[88:91], v1, s[12:15], s28 offen offset:0 sc1
    v_mfma_f32_16x16x32_bf16 a[232:235], v[64:67], v[128:131], a[232:235]
    s_waitcnt lgkmcnt(4)
    ds_read_b128 v[88:91], v13 offset:45312
    v_fma_f32 v30, v30, v23, v23
    v_mfma_f32_16x16x32_bf16 a[232:235], v[68:71], a[0:3], a[232:235]
    v_rcp_f32 v30, v30
    v_mfma_f32_16x16x32_bf16 a[236:239], v[68:71], a[4:7], a[236:239]
    s_waitcnt lgkmcnt(4)
    ds_read_b128 v[92:95], v13 offset:47360
    v_mul_f32 v30, v30, v186
    v_mfma_f32_16x16x32_bf16 a[236:239], v[64:67], v[132:135], a[236:239]
    s_barrier
    v_mfma_f32_16x16x32_bf16 a[244:247], v[72:75], v[132:135], a[244:247]
    s_waitcnt lgkmcnt(4)
    ds_read_b128 v[64:67], v13 offset:49152
    v_mul_f32 v31, v187, v22
    v_mfma_f32_16x16x32_bf16 a[244:247], v[76:79], a[4:7], a[244:247]
    buffer_load_dwordx4 a[92:95], v1, s[12:15], s28 offen offset:256 sc1
    v_mfma_f32_16x16x32_bf16 a[240:243], v[76:79], a[0:3], a[240:243]
    s_waitcnt lgkmcnt(4)
    ds_read_b128 v[68:71], v13 offset:51200
    s_add_u32 m0, s22, 65536
    v_mfma_f32_16x16x32_bf16 a[240:243], v[72:75], v[128:131], a[240:243]
    s_add_u32 s16, s16, 16384
    v_exp_f32 v31, v31
    v_mfma_f32_16x16x32_bf16 v[208:211], v[80:83], v[128:131], v[208:211]
    s_waitcnt lgkmcnt(4)
    ds_read_b128 v[72:75], v13 offset:49408
    v_fma_f32 v31, v31, v23, v23
    v_mfma_f32_16x16x32_bf16 v[208:211], v[84:87], a[0:3], v[208:211]
    buffer_load_dwordx4 v14, s[12:15], s16 offen offset:0 lds
    v_mfma_f32_16x16x32_bf16 v[212:215], v[84:87], a[4:7], v[212:215]
    s_waitcnt lgkmcnt(4)
    ds_read_b128 v[76:79], v13 offset:51456
    v_rcp_f32 v31, v31
    v_mfma_f32_16x16x32_bf16 v[212:215], v[80:83], v[132:135], v[212:215]
    s_waitcnt vmcnt(15)
    v_cmp_gt_u32 vcc, 3, v109
    v_mul_f32 v31, v31, v187
    v_mfma_f32_16x16x32_bf16 v[220:223], v[88:91], v[132:135], v[220:223]
    s_waitcnt lgkmcnt(4)
    ds_read_b128 v[80:83], v13 offset:53248
    s_cbranch_vccnz SLOWX_ffb_kernel
BACKX_ffb_kernel:
    v_mfma_f32_16x16x32_bf16 v[220:223], v[92:95], a[4:7], v[220:223]
    buffer_load_dwordx4 v14, s[12:15], s16 offen offset:1024 lds
    v_mfma_f32_16x16x32_bf16 v[216:219], v[92:95], a[0:3], v[216:219]
    s_waitcnt lgkmcnt(4)
    ds_read_b128 v[84:87], v13 offset:55296
    v_cvt_pk_bf16_f32 v176, v24, v25
    v_mfma_f32_16x16x32_bf16 v[216:219], v[88:91], v[128:131], v[216:219]
    buffer_load_dwordx4 v[120:123], v9, s[12:15], s3 offen offset:0 sc1
    v_mfma_f32_16x16x32_bf16 a[168:171], v[64:67], a[8:11], a[168:171]
    s_waitcnt lgkmcnt(4)
    ds_read_b128 v[88:91], v13 offset:53504
    v_cvt_pk_bf16_f32 v177, v26, v27
    v_mfma_f32_16x16x32_bf16 a[168:171], v[68:71], a[16:19], a[168:171]
    v_cvt_pk_bf16_f32 v178, v28, v29
    v_cvt_pk_bf16_f32 v179, v30, v31
    v_mfma_f32_16x16x32_bf16 a[172:175], v[68:71], a[20:23], a[172:175]
    s_waitcnt lgkmcnt(4)
    ds_read_b128 v[92:95], v13 offset:55552
    v_mul_f32 v32, v180, v56
    v_mfma_f32_16x16x32_bf16 a[172:175], v[64:67], a[12:15], a[172:175]
    buffer_store_dwordx4 v[176:179], v1, s[12:15], s45 offen offset:0 sc1
    v_mfma_f32_16x16x32_bf16 a[180:183], v[72:75], a[12:15], a[180:183]
    s_waitcnt lgkmcnt(4)
    ds_read_b128 v[64:67], v13 offset:57344
    v_exp_f32 v32, v32
    v_mfma_f32_16x16x32_bf16 a[180:183], v[76:79], a[20:23], a[180:183]
    v_fma_f32 v32, v32, v57, v57
    v_mul_f32 v33, v181, v56
    v_mfma_f32_16x16x32_bf16 a[176:179], v[76:79], a[16:19], a[176:179]
    s_waitcnt lgkmcnt(4)
    ds_read_b128 v[68:71], v13 offset:59392
    v_rcp_f32 v32, v32
    v_mfma_f32_16x16x32_bf16 a[176:179], v[72:75], a[8:11], a[176:179]
    buffer_load_dwordx4 v14, s[12:15], s16 offen offset:2048 lds
    v_mfma_f32_16x16x32_bf16 a[184:187], v[80:83], a[8:11], a[184:187]
    s_waitcnt lgkmcnt(4)
    ds_read_b128 v[72:75], v13 offset:57600
    v_exp_f32 v33, v33
    v_mfma_f32_16x16x32_bf16 a[184:187], v[84:87], a[16:19], a[184:187]
    v_mul_f32 v32, v32, v180
    v_fma_f32 v33, v33, v57, v57
    v_mfma_f32_16x16x32_bf16 a[188:191], v[84:87], a[20:23], a[188:191]
    s_waitcnt lgkmcnt(4)
    ds_read_b128 v[76:79], v13 offset:59648
    v_rcp_f32 v33, v33
    v_mfma_f32_16x16x32_bf16 a[188:191], v[80:83], a[12:15], a[188:191]
    buffer_load_dwordx4 v14, s[12:15], s16 offen offset:3072 lds
    v_mfma_f32_16x16x32_bf16 a[196:199], v[88:91], a[12:15], a[196:199]
    s_waitcnt lgkmcnt(4)
    ds_read_b128 v[80:83], v13 offset:61440
    v_mul_f32 v33, v33, v181
    v_mfma_f32_16x16x32_bf16 a[196:199], v[92:95], a[20:23], a[196:199]
    buffer_load_dword v61, v58, s[12:15], s26 offen sc1
    v_mfma_f32_16x16x32_bf16 a[192:195], v[92:95], a[16:19], a[192:195]
    s_waitcnt lgkmcnt(4)
    ds_read_b128 v[84:87], v13 offset:63488
    s_add_u32 m0, s22, 81920
    v_mfma_f32_16x16x32_bf16 a[192:195], v[88:91], a[8:11], a[192:195]
    s_add_u32 s16, s16, 16384
    v_mul_f32 v34, v182, v56
    v_mul_f32 v35, v183, v56
    v_mfma_f32_16x16x32_bf16 a[200:203], v[64:67], a[8:11], a[200:203]
    s_waitcnt lgkmcnt(4)
    ds_read_b128 v[88:91], v13 offset:61696
    v_exp_f32 v34, v34
    v_mfma_f32_16x16x32_bf16 a[200:203], v[68:71], a[16:19], a[200:203]
    buffer_load_dwordx4 v14, s[12:15], s16 offen offset:0 lds
    v_mfma_f32_16x16x32_bf16 a[204:207], v[68:71], a[20:23], a[204:207]
    s_waitcnt lgkmcnt(4)
    ds_read_b128 v[92:95], v13 offset:63744
    v_exp_f32 v35, v35
    v_mfma_f32_16x16x32_bf16 a[204:207], v[64:67], a[12:15], a[204:207]
    s_barrier
    v_mfma_f32_16x16x32_bf16 a[212:215], v[72:75], a[12:15], a[212:215]
    s_waitcnt lgkmcnt(4)
    ds_read_b128 v[64:67], v12 offset:0
    v_fma_f32 v34, v34, v57, v57
    v_mfma_f32_16x16x32_bf16 a[212:215], v[76:79], a[20:23], a[212:215]
    buffer_load_dwordx4 v14, s[12:15], s16 offen offset:1024 lds
    v_mfma_f32_16x16x32_bf16 a[208:211], v[76:79], a[16:19], a[208:211]
    s_waitcnt lgkmcnt(4)
    ds_read_b128 v[68:71], v12 offset:2048
    v_rcp_f32 v34, v34
    v_mfma_f32_16x16x32_bf16 a[208:211], v[72:75], a[8:11], a[208:211]
    v_mul_f32 v34, v34, v182
    v_fma_f32 v35, v35, v57, v57
    v_mfma_f32_16x16x32_bf16 a[216:219], v[80:83], a[8:11], a[216:219]
    s_waitcnt lgkmcnt(4)
    ds_read_b128 v[72:75], v12 offset:256
    v_rcp_f32 v35, v35
    v_mfma_f32_16x16x32_bf16 a[216:219], v[84:87], a[16:19], a[216:219]
    buffer_load_dwordx4 v14, s[12:15], s16 offen offset:2048 lds
    v_mfma_f32_16x16x32_bf16 a[220:223], v[84:87], a[20:23], a[220:223]
    s_waitcnt lgkmcnt(4)
    ds_read_b128 v[76:79], v12 offset:2304
    v_mul_f32 v35, v35, v183
    v_mfma_f32_16x16x32_bf16 a[220:223], v[80:83], a[12:15], a[220:223]
    v_mul_f32 v36, v188, v56
    v_mul_f32 v37, v189, v56
    v_mfma_f32_16x16x32_bf16 a[228:231], v[88:91], a[12:15], a[228:231]
    s_waitcnt lgkmcnt(4)
    ds_read_b128 v[80:83], v12 offset:4096
    v_exp_f32 v36, v36
    v_mfma_f32_16x16x32_bf16 a[228:231], v[92:95], a[20:23], a[228:231]
    buffer_load_dwordx4 v14, s[12:15], s16 offen offset:3072 lds
    v_mfma_f32_16x16x32_bf16 a[224:227], v[92:95], a[16:19], a[224:227]
    s_waitcnt lgkmcnt(4)
    ds_read_b128 v[84:87], v12 offset:6144
    s_add_u32 m0, s22, 98304
    v_mfma_f32_16x16x32_bf16 a[224:227], v[88:91], a[8:11], a[224:227]
    s_add_u32 s16, s16, 16384
    v_fma_f32 v36, v36, v57, v57
    v_mul_f32 v38, v190, v56
    v_mfma_f32_16x16x32_bf16 a[232:235], v[64:67], a[8:11], a[232:235]
    s_waitcnt lgkmcnt(4)
    ds_read_b128 v[88:91], v12 offset:4352
    v_rcp_f32 v36, v36
    v_mfma_f32_16x16x32_bf16 a[232:235], v[68:71], a[16:19], a[232:235]
    buffer_load_dwordx4 v14, s[12:15], s16 offen offset:0 lds
    v_mfma_f32_16x16x32_bf16 a[236:239], v[68:71], a[20:23], a[236:239]
    s_waitcnt lgkmcnt(4)
    ds_read_b128 v[92:95], v12 offset:6400
    v_exp_f32 v37, v37
    v_mfma_f32_16x16x32_bf16 a[236:239], v[64:67], a[12:15], a[236:239]
    v_mul_f32 v36, v36, v188
    v_fma_f32 v37, v37, v57, v57
    v_mfma_f32_16x16x32_bf16 a[244:247], v[72:75], a[12:15], a[244:247]
    s_waitcnt lgkmcnt(4)
    ds_read_b128 v[64:67], v12 offset:8192
    v_rcp_f32 v37, v37
    v_mfma_f32_16x16x32_bf16 a[244:247], v[76:79], a[20:23], a[244:247]
    buffer_load_dwordx4 v14, s[12:15], s16 offen offset:1024 lds
    v_mfma_f32_16x16x32_bf16 a[240:243], v[76:79], a[16:19], a[240:243]
    s_waitcnt lgkmcnt(4)
    ds_read_b128 v[68:71], v12 offset:10240
    v_exp_f32 v38, v38
    v_mfma_f32_16x16x32_bf16 a[240:243], v[72:75], a[8:11], a[240:243]
    v_mul_f32 v37, v37, v189
    v_fma_f32 v38, v38, v57, v57
    v_mfma_f32_16x16x32_bf16 v[208:211], v[80:83], a[8:11], v[208:211]
    s_waitcnt lgkmcnt(4)
    ds_read_b128 v[72:75], v12 offset:8448
    v_rcp_f32 v38, v38
    v_mfma_f32_16x16x32_bf16 v[208:211], v[84:87], a[16:19], v[208:211]
    buffer_load_dwordx4 v14, s[12:15], s16 offen offset:2048 lds
    v_mfma_f32_16x16x32_bf16 v[212:215], v[84:87], a[20:23], v[212:215]
    s_waitcnt lgkmcnt(4)
    ds_read_b128 v[76:79], v12 offset:10496
    v_mul_f32 v38, v38, v190
    v_mfma_f32_16x16x32_bf16 v[212:215], v[80:83], a[12:15], v[212:215]
    v_mul_f32 v39, v191, v56
    v_cvt_pk_bf16_f32 v180, v32, v33
    v_mfma_f32_16x16x32_bf16 v[220:223], v[88:91], a[12:15], v[220:223]
    s_waitcnt lgkmcnt(4)
    ds_read_b128 v[80:83], v12 offset:12288
    v_exp_f32 v39, v39
    v_mfma_f32_16x16x32_bf16 v[220:223], v[92:95], a[20:23], v[220:223]
    buffer_load_dwordx4 v14, s[12:15], s16 offen offset:3072 lds
    v_mfma_f32_16x16x32_bf16 v[216:219], v[92:95], a[16:19], v[216:219]
    s_waitcnt lgkmcnt(4)
    ds_read_b128 v[84:87], v12 offset:14336
    v_fma_f32 v39, v39, v57, v57
    v_mfma_f32_16x16x32_bf16 v[216:219], v[88:91], a[8:11], v[216:219]
    v_rcp_f32 v39, v39
    v_mfma_f32_16x16x32_bf16 a[168:171], v[64:67], v[144:147], a[168:171]
    s_waitcnt lgkmcnt(4)
    ds_read_b128 v[88:91], v12 offset:12544
    v_mul_f32 v39, v39, v191
    v_mfma_f32_16x16x32_bf16 a[168:171], v[68:71], a[24:27], a[168:171]
    v_cvt_pk_bf16_f32 v181, v34, v35
    v_cvt_pk_bf16_f32 v182, v36, v37
    v_mfma_f32_16x16x32_bf16 a[172:175], v[68:71], a[28:31], a[172:175]
    s_waitcnt lgkmcnt(4)
    ds_read_b128 v[92:95], v12 offset:14592
    v_cvt_pk_bf16_f32 v183, v38, v39
    v_mfma_f32_16x16x32_bf16 a[172:175], v[64:67], v[148:151], a[172:175]
    s_barrier
    v_mfma_f32_16x16x32_bf16 a[180:183], v[72:75], v[148:151], a[180:183]
    s_waitcnt lgkmcnt(4)
    ds_read_b128 v[64:67], v12 offset:16384
    s_add_u32 m0, s22, 114688
    v_mfma_f32_16x16x32_bf16 a[180:183], v[76:79], a[28:31], a[180:183]
    buffer_store_dwordx4 v[180:183], v1, s[12:15], s45 offen offset:256 sc1
    v_mfma_f32_16x16x32_bf16 a[176:179], v[76:79], a[24:27], a[176:179]
    s_waitcnt lgkmcnt(4)
    ds_read_b128 v[68:71], v12 offset:18432
    s_add_u32 s16, s16, 16384
    v_mfma_f32_16x16x32_bf16 a[176:179], v[72:75], v[144:147], a[176:179]
    v_mul_f32 v24, v192, v22
    v_mul_f32 v25, v193, v22
    v_mfma_f32_16x16x32_bf16 a[184:187], v[80:83], v[144:147], a[184:187]
    s_waitcnt lgkmcnt(4)
    ds_read_b128 v[72:75], v12 offset:16640
    v_exp_f32 v24, v24
    v_mfma_f32_16x16x32_bf16 a[184:187], v[84:87], a[24:27], a[184:187]
    buffer_load_dwordx4 v14, s[12:15], s16 offen offset:0 lds
    v_mfma_f32_16x16x32_bf16 a[188:191], v[84:87], a[28:31], a[188:191]
    s_waitcnt lgkmcnt(4)
    ds_read_b128 v[76:79], v12 offset:18688
    v_exp_f32 v25, v25
    v_mfma_f32_16x16x32_bf16 a[188:191], v[80:83], v[148:151], a[188:191]
    v_fma_f32 v24, v24, v23, v23
    v_fma_f32 v25, v25, v23, v23
    v_mfma_f32_16x16x32_bf16 a[196:199], v[88:91], v[148:151], a[196:199]
    s_waitcnt lgkmcnt(4)
    ds_read_b128 v[80:83], v12 offset:20480
    v_rcp_f32 v24, v24
    v_mfma_f32_16x16x32_bf16 a[196:199], v[92:95], a[28:31], a[196:199]
    buffer_load_dwordx4 v14, s[12:15], s16 offen offset:1024 lds
    v_mfma_f32_16x16x32_bf16 a[192:195], v[92:95], a[24:27], a[192:195]
    s_waitcnt lgkmcnt(4)
    ds_read_b128 v[84:87], v12 offset:22528
    v_rcp_f32 v25, v25
    v_mfma_f32_16x16x32_bf16 a[192:195], v[88:91], v[144:147], a[192:195]
    v_mul_f32 v24, v24, v192
    v_mul_f32 v25, v25, v193
    v_mfma_f32_16x16x32_bf16 a[200:203], v[64:67], v[144:147], a[200:203]
    s_waitcnt lgkmcnt(4)
    ds_read_b128 v[88:91], v12 offset:20736
    v_mul_f32 v26, v194, v22
    v_mfma_f32_16x16x32_bf16 a[200:203], v[68:71], a[24:27], a[200:203]
    buffer_load_dwordx4 v14, s[12:15], s16 offen offset:2048 lds
    v_mfma_f32_16x16x32_bf16 a[204:207], v[68:71], a[28:31], a[204:207]
    s_waitcnt lgkmcnt(4)
    ds_read_b128 v[92:95], v12 offset:22784
    v_exp_f32 v26, v26
    v_mfma_f32_16x16x32_bf16 a[204:207], v[64:67], v[148:151], a[204:207]
    v_fma_f32 v26, v26, v23, v23
    v_mul_f32 v27, v195, v22
    v_mfma_f32_16x16x32_bf16 a[212:215], v[72:75], v[148:151], a[212:215]
    s_waitcnt lgkmcnt(4)
    ds_read_b128 v[64:67], v12 offset:24576
    v_rcp_f32 v26, v26
    v_mfma_f32_16x16x32_bf16 a[212:215], v[76:79], a[28:31], a[212:215]
    buffer_load_dwordx4 v14, s[12:15], s16 offen offset:3072 lds
    v_mfma_f32_16x16x32_bf16 a[208:211], v[76:79], a[24:27], a[208:211]
    s_waitcnt lgkmcnt(4)
    ds_read_b128 v[68:71], v12 offset:26624
    v_exp_f32 v27, v27
    v_mfma_f32_16x16x32_bf16 a[208:211], v[72:75], v[144:147], a[208:211]
    v_mul_f32 v26, v26, v194
    v_fma_f32 v27, v27, v23, v23
    v_mfma_f32_16x16x32_bf16 a[216:219], v[80:83], v[144:147], a[216:219]
    s_waitcnt lgkmcnt(4)
    ds_read_b128 v[72:75], v12 offset:24832
    v_rcp_f32 v27, v27
    v_mfma_f32_16x16x32_bf16 a[216:219], v[84:87], a[24:27], a[216:219]
    v_mul_f32 v27, v27, v195
    v_mul_f32 v28, v200, v22
    v_mfma_f32_16x16x32_bf16 a[220:223], v[84:87], a[28:31], a[220:223]
    s_waitcnt lgkmcnt(4)
    ds_read_b128 v[76:79], v12 offset:26880
    v_exp_f32 v28, v28
    v_mfma_f32_16x16x32_bf16 a[220:223], v[80:83], v[148:151], a[220:223]
    v_fma_f32 v28, v28, v23, v23
    v_mul_f32 v29, v201, v22
    v_mfma_f32_16x16x32_bf16 a[228:231], v[88:91], v[148:151], a[228:231]
    s_waitcnt lgkmcnt(4)
    ds_read_b128 v[80:83], v12 offset:28672
    v_rcp_f32 v28, v28
    v_mfma_f32_16x16x32_bf16 a[228:231], v[92:95], a[28:31], a[228:231]
    s_waitcnt vmcnt(13)
    v_cmp_gt_u32 vcc, 5, v61
    v_mul_f32 v28, v28, v200
    v_mfma_f32_16x16x32_bf16 a[224:227], v[92:95], a[24:27], a[224:227]
    s_waitcnt lgkmcnt(4)
    ds_read_b128 v[84:87], v12 offset:30720
    s_cbranch_vccnz SLOW4_ffb_kernel
BACK4_ffb_kernel:
    v_mfma_f32_16x16x32_bf16 a[224:227], v[88:91], v[144:147], a[224:227]
    s_add_u32 s28, s41, 8192
    v_exp_f32 v29, v29
    v_mfma_f32_16x16x32_bf16 a[232:235], v[64:67], v[144:147], a[232:235]
    s_waitcnt lgkmcnt(4)
    ds_read_b128 v[88:91], v12 offset:28928
    v_fma_f32 v29, v29, v23, v23
    v_mfma_f32_16x16x32_bf16 a[232:235], v[68:71], a[24:27], a[232:235]
    buffer_load_dwordx4 a[96:99], v1, s[12:15], s28 offen offset:0 sc1
    v_mfma_f32_16x16x32_bf16 a[236:239], v[68:71], a[28:31], a[236:239]
    s_waitcnt lgkmcnt(4)
    ds_read_b128 v[92:95], v12 offset:30976
    v_rcp_f32 v29, v29
    v_mfma_f32_16x16x32_bf16 a[236:239], v[64:67], v[148:151], a[236:239]
    s_barrier
    v_mfma_f32_16x16x32_bf16 a[244:247], v[72:75], v[148:151], a[244:247]
    s_waitcnt lgkmcnt(4)
    ds_read_b128 v[64:67], v12 offset:32768
    v_mul_f32 v29, v29, v201
    v_mfma_f32_16x16x32_bf16 a[244:247], v[76:79], a[28:31], a[244:247]
    buffer_load_dwordx4 a[100:103], v1, s[12:15], s28 offen offset:256 sc1
    v_mfma_f32_16x16x32_bf16 a[240:243], v[76:79], a[24:27], a[240:243]
    s_waitcnt lgkmcnt(4)
    ds_read_b128 v[68:71], v12 offset:34816
    s_add_u32 s28, s42, 8192
    v_mfma_f32_16x16x32_bf16 a[240:243], v[72:75], v[144:147], a[240:243]
    v_mul_f32 v30, v202, v22
    v_mul_f32 v31, v203, v22
    v_mfma_f32_16x16x32_bf16 v[208:211], v[80:83], v[144:147], v[208:211]
    s_waitcnt lgkmcnt(4)
    ds_read_b128 v[72:75], v12 offset:33024
    v_exp_f32 v30, v30
    v_mfma_f32_16x16x32_bf16 v[208:211], v[84:87], a[24:27], v[208:211]
    buffer_load_dwordx4 a[104:107], v1, s[12:15], s28 offen offset:0 sc1
    v_mfma_f32_16x16x32_bf16 v[212:215], v[84:87], a[28:31], v[212:215]
    s_waitcnt lgkmcnt(4)
    ds_read_b128 v[76:79], v12 offset:35072
    v_exp_f32 v31, v31
    v_mfma_f32_16x16x32_bf16 v[212:215], v[80:83], v[148:151], v[212:215]
    v_fma_f32 v30, v30, v23, v23
    v_fma_f32 v31, v31, v23, v23
    v_mfma_f32_16x16x32_bf16 v[220:223], v[88:91], v[148:151], v[220:223]
    s_waitcnt lgkmcnt(4)
    ds_read_b128 v[80:83], v12 offset:36864
    v_rcp_f32 v30, v30
    v_mfma_f32_16x16x32_bf16 v[220:223], v[92:95], a[28:31], v[220:223]
    buffer_load_dwordx4 a[108:111], v1, s[12:15], s28 offen offset:256 sc1
    v_mfma_f32_16x16x32_bf16 v[216:219], v[92:95], a[24:27], v[216:219]
    s_waitcnt lgkmcnt(4)
    ds_read_b128 v[84:87], v12 offset:38912
    s_add_u32 s28, s43, 8192
    v_mfma_f32_16x16x32_bf16 v[216:219], v[88:91], v[144:147], v[216:219]
    v_mul_f32 v30, v30, v202
    v_cvt_pk_bf16_f32 v192, v24, v25
    v_mfma_f32_16x16x32_bf16 a[168:171], v[64:67], a[32:35], a[168:171]
    s_waitcnt lgkmcnt(4)
    ds_read_b128 v[88:91], v12 offset:37120
    v_rcp_f32 v31, v31
    v_mfma_f32_16x16x32_bf16 a[168:171], v[68:71], a[40:43], a[168:171]
    buffer_load_dwordx4 a[112:115], v1, s[12:15], s28 offen offset:0 sc1
    v_mfma_f32_16x16x32_bf16 a[172:175], v[68:71], a[44:47], a[172:175]
    s_waitcnt lgkmcnt(4)
    ds_read_b128 v[92:95], v12 offset:39168
    v_mul_f32 v31, v31, v203
    v_mfma_f32_16x16x32_bf16 a[172:175], v[64:67], a[36:39], a[172:175]
    v_cvt_pk_bf16_f32 v193, v26, v27
    v_cvt_pk_bf16_f32 v194, v28, v29
    v_mfma_f32_16x16x32_bf16 a[180:183], v[72:75], a[36:39], a[180:183]
    s_waitcnt lgkmcnt(4)
    ds_read_b128 v[64:67], v12 offset:40960
    v_cvt_pk_bf16_f32 v195, v30, v31
    v_mfma_f32_16x16x32_bf16 a[180:183], v[76:79], a[44:47], a[180:183]
    buffer_store_dwordx4 v[192:195], v1, s[12:15], s27 offen offset:0 sc1
    v_mfma_f32_16x16x32_bf16 a[176:179], v[76:79], a[40:43], a[176:179]
    s_waitcnt lgkmcnt(4)
    ds_read_b128 v[68:71], v12 offset:43008
    v_mul_f32 v32, v196, v56
    v_mfma_f32_16x16x32_bf16 a[176:179], v[72:75], a[32:35], a[176:179]
    v_exp_f32 v32, v32
    v_mfma_f32_16x16x32_bf16 a[184:187], v[80:83], a[32:35], a[184:187]
    s_waitcnt lgkmcnt(4)
    ds_read_b128 v[72:75], v12 offset:41216
    v_fma_f32 v32, v32, v57, v57
    v_mfma_f32_16x16x32_bf16 a[184:187], v[84:87], a[40:43], a[184:187]
    buffer_load_dwordx4 a[116:119], v1, s[12:15], s28 offen offset:256 sc1
    v_mfma_f32_16x16x32_bf16 a[188:191], v[84:87], a[44:47], a[188:191]
    s_waitcnt lgkmcnt(4)
    ds_read_b128 v[76:79], v12 offset:43264
    s_add_u32 m0, s22, 0
    v_mfma_f32_16x16x32_bf16 a[188:191], v[80:83], a[36:39], a[188:191]
    s_add_u32 s16, s16, 16384
    v_rcp_f32 v32, v32
    v_mfma_f32_16x16x32_bf16 a[196:199], v[88:91], a[36:39], a[196:199]
    s_waitcnt lgkmcnt(4)
    ds_read_b128 v[80:83], v12 offset:45056
    v_mul_f32 v32, v32, v196
    v_mfma_f32_16x16x32_bf16 a[196:199], v[92:95], a[44:47], a[196:199]
    buffer_load_dwordx4 v14, s[12:15], s16 offen offset:0 lds
    v_mfma_f32_16x16x32_bf16 a[192:195], v[92:95], a[40:43], a[192:195]
    s_waitcnt lgkmcnt(4)
    ds_read_b128 v[84:87], v12 offset:47104
    v_mul_f32 v33, v197, v56
    v_mfma_f32_16x16x32_bf16 a[192:195], v[88:91], a[32:35], a[192:195]
    v_exp_f32 v33, v33
    v_mfma_f32_16x16x32_bf16 a[200:203], v[64:67], a[32:35], a[200:203]
    s_waitcnt lgkmcnt(4)
    ds_read_b128 v[88:91], v12 offset:45312
    v_fma_f32 v33, v33, v57, v57
    v_mfma_f32_16x16x32_bf16 a[200:203], v[68:71], a[40:43], a[200:203]
    buffer_load_dwordx4 v14, s[12:15], s16 offen offset:1024 lds
    v_mfma_f32_16x16x32_bf16 a[204:207], v[68:71], a[44:47], a[204:207]
    s_waitcnt lgkmcnt(4)
    ds_read_b128 v[92:95], v12 offset:47360
    v_rcp_f32 v33, v33
    v_mfma_f32_16x16x32_bf16 a[204:207], v[64:67], a[36:39], a[204:207]
    s_barrier
    v_mfma_f32_16x16x32_bf16 a[212:215], v[72:75], a[36:39], a[212:215]
    s_waitcnt lgkmcnt(4)
    ds_read_b128 v[64:67], v12 offset:49152
    v_mul_f32 v33, v33, v197
    v_mfma_f32_16x16x32_bf16 a[212:215], v[76:79], a[44:47], a[212:215]
    s_waitcnt vmcnt(13)
    buffer_store_dword v60, v59, s[12:15], s26 offen sc1
    v_mfma_f32_16x16x32_bf16 a[208:211], v[76:79], a[40:43], a[208:211]
    s_waitcnt lgkmcnt(4)
    ds_read_b128 v[68:71], v12 offset:51200
    v_mov_b32 v60, 7
    v_mfma_f32_16x16x32_bf16 a[208:211], v[72:75], a[32:35], a[208:211]
    v_mul_f32 v34, v198, v56
    v_mul_f32 v35, v199, v56
    v_mfma_f32_16x16x32_bf16 a[216:219], v[80:83], a[32:35], a[216:219]
    s_waitcnt lgkmcnt(4)
    ds_read_b128 v[72:75], v12 offset:49408
    v_exp_f32 v34, v34
    v_mfma_f32_16x16x32_bf16 a[216:219], v[84:87], a[40:43], a[216:219]
    buffer_load_dwordx4 v14, s[12:15], s16 offen offset:2048 lds
    v_mfma_f32_16x16x32_bf16 a[220:223], v[84:87], a[44:47], a[220:223]
    s_waitcnt lgkmcnt(4)
    ds_read_b128 v[76:79], v12 offset:51456
    v_exp_f32 v35, v35
    v_mfma_f32_16x16x32_bf16 a[220:223], v[80:83], a[36:39], a[220:223]
    buffer_load_dwordx4 v[136:139], v9, s[12:15], s3 offen offset:64 sc1
    v_mfma_f32_16x16x32_bf16 a[228:231], v[88:91], a[36:39], a[228:231]
    s_waitcnt lgkmcnt(4)
    ds_read_b128 v[80:83], v12 offset:53248
    v_fma_f32 v34, v34, v57, v57
    v_mfma_f32_16x16x32_bf16 a[228:231], v[92:95], a[44:47], a[228:231]
    v_rcp_f32 v34, v34
    v_mfma_f32_16x16x32_bf16 a[224:227], v[92:95], a[40:43], a[224:227]
    s_waitcnt lgkmcnt(4)
    ds_read_b128 v[84:87], v12 offset:55296
    v_mul_f32 v34, v34, v198
    v_mfma_f32_16x16x32_bf16 a[224:227], v[88:91], a[32:35], a[224:227]
    buffer_load_dwordx4 v14, s[12:15], s16 offen offset:3072 lds
    v_mfma_f32_16x16x32_bf16 a[232:235], v[64:67], a[32:35], a[232:235]
    s_waitcnt lgkmcnt(4)
    ds_read_b128 v[88:91], v12 offset:53504
    s_add_u32 m0, s22, 16384
    v_mfma_f32_16x16x32_bf16 a[232:235], v[68:71], a[40:43], a[232:235]
    s_add_u32 s16, s16, 16384
    v_fma_f32 v35, v35, v57, v57
    v_mul_f32 v36, v204, v56
    v_mfma_f32_16x16x32_bf16 a[236:239], v[68:71], a[44:47], a[236:239]
    s_waitcnt lgkmcnt(4)
    ds_read_b128 v[92:95], v12 offset:55552
    v_mul_f32 v37, v205, v56
    v_mfma_f32_16x16x32_bf16 a[236:239], v[64:67], a[36:39], a[236:239]
    buffer_load_dwordx4 v14, s[12:15], s16 offen offset:0 lds
    v_mfma_f32_16x16x32_bf16 a[244:247], v[72:75], a[36:39], a[244:247]
    s_waitcnt lgkmcnt(4)
    ds_read_b128 v[64:67], v12 offset:57344
    v_mul_f32 v38, v206, v56
    v_mfma_f32_16x16x32_bf16 a[244:247], v[76:79], a[44:47], a[244:247]
    v_rcp_f32 v35, v35
    v_mfma_f32_16x16x32_bf16 a[240:243], v[76:79], a[40:43], a[240:243]
    s_waitcnt lgkmcnt(4)
    ds_read_b128 v[68:71], v12 offset:59392
    v_mul_f32 v35, v35, v199
    v_mfma_f32_16x16x32_bf16 a[240:243], v[72:75], a[32:35], a[240:243]
    buffer_load_dwordx4 v14, s[12:15], s16 offen offset:1024 lds
    v_mfma_f32_16x16x32_bf16 v[208:211], v[80:83], a[32:35], v[208:211]
    s_waitcnt lgkmcnt(4)
    ds_read_b128 v[72:75], v12 offset:57600
    v_mul_f32 v39, v207, v56
    v_mfma_f32_16x16x32_bf16 v[208:211], v[84:87], a[40:43], v[208:211]
    v_exp_f32 v36, v36
    v_mfma_f32_16x16x32_bf16 v[212:215], v[84:87], a[44:47], v[212:215]
    s_waitcnt lgkmcnt(4)
    ds_read_b128 v[76:79], v12 offset:59648
    v_fma_f32 v36, v36, v57, v57
    v_mfma_f32_16x16x32_bf16 v[212:215], v[80:83], a[36:39], v[212:215]
    buffer_load_dwordx4 v14, s[12:15], s16 offen offset:2048 lds
    v_mfma_f32_16x16x32_bf16 v[220:223], v[88:91], a[36:39], v[220:223]
    s_waitcnt lgkmcnt(4)
    ds_read_b128 v[80:83], v12 offset:61440
    v_cvt_pk_bf16_f32 v196, v32, v33
    v_mfma_f32_16x16x32_bf16 v[220:223], v[92:95], a[44:47], v[220:223]
    v_rcp_f32 v36, v36
    v_mfma_f32_16x16x32_bf16 v[216:219], v[92:95], a[40:43], v[216:219]
    s_waitcnt lgkmcnt(4)
    ds_read_b128 v[84:87], v12 offset:63488
    v_mul_f32 v36, v36, v204
    v_mfma_f32_16x16x32_bf16 v[216:219], v[88:91], a[32:35], v[216:219]
    buffer_load_dwordx4 v14, s[12:15], s16 offen offset:3072 lds
    v_mfma_f32_16x16x32_bf16 a[168:171], v[64:67], v[160:163], a[168:171]
    s_waitcnt lgkmcnt(4)
    ds_read_b128 v[88:91], v12 offset:61696
    v_cvt_pk_bf16_f32 v197, v34, v35
    v_mfma_f32_16x16x32_bf16 a[168:171], v[68:71], a[48:51], a[168:171]
    v_exp_f32 v37, v37
    v_mfma_f32_16x16x32_bf16 a[172:175], v[68:71], a[52:55], a[172:175]
    s_waitcnt lgkmcnt(4)
    ds_read_b128 v[92:95], v12 offset:63744
    v_fma_f32 v37, v37, v57, v57
    v_mfma_f32_16x16x32_bf16 a[172:175], v[64:67], v[164:167], a[172:175]
    s_barrier
    v_mfma_f32_16x16x32_bf16 a[180:183], v[72:75], v[164:167], a[180:183]
    s_waitcnt lgkmcnt(4)
    ds_read_b128 v[64:67], v13 offset:0
    v_mfma_f32_16x16x32_bf16 a[180:183], v[76:79], a[52:55], a[180:183]
    buffer_load_dword v62, v58, s[12:15], s26 offen sc1
    v_mfma_f32_16x16x32_bf16 a[176:179], v[76:79], a[48:51], a[176:179]
    s_waitcnt lgkmcnt(4)
    ds_read_b128 v[68:71], v13 offset:2048
    s_add_u32 m0, s22, 32768
    v_mfma_f32_16x16x32_bf16 a[176:179], v[72:75], v[160:163], a[176:179]
    s_add_u32 s16, s16, 16384
    v_rcp_f32 v37, v37
    v_mfma_f32_16x16x32_bf16 a[184:187], v[80:83], v[160:163], a[184:187]
    s_waitcnt lgkmcnt(4)
    ds_read_b128 v[72:75], v13 offset:256
    v_mul_f32 v37, v37, v205
    v_mfma_f32_16x16x32_bf16 a[184:187], v[84:87], a[48:51], a[184:187]
    buffer_load_dwordx4 v14, s[12:15], s16 offen offset:0 lds
    v_mfma_f32_16x16x32_bf16 a[188:191], v[84:87], a[52:55], a[188:191]
    s_waitcnt lgkmcnt(4)
    ds_read_b128 v[76:79], v13 offset:2304
    v_cvt_pk_bf16_f32 v198, v36, v37
    v_mfma_f32_16x16x32_bf16 a[188:191], v[80:83], v[164:167], a[188:191]
    v_exp_f32 v38, v38
    v_mfma_f32_16x16x32_bf16 a[196:199], v[88:91], v[164:167], a[196:199]
    s_waitcnt lgkmcnt(4)
    ds_read_b128 v[80:83], v13 offset:4096
    v_fma_f32 v38, v38, v57, v57
    v_mfma_f32_16x16x32_bf16 a[196:199], v[92:95], a[52:55], a[196:199]
    buffer_load_dwordx4 v14, s[12:15], s16 offen offset:1024 lds
    v_mfma_f32_16x16x32_bf16 a[192:195], v[92:95], a[48:51], a[192:195]
    s_waitcnt lgkmcnt(4)
    ds_read_b128 v[84:87], v13 offset:6144
    v_mfma_f32_16x16x32_bf16 a[192:195], v[88:91], v[160:163], a[192:195]
    v_rcp_f32 v38, v38
    v_mfma_f32_16x16x32_bf16 a[200:203], v[64:67], v[160:163], a[200:203]
    s_waitcnt lgkmcnt(4)
    ds_read_b128 v[88:91], v13 offset:4352
    v_mul_f32 v38, v38, v206
    v_mfma_f32_16x16x32_bf16 a[200:203], v[68:71], a[48:51], a[200:203]
    buffer_load_dwordx4 v14, s[12:15], s16 offen offset:2048 lds
    v_mfma_f32_16x16x32_bf16 a[204:207], v[68:71], a[52:55], a[204:207]
    s_waitcnt lgkmcnt(4)
    ds_read_b128 v[92:95], v13 offset:6400
    v_mfma_f32_16x16x32_bf16 a[204:207], v[64:67], v[164:167], a[204:207]
    v_exp_f32 v39, v39
    v_mfma_f32_16x16x32_bf16 a[212:215], v[72:75], v[164:167], a[212:215]
    s_waitcnt lgkmcnt(4)
    ds_read_b128 v[64:67], v13 offset:8192
    v_fma_f32 v39, v39, v57, v57
    v_mfma_f32_16x16x32_bf16 a[212:215], v[76:79], a[52:55], a[212:215]
    buffer_load_dwordx4 v14, s[12:15], s16 offen offset:3072 lds
    v_mfma_f32_16x16x32_bf16 a[208:211], v[76:79], a[48:51], a[208:211]
    s_waitcnt lgkmcnt(4)
    ds_read_b128 v[68:71], v13 offset:10240
    v_mfma_f32_16x16x32_bf16 a[208:211], v[72:75], v[160:163], a[208:211]
    v_rcp_f32 v39, v39
    v_mfma_f32_16x16x32_bf16 a[216:219], v[80:83], v[160:163], a[216:219]
    s_waitcnt lgkmcnt(4)
    ds_read_b128 v[72:75], v13 offset:8448
    v_mul_f32 v39, v39, v207
    v_mfma_f32_16x16x32_bf16 a[216:219], v[84:87], a[48:51], a[216:219]
    v_cvt_pk_bf16_f32 v199, v38, v39
    v_mfma_f32_16x16x32_bf16 a[220:223], v[84:87], a[52:55], a[220:223]
    s_waitcnt lgkmcnt(4)
    ds_read_b128 v[76:79], v13 offset:10496
    v_mfma_f32_16x16x32_bf16 a[220:223], v[80:83], v[164:167], a[220:223]
    buffer_store_dwordx4 v[196:199], v1, s[12:15], s27 offen offset:256 sc1
    v_mfma_f32_16x16x32_bf16 a[228:231], v[88:91], v[164:167], a[228:231]
    s_waitcnt lgkmcnt(4)
    ds_read_b128 v[80:83], v13 offset:12288
    v_mfma_f32_16x16x32_bf16 a[228:231], v[92:95], a[52:55], a[228:231]
    v_mfma_f32_16x16x32_bf16 a[224:227], v[92:95], a[48:51], a[224:227]
    s_waitcnt lgkmcnt(4)
    ds_read_b128 v[84:87], v13 offset:14336
    v_mfma_f32_16x16x32_bf16 a[224:227], v[88:91], v[160:163], a[224:227]
    v_mfma_f32_16x16x32_bf16 a[232:235], v[64:67], v[160:163], a[232:235]
    s_waitcnt lgkmcnt(4)
    ds_read_b128 v[88:91], v13 offset:12544
    v_mfma_f32_16x16x32_bf16 a[232:235], v[68:71], a[48:51], a[232:235]
    v_mfma_f32_16x16x32_bf16 a[236:239], v[68:71], a[52:55], a[236:239]
    s_waitcnt lgkmcnt(4)
    ds_read_b128 v[92:95], v13 offset:14592
    v_mfma_f32_16x16x32_bf16 a[236:239], v[64:67], v[164:167], a[236:239]
    s_barrier
    v_mfma_f32_16x16x32_bf16 a[244:247], v[72:75], v[164:167], a[244:247]
    s_waitcnt lgkmcnt(4)
    ds_read_b128 v[64:67], v13 offset:16384
    s_add_u32 m0, s22, 49152
    v_mfma_f32_16x16x32_bf16 a[244:247], v[76:79], a[52:55], a[244:247]
    s_add_u32 s16, s16, 16384
    v_mfma_f32_16x16x32_bf16 a[240:243], v[76:79], a[48:51], a[240:243]
    s_waitcnt lgkmcnt(4)
    ds_read_b128 v[68:71], v13 offset:18432
    v_mfma_f32_16x16x32_bf16 a[240:243], v[72:75], v[160:163], a[240:243]
    buffer_load_dwordx4 v14, s[12:15], s16 offen offset:0 lds
    v_mfma_f32_16x16x32_bf16 v[208:211], v[80:83], v[160:163], v[208:211]
    s_waitcnt lgkmcnt(4)
    ds_read_b128 v[72:75], v13 offset:16640
    v_mfma_f32_16x16x32_bf16 v[208:211], v[84:87], a[48:51], v[208:211]
    v_mfma_f32_16x16x32_bf16 v[212:215], v[84:87], a[52:55], v[212:215]
    s_waitcnt lgkmcnt(4)
    ds_read_b128 v[76:79], v13 offset:18688
    v_mfma_f32_16x16x32_bf16 v[212:215], v[80:83], v[164:167], v[212:215]
    buffer_load_dwordx4 v14, s[12:15], s16 offen offset:1024 lds
    v_mfma_f32_16x16x32_bf16 v[220:223], v[88:91], v[164:167], v[220:223]
    s_waitcnt lgkmcnt(4)
    ds_read_b128 v[80:83], v13 offset:20480
    v_mfma_f32_16x16x32_bf16 v[220:223], v[92:95], a[52:55], v[220:223]
    v_mfma_f32_16x16x32_bf16 v[216:219], v[92:95], a[48:51], v[216:219]
    s_waitcnt lgkmcnt(4)
    ds_read_b128 v[84:87], v13 offset:22528
    v_mfma_f32_16x16x32_bf16 v[216:219], v[88:91], v[160:163], v[216:219]
    buffer_load_dwordx4 v14, s[12:15], s16 offen offset:2048 lds
    v_mfma_f32_16x16x32_bf16 a[168:171], v[64:67], a[56:59], a[168:171]
    s_waitcnt lgkmcnt(4)
    ds_read_b128 v[88:91], v13 offset:20736
    v_mfma_f32_16x16x32_bf16 a[168:171], v[68:71], a[64:67], a[168:171]
    v_mfma_f32_16x16x32_bf16 a[172:175], v[68:71], a[68:71], a[172:175]
    s_waitcnt lgkmcnt(4)
    ds_read_b128 v[92:95], v13 offset:22784
    v_mfma_f32_16x16x32_bf16 a[172:175], v[64:67], a[60:63], a[172:175]
    buffer_load_dwordx4 v14, s[12:15], s16 offen offset:3072 lds
    v_mfma_f32_16x16x32_bf16 a[180:183], v[72:75], a[60:63], a[180:183]
    s_waitcnt lgkmcnt(4)
    ds_read_b128 v[64:67], v13 offset:24576
    v_mfma_f32_16x16x32_bf16 a[180:183], v[76:79], a[68:71], a[180:183]
    v_mfma_f32_16x16x32_bf16 a[176:179], v[76:79], a[64:67], a[176:179]
    s_waitcnt lgkmcnt(4)
    ds_read_b128 v[68:71], v13 offset:26624
    v_mfma_f32_16x16x32_bf16 a[176:179], v[72:75], a[56:59], a[176:179]
    v_mfma_f32_16x16x32_bf16 a[184:187], v[80:83], a[56:59], a[184:187]
    s_waitcnt lgkmcnt(4)
    ds_read_b128 v[72:75], v13 offset:24832
    v_mfma_f32_16x16x32_bf16 a[184:187], v[84:87], a[64:67], a[184:187]
    v_mfma_f32_16x16x32_bf16 a[188:191], v[84:87], a[68:71], a[188:191]
    s_waitcnt lgkmcnt(4)
    ds_read_b128 v[76:79], v13 offset:26880
    v_mfma_f32_16x16x32_bf16 a[188:191], v[80:83], a[60:63], a[188:191]
    v_mfma_f32_16x16x32_bf16 a[196:199], v[88:91], a[60:63], a[196:199]
    s_waitcnt lgkmcnt(4)
    ds_read_b128 v[80:83], v13 offset:28672
    v_mfma_f32_16x16x32_bf16 a[196:199], v[92:95], a[68:71], a[196:199]
    v_mfma_f32_16x16x32_bf16 a[192:195], v[92:95], a[64:67], a[192:195]
    s_waitcnt lgkmcnt(4)
    ds_read_b128 v[84:87], v13 offset:30720
    v_mfma_f32_16x16x32_bf16 a[192:195], v[88:91], a[56:59], a[192:195]
    v_mfma_f32_16x16x32_bf16 a[200:203], v[64:67], a[56:59], a[200:203]
    s_waitcnt lgkmcnt(4)
    ds_read_b128 v[88:91], v13 offset:28928
    v_mfma_f32_16x16x32_bf16 a[200:203], v[68:71], a[64:67], a[200:203]
    v_mfma_f32_16x16x32_bf16 a[204:207], v[68:71], a[68:71], a[204:207]
    s_waitcnt lgkmcnt(4)
    ds_read_b128 v[92:95], v13 offset:30976
    v_mfma_f32_16x16x32_bf16 a[204:207], v[64:67], a[60:63], a[204:207]
    s_barrier
    v_mfma_f32_16x16x32_bf16 a[212:215], v[72:75], a[60:63], a[212:215]
    s_waitcnt lgkmcnt(4)
    ds_read_b128 v[64:67], v13 offset:32768
    s_add_u32 m0, s22, 65536
    v_mfma_f32_16x16x32_bf16 a[212:215], v[76:79], a[68:71], a[212:215]
    s_waitcnt vmcnt(9)
    v_cmp_gt_u32 vcc, 6, v62
    v_mfma_f32_16x16x32_bf16 a[208:211], v[76:79], a[64:67], a[208:211]
    s_waitcnt lgkmcnt(4)
    ds_read_b128 v[68:71], v13 offset:34816
    s_add_u32 s16, s16, 16384
    v_mfma_f32_16x16x32_bf16 a[208:211], v[72:75], a[56:59], a[208:211]
    buffer_load_dwordx4 v14, s[12:15], s16 offen offset:0 lds
    v_mfma_f32_16x16x32_bf16 a[216:219], v[80:83], a[56:59], a[216:219]
    s_waitcnt lgkmcnt(4)
    ds_read_b128 v[72:75], v13 offset:33024
    s_cbranch_vccnz SLOW5_ffb_kernel
BACK5_ffb_kernel:
    v_mfma_f32_16x16x32_bf16 a[216:219], v[84:87], a[64:67], a[216:219]
    v_mfma_f32_16x16x32_bf16 a[220:223], v[84:87], a[68:71], a[220:223]
    s_waitcnt lgkmcnt(4)
    ds_read_b128 v[76:79], v13 offset:35072
    v_mfma_f32_16x16x32_bf16 a[220:223], v[80:83], a[60:63], a[220:223]
    buffer_load_dwordx4 v14, s[12:15], s16 offen offset:1024 lds
    v_mfma_f32_16x16x32_bf16 a[228:231], v[88:91], a[60:63], a[228:231]
    s_waitcnt lgkmcnt(4)
    ds_read_b128 v[80:83], v13 offset:36864
    s_add_u32 s28, s41, 10240
    v_mfma_f32_16x16x32_bf16 a[228:231], v[92:95], a[68:71], a[228:231]
    v_mfma_f32_16x16x32_bf16 a[224:227], v[92:95], a[64:67], a[224:227]
    s_waitcnt lgkmcnt(4)
    ds_read_b128 v[84:87], v13 offset:38912
    v_mfma_f32_16x16x32_bf16 a[224:227], v[88:91], a[56:59], a[224:227]
    buffer_load_dwordx4 a[120:123], v1, s[12:15], s28 offen offset:0 sc1
    v_mfma_f32_16x16x32_bf16 a[232:235], v[64:67], a[56:59], a[232:235]
    s_waitcnt lgkmcnt(4)
    ds_read_b128 v[88:91], v13 offset:37120
    v_mfma_f32_16x16x32_bf16 a[232:235], v[68:71], a[64:67], a[232:235]
    v_mfma_f32_16x16x32_bf16 a[236:239], v[68:71], a[68:71], a[236:239]
    s_waitcnt lgkmcnt(4)
    ds_read_b128 v[92:95], v13 offset:39168
    v_mfma_f32_16x16x32_bf16 a[236:239], v[64:67], a[60:63], a[236:239]
    buffer_load_dwordx4 a[124:127], v1, s[12:15], s28 offen offset:256 sc1
    v_mfma_f32_16x16x32_bf16 a[244:247], v[72:75], a[60:63], a[244:247]
    s_waitcnt lgkmcnt(4)
    ds_read_b128 v[64:67], v13 offset:40960
    s_add_u32 s28, s42, 10240
    v_mfma_f32_16x16x32_bf16 a[244:247], v[76:79], a[68:71], a[244:247]
    v_mfma_f32_16x16x32_bf16 a[240:243], v[76:79], a[64:67], a[240:243]
    s_waitcnt lgkmcnt(4)
    ds_read_b128 v[68:71], v13 offset:43008
    v_mfma_f32_16x16x32_bf16 a[240:243], v[72:75], a[56:59], a[240:243]
    buffer_load_dwordx4 a[128:131], v1, s[12:15], s28 offen offset:0 sc1
    v_mfma_f32_16x16x32_bf16 v[208:211], v[80:83], a[56:59], v[208:211]
    s_waitcnt lgkmcnt(4)
    ds_read_b128 v[72:75], v13 offset:41216
    v_mfma_f32_16x16x32_bf16 v[208:211], v[84:87], a[64:67], v[208:211]
    s_waitcnt vmcnt(9)
    buffer_store_dword v60, v59, s[12:15], s26 offen sc1
    v_mfma_f32_16x16x32_bf16 v[212:215], v[84:87], a[68:71], v[212:215]
    s_waitcnt lgkmcnt(4)
    ds_read_b128 v[76:79], v13 offset:43264
    v_mov_b32 v60, 8
    v_mfma_f32_16x16x32_bf16 v[212:215], v[80:83], a[60:63], v[212:215]
    v_mfma_f32_16x16x32_bf16 v[220:223], v[88:91], a[60:63], v[220:223]
    s_waitcnt lgkmcnt(4)
    ds_read_b128 v[80:83], v13 offset:45056
    v_mfma_f32_16x16x32_bf16 v[220:223], v[92:95], a[68:71], v[220:223]
    buffer_load_dwordx4 a[132:135], v1, s[12:15], s28 offen offset:256 sc1
    v_mfma_f32_16x16x32_bf16 v[216:219], v[92:95], a[64:67], v[216:219]
    s_waitcnt lgkmcnt(4)
    ds_read_b128 v[84:87], v13 offset:47104
    s_add_u32 s28, s43, 10240
    v_mfma_f32_16x16x32_bf16 v[216:219], v[88:91], a[56:59], v[216:219]
    v_mfma_f32_16x16x32_bf16 a[168:171], v[64:67], v[176:179], a[168:171]
    s_waitcnt lgkmcnt(4)
    ds_read_b128 v[88:91], v13 offset:45312
    v_mfma_f32_16x16x32_bf16 a[168:171], v[68:71], a[72:75], a[168:171]
    buffer_load_dwordx4 a[136:139], v1, s[12:15], s28 offen offset:0 sc1
    v_mfma_f32_16x16x32_bf16 a[172:175], v[68:71], a[76:79], a[172:175]
    s_waitcnt lgkmcnt(4)
    ds_read_b128 v[92:95], v13 offset:47360
    v_mfma_f32_16x16x32_bf16 a[172:175], v[64:67], v[180:183], a[172:175]
    s_barrier
    v_mfma_f32_16x16x32_bf16 a[180:183], v[72:75], v[180:183], a[180:183]
    s_waitcnt lgkmcnt(4)
    ds_read_b128 v[64:67], v13 offset:49152
    v_mfma_f32_16x16x32_bf16 a[180:183], v[76:79], a[76:79], a[180:183]
    buffer_load_dwordx4 a[140:143], v1, s[12:15], s28 offen offset:256 sc1
    v_mfma_f32_16x16x32_bf16 a[176:179], v[76:79], a[72:75], a[176:179]
    s_waitcnt lgkmcnt(4)
    ds_read_b128 v[68:71], v13 offset:51200
    v_mfma_f32_16x16x32_bf16 a[176:179], v[72:75], v[176:179], a[176:179]
    buffer_load_dwordx4 v[124:127], v10, s[12:15], s3 offen offset:0 sc1
    v_mfma_f32_16x16x32_bf16 a[184:187], v[80:83], v[176:179], a[184:187]
    s_waitcnt lgkmcnt(4)
    ds_read_b128 v[72:75], v13 offset:49408
    v_mfma_f32_16x16x32_bf16 a[184:187], v[84:87], a[72:75], a[184:187]
    v_mfma_f32_16x16x32_bf16 a[188:191], v[84:87], a[76:79], a[188:191]
    s_waitcnt lgkmcnt(4)
    ds_read_b128 v[76:79], v13 offset:51456
    v_mfma_f32_16x16x32_bf16 a[188:191], v[80:83], v[180:183], a[188:191]
    buffer_load_dwordx4 v14, s[12:15], s16 offen offset:2048 lds
    v_mfma_f32_16x16x32_bf16 a[196:199], v[88:91], v[180:183], a[196:199]
    s_waitcnt lgkmcnt(4)
    ds_read_b128 v[80:83], v13 offset:53248
    v_mfma_f32_16x16x32_bf16 a[196:199], v[92:95], a[76:79], a[196:199]
    v_mfma_f32_16x16x32_bf16 a[192:195], v[92:95], a[72:75], a[192:195]
    s_waitcnt lgkmcnt(4)
    ds_read_b128 v[84:87], v13 offset:55296
    v_mfma_f32_16x16x32_bf16 a[192:195], v[88:91], v[176:179], a[192:195]
    buffer_load_dwordx4 v14, s[12:15], s16 offen offset:3072 lds
    v_mfma_f32_16x16x32_bf16 a[200:203], v[64:67], v[176:179], a[200:203]
    s_waitcnt lgkmcnt(4)
    ds_read_b128 v[88:91], v13 offset:53504
    s_add_u32 m0, s22, 81920
    v_mfma_f32_16x16x32_bf16 a[200:203], v[68:71], a[72:75], a[200:203]
    s_add_u32 s16, s16, 16384
    v_mfma_f32_16x16x32_bf16 a[204:207], v[68:71], a[76:79], a[204:207]
    s_waitcnt lgkmcnt(4)
    ds_read_b128 v[92:95], v13 offset:55552
    v_mfma_f32_16x16x32_bf16 a[204:207], v[64:67], v[180:183], a[204:207]
    buffer_load_dwordx4 v14, s[12:15], s16 offen offset:0 lds
    v_mfma_f32_16x16x32_bf16 a[212:215], v[72:75], v[180:183], a[212:215]
    s_waitcnt lgkmcnt(4)
    ds_read_b128 v[64:67], v13 offset:57344
    v_mfma_f32_16x16x32_bf16 a[212:215], v[76:79], a[76:79], a[212:215]
    v_mfma_f32_16x16x32_bf16 a[208:211], v[76:79], a[72:75], a[208:211]
    s_waitcnt lgkmcnt(4)
    ds_read_b128 v[68:71], v13 offset:59392
    v_mfma_f32_16x16x32_bf16 a[208:211], v[72:75], v[176:179], a[208:211]
    buffer_load_dwordx4 v14, s[12:15], s16 offen offset:1024 lds
    v_mfma_f32_16x16x32_bf16 a[216:219], v[80:83], v[176:179], a[216:219]
    s_waitcnt lgkmcnt(4)
    ds_read_b128 v[72:75], v13 offset:57600
    v_mfma_f32_16x16x32_bf16 a[216:219], v[84:87], a[72:75], a[216:219]
    buffer_load_dword v61, v58, s[12:15], s26 offen sc1
    v_mfma_f32_16x16x32_bf16 a[220:223], v[84:87], a[76:79], a[220:223]
    s_waitcnt lgkmcnt(4)
    ds_read_b128 v[76:79], v13 offset:59648
    v_mfma_f32_16x16x32_bf16 a[220:223], v[80:83], v[180:183], a[220:223]
    v_mfma_f32_16x16x32_bf16 a[228:231], v[88:91], v[180:183], a[228:231]
    s_waitcnt lgkmcnt(4)
    ds_read_b128 v[80:83], v13 offset:61440
    v_mfma_f32_16x16x32_bf16 a[228:231], v[92:95], a[76:79], a[228:231]
    buffer_load_dwordx4 v14, s[12:15], s16 offen offset:2048 lds
    v_mfma_f32_16x16x32_bf16 a[224:227], v[92:95], a[72:75], a[224:227]
    s_waitcnt lgkmcnt(4)
    ds_read_b128 v[84:87], v13 offset:63488
    v_mfma_f32_16x16x32_bf16 a[224:227], v[88:91], v[176:179], a[224:227]
    v_mfma_f32_16x16x32_bf16 a[232:235], v[64:67], v[176:179], a[232:235]
    s_waitcnt lgkmcnt(4)
    ds_read_b128 v[88:91], v13 offset:61696
    v_mfma_f32_16x16x32_bf16 a[232:235], v[68:71], a[72:75], a[232:235]
    buffer_load_dwordx4 v14, s[12:15], s16 offen offset:3072 lds
    v_mfma_f32_16x16x32_bf16 a[236:239], v[68:71], a[76:79], a[236:239]
    s_waitcnt lgkmcnt(4)
    ds_read_b128 v[92:95], v13 offset:63744
    v_mfma_f32_16x16x32_bf16 a[236:239], v[64:67], v[180:183], a[236:239]
    s_barrier
    v_mfma_f32_16x16x32_bf16 a[244:247], v[72:75], v[180:183], a[244:247]
    s_waitcnt lgkmcnt(4)
    ds_read_b128 v[64:67], v12 offset:0
    s_add_u32 m0, s22, 98304
    v_mfma_f32_16x16x32_bf16 a[244:247], v[76:79], a[76:79], a[244:247]
    s_add_u32 s16, s16, 16384
    v_mfma_f32_16x16x32_bf16 a[240:243], v[76:79], a[72:75], a[240:243]
    s_waitcnt lgkmcnt(4)
    ds_read_b128 v[68:71], v12 offset:2048
    v_mfma_f32_16x16x32_bf16 a[240:243], v[72:75], v[176:179], a[240:243]
    buffer_load_dwordx4 v14, s[12:15], s16 offen offset:0 lds
    v_mfma_f32_16x16x32_bf16 v[208:211], v[80:83], v[176:179], v[208:211]
    s_waitcnt lgkmcnt(4)
    ds_read_b128 v[72:75], v12 offset:256
    v_mfma_f32_16x16x32_bf16 v[208:211], v[84:87], a[72:75], v[208:211]
    v_mfma_f32_16x16x32_bf16 v[212:215], v[84:87], a[76:79], v[212:215]
    s_waitcnt lgkmcnt(4)
    ds_read_b128 v[76:79], v12 offset:2304
    v_mfma_f32_16x16x32_bf16 v[212:215], v[80:83], v[180:183], v[212:215]
    buffer_load_dwordx4 v14, s[12:15], s16 offen offset:1024 lds
    v_mfma_f32_16x16x32_bf16 v[220:223], v[88:91], v[180:183], v[220:223]
    s_waitcnt lgkmcnt(4)
    ds_read_b128 v[80:83], v12 offset:4096
    v_mfma_f32_16x16x32_bf16 v[220:223], v[92:95], a[76:79], v[220:223]
    v_mfma_f32_16x16x32_bf16 v[216:219], v[92:95], a[72:75], v[216:219]
    s_waitcnt lgkmcnt(4)
    ds_read_b128 v[84:87], v12 offset:6144
    v_mfma_f32_16x16x32_bf16 v[216:219], v[88:91], v[176:179], v[216:219]
    buffer_load_dwordx4 v14, s[12:15], s16 offen offset:2048 lds
    v_mfma_f32_16x16x32_bf16 a[168:171], v[64:67], a[80:83], a[168:171]
    s_waitcnt lgkmcnt(4)
    ds_read_b128 v[88:91], v12 offset:4352
    v_mfma_f32_16x16x32_bf16 a[168:171], v[68:71], a[88:91], a[168:171]
    v_mfma_f32_16x16x32_bf16 a[172:175], v[68:71], a[92:95], a[172:175]
    s_waitcnt lgkmcnt(4)
    ds_read_b128 v[92:95], v12 offset:6400
    v_mfma_f32_16x16x32_bf16 a[172:175], v[64:67], a[84:87], a[172:175]
    buffer_load_dwordx4 v14, s[12:15], s16 offen offset:3072 lds
    v_mfma_f32_16x16x32_bf16 a[180:183], v[72:75], a[84:87], a[180:183]
    s_waitcnt lgkmcnt(4)
    ds_read_b128 v[64:67], v12 offset:8192
    v_mfma_f32_16x16x32_bf16 a[180:183], v[76:79], a[92:95], a[180:183]
    v_mfma_f32_16x16x32_bf16 a[176:179], v[76:79], a[88:91], a[176:179]
    s_waitcnt lgkmcnt(4)
    ds_read_b128 v[68:71], v12 offset:10240
    v_mfma_f32_16x16x32_bf16 a[176:179], v[72:75], a[80:83], a[176:179]
    v_mfma_f32_16x16x32_bf16 a[184:187], v[80:83], a[80:83], a[184:187]
    s_waitcnt lgkmcnt(4)
    ds_read_b128 v[72:75], v12 offset:8448
    v_mfma_f32_16x16x32_bf16 a[184:187], v[84:87], a[88:91], a[184:187]
    v_mfma_f32_16x16x32_bf16 a[188:191], v[84:87], a[92:95], a[188:191]
    s_waitcnt lgkmcnt(4)
    ds_read_b128 v[76:79], v12 offset:10496
    v_mfma_f32_16x16x32_bf16 a[188:191], v[80:83], a[84:87], a[188:191]
    v_mfma_f32_16x16x32_bf16 a[196:199], v[88:91], a[84:87], a[196:199]
    s_waitcnt lgkmcnt(4)
    ds_read_b128 v[80:83], v12 offset:12288
    v_mfma_f32_16x16x32_bf16 a[196:199], v[92:95], a[92:95], a[196:199]
    v_mfma_f32_16x16x32_bf16 a[192:195], v[92:95], a[88:91], a[192:195]
    s_waitcnt lgkmcnt(4)
    ds_read_b128 v[84:87], v12 offset:14336
    v_mfma_f32_16x16x32_bf16 a[192:195], v[88:91], a[80:83], a[192:195]
    v_mfma_f32_16x16x32_bf16 a[200:203], v[64:67], a[80:83], a[200:203]
    s_waitcnt lgkmcnt(4)
    ds_read_b128 v[88:91], v12 offset:12544
    v_mfma_f32_16x16x32_bf16 a[200:203], v[68:71], a[88:91], a[200:203]
    v_mfma_f32_16x16x32_bf16 a[204:207], v[68:71], a[92:95], a[204:207]
    s_waitcnt lgkmcnt(4)
    ds_read_b128 v[92:95], v12 offset:14592
    v_mfma_f32_16x16x32_bf16 a[204:207], v[64:67], a[84:87], a[204:207]
    s_barrier
    v_mfma_f32_16x16x32_bf16 a[212:215], v[72:75], a[84:87], a[212:215]
    s_waitcnt lgkmcnt(4)
    ds_read_b128 v[64:67], v12 offset:16384
    s_add_u32 m0, s22, 114688
    v_mfma_f32_16x16x32_bf16 a[212:215], v[76:79], a[92:95], a[212:215]
    s_add_u32 s16, s16, 16384
    v_mfma_f32_16x16x32_bf16 a[208:211], v[76:79], a[88:91], a[208:211]
    s_waitcnt lgkmcnt(4)
    ds_read_b128 v[68:71], v12 offset:18432
    v_mfma_f32_16x16x32_bf16 a[208:211], v[72:75], a[80:83], a[208:211]
    buffer_load_dwordx4 v14, s[12:15], s16 offen offset:0 lds
    v_mfma_f32_16x16x32_bf16 a[216:219], v[80:83], a[80:83], a[216:219]
    s_waitcnt lgkmcnt(4)
    ds_read_b128 v[72:75], v12 offset:16640
    v_mfma_f32_16x16x32_bf16 a[216:219], v[84:87], a[88:91], a[216:219]
    v_mfma_f32_16x16x32_bf16 a[220:223], v[84:87], a[92:95], a[220:223]
    s_waitcnt lgkmcnt(4)
    ds_read_b128 v[76:79], v12 offset:18688
    v_mfma_f32_16x16x32_bf16 a[220:223], v[80:83], a[84:87], a[220:223]
    buffer_load_dwordx4 v14, s[12:15], s16 offen offset:1024 lds
    v_mfma_f32_16x16x32_bf16 a[228:231], v[88:91], a[84:87], a[228:231]
    s_waitcnt lgkmcnt(4)
    ds_read_b128 v[80:83], v12 offset:20480
    v_mfma_f32_16x16x32_bf16 a[228:231], v[92:95], a[92:95], a[228:231]
    v_mfma_f32_16x16x32_bf16 a[224:227], v[92:95], a[88:91], a[224:227]
    s_waitcnt lgkmcnt(4)
    ds_read_b128 v[84:87], v12 offset:22528
    v_mfma_f32_16x16x32_bf16 a[224:227], v[88:91], a[80:83], a[224:227]
    buffer_load_dwordx4 v14, s[12:15], s16 offen offset:2048 lds
    v_mfma_f32_16x16x32_bf16 a[232:235], v[64:67], a[80:83], a[232:235]
    s_waitcnt lgkmcnt(4)
    ds_read_b128 v[88:91], v12 offset:20736
    v_mfma_f32_16x16x32_bf16 a[232:235], v[68:71], a[88:91], a[232:235]
    v_mfma_f32_16x16x32_bf16 a[236:239], v[68:71], a[92:95], a[236:239]
    s_waitcnt lgkmcnt(4)
    ds_read_b128 v[92:95], v12 offset:22784
    v_mfma_f32_16x16x32_bf16 a[236:239], v[64:67], a[84:87], a[236:239]
    buffer_load_dwordx4 v14, s[12:15], s16 offen offset:3072 lds
    v_mfma_f32_16x16x32_bf16 a[244:247], v[72:75], a[84:87], a[244:247]
    s_waitcnt lgkmcnt(4)
    ds_read_b128 v[64:67], v12 offset:24576
    v_mfma_f32_16x16x32_bf16 a[244:247], v[76:79], a[92:95], a[244:247]
    v_mfma_f32_16x16x32_bf16 a[240:243], v[76:79], a[88:91], a[240:243]
    s_waitcnt lgkmcnt(4)
    ds_read_b128 v[68:71], v12 offset:26624
    v_mfma_f32_16x16x32_bf16 a[240:243], v[72:75], a[80:83], a[240:243]
    v_mfma_f32_16x16x32_bf16 v[208:211], v[80:83], a[80:83], v[208:211]
    s_waitcnt lgkmcnt(4)
    ds_read_b128 v[72:75], v12 offset:24832
    v_mfma_f32_16x16x32_bf16 v[208:211], v[84:87], a[88:91], v[208:211]
    s_waitcnt vmcnt(10)
    v_cmp_gt_u32 vcc, 7, v61
    v_mfma_f32_16x16x32_bf16 v[212:215], v[84:87], a[92:95], v[212:215]
    s_waitcnt lgkmcnt(4)
    ds_read_b128 v[76:79], v12 offset:26880
    s_cbranch_vccnz SLOW6_ffb_kernel
BACK6_ffb_kernel:
    v_mfma_f32_16x16x32_bf16 v[212:215], v[80:83], a[84:87], v[212:215]
    s_add_u32 s28, s41, 12288
    v_mfma_f32_16x16x32_bf16 v[220:223], v[88:91], a[84:87], v[220:223]
    s_waitcnt lgkmcnt(4)
    ds_read_b128 v[80:83], v12 offset:28672
    v_mfma_f32_16x16x32_bf16 v[220:223], v[92:95], a[92:95], v[220:223]
    buffer_load_dwordx4 a[144:147], v1, s[12:15], s28 offen offset:0 sc1
    v_mfma_f32_16x16x32_bf16 v[216:219], v[92:95], a[88:91], v[216:219]
    s_waitcnt lgkmcnt(4)
    ds_read_b128 v[84:87], v12 offset:30720
    v_mfma_f32_16x16x32_bf16 v[216:219], v[88:91], a[80:83], v[216:219]
    v_mfma_f32_16x16x32_bf16 a[168:171], v[64:67], v[192:195], a[168:171]
    s_waitcnt lgkmcnt(4)
    ds_read_b128 v[88:91], v12 offset:28928
    v_mfma_f32_16x16x32_bf16 a[168:171], v[68:71], a[96:99], a[168:171]
    buffer_load_dwordx4 a[148:151], v1, s[12:15], s28 offen offset:256 sc1
    v_mfma_f32_16x16x32_bf16 a[172:175], v[68:71], a[100:103], a[172:175]
    s_waitcnt lgkmcnt(4)
    ds_read_b128 v[92:95], v12 offset:30976
    s_add_u32 s28, s42, 12288
    v_mfma_f32_16x16x32_bf16 a[172:175], v[64:67], v[196:199], a[172:175]
    s_barrier
    v_mfma_f32_16x16x32_bf16 a[180:183], v[72:75], v[196:199], a[180:183]
    s_waitcnt lgkmcnt(4)
    ds_read_b128 v[64:67], v12 offset:32768
    v_mfma_f32_16x16x32_bf16 a[180:183], v[76:79], a[100:103], a[180:183]
    buffer_load_dwordx4 a[152:155], v1, s[12:15], s28 offen offset:0 sc1
    v_mfma_f32_16x16x32_bf16 a[176:179], v[76:79], a[96:99], a[176:179]
    s_waitcnt lgkmcnt(4)
    ds_read_b128 v[68:71], v12 offset:34816
    v_mfma_f32_16x16x32_bf16 a[176:179], v[72:75], v[192:195], a[176:179]
    v_mfma_f32_16x16x32_bf16 a[184:187], v[80:83], v[192:195], a[184:187]
    s_waitcnt lgkmcnt(4)
    ds_read_b128 v[72:75], v12 offset:33024
    v_mfma_f32_16x16x32_bf16 a[184:187], v[84:87], a[96:99], a[184:187]
    buffer_load_dwordx4 a[156:159], v1, s[12:15], s28 offen offset:256 sc1
    v_mfma_f32_16x16x32_bf16 a[188:191], v[84:87], a[100:103], a[188:191]
    s_waitcnt lgkmcnt(4)
    ds_read_b128 v[76:79], v12 offset:35072
    s_add_u32 s28, s43, 12288
    v_mfma_f32_16x16x32_bf16 a[188:191], v[80:83], v[196:199], a[188:191]
    v_mfma_f32_16x16x32_bf16 a[196:199], v[88:91], v[196:199], a[196:199]
    s_waitcnt lgkmcnt(4)
    ds_read_b128 v[80:83], v12 offset:36864
    v_mfma_f32_16x16x32_bf16 a[196:199], v[92:95], a[100:103], a[196:199]
    buffer_load_dwordx4 a[160:163], v1, s[12:15], s28 offen offset:0 sc1
    v_mfma_f32_16x16x32_bf16 a[192:195], v[92:95], a[96:99], a[192:195]
    s_waitcnt lgkmcnt(4)
    ds_read_b128 v[84:87], v12 offset:38912
    v_mfma_f32_16x16x32_bf16 a[192:195], v[88:91], v[192:195], a[192:195]
    v_mfma_f32_16x16x32_bf16 a[200:203], v[64:67], v[192:195], a[200:203]
    s_waitcnt lgkmcnt(4)
    ds_read_b128 v[88:91], v12 offset:37120
    v_mfma_f32_16x16x32_bf16 a[200:203], v[68:71], a[96:99], a[200:203]
    buffer_load_dwordx4 a[164:167], v1, s[12:15], s28 offen offset:256 sc1
    v_mfma_f32_16x16x32_bf16 a[204:207], v[68:71], a[100:103], a[204:207]
    s_waitcnt lgkmcnt(4)
    ds_read_b128 v[92:95], v12 offset:39168
    s_add_u32 m0, s22, 0
    v_mfma_f32_16x16x32_bf16 a[204:207], v[64:67], v[196:199], a[204:207]
    s_add_u32 s16, s16, 16384
    v_mfma_f32_16x16x32_bf16 a[212:215], v[72:75], v[196:199], a[212:215]
    s_waitcnt lgkmcnt(4)
    ds_read_b128 v[64:67], v12 offset:40960
    v_mfma_f32_16x16x32_bf16 a[212:215], v[76:79], a[100:103], a[212:215]
    buffer_load_dwordx4 v14, s[12:15], s16 offen offset:0 lds
    v_mfma_f32_16x16x32_bf16 a[208:211], v[76:79], a[96:99], a[208:211]
    s_waitcnt lgkmcnt(4)
    ds_read_b128 v[68:71], v12 offset:43008
    v_mfma_f32_16x16x32_bf16 a[208:211], v[72:75], v[192:195], a[208:211]
    v_mfma_f32_16x16x32_bf16 a[216:219], v[80:83], v[192:195], a[216:219]
    s_waitcnt lgkmcnt(4)
    ds_read_b128 v[72:75], v12 offset:41216
    v_mfma_f32_16x16x32_bf16 a[216:219], v[84:87], a[96:99], a[216:219]
    buffer_load_dwordx4 v14, s[12:15], s16 offen offset:1024 lds
    v_mfma_f32_16x16x32_bf16 a[220:223], v[84:87], a[100:103], a[220:223]
    s_waitcnt lgkmcnt(4)
    ds_read_b128 v[76:79], v12 offset:43264
    v_mfma_f32_16x16x32_bf16 a[220:223], v[80:83], v[196:199], a[220:223]
    v_mfma_f32_16x16x32_bf16 a[228:231], v[88:91], v[196:199], a[228:231]
    s_waitcnt lgkmcnt(4)
    ds_read_b128 v[80:83], v12 offset:45056
    v_mfma_f32_16x16x32_bf16 a[228:231], v[92:95], a[100:103], a[228:231]
    buffer_load_dwordx4 v14, s[12:15], s16 offen offset:2048 lds
    v_mfma_f32_16x16x32_bf16 a[224:227], v[92:95], a[96:99], a[224:227]
    s_waitcnt lgkmcnt(4)
    ds_read_b128 v[84:87], v12 offset:47104
    v_mfma_f32_16x16x32_bf16 a[224:227], v[88:91], v[192:195], a[224:227]
    v_mfma_f32_16x16x32_bf16 a[232:235], v[64:67], v[192:195], a[232:235]
    s_waitcnt lgkmcnt(4)
    ds_read_b128 v[88:91], v12 offset:45312
    v_mfma_f32_16x16x32_bf16 a[232:235], v[68:71], a[96:99], a[232:235]
    buffer_load_dwordx4 v14, s[12:15], s16 offen offset:3072 lds
    v_mfma_f32_16x16x32_bf16 a[236:239], v[68:71], a[100:103], a[236:239]
    s_waitcnt lgkmcnt(4)
    ds_read_b128 v[92:95], v12 offset:47360
    v_mfma_f32_16x16x32_bf16 a[236:239], v[64:67], v[196:199], a[236:239]
    s_barrier
    v_mfma_f32_16x16x32_bf16 a[244:247], v[72:75], v[196:199], a[244:247]
    s_waitcnt lgkmcnt(4)
    ds_read_b128 v[64:67], v12 offset:49152
    v_mfma_f32_16x16x32_bf16 a[244:247], v[76:79], a[100:103], a[244:247]
    buffer_load_dwordx4 v[140:143], v10, s[12:15], s3 offen offset:64 sc1
    v_mfma_f32_16x16x32_bf16 a[240:243], v[76:79], a[96:99], a[240:243]
    s_waitcnt lgkmcnt(4)
    ds_read_b128 v[68:71], v12 offset:51200
    s_add_u32 m0, s22, 16384
    v_mfma_f32_16x16x32_bf16 a[240:243], v[72:75], v[192:195], a[240:243]
    s_add_u32 s16, s16, 16384
    v_mfma_f32_16x16x32_bf16 v[208:211], v[80:83], v[192:195], v[208:211]
    s_waitcnt lgkmcnt(4)
    ds_read_b128 v[72:75], v12 offset:49408
    v_mfma_f32_16x16x32_bf16 v[208:211], v[84:87], a[96:99], v[208:211]
    buffer_load_dwordx4 v14, s[12:15], s16 offen offset:0 lds
    v_mfma_f32_16x16x32_bf16 v[212:215], v[84:87], a[100:103], v[212:215]
    s_waitcnt lgkmcnt(4)
    ds_read_b128 v[76:79], v12 offset:51456
    v_mfma_f32_16x16x32_bf16 v[212:215], v[80:83], v[196:199], v[212:215]
    v_mfma_f32_16x16x32_bf16 v[220:223], v[88:91], v[196:199], v[220:223]
    s_waitcnt lgkmcnt(4)
    ds_read_b128 v[80:83], v12 offset:53504
    v_mfma_f32_16x16x32_bf16 v[220:223], v[92:95], a[100:103], v[220:223]
    buffer_load_dwordx4 v14, s[12:15], s16 offen offset:1024 lds
    v_mfma_f32_16x16x32_bf16 v[216:219], v[92:95], a[96:99], v[216:219]
    s_waitcnt lgkmcnt(4)
    ds_read_b128 v[84:87], v12 offset:55552
    v_mfma_f32_16x16x32_bf16 v[216:219], v[88:91], v[192:195], v[216:219]
    v_mfma_f32_16x16x32_bf16 a[168:171], v[64:67], a[104:107], a[168:171]
    s_waitcnt lgkmcnt(4)
    ds_read_b128 v[88:91], v12 offset:53248
    v_mfma_f32_16x16x32_bf16 a[168:171], v[68:71], a[112:115], a[168:171]
    buffer_load_dwordx4 v14, s[12:15], s16 offen offset:2048 lds
    v_mfma_f32_16x16x32_bf16 a[172:175], v[68:71], a[116:119], a[172:175]
    s_waitcnt lgkmcnt(4)
    ds_read_b128 v[92:95], v12 offset:55296
    v_mfma_f32_16x16x32_bf16 a[172:175], v[64:67], a[108:111], a[172:175]
    v_mfma_f32_16x16x32_bf16 a[180:183], v[72:75], a[108:111], a[180:183]
    s_waitcnt lgkmcnt(4)
    ds_read_b128 v[64:67], v12 offset:57344
    v_mfma_f32_16x16x32_bf16 a[180:183], v[76:79], a[116:119], a[180:183]
    buffer_load_dwordx4 v14, s[12:15], s16 offen offset:3072 lds
    v_mfma_f32_16x16x32_bf16 a[176:179], v[76:79], a[112:115], a[176:179]
    s_waitcnt lgkmcnt(4)
    ds_read_b128 v[68:71], v12 offset:59392
    v_mfma_f32_16x16x32_bf16 a[176:179], v[72:75], a[104:107], a[176:179]
    v_mfma_f32_16x16x32_bf16 a[176:179], v[80:83], a[120:123], a[176:179]
    s_waitcnt lgkmcnt(4)
    ds_read_b128 v[72:75], v12 offset:57600
    v_mfma_f32_16x16x32_bf16 a[176:179], v[84:87], a[128:131], a[176:179]
    v_mfma_f32_16x16x32_bf16 a[180:183], v[84:87], a[132:135], a[180:183]
    s_waitcnt lgkmcnt(4)
    ds_read_b128 v[76:79], v12 offset:59648
    v_mfma_f32_16x16x32_bf16 a[180:183], v[80:83], a[124:127], a[180:183]
    v_mfma_f32_16x16x32_bf16 a[172:175], v[88:91], a[124:127], a[172:175]
    s_waitcnt lgkmcnt(4)
    ds_read_b128 v[80:83], v12 offset:61696
    v_mfma_f32_16x16x32_bf16 a[172:175], v[92:95], a[132:135], a[172:175]
    v_mfma_f32_16x16x32_bf16 a[168:171], v[92:95], a[128:131], a[168:171]
    s_waitcnt lgkmcnt(4)
    ds_read_b128 v[84:87], v12 offset:63744
    v_mfma_f32_16x16x32_bf16 a[168:171], v[88:91], a[120:123], a[168:171]
    v_mfma_f32_16x16x32_bf16 a[168:171], v[64:67], a[136:139], a[168:171]
    s_waitcnt vmcnt(14) lgkmcnt(4)
    ds_read_b128 v[88:91], v12 offset:61440
    v_mfma_f32_16x16x32_bf16 a[168:171], v[68:71], a[144:147], a[168:171]
    s_waitcnt vmcnt(13)
    v_mfma_f32_16x16x32_bf16 a[172:175], v[68:71], a[148:151], a[172:175]
    s_waitcnt lgkmcnt(4)
    ds_read_b128 v[92:95], v12 offset:63488
    v_mfma_f32_16x16x32_bf16 a[172:175], v[64:67], a[140:143], a[172:175]
    s_barrier
    v_mfma_f32_16x16x32_bf16 a[180:183], v[72:75], a[140:143], a[180:183]
    s_waitcnt lgkmcnt(4)
    ds_read_b128 v[64:67], v13 offset:0
    s_add_u32 m0, s22, 32768
    v_mfma_f32_16x16x32_bf16 a[180:183], v[76:79], a[148:151], a[180:183]
    s_add_u32 s16, s16, 16384
    v_mfma_f32_16x16x32_bf16 a[176:179], v[76:79], a[144:147], a[176:179]
    s_waitcnt lgkmcnt(4)
    ds_read_b128 v[68:71], v13 offset:2048
    v_mfma_f32_16x16x32_bf16 a[176:179], v[72:75], a[136:139], a[176:179]
    s_waitcnt vmcnt(12)
    buffer_load_dwordx4 v14, s[12:15], s16 offen offset:0 lds
    v_mfma_f32_16x16x32_bf16 a[176:179], v[80:83], a[152:155], a[176:179]
    s_waitcnt vmcnt(11) lgkmcnt(4)
    ds_read_b128 v[72:75], v13 offset:256
    v_mfma_f32_16x16x32_bf16 a[176:179], v[84:87], a[160:163], a[176:179]
    s_waitcnt vmcnt(10)
    v_mfma_f32_16x16x32_bf16 a[180:183], v[84:87], a[164:167], a[180:183]
    s_waitcnt lgkmcnt(4)
    ds_read_b128 v[76:79], v13 offset:2304
    v_mfma_f32_16x16x32_bf16 a[180:183], v[80:83], a[156:159], a[180:183]
    buffer_load_dwordx4 v14, s[12:15], s16 offen offset:1024 lds
    v_mfma_f32_16x16x32_bf16 a[172:175], v[88:91], a[156:159], a[172:175]
    s_waitcnt lgkmcnt(4)
    ds_read_b128 v[80:83], v13 offset:4352
    v_mfma_f32_16x16x32_bf16 a[172:175], v[92:95], a[164:167], a[172:175]
    v_mfma_f32_16x16x32_bf16 a[168:171], v[92:95], a[160:163], a[168:171]
    s_waitcnt lgkmcnt(4)
    ds_read_b128 v[84:87], v13 offset:6400
    v_mfma_f32_16x16x32_bf16 a[168:171], v[88:91], a[152:155], a[168:171]
    buffer_load_dwordx4 v14, s[12:15], s16 offen offset:2048 lds
    v_mfma_f32_16x16x32_bf16 a[184:187], v[64:67], a[104:107], a[184:187]
    s_waitcnt lgkmcnt(4)
    ds_read_b128 v[88:91], v13 offset:4096
    v_mfma_f32_16x16x32_bf16 a[184:187], v[68:71], a[112:115], a[184:187]
    v_mfma_f32_16x16x32_bf16 a[188:191], v[68:71], a[116:119], a[188:191]
    s_waitcnt lgkmcnt(4)
    ds_read_b128 v[92:95], v13 offset:6144
    v_mfma_f32_16x16x32_bf16 a[188:191], v[64:67], a[108:111], a[188:191]
    buffer_load_dwordx4 v14, s[12:15], s16 offen offset:3072 lds
    v_mfma_f32_16x16x32_bf16 a[196:199], v[72:75], a[108:111], a[196:199]
    s_waitcnt lgkmcnt(4)
    ds_read_b128 v[64:67], v13 offset:8192
    v_mfma_f32_16x16x32_bf16 a[196:199], v[76:79], a[116:119], a[196:199]
    v_mfma_f32_16x16x32_bf16 a[192:195], v[76:79], a[112:115], a[192:195]
    s_waitcnt lgkmcnt(4)
    ds_read_b128 v[68:71], v13 offset:10240
    v_mfma_f32_16x16x32_bf16 a[192:195], v[72:75], a[104:107], a[192:195]
    v_accvgpr_read_b32 v24, a168
    v_accvgpr_read_b32 v25, a169
    v_mfma_f32_16x16x32_bf16 a[192:195], v[80:83], a[120:123], a[192:195]
    s_waitcnt lgkmcnt(4)
    ds_read_b128 v[72:75], v13 offset:8448
    v_accvgpr_read_b32 v26, a170
    v_mfma_f32_16x16x32_bf16 a[192:195], v[84:87], a[128:131], a[192:195]
    v_accvgpr_read_b32 v27, a171
    v_accvgpr_read_b32 v28, a176
    v_mfma_f32_16x16x32_bf16 a[196:199], v[84:87], a[132:135], a[196:199]
    s_waitcnt lgkmcnt(4)
    ds_read_b128 v[76:79], v13 offset:10496
    v_accvgpr_read_b32 v29, a177
    v_mfma_f32_16x16x32_bf16 a[196:199], v[80:83], a[124:127], a[196:199]
    v_accvgpr_read_b32 v30, a178
    v_accvgpr_read_b32 v31, a179
    v_mfma_f32_16x16x32_bf16 a[188:191], v[88:91], a[124:127], a[188:191]
    s_waitcnt lgkmcnt(4)
    ds_read_b128 v[80:83], v13 offset:12544
    v_cvt_pk_bf16_f32 v40, v24, v25
    v_mfma_f32_16x16x32_bf16 a[188:191], v[92:95], a[132:135], a[188:191]
    v_cvt_pk_bf16_f32 v41, v26, v27
    v_cvt_pk_bf16_f32 v42, v28, v29
    v_mfma_f32_16x16x32_bf16 a[184:187], v[92:95], a[128:131], a[184:187]
    s_waitcnt lgkmcnt(4)
    ds_read_b128 v[84:87], v13 offset:14592
    v_cvt_pk_bf16_f32 v43, v30, v31
    v_mfma_f32_16x16x32_bf16 a[184:187], v[88:91], a[120:123], a[184:187]
    buffer_store_dwordx4 v[40:43], v4, s[12:15], s24 offen offset:0 sc1
    v_mfma_f32_16x16x32_bf16 a[184:187], v[64:67], a[136:139], a[184:187]
    s_waitcnt lgkmcnt(4)
    ds_read_b128 v[88:91], v13 offset:12288
    s_nop 0
    v_mfma_f32_16x16x32_bf16 a[184:187], v[68:71], a[144:147], a[184:187]
    v_accvgpr_read_b32 v32, a172
    v_accvgpr_read_b32 v33, a173
    v_mfma_f32_16x16x32_bf16 a[188:191], v[68:71], a[148:151], a[188:191]
    s_waitcnt lgkmcnt(4)
    ds_read_b128 v[92:95], v13 offset:14336
    v_accvgpr_read_b32 v34, a174
    v_mfma_f32_16x16x32_bf16 a[188:191], v[64:67], a[140:143], a[188:191]
    s_barrier
    v_mfma_f32_16x16x32_bf16 a[196:199], v[72:75], a[140:143], a[196:199]
    s_waitcnt lgkmcnt(4)
    ds_read_b128 v[64:67], v13 offset:16384
    s_add_u32 m0, s22, 49152
    v_mfma_f32_16x16x32_bf16 a[196:199], v[76:79], a[148:151], a[196:199]
    s_add_u32 s16, s16, 16384
    v_accvgpr_read_b32 v35, a175
    v_accvgpr_read_b32 v36, a180
    v_mfma_f32_16x16x32_bf16 a[192:195], v[76:79], a[144:147], a[192:195]
    s_waitcnt lgkmcnt(4)
    ds_read_b128 v[68:71], v13 offset:18432
    v_accvgpr_read_b32 v37, a181
    v_mfma_f32_16x16x32_bf16 a[192:195], v[72:75], a[136:139], a[192:195]
    buffer_load_dwordx4 v14, s[12:15], s16 offen offset:0 lds
    v_mfma_f32_16x16x32_bf16 a[192:195], v[80:83], a[152:155], a[192:195]
    s_waitcnt lgkmcnt(4)
    ds_read_b128 v[72:75], v13 offset:16640
    v_accvgpr_read_b32 v38, a182
    v_mfma_f32_16x16x32_bf16 a[192:195], v[84:87], a[160:163], a[192:195]
    v_accvgpr_read_b32 v39, a183
    v_cvt_pk_bf16_f32 v44, v32, v33
    v_mfma_f32_16x16x32_bf16 a[196:199], v[84:87], a[164:167], a[196:199]
    s_waitcnt lgkmcnt(4)
    ds_read_b128 v[76:79], v13 offset:18688
    v_cvt_pk_bf16_f32 v45, v34, v35
    v_mfma_f32_16x16x32_bf16 a[196:199], v[80:83], a[156:159], a[196:199]
    buffer_load_dwordx4 v14, s[12:15], s16 offen offset:1024 lds
    v_mfma_f32_16x16x32_bf16 a[188:191], v[88:91], a[156:159], a[188:191]
    s_waitcnt lgkmcnt(4)
    ds_read_b128 v[80:83], v13 offset:20736
    v_cvt_pk_bf16_f32 v46, v36, v37
    v_mfma_f32_16x16x32_bf16 a[188:191], v[92:95], a[164:167], a[188:191]
    v_cvt_pk_bf16_f32 v47, v38, v39
    v_mfma_f32_16x16x32_bf16 a[184:187], v[92:95], a[160:163], a[184:187]
    s_waitcnt lgkmcnt(4)
    ds_read_b128 v[84:87], v13 offset:22784
    v_mfma_f32_16x16x32_bf16 a[184:187], v[88:91], a[152:155], a[184:187]
    buffer_store_dwordx4 v[44:47], v4, s[12:15], s24 offen offset:1024 sc1
    v_mfma_f32_16x16x32_bf16 a[200:203], v[64:67], a[104:107], a[200:203]
    s_waitcnt lgkmcnt(4)
    ds_read_b128 v[88:91], v13 offset:20480
    s_nop 0
    v_mfma_f32_16x16x32_bf16 a[200:203], v[68:71], a[112:115], a[200:203]
    v_mfma_f32_16x16x32_bf16 a[204:207], v[68:71], a[116:119], a[204:207]
    s_waitcnt lgkmcnt(4)
    ds_read_b128 v[92:95], v13 offset:22528
    v_mfma_f32_16x16x32_bf16 a[204:207], v[64:67], a[108:111], a[204:207]
    buffer_load_dwordx4 v14, s[12:15], s16 offen offset:2048 lds
    v_mfma_f32_16x16x32_bf16 a[212:215], v[72:75], a[108:111], a[212:215]
    s_waitcnt lgkmcnt(4)
    ds_read_b128 v[64:67], v13 offset:24576
    v_mfma_f32_16x16x32_bf16 a[212:215], v[76:79], a[116:119], a[212:215]
    v_mfma_f32_16x16x32_bf16 a[208:211], v[76:79], a[112:115], a[208:211]
    s_waitcnt lgkmcnt(4)
    ds_read_b128 v[68:71], v13 offset:26624
    v_mfma_f32_16x16x32_bf16 a[208:211], v[72:75], a[104:107], a[208:211]
    buffer_load_dwordx4 v14, s[12:15], s16 offen offset:3072 lds
    v_mfma_f32_16x16x32_bf16 a[208:211], v[80:83], a[120:123], a[208:211]
    s_waitcnt lgkmcnt(4)
    ds_read_b128 v[72:75], v13 offset:24832
    v_accvgpr_read_b32 v24, a184
    v_mfma_f32_16x16x32_bf16 a[208:211], v[84:87], a[128:131], a[208:211]
    v_accvgpr_read_b32 v25, a185
    v_accvgpr_read_b32 v26, a186
    v_mfma_f32_16x16x32_bf16 a[212:215], v[84:87], a[132:135], a[212:215]
    s_waitcnt lgkmcnt(4)
    ds_read_b128 v[76:79], v13 offset:26880
    v_accvgpr_read_b32 v27, a187
    v_mfma_f32_16x16x32_bf16 a[212:215], v[80:83], a[124:127], a[212:215]
    v_accvgpr_read_b32 v28, a192
    v_accvgpr_read_b32 v29, a193
    v_mfma_f32_16x16x32_bf16 a[204:207], v[88:91], a[124:127], a[204:207]
    s_waitcnt lgkmcnt(4)
    ds_read_b128 v[80:83], v13 offset:28928
    v_accvgpr_read_b32 v30, a194
    v_mfma_f32_16x16x32_bf16 a[204:207], v[92:95], a[132:135], a[204:207]
    v_accvgpr_read_b32 v31, a195
    v_cvt_pk_bf16_f32 v48, v24, v25
    v_mfma_f32_16x16x32_bf16 a[200:203], v[92:95], a[128:131], a[200:203]
    s_waitcnt lgkmcnt(4)
    ds_read_b128 v[84:87], v13 offset:30976
    v_cvt_pk_bf16_f32 v49, v26, v27
    v_mfma_f32_16x16x32_bf16 a[200:203], v[88:91], a[120:123], a[200:203]
    v_cvt_pk_bf16_f32 v50, v28, v29
    v_cvt_pk_bf16_f32 v51, v30, v31
    v_mfma_f32_16x16x32_bf16 a[200:203], v[64:67], a[136:139], a[200:203]
    s_waitcnt lgkmcnt(4)
    ds_read_b128 v[88:91], v13 offset:28672
    v_accvgpr_read_b32 v32, a188
    v_mfma_f32_16x16x32_bf16 a[200:203], v[68:71], a[144:147], a[200:203]
    buffer_store_dwordx4 v[48:51], v4, s[12:15], s24 offen offset:2048 sc1
    v_mfma_f32_16x16x32_bf16 a[204:207], v[68:71], a[148:151], a[204:207]
    s_waitcnt lgkmcnt(4)
    ds_read_b128 v[92:95], v13 offset:30720
    s_nop 0
    v_mfma_f32_16x16x32_bf16 a[204:207], v[64:67], a[140:143], a[204:207]
    s_barrier
    v_mfma_f32_16x16x32_bf16 a[212:215], v[72:75], a[140:143], a[212:215]
    s_waitcnt lgkmcnt(4)
    ds_read_b128 v[64:67], v13 offset:32768
    s_add_u32 m0, s22, 65536
    v_mfma_f32_16x16x32_bf16 a[212:215], v[76:79], a[148:151], a[212:215]
    s_add_u32 s16, s16, 16384
    v_accvgpr_read_b32 v33, a189
    v_accvgpr_read_b32 v34, a190
    v_mfma_f32_16x16x32_bf16 a[208:211], v[76:79], a[144:147], a[208:211]
    s_waitcnt lgkmcnt(4)
    ds_read_b128 v[68:71], v13 offset:34816
    v_accvgpr_read_b32 v35, a191
    v_mfma_f32_16x16x32_bf16 a[208:211], v[72:75], a[136:139], a[208:211]
    buffer_load_dwordx4 v14, s[12:15], s16 offen offset:0 lds
    v_mfma_f32_16x16x32_bf16 a[208:211], v[80:83], a[152:155], a[208:211]
    s_waitcnt lgkmcnt(4)
    ds_read_b128 v[72:75], v13 offset:33024
    v_accvgpr_read_b32 v36, a196
    v_mfma_f32_16x16x32_bf16 a[208:211], v[84:87], a[160:163], a[208:211]
    v_accvgpr_read_b32 v37, a197
    v_accvgpr_read_b32 v38, a198
    v_mfma_f32_16x16x32_bf16 a[212:215], v[84:87], a[164:167], a[212:215]
    s_waitcnt lgkmcnt(4)
    ds_read_b128 v[76:79], v13 offset:35072
    v_accvgpr_read_b32 v39, a199
    v_mfma_f32_16x16x32_bf16 a[212:215], v[80:83], a[156:159], a[212:215]
    buffer_load_dwordx4 v14, s[12:15], s16 offen offset:1024 lds
    v_mfma_f32_16x16x32_bf16 a[204:207], v[88:91], a[156:159], a[204:207]
    s_waitcnt lgkmcnt(4)
    ds_read_b128 v[80:83], v13 offset:37120
    v_cvt_pk_bf16_f32 v52, v32, v33
    v_mfma_f32_16x16x32_bf16 a[204:207], v[92:95], a[164:167], a[204:207]
    v_cvt_pk_bf16_f32 v53, v34, v35
    v_cvt_pk_bf16_f32 v54, v36, v37
    v_mfma_f32_16x16x32_bf16 a[200:203], v[92:95], a[160:163], a[200:203]
    s_waitcnt lgkmcnt(4)
    ds_read_b128 v[84:87], v13 offset:39168
    v_cvt_pk_bf16_f32 v55, v38, v39
    v_mfma_f32_16x16x32_bf16 a[200:203], v[88:91], a[152:155], a[200:203]
    buffer_store_dwordx4 v[52:55], v4, s[12:15], s24 offen offset:3072 sc1
    v_mfma_f32_16x16x32_bf16 a[216:219], v[64:67], a[104:107], a[216:219]
    s_waitcnt lgkmcnt(4)
    ds_read_b128 v[88:91], v13 offset:36864
    s_nop 0
    v_mfma_f32_16x16x32_bf16 a[216:219], v[68:71], a[112:115], a[216:219]
    v_mfma_f32_16x16x32_bf16 a[220:223], v[68:71], a[116:119], a[220:223]
    s_waitcnt lgkmcnt(4)
    ds_read_b128 v[92:95], v13 offset:38912
    v_mfma_f32_16x16x32_bf16 a[220:223], v[64:67], a[108:111], a[220:223]
    buffer_load_dwordx4 v14, s[12:15], s16 offen offset:2048 lds
    v_mfma_f32_16x16x32_bf16 a[228:231], v[72:75], a[108:111], a[228:231]
    s_waitcnt lgkmcnt(4)
    ds_read_b128 v[64:67], v13 offset:40960
    v_mfma_f32_16x16x32_bf16 a[228:231], v[76:79], a[116:119], a[228:231]
    v_mfma_f32_16x16x32_bf16 a[224:227], v[76:79], a[112:115], a[224:227]
    s_waitcnt lgkmcnt(4)
    ds_read_b128 v[68:71], v13 offset:43008
    v_mfma_f32_16x16x32_bf16 a[224:227], v[72:75], a[104:107], a[224:227]
    buffer_load_dwordx4 v14, s[12:15], s16 offen offset:3072 lds
    v_mfma_f32_16x16x32_bf16 a[224:227], v[80:83], a[120:123], a[224:227]
    s_waitcnt lgkmcnt(4)
    ds_read_b128 v[72:75], v13 offset:41216
    v_accvgpr_read_b32 v24, a200
    v_mfma_f32_16x16x32_bf16 a[224:227], v[84:87], a[128:131], a[224:227]
    v_accvgpr_read_b32 v25, a201
    v_accvgpr_read_b32 v26, a202
    v_mfma_f32_16x16x32_bf16 a[228:231], v[84:87], a[132:135], a[228:231]
    s_waitcnt lgkmcnt(4)
    ds_read_b128 v[76:79], v13 offset:43264
    v_accvgpr_read_b32 v27, a203
    v_mfma_f32_16x16x32_bf16 a[228:231], v[80:83], a[124:127], a[228:231]
    v_accvgpr_read_b32 v28, a208
    v_accvgpr_read_b32 v29, a209
    v_mfma_f32_16x16x32_bf16 a[220:223], v[88:91], a[124:127], a[220:223]
    s_waitcnt lgkmcnt(4)
    ds_read_b128 v[80:83], v13 offset:45312
    v_accvgpr_read_b32 v30, a210
    v_mfma_f32_16x16x32_bf16 a[220:223], v[92:95], a[132:135], a[220:223]
    v_accvgpr_read_b32 v31, a211
    v_cvt_pk_bf16_f32 v40, v24, v25
    v_mfma_f32_16x16x32_bf16 a[216:219], v[92:95], a[128:131], a[216:219]
    s_waitcnt lgkmcnt(4)
    ds_read_b128 v[84:87], v13 offset:47360
    v_cvt_pk_bf16_f32 v41, v26, v27
    v_mfma_f32_16x16x32_bf16 a[216:219], v[88:91], a[120:123], a[216:219]
    v_cvt_pk_bf16_f32 v42, v28, v29
    v_cvt_pk_bf16_f32 v43, v30, v31
    v_mfma_f32_16x16x32_bf16 a[216:219], v[64:67], a[136:139], a[216:219]
    s_waitcnt lgkmcnt(4)
    ds_read_b128 v[88:91], v13 offset:45056
    v_accvgpr_read_b32 v32, a204
    v_mfma_f32_16x16x32_bf16 a[216:219], v[68:71], a[144:147], a[216:219]
    buffer_store_dwordx4 v[40:43], v4, s[12:15], s29 offen offset:0 sc1
    v_mfma_f32_16x16x32_bf16 a[220:223], v[68:71], a[148:151], a[220:223]
    s_waitcnt lgkmcnt(4)
    ds_read_b128 v[92:95], v13 offset:47104
    s_nop 0
    v_mfma_f32_16x16x32_bf16 a[220:223], v[64:67], a[140:143], a[220:223]
    s_barrier
    v_mfma_f32_16x16x32_bf16 a[228:231], v[72:75], a[140:143], a[228:231]
    s_waitcnt lgkmcnt(4)
    ds_read_b128 v[64:67], v13 offset:49152
    s_add_u32 m0, s22, 81920
    v_mfma_f32_16x16x32_bf16 a[228:231], v[76:79], a[148:151], a[228:231]
    s_add_u32 s16, s16, 16384
    v_accvgpr_read_b32 v33, a205
    v_accvgpr_read_b32 v34, a206
    v_mfma_f32_16x16x32_bf16 a[224:227], v[76:79], a[144:147], a[224:227]
    s_waitcnt lgkmcnt(4)
    ds_read_b128 v[68:71], v13 offset:51200
    v_accvgpr_read_b32 v35, a207
    v_mfma_f32_16x16x32_bf16 a[224:227], v[72:75], a[136:139], a[224:227]
    buffer_load_dwordx4 v14, s[12:15], s16 offen offset:0 lds
    v_mfma_f32_16x16x32_bf16 a[224:227], v[80:83], a[152:155], a[224:227]
    s_waitcnt lgkmcnt(4)
    ds_read_b128 v[72:75], v13 offset:49408
    v_accvgpr_read_b32 v36, a212
    v_mfma_f32_16x16x32_bf16 a[224:227], v[84:87], a[160:163], a[224:227]
    v_accvgpr_read_b32 v37, a213
    v_accvgpr_read_b32 v38, a214
    v_mfma_f32_16x16x32_bf16 a[228:231], v[84:87], a[164:167], a[228:231]
    s_waitcnt lgkmcnt(4)
    ds_read_b128 v[76:79], v13 offset:51456
    v_accvgpr_read_b32 v39, a215
    v_mfma_f32_16x16x32_bf16 a[228:231], v[80:83], a[156:159], a[228:231]
    buffer_load_dwordx4 v14, s[12:15], s16 offen offset:1024 lds
    v_mfma_f32_16x16x32_bf16 a[220:223], v[88:91], a[156:159], a[220:223]
    s_waitcnt lgkmcnt(4)
    ds_read_b128 v[80:83], v13 offset:53504
    v_cvt_pk_bf16_f32 v44, v32, v33
    v_mfma_f32_16x16x32_bf16 a[220:223], v[92:95], a[164:167], a[220:223]
    v_cvt_pk_bf16_f32 v45, v34, v35
    v_cvt_pk_bf16_f32 v46, v36, v37
    v_mfma_f32_16x16x32_bf16 a[216:219], v[92:95], a[160:163], a[216:219]
    s_waitcnt lgkmcnt(4)
    ds_read_b128 v[84:87], v13 offset:55552
    v_cvt_pk_bf16_f32 v47, v38, v39
    v_mfma_f32_16x16x32_bf16 a[216:219], v[88:91], a[152:155], a[216:219]
    buffer_store_dwordx4 v[44:47], v4, s[12:15], s29 offen offset:1024 sc1
    v_mfma_f32_16x16x32_bf16 a[232:235], v[64:67], a[104:107], a[232:235]
    s_waitcnt lgkmcnt(4)
    ds_read_b128 v[88:91], v13 offset:53248
    s_nop 0
    v_mfma_f32_16x16x32_bf16 a[232:235], v[68:71], a[112:115], a[232:235]
    v_mfma_f32_16x16x32_bf16 a[236:239], v[68:71], a[116:119], a[236:239]
    s_waitcnt lgkmcnt(4)
    ds_read_b128 v[92:95], v13 offset:55296
    v_mfma_f32_16x16x32_bf16 a[236:239], v[64:67], a[108:111], a[236:239]
    buffer_load_dwordx4 v14, s[12:15], s16 offen offset:2048 lds
    v_mfma_f32_16x16x32_bf16 a[244:247], v[72:75], a[108:111], a[244:247]
    s_waitcnt lgkmcnt(4)
    ds_read_b128 v[64:67], v13 offset:57344
    v_mfma_f32_16x16x32_bf16 a[244:247], v[76:79], a[116:119], a[244:247]
    v_mfma_f32_16x16x32_bf16 a[240:243], v[76:79], a[112:115], a[240:243]
    s_waitcnt lgkmcnt(4)
    ds_read_b128 v[68:71], v13 offset:59392
    v_mfma_f32_16x16x32_bf16 a[240:243], v[72:75], a[104:107], a[240:243]
    buffer_load_dwordx4 v14, s[12:15], s16 offen offset:3072 lds
    v_mfma_f32_16x16x32_bf16 a[240:243], v[80:83], a[120:123], a[240:243]
    s_waitcnt lgkmcnt(4)
    ds_read_b128 v[72:75], v13 offset:57600
    v_accvgpr_read_b32 v24, a216
    v_mfma_f32_16x16x32_bf16 a[240:243], v[84:87], a[128:131], a[240:243]
    v_accvgpr_read_b32 v25, a217
    v_accvgpr_read_b32 v26, a218
    v_mfma_f32_16x16x32_bf16 a[244:247], v[84:87], a[132:135], a[244:247]
    s_waitcnt lgkmcnt(4)
    ds_read_b128 v[76:79], v13 offset:59648
    v_accvgpr_read_b32 v27, a219
    v_mfma_f32_16x16x32_bf16 a[244:247], v[80:83], a[124:127], a[244:247]
    v_accvgpr_read_b32 v28, a224
    v_accvgpr_read_b32 v29, a225
    v_mfma_f32_16x16x32_bf16 a[236:239], v[88:91], a[124:127], a[236:239]
    s_waitcnt lgkmcnt(4)
    ds_read_b128 v[80:83], v13 offset:61696
    v_accvgpr_read_b32 v30, a226
    v_mfma_f32_16x16x32_bf16 a[236:239], v[92:95], a[132:135], a[236:239]
    v_accvgpr_read_b32 v31, a227
    v_cvt_pk_bf16_f32 v48, v24, v25
    v_mfma_f32_16x16x32_bf16 a[232:235], v[92:95], a[128:131], a[232:235]
    s_waitcnt lgkmcnt(4)
    ds_read_b128 v[84:87], v13 offset:63744
    v_cvt_pk_bf16_f32 v49, v26, v27
    v_mfma_f32_16x16x32_bf16 a[232:235], v[88:91], a[120:123], a[232:235]
    v_cvt_pk_bf16_f32 v50, v28, v29
    v_cvt_pk_bf16_f32 v51, v30, v31
    v_mfma_f32_16x16x32_bf16 a[232:235], v[64:67], a[136:139], a[232:235]
    s_waitcnt lgkmcnt(4)
    ds_read_b128 v[88:91], v13 offset:61440
    v_accvgpr_read_b32 v32, a220
    v_mfma_f32_16x16x32_bf16 a[232:235], v[68:71], a[144:147], a[232:235]
    buffer_store_dwordx4 v[48:51], v4, s[12:15], s29 offen offset:2048 sc1
    v_mfma_f32_16x16x32_bf16 a[236:239], v[68:71], a[148:151], a[236:239]
    s_waitcnt lgkmcnt(4)
    ds_read_b128 v[92:95], v13 offset:63488
    s_nop 0
    v_mfma_f32_16x16x32_bf16 a[236:239], v[64:67], a[140:143], a[236:239]
    s_waitcnt vmcnt(28)
    s_barrier
    v_mfma_f32_16x16x32_bf16 a[244:247], v[72:75], a[140:143], a[244:247]
    s_waitcnt lgkmcnt(4)
    ds_read_b128 v[64:67], v12 offset:0
    s_add_u32 m0, s22, 98304
    v_mfma_f32_16x16x32_bf16 a[244:247], v[76:79], a[148:151], a[244:247]
    s_add_u32 s16, s16, 16384
    v_accvgpr_read_b32 v33, a221
    v_accvgpr_read_b32 v34, a222
    v_mfma_f32_16x16x32_bf16 a[240:243], v[76:79], a[144:147], a[240:243]
    s_waitcnt lgkmcnt(4)
    ds_read_b128 v[68:71], v12 offset:2048
    v_accvgpr_read_b32 v35, a223
    v_mfma_f32_16x16x32_bf16 a[240:243], v[72:75], a[136:139], a[240:243]
    buffer_load_dwordx4 v14, s[12:15], s16 offen offset:0 lds
    v_mfma_f32_16x16x32_bf16 a[240:243], v[80:83], a[152:155], a[240:243]
    s_waitcnt lgkmcnt(4)
    ds_read_b128 v[72:75], v12 offset:256
    v_accvgpr_read_b32 v36, a228
    v_mfma_f32_16x16x32_bf16 a[240:243], v[84:87], a[160:163], a[240:243]
    s_waitcnt vmcnt(10)
    buffer_store_dword v60, v59, s[12:15], s26 offen sc1
    v_mfma_f32_16x16x32_bf16 a[244:247], v[84:87], a[164:167], a[244:247]
    s_waitcnt lgkmcnt(4)
    ds_read_b128 v[76:79], v12 offset:2304
    v_mov_b32 v60, 9
    v_mfma_f32_16x16x32_bf16 a[244:247], v[80:83], a[156:159], a[244:247]
    v_accvgpr_read_b32 v37, a229
    v_accvgpr_read_b32 v38, a230
    v_mfma_f32_16x16x32_bf16 a[236:239], v[88:91], a[156:159], a[236:239]
    s_waitcnt lgkmcnt(4)
    ds_read_b128 v[80:83], v12 offset:4352
    v_accvgpr_read_b32 v39, a231
    v_mfma_f32_16x16x32_bf16 a[236:239], v[92:95], a[164:167], a[236:239]
    buffer_load_dwordx4 v14, s[12:15], s16 offen offset:1024 lds
    v_mfma_f32_16x16x32_bf16 a[232:235], v[92:95], a[160:163], a[232:235]
    s_waitcnt lgkmcnt(4)
    ds_read_b128 v[84:87], v12 offset:6400
    v_cvt_pk_bf16_f32 v52, v32, v33
    v_mfma_f32_16x16x32_bf16 a[232:235], v[88:91], a[152:155], a[232:235]
    v_cvt_pk_bf16_f32 v53, v34, v35
    v_cvt_pk_bf16_f32 v54, v36, v37
    v_mfma_f32_16x16x32_bf16 v[208:211], v[64:67], a[104:107], v[208:211]
    s_waitcnt lgkmcnt(4)
    ds_read_b128 v[88:91], v12 offset:4096
    v_cvt_pk_bf16_f32 v55, v38, v39
    v_mfma_f32_16x16x32_bf16 v[208:211], v[68:71], a[112:115], v[208:211]
    buffer_store_dwordx4 v[52:55], v4, s[12:15], s29 offen offset:3072 sc1
    v_mfma_f32_16x16x32_bf16 v[212:215], v[68:71], a[116:119], v[212:215]
    s_waitcnt lgkmcnt(4)
    ds_read_b128 v[92:95], v12 offset:6144
    s_nop 0
    v_mfma_f32_16x16x32_bf16 v[212:215], v[64:67], a[108:111], v[212:215]
    v_mfma_f32_16x16x32_bf16 v[220:223], v[72:75], a[108:111], v[220:223]
    s_waitcnt lgkmcnt(4)
    ds_read_b128 v[64:67], v12 offset:8192
    v_mfma_f32_16x16x32_bf16 v[220:223], v[76:79], a[116:119], v[220:223]
    buffer_load_dwordx4 v14, s[12:15], s16 offen offset:2048 lds
    v_mfma_f32_16x16x32_bf16 v[216:219], v[76:79], a[112:115], v[216:219]
    s_waitcnt lgkmcnt(4)
    ds_read_b128 v[68:71], v12 offset:10240
    v_mfma_f32_16x16x32_bf16 v[216:219], v[72:75], a[104:107], v[216:219]
    v_accvgpr_read_b32 v24, a232
    v_accvgpr_read_b32 v25, a233
    v_mfma_f32_16x16x32_bf16 v[216:219], v[80:83], a[120:123], v[216:219]
    s_waitcnt lgkmcnt(4)
    ds_read_b128 v[72:75], v12 offset:8448
    v_accvgpr_read_b32 v26, a234
    v_mfma_f32_16x16x32_bf16 v[216:219], v[84:87], a[128:131], v[216:219]
    buffer_load_dwordx4 v14, s[12:15], s16 offen offset:3072 lds
    v_mfma_f32_16x16x32_bf16 v[220:223], v[84:87], a[132:135], v[220:223]
    s_waitcnt lgkmcnt(4)
    ds_read_b128 v[76:79], v12 offset:10496
    v_accvgpr_read_b32 v27, a235
    v_mfma_f32_16x16x32_bf16 v[220:223], v[80:83], a[124:127], v[220:223]
    v_accvgpr_read_b32 v28, a240
    v_accvgpr_read_b32 v29, a241
    v_mfma_f32_16x16x32_bf16 v[212:215], v[88:91], a[124:127], v[212:215]
    s_waitcnt lgkmcnt(4)
    ds_read_b128 v[80:83], v12 offset:12544
    v_accvgpr_read_b32 v30, a242
    v_mfma_f32_16x16x32_bf16 v[212:215], v[92:95], a[132:135], v[212:215]
    v_accvgpr_read_b32 v31, a243
    v_cvt_pk_bf16_f32 v40, v24, v25
    v_mfma_f32_16x16x32_bf16 v[208:211], v[92:95], a[128:131], v[208:211]
    s_waitcnt lgkmcnt(4)
    ds_read_b128 v[84:87], v12 offset:14592
    v_cvt_pk_bf16_f32 v41, v26, v27
    v_mfma_f32_16x16x32_bf16 v[208:211], v[88:91], a[120:123], v[208:211]
    v_cvt_pk_bf16_f32 v42, v28, v29
    v_cvt_pk_bf16_f32 v43, v30, v31
    v_mfma_f32_16x16x32_bf16 v[208:211], v[64:67], a[136:139], v[208:211]
    s_waitcnt lgkmcnt(4)
    ds_read_b128 v[88:91], v12 offset:12288
    v_accvgpr_read_b32 v32, a236
    v_mfma_f32_16x16x32_bf16 v[208:211], v[68:71], a[144:147], v[208:211]
    buffer_store_dwordx4 v[40:43], v4, s[12:15], s44 offen offset:0 sc1
    v_mfma_f32_16x16x32_bf16 v[212:215], v[68:71], a[148:151], v[212:215]
    s_waitcnt lgkmcnt(4)
    ds_read_b128 v[92:95], v12 offset:14336
    s_nop 0
    v_mfma_f32_16x16x32_bf16 v[212:215], v[64:67], a[140:143], v[212:215]
    s_barrier
    v_mfma_f32_16x16x32_bf16 v[220:223], v[72:75], a[140:143], v[220:223]
    s_waitcnt lgkmcnt(4)
    ds_read_b128 v[64:67], v12 offset:16384
    s_add_u32 m0, s22, 114688
    v_mfma_f32_16x16x32_bf16 v[220:223], v[76:79], a[148:151], v[220:223]
    s_add_u32 s16, s16, 16384
    v_accvgpr_read_b32 v33, a237
    v_accvgpr_read_b32 v34, a238
    v_mfma_f32_16x16x32_bf16 v[216:219], v[76:79], a[144:147], v[216:219]
    s_waitcnt lgkmcnt(4)
    ds_read_b128 v[68:71], v12 offset:18432
    v_accvgpr_read_b32 v35, a239
    v_mfma_f32_16x16x32_bf16 v[216:219], v[72:75], a[136:139], v[216:219]
    buffer_load_dwordx4 v14, s[12:15], s16 offen offset:0 lds
    v_mfma_f32_16x16x32_bf16 v[216:219], v[80:83], a[152:155], v[216:219]
    s_waitcnt lgkmcnt(4)
    ds_read_b128 v[72:75], v12 offset:16640
    v_accvgpr_read_b32 v36, a244
    v_mfma_f32_16x16x32_bf16 v[216:219], v[84:87], a[160:163], v[216:219]
    v_accvgpr_read_b32 v37, a245
    v_accvgpr_read_b32 v38, a246
    v_mfma_f32_16x16x32_bf16 v[220:223], v[84:87], a[164:167], v[220:223]
    s_waitcnt lgkmcnt(4)
    ds_read_b128 v[76:79], v12 offset:18688
    v_accvgpr_read_b32 v39, a247
    v_mfma_f32_16x16x32_bf16 v[220:223], v[80:83], a[156:159], v[220:223]
    buffer_load_dwordx4 v14, s[12:15], s16 offen offset:1024 lds
    v_mfma_f32_16x16x32_bf16 v[212:215], v[88:91], a[156:159], v[212:215]
    s_waitcnt lgkmcnt(4)
    ds_read_b128 v[80:83], v12 offset:20736
    v_cvt_pk_bf16_f32 v44, v32, v33
    v_mfma_f32_16x16x32_bf16 v[212:215], v[92:95], a[164:167], v[212:215]
    v_cvt_pk_bf16_f32 v45, v34, v35
    v_cvt_pk_bf16_f32 v46, v36, v37
    v_mfma_f32_16x16x32_bf16 v[208:211], v[92:95], a[160:163], v[208:211]
    s_waitcnt lgkmcnt(4)
    ds_read_b128 v[84:87], v12 offset:22784
    v_cvt_pk_bf16_f32 v47, v38, v39
    v_mfma_f32_16x16x32_bf16 v[208:211], v[88:91], a[152:155], v[208:211]
    buffer_store_dwordx4 v[44:47], v4, s[12:15], s44 offen offset:1024 sc1
    v_mfma_f32_16x16x32_bf16 v[240:243], v[18:21], v[136:139], 0
    v_mfma_f32_16x16x32_bf16 v[244:247], v[18:21], v[140:143], 0
    v_mfma_f32_16x16x32_bf16 v[248:251], v[16:19], v[136:139], 0
    v_mfma_f32_16x16x32_bf16 v[252:255], v[16:19], v[140:143], 0
    v_mfma_f32_16x16x32_bf16 v[224:227], v[18:21], v[120:123], 0
    v_mfma_f32_16x16x32_bf16 v[228:231], v[18:21], v[124:127], 0
    v_mfma_f32_16x16x32_bf16 v[232:235], v[16:19], v[120:123], 0
    v_mfma_f32_16x16x32_bf16 v[236:239], v[16:19], v[124:127], 0
    v_mfma_f32_16x16x32_bf16 v[224:227], v[64:67], v[96:99], v[224:227]
    s_waitcnt lgkmcnt(4)
    ds_read_b128 v[88:91], v12 offset:20480
    s_nop 0
    v_mfma_f32_16x16x32_bf16 v[224:227], v[68:71], v[112:115], v[224:227]
    buffer_load_dwordx4 v14, s[12:15], s16 offen offset:2048 lds
    v_mfma_f32_16x16x32_bf16 v[228:231], v[68:71], v[116:119], v[228:231]
    s_waitcnt lgkmcnt(4)
    ds_read_b128 v[92:95], v12 offset:22528
    v_cvt_pk_bf16_f32 v48, v208, v209
    v_mfma_f32_16x16x32_bf16 v[228:231], v[64:67], v[100:103], v[228:231]
    v_cvt_pk_bf16_f32 v49, v210, v211
    v_cvt_pk_bf16_f32 v50, v216, v217
    v_mfma_f32_16x16x32_bf16 v[236:239], v[72:75], v[100:103], v[236:239]
    s_waitcnt lgkmcnt(4)
    ds_read_b128 v[64:67], v12 offset:24576
    v_cvt_pk_bf16_f32 v51, v218, v219
    v_mfma_f32_16x16x32_bf16 v[236:239], v[76:79], v[116:119], v[236:239]
    buffer_store_dwordx4 v[48:51], v4, s[12:15], s44 offen offset:2048 sc1
    v_mfma_f32_16x16x32_bf16 v[232:235], v[76:79], v[112:115], v[232:235]
    s_waitcnt lgkmcnt(4)
    ds_read_b128 v[68:71], v12 offset:26624
    s_nop 0
    v_mfma_f32_16x16x32_bf16 v[232:235], v[72:75], v[96:99], v[232:235]
    v_cvt_pk_bf16_f32 v52, v212, v213
    v_cvt_pk_bf16_f32 v53, v214, v215
    v_mfma_f32_16x16x32_bf16 v[232:235], v[80:83], v[128:131], v[232:235]
    s_waitcnt lgkmcnt(4)
    ds_read_b128 v[72:75], v12 offset:24832
    v_cvt_pk_bf16_f32 v54, v220, v221
    v_mfma_f32_16x16x32_bf16 v[232:235], v[84:87], a[0:3], v[232:235]
    buffer_load_dwordx4 v14, s[12:15], s16 offen offset:3072 lds
    v_mfma_f32_16x16x32_bf16 v[236:239], v[84:87], a[4:7], v[236:239]
    s_waitcnt lgkmcnt(4)
    ds_read_b128 v[76:79], v12 offset:26880
    v_cvt_pk_bf16_f32 v55, v222, v223
    v_mfma_f32_16x16x32_bf16 v[236:239], v[80:83], v[132:135], v[236:239]
    buffer_store_dwordx4 v[52:55], v4, s[12:15], s44 offen offset:3072 sc1
    v_mfma_f32_16x16x32_bf16 v[228:231], v[88:91], v[132:135], v[228:231]
    s_waitcnt lgkmcnt(4)
    ds_read_b128 v[80:83], v12 offset:28928
    s_nop 0
    v_mfma_f32_16x16x32_bf16 v[228:231], v[92:95], a[4:7], v[228:231]
    buffer_load_dword v110, off, s[12:15], s17 sc1
    v_mfma_f32_16x16x32_bf16 v[224:227], v[92:95], a[0:3], v[224:227]
    s_waitcnt lgkmcnt(4)
    ds_read_b128 v[84:87], v12 offset:30976
    v_mfma_f32_16x16x32_bf16 v[224:227], v[88:91], v[128:131], v[224:227]
    v_mfma_f32_16x16x32_bf16 v[224:227], v[64:67], a[8:11], v[224:227]
    s_waitcnt lgkmcnt(4)
    ds_read_b128 v[88:91], v12 offset:28672
    v_mfma_f32_16x16x32_bf16 v[224:227], v[68:71], a[16:19], v[224:227]
    s_waitcnt vmcnt(11)
    buffer_store_dword v60, v59, s[12:15], s26 offen sc1
    v_mfma_f32_16x16x32_bf16 v[228:231], v[68:71], a[20:23], v[228:231]
    s_waitcnt lgkmcnt(4)
    ds_read_b128 v[92:95], v12 offset:30720
    v_mov_b32 v60, 10
    v_mfma_f32_16x16x32_bf16 v[228:231], v[64:67], a[12:15], v[228:231]
    s_barrier
    v_mfma_f32_16x16x32_bf16 v[236:239], v[72:75], a[12:15], v[236:239]
    s_waitcnt lgkmcnt(4)
    ds_read_b128 v[64:67], v12 offset:32768
    v_mfma_f32_16x16x32_bf16 v[236:239], v[76:79], a[20:23], v[236:239]
    v_mfma_f32_16x16x32_bf16 v[232:235], v[76:79], a[16:19], v[232:235]
    s_waitcnt lgkmcnt(4)
    ds_read_b128 v[68:71], v12 offset:34816
    v_mfma_f32_16x16x32_bf16 v[232:235], v[72:75], a[8:11], v[232:235]
    v_mfma_f32_16x16x32_bf16 v[232:235], v[80:83], v[144:147], v[232:235]
    s_waitcnt lgkmcnt(4)
    ds_read_b128 v[72:75], v12 offset:33024
    v_mfma_f32_16x16x32_bf16 v[232:235], v[84:87], a[24:27], v[232:235]
    v_mfma_f32_16x16x32_bf16 v[236:239], v[84:87], a[28:31], v[236:239]
    s_waitcnt lgkmcnt(4)
    ds_read_b128 v[76:79], v12 offset:35072
    v_mfma_f32_16x16x32_bf16 v[236:239], v[80:83], v[148:151], v[236:239]
    v_mfma_f32_16x16x32_bf16 v[228:231], v[88:91], v[148:151], v[228:231]
    s_waitcnt lgkmcnt(4)
    ds_read_b128 v[80:83], v12 offset:37120
    v_mfma_f32_16x16x32_bf16 v[228:231], v[92:95], a[28:31], v[228:231]
    v_mfma_f32_16x16x32_bf16 v[224:227], v[92:95], a[24:27], v[224:227]
    s_waitcnt lgkmcnt(4)
    ds_read_b128 v[84:87], v12 offset:39168
    v_mfma_f32_16x16x32_bf16 v[224:227], v[88:91], v[144:147], v[224:227]
    v_mfma_f32_16x16x32_bf16 v[224:227], v[64:67], a[32:35], v[224:227]
    s_waitcnt lgkmcnt(4)
    ds_read_b128 v[88:91], v12 offset:36864
    v_mfma_f32_16x16x32_bf16 v[224:227], v[68:71], a[40:43], v[224:227]
    v_mfma_f32_16x16x32_bf16 v[228:231], v[68:71], a[44:47], v[228:231]
    s_waitcnt lgkmcnt(4)
    ds_read_b128 v[92:95], v12 offset:38912
    v_mfma_f32_16x16x32_bf16 v[228:231], v[64:67], a[36:39], v[228:231]
    v_mfma_f32_16x16x32_bf16 v[236:239], v[72:75], a[36:39], v[236:239]
    s_waitcnt lgkmcnt(4)
    ds_read_b128 v[64:67], v12 offset:40960
    v_mfma_f32_16x16x32_bf16 v[236:239], v[76:79], a[44:47], v[236:239]
    v_mfma_f32_16x16x32_bf16 v[232:235], v[76:79], a[40:43], v[232:235]
    s_waitcnt lgkmcnt(4)
    ds_read_b128 v[68:71], v12 offset:43008
    v_mfma_f32_16x16x32_bf16 v[232:235], v[72:75], a[32:35], v[232:235]
    v_mfma_f32_16x16x32_bf16 v[232:235], v[80:83], v[160:163], v[232:235]
    s_waitcnt lgkmcnt(4)
    ds_read_b128 v[72:75], v12 offset:41216
    v_mfma_f32_16x16x32_bf16 v[232:235], v[84:87], a[48:51], v[232:235]
    v_mfma_f32_16x16x32_bf16 v[236:239], v[84:87], a[52:55], v[236:239]
    s_waitcnt lgkmcnt(4)
    ds_read_b128 v[76:79], v12 offset:43264
    v_mfma_f32_16x16x32_bf16 v[236:239], v[80:83], v[164:167], v[236:239]
    v_mfma_f32_16x16x32_bf16 v[228:231], v[88:91], v[164:167], v[228:231]
    s_waitcnt lgkmcnt(4)
    ds_read_b128 v[80:83], v12 offset:45312
    v_mfma_f32_16x16x32_bf16 v[228:231], v[92:95], a[52:55], v[228:231]
    v_mfma_f32_16x16x32_bf16 v[224:227], v[92:95], a[48:51], v[224:227]
    s_waitcnt lgkmcnt(4)
    ds_read_b128 v[84:87], v12 offset:47360
    v_mfma_f32_16x16x32_bf16 v[224:227], v[88:91], v[160:163], v[224:227]
    v_mfma_f32_16x16x32_bf16 v[224:227], v[64:67], a[56:59], v[224:227]
    s_waitcnt lgkmcnt(4)
    ds_read_b128 v[88:91], v12 offset:45056
    v_mfma_f32_16x16x32_bf16 v[224:227], v[68:71], a[64:67], v[224:227]
    v_mfma_f32_16x16x32_bf16 v[228:231], v[68:71], a[68:71], v[228:231]
    s_waitcnt lgkmcnt(4)
    ds_read_b128 v[92:95], v12 offset:47104
    v_mfma_f32_16x16x32_bf16 v[228:231], v[64:67], a[60:63], v[228:231]
    s_barrier
    v_mfma_f32_16x16x32_bf16 v[236:239], v[72:75], a[60:63], v[236:239]
    s_waitcnt lgkmcnt(4)
    ds_read_b128 v[64:67], v12 offset:49152
    v_mfma_f32_16x16x32_bf16 v[236:239], v[76:79], a[68:71], v[236:239]
    v_mfma_f32_16x16x32_bf16 v[232:235], v[76:79], a[64:67], v[232:235]
    s_waitcnt lgkmcnt(4)
    ds_read_b128 v[68:71], v12 offset:51200
    v_mfma_f32_16x16x32_bf16 v[232:235], v[72:75], a[56:59], v[232:235]
    v_mfma_f32_16x16x32_bf16 v[232:235], v[80:83], v[176:179], v[232:235]
    s_waitcnt lgkmcnt(4)
    ds_read_b128 v[72:75], v12 offset:49408
    v_mfma_f32_16x16x32_bf16 v[232:235], v[84:87], a[72:75], v[232:235]
    v_mfma_f32_16x16x32_bf16 v[236:239], v[84:87], a[76:79], v[236:239]
    s_waitcnt lgkmcnt(4)
    ds_read_b128 v[76:79], v12 offset:51456
    v_mfma_f32_16x16x32_bf16 v[236:239], v[80:83], v[180:183], v[236:239]
    v_mfma_f32_16x16x32_bf16 v[228:231], v[88:91], v[180:183], v[228:231]
    s_waitcnt lgkmcnt(4)
    ds_read_b128 v[80:83], v12 offset:53504
    v_mfma_f32_16x16x32_bf16 v[228:231], v[92:95], a[76:79], v[228:231]
    v_mfma_f32_16x16x32_bf16 v[224:227], v[92:95], a[72:75], v[224:227]
    s_waitcnt lgkmcnt(4)
    ds_read_b128 v[84:87], v12 offset:55552
    v_mfma_f32_16x16x32_bf16 v[224:227], v[88:91], v[176:179], v[224:227]
    buffer_load_dword v111, off, s[12:15], s18 sc1
    v_mfma_f32_16x16x32_bf16 v[224:227], v[64:67], a[80:83], v[224:227]
    s_waitcnt lgkmcnt(4)
    ds_read_b128 v[88:91], v12 offset:53248
    v_mfma_f32_16x16x32_bf16 v[224:227], v[68:71], a[88:91], v[224:227]
    s_waitcnt vmcnt(2)
    v_cmp_gt_u32 vcc, 8, v110
    v_mfma_f32_16x16x32_bf16 v[228:231], v[68:71], a[92:95], v[228:231]
    s_waitcnt lgkmcnt(4)
    ds_read_b128 v[92:95], v12 offset:55296
    s_cmp_lg_u64 vcc, 0
    s_cselect_b32 s20, 0x40000000, 0
    v_mfma_f32_16x16x32_bf16 v[228:231], v[64:67], a[84:87], v[228:231]
    buffer_store_dword v60, v59, s[12:15], s26 offen sc1
    v_mfma_f32_16x16x32_bf16 v[236:239], v[72:75], a[84:87], v[236:239]
    s_waitcnt lgkmcnt(4)
    ds_read_b128 v[64:67], v12 offset:57344
    v_mov_b32 v60, 11
    v_mfma_f32_16x16x32_bf16 v[236:239], v[76:79], a[92:95], v[236:239]
    v_or_b32 v106, s20, v4
    v_mfma_f32_16x16x32_bf16 v[232:235], v[76:79], a[88:91], v[232:235]
    s_waitcnt lgkmcnt(4)
    ds_read_b128 v[68:71], v12 offset:59392
    s_nop 0
    v_mfma_f32_16x16x32_bf16 v[232:235], v[72:75], a[80:83], v[232:235]
    buffer_load_dwordx4 a[168:171], v106, s[12:15], s50 offen offset:0 sc1
    v_mfma_f32_16x16x32_bf16 v[232:235], v[80:83], v[192:195], v[232:235]
    s_waitcnt lgkmcnt(4)
    ds_read_b128 v[72:75], v12 offset:57600
    v_mfma_f32_16x16x32_bf16 v[232:235], v[84:87], a[96:99], v[232:235]
    buffer_load_dwordx4 a[172:175], v106, s[12:15], s50 offen offset:1024 sc1
    v_mfma_f32_16x16x32_bf16 v[236:239], v[84:87], a[100:103], v[236:239]
    s_waitcnt lgkmcnt(4)
    ds_read_b128 v[76:79], v12 offset:59648
    v_mfma_f32_16x16x32_bf16 v[236:239], v[80:83], v[196:199], v[236:239]
    buffer_load_dwordx4 a[176:179], v106, s[12:15], s50 offen offset:2048 sc1
    v_mfma_f32_16x16x32_bf16 v[228:231], v[88:91], v[196:199], v[228:231]
    s_waitcnt lgkmcnt(4)
    ds_read_b128 v[80:83], v12 offset:61696
    v_mfma_f32_16x16x32_bf16 v[228:231], v[92:95], a[100:103], v[228:231]
    buffer_load_dwordx4 a[180:183], v106, s[12:15], s50 offen offset:3072 sc1
    v_mfma_f32_16x16x32_bf16 v[224:227], v[92:95], a[96:99], v[224:227]
    s_waitcnt lgkmcnt(4)
    ds_read_b128 v[84:87], v12 offset:63744
    v_mfma_f32_16x16x32_bf16 v[224:227], v[88:91], v[192:195], v[224:227]
    v_mfma_f32_16x16x32_bf16 v[224:227], v[64:67], a[104:107], v[224:227]
    s_waitcnt lgkmcnt(4)
    ds_read_b128 v[88:91], v12 offset:61440
    v_mfma_f32_16x16x32_bf16 v[224:227], v[68:71], a[112:115], v[224:227]
    v_mfma_f32_16x16x32_bf16 v[228:231], v[68:71], a[116:119], v[228:231]
    s_waitcnt lgkmcnt(4)
    ds_read_b128 v[92:95], v12 offset:63488
    v_mfma_f32_16x16x32_bf16 v[228:231], v[64:67], a[108:111], v[228:231]
    s_barrier
    v_mfma_f32_16x16x32_bf16 v[236:239], v[72:75], a[108:111], v[236:239]
    s_waitcnt lgkmcnt(4)
    ds_read_b128 v[64:67], v13 offset:0
    v_mfma_f32_16x16x32_bf16 v[236:239], v[76:79], a[116:119], v[236:239]
    v_mfma_f32_16x16x32_bf16 v[232:235], v[76:79], a[112:115], v[232:235]
    s_waitcnt lgkmcnt(4)
    ds_read_b128 v[68:71], v13 offset:2048
    v_mfma_f32_16x16x32_bf16 v[232:235], v[72:75], a[104:107], v[232:235]
    v_mfma_f32_16x16x32_bf16 v[232:235], v[80:83], a[120:123], v[232:235]
    s_waitcnt lgkmcnt(4)
    ds_read_b128 v[72:75], v13 offset:256
    v_mfma_f32_16x16x32_bf16 v[232:235], v[84:87], a[128:131], v[232:235]
    v_mfma_f32_16x16x32_bf16 v[236:239], v[84:87], a[132:135], v[236:239]
    s_waitcnt lgkmcnt(4)
    ds_read_b128 v[76:79], v13 offset:2304
    v_mfma_f32_16x16x32_bf16 v[236:239], v[80:83], a[124:127], v[236:239]
    v_mfma_f32_16x16x32_bf16 v[228:231], v[88:91], a[124:127], v[228:231]
    s_waitcnt lgkmcnt(4)
    ds_read_b128 v[80:83], v13 offset:4352
    v_mfma_f32_16x16x32_bf16 v[228:231], v[92:95], a[132:135], v[228:231]
    v_mfma_f32_16x16x32_bf16 v[224:227], v[92:95], a[128:131], v[224:227]
    s_waitcnt lgkmcnt(4)
    ds_read_b128 v[84:87], v13 offset:6400
    v_mfma_f32_16x16x32_bf16 v[224:227], v[88:91], a[120:123], v[224:227]
    v_mfma_f32_16x16x32_bf16 v[224:227], v[64:67], a[136:139], v[224:227]
    s_waitcnt lgkmcnt(4)
    ds_read_b128 v[88:91], v13 offset:4096
    v_mfma_f32_16x16x32_bf16 v[224:227], v[68:71], a[144:147], v[224:227]
    v_mfma_f32_16x16x32_bf16 v[228:231], v[68:71], a[148:151], v[228:231]
    s_waitcnt lgkmcnt(4)
    ds_read_b128 v[92:95], v13 offset:6144
    v_mfma_f32_16x16x32_bf16 v[228:231], v[64:67], a[140:143], v[228:231]
    v_mfma_f32_16x16x32_bf16 v[236:239], v[72:75], a[140:143], v[236:239]
    s_waitcnt lgkmcnt(4)
    ds_read_b128 v[64:67], v13 offset:8192
    v_mfma_f32_16x16x32_bf16 v[236:239], v[76:79], a[148:151], v[236:239]
    v_mfma_f32_16x16x32_bf16 v[232:235], v[76:79], a[144:147], v[232:235]
    s_waitcnt lgkmcnt(4)
    ds_read_b128 v[68:71], v13 offset:10240
    v_mfma_f32_16x16x32_bf16 v[232:235], v[72:75], a[136:139], v[232:235]
    v_mfma_f32_16x16x32_bf16 v[232:235], v[80:83], a[152:155], v[232:235]
    s_waitcnt lgkmcnt(4)
    ds_read_b128 v[72:75], v13 offset:8448
    v_mfma_f32_16x16x32_bf16 v[232:235], v[84:87], a[160:163], v[232:235]
    v_mfma_f32_16x16x32_bf16 v[236:239], v[84:87], a[164:167], v[236:239]
    s_waitcnt lgkmcnt(4)
    ds_read_b128 v[76:79], v13 offset:10496
    v_mfma_f32_16x16x32_bf16 v[236:239], v[80:83], a[156:159], v[236:239]
    v_mfma_f32_16x16x32_bf16 v[228:231], v[88:91], a[156:159], v[228:231]
    s_waitcnt lgkmcnt(4)
    ds_read_b128 v[80:83], v13 offset:12544
    v_mfma_f32_16x16x32_bf16 v[228:231], v[92:95], a[164:167], v[228:231]
    v_mfma_f32_16x16x32_bf16 v[224:227], v[92:95], a[160:163], v[224:227]
    s_waitcnt lgkmcnt(4)
    ds_read_b128 v[84:87], v13 offset:14592
    v_mfma_f32_16x16x32_bf16 v[224:227], v[88:91], a[152:155], v[224:227]
    v_mfma_f32_16x16x32_bf16 v[240:243], v[64:67], v[96:99], v[240:243]
    s_waitcnt lgkmcnt(4)
    ds_read_b128 v[88:91], v13 offset:12288
    v_mfma_f32_16x16x32_bf16 v[240:243], v[68:71], v[112:115], v[240:243]
    s_waitcnt vmcnt(5)
    v_cmp_gt_u32 vcc, 9, v111
    v_mfma_f32_16x16x32_bf16 v[244:247], v[68:71], v[116:119], v[244:247]
    s_waitcnt lgkmcnt(4)
    ds_read_b128 v[92:95], v13 offset:14336
    s_cmp_lg_u64 vcc, 0
    s_cselect_b32 s21, 0x40000000, 0
    v_mfma_f32_16x16x32_bf16 v[244:247], v[64:67], v[100:103], v[244:247]
    s_barrier
    v_mfma_f32_16x16x32_bf16 v[252:255], v[72:75], v[100:103], v[252:255]
    s_waitcnt lgkmcnt(4)
    ds_read_b128 v[64:67], v13 offset:16384
    v_or_b32 v107, s21, v4
    v_mfma_f32_16x16x32_bf16 v[252:255], v[76:79], v[116:119], v[252:255]
    s_nop 0
    v_mfma_f32_16x16x32_bf16 v[248:251], v[76:79], v[112:115], v[248:251]
    s_waitcnt lgkmcnt(4)
    ds_read_b128 v[68:71], v13 offset:18432
    v_mfma_f32_16x16x32_bf16 v[248:251], v[72:75], v[96:99], v[248:251]
    buffer_load_dword v61, v108, s[12:15], s26 offen sc1
    v_mfma_f32_16x16x32_bf16 v[248:251], v[80:83], v[128:131], v[248:251]
    s_waitcnt lgkmcnt(4)
    ds_read_b128 v[72:75], v13 offset:16640
    s_lshr_b32 s6, s20, 30
    s_lshr_b32 s7, s21, 29
    v_mfma_f32_16x16x32_bf16 v[248:251], v[84:87], a[0:3], v[248:251]
    buffer_load_dwordx4 a[184:187], v107, s[12:15], s51 offen offset:0 sc1
    v_mfma_f32_16x16x32_bf16 v[252:255], v[84:87], a[4:7], v[252:255]
    s_waitcnt lgkmcnt(4)
    ds_read_b128 v[76:79], v13 offset:18688
    s_or_b32 s6, s6, s7
    s_or_b32 s6, s6, 4
    v_mfma_f32_16x16x32_bf16 v[252:255], v[80:83], v[132:135], v[252:255]
    buffer_load_dwordx4 a[188:191], v107, s[12:15], s51 offen offset:1024 sc1
    v_mfma_f32_16x16x32_bf16 v[244:247], v[88:91], v[132:135], v[244:247]
    s_waitcnt lgkmcnt(4)
    ds_read_b128 v[80:83], v13 offset:20736
    v_mfma_f32_16x16x32_bf16 v[244:247], v[92:95], a[4:7], v[244:247]
    buffer_load_dwordx4 a[192:195], v107, s[12:15], s51 offen offset:2048 sc1
    v_mfma_f32_16x16x32_bf16 v[240:243], v[92:95], a[0:3], v[240:243]
    s_waitcnt lgkmcnt(4)
    ds_read_b128 v[84:87], v13 offset:22784
    v_mfma_f32_16x16x32_bf16 v[240:243], v[88:91], v[128:131], v[240:243]
    buffer_load_dwordx4 a[196:199], v107, s[12:15], s51 offen offset:3072 sc1
    v_mfma_f32_16x16x32_bf16 v[240:243], v[64:67], a[8:11], v[240:243]
    s_waitcnt lgkmcnt(4)
    ds_read_b128 v[88:91], v13 offset:20480
    v_mfma_f32_16x16x32_bf16 v[240:243], v[68:71], a[16:19], v[240:243]
    v_mfma_f32_16x16x32_bf16 v[244:247], v[68:71], a[20:23], v[244:247]
    s_waitcnt lgkmcnt(4)
    ds_read_b128 v[92:95], v13 offset:22528
    v_mfma_f32_16x16x32_bf16 v[244:247], v[64:67], a[12:15], v[244:247]
    v_mfma_f32_16x16x32_bf16 v[252:255], v[72:75], a[12:15], v[252:255]
    s_waitcnt lgkmcnt(4)
    ds_read_b128 v[64:67], v13 offset:24576
    v_mfma_f32_16x16x32_bf16 v[252:255], v[76:79], a[20:23], v[252:255]
    v_mfma_f32_16x16x32_bf16 v[248:251], v[76:79], a[16:19], v[248:251]
    s_waitcnt lgkmcnt(4)
    ds_read_b128 v[68:71], v13 offset:26624
    v_mfma_f32_16x16x32_bf16 v[248:251], v[72:75], a[8:11], v[248:251]
    v_mfma_f32_16x16x32_bf16 v[248:251], v[80:83], v[144:147], v[248:251]
    s_waitcnt lgkmcnt(4)
    ds_read_b128 v[72:75], v13 offset:24832
    v_mfma_f32_16x16x32_bf16 v[248:251], v[84:87], a[24:27], v[248:251]
    v_mfma_f32_16x16x32_bf16 v[252:255], v[84:87], a[28:31], v[252:255]
    s_waitcnt lgkmcnt(4)
    ds_read_b128 v[76:79], v13 offset:26880
    v_mfma_f32_16x16x32_bf16 v[252:255], v[80:83], v[148:151], v[252:255]
    v_mfma_f32_16x16x32_bf16 v[244:247], v[88:91], v[148:151], v[244:247]
    s_waitcnt lgkmcnt(4)
    ds_read_b128 v[80:83], v13 offset:28928
    v_mfma_f32_16x16x32_bf16 v[244:247], v[92:95], a[28:31], v[244:247]
    v_mfma_f32_16x16x32_bf16 v[240:243], v[92:95], a[24:27], v[240:243]
    s_waitcnt lgkmcnt(4)
    ds_read_b128 v[84:87], v13 offset:30976
    v_mfma_f32_16x16x32_bf16 v[240:243], v[88:91], v[144:147], v[240:243]
    v_mfma_f32_16x16x32_bf16 v[240:243], v[64:67], a[32:35], v[240:243]
    s_waitcnt lgkmcnt(4)
    ds_read_b128 v[88:91], v13 offset:28672
    v_mfma_f32_16x16x32_bf16 v[240:243], v[68:71], a[40:43], v[240:243]
    v_mfma_f32_16x16x32_bf16 v[244:247], v[68:71], a[44:47], v[244:247]
    s_waitcnt lgkmcnt(4)
    ds_read_b128 v[92:95], v13 offset:30720
    v_mfma_f32_16x16x32_bf16 v[244:247], v[64:67], a[36:39], v[244:247]
    s_barrier
    v_mfma_f32_16x16x32_bf16 v[252:255], v[72:75], a[36:39], v[252:255]
    s_waitcnt lgkmcnt(4)
    ds_read_b128 v[64:67], v13 offset:32768
    v_mfma_f32_16x16x32_bf16 v[252:255], v[76:79], a[44:47], v[252:255]
    v_mfma_f32_16x16x32_bf16 v[248:251], v[76:79], a[40:43], v[248:251]
    s_waitcnt lgkmcnt(4)
    ds_read_b128 v[68:71], v13 offset:34816
    v_mfma_f32_16x16x32_bf16 v[248:251], v[72:75], a[32:35], v[248:251]
    v_mfma_f32_16x16x32_bf16 v[248:251], v[80:83], v[160:163], v[248:251]
    s_waitcnt lgkmcnt(4)
    ds_read_b128 v[72:75], v13 offset:33024
    v_mfma_f32_16x16x32_bf16 v[248:251], v[84:87], a[48:51], v[248:251]
    v_mfma_f32_16x16x32_bf16 v[252:255], v[84:87], a[52:55], v[252:255]
    s_waitcnt lgkmcnt(4)
    ds_read_b128 v[76:79], v13 offset:35072
    v_mfma_f32_16x16x32_bf16 v[252:255], v[80:83], v[164:167], v[252:255]
    v_mfma_f32_16x16x32_bf16 v[244:247], v[88:91], v[164:167], v[244:247]
    s_waitcnt lgkmcnt(4)
    ds_read_b128 v[80:83], v13 offset:37120
    v_mfma_f32_16x16x32_bf16 v[244:247], v[92:95], a[52:55], v[244:247]
    v_mfma_f32_16x16x32_bf16 v[240:243], v[92:95], a[48:51], v[240:243]
    s_waitcnt lgkmcnt(4)
    ds_read_b128 v[84:87], v13 offset:39168
    v_mfma_f32_16x16x32_bf16 v[240:243], v[88:91], v[160:163], v[240:243]
    v_mfma_f32_16x16x32_bf16 v[240:243], v[64:67], a[56:59], v[240:243]
    s_waitcnt lgkmcnt(4)
    ds_read_b128 v[88:91], v13 offset:36864
    v_mfma_f32_16x16x32_bf16 v[240:243], v[68:71], a[64:67], v[240:243]
    v_mfma_f32_16x16x32_bf16 v[244:247], v[68:71], a[68:71], v[244:247]
    s_waitcnt lgkmcnt(4)
    ds_read_b128 v[92:95], v13 offset:38912
    v_mfma_f32_16x16x32_bf16 v[244:247], v[64:67], a[60:63], v[244:247]
    v_mfma_f32_16x16x32_bf16 v[252:255], v[72:75], a[60:63], v[252:255]
    s_waitcnt lgkmcnt(4)
    ds_read_b128 v[64:67], v13 offset:40960
    v_mfma_f32_16x16x32_bf16 v[252:255], v[76:79], a[68:71], v[252:255]
    v_mfma_f32_16x16x32_bf16 v[248:251], v[76:79], a[64:67], v[248:251]
    s_waitcnt lgkmcnt(4)
    ds_read_b128 v[68:71], v13 offset:43008
    v_mfma_f32_16x16x32_bf16 v[248:251], v[72:75], a[56:59], v[248:251]
    v_mfma_f32_16x16x32_bf16 v[248:251], v[80:83], v[176:179], v[248:251]
    s_waitcnt lgkmcnt(4)
    ds_read_b128 v[72:75], v13 offset:41216
    v_mfma_f32_16x16x32_bf16 v[248:251], v[84:87], a[72:75], v[248:251]
    s_waitcnt vmcnt(4)
    v_cmp_gt_u32 vcc, v104, v61
    v_mfma_f32_16x16x32_bf16 v[252:255], v[84:87], a[76:79], v[252:255]
    s_waitcnt lgkmcnt(4)
    ds_read_b128 v[76:79], v13 offset:43264
    s_andn2_b32 s7, s6, vcc_lo
    s_and_b32 s6, s6, vcc_lo
    s_bitcmp0_b32 s7, 2
    s_cbranch_scc1 T2_ffb_kernel
    buffer_load_dwordx4 a[200:203], v4, s[12:15], s53 offen offset:0 sc1
    buffer_load_dwordx4 a[204:207], v4, s[12:15], s53 offen offset:1024 sc1
    buffer_load_dwordx4 a[208:211], v4, s[12:15], s53 offen offset:2048 sc1
    buffer_load_dwordx4 a[212:215], v4, s[12:15], s53 offen offset:3072 sc1
T2_ffb_kernel:
    s_bitcmp0_b32 s7, 1
    s_cbranch_scc1 T1_ffb_kernel
    buffer_load_dwordx4 a[184:187], v4, s[12:15], s51 offen offset:0 sc1
    buffer_load_dwordx4 a[188:191], v4, s[12:15], s51 offen offset:1024 sc1
    buffer_load_dwordx4 a[192:195], v4, s[12:15], s51 offen offset:2048 sc1
    buffer_load_dwordx4 a[196:199], v4, s[12:15], s51 offen offset:3072 sc1
T1_ffb_kernel:
    s_bitcmp0_b32 s7, 0
    s_cbranch_scc1 T0_ffb_kernel
    buffer_load_dwordx4 a[168:171], v4, s[12:15], s50 offen offset:0 sc1
    buffer_load_dwordx4 a[172:175], v4, s[12:15], s50 offen offset:1024 sc1
    buffer_load_dwordx4 a[176:179], v4, s[12:15], s50 offen offset:2048 sc1
    buffer_load_dwordx4 a[180:183], v4, s[12:15], s50 offen offset:3072 sc1
T0_ffb_kernel:
    v_mfma_f32_16x16x32_bf16 v[252:255], v[80:83], v[180:183], v[252:255]
    v_mfma_f32_16x16x32_bf16 v[244:247], v[88:91], v[180:183], v[244:247]
    s_waitcnt lgkmcnt(4)
    ds_read_b128 v[80:83], v13 offset:45312
    v_mfma_f32_16x16x32_bf16 v[244:247], v[92:95], a[76:79], v[244:247]
    v_mfma_f32_16x16x32_bf16 v[240:243], v[92:95], a[72:75], v[240:243]
    s_waitcnt lgkmcnt(4)
    ds_read_b128 v[84:87], v13 offset:47360
    v_mfma_f32_16x16x32_bf16 v[240:243], v[88:91], v[176:179], v[240:243]
    v_mfma_f32_16x16x32_bf16 v[240:243], v[64:67], a[80:83], v[240:243]
    s_waitcnt lgkmcnt(4)
    ds_read_b128 v[88:91], v13 offset:45056
    v_mfma_f32_16x16x32_bf16 v[240:243], v[68:71], a[88:91], v[240:243]
    v_mfma_f32_16x16x32_bf16 v[244:247], v[68:71], a[92:95], v[244:247]
    s_waitcnt lgkmcnt(4)
    ds_read_b128 v[92:95], v13 offset:47104
    v_mfma_f32_16x16x32_bf16 v[244:247], v[64:67], a[84:87], v[244:247]
    s_barrier
    v_mfma_f32_16x16x32_bf16 v[252:255], v[72:75], a[84:87], v[252:255]
    s_waitcnt lgkmcnt(4)
    ds_read_b128 v[64:67], v13 offset:49152
    v_mfma_f32_16x16x32_bf16 v[252:255], v[76:79], a[92:95], v[252:255]
    buffer_load_dword v62, v108, s[12:15], s26 offen sc1
    v_mfma_f32_16x16x32_bf16 v[248:251], v[76:79], a[88:91], v[248:251]
    s_waitcnt lgkmcnt(4)
    ds_read_b128 v[68:71], v13 offset:51200
    v_mfma_f32_16x16x32_bf16 v[248:251], v[72:75], a[80:83], v[248:251]
    v_mfma_f32_16x16x32_bf16 v[248:251], v[80:83], v[192:195], v[248:251]
    s_waitcnt lgkmcnt(4)
    ds_read_b128 v[72:75], v13 offset:49408
    v_mfma_f32_16x16x32_bf16 v[248:251], v[84:87], a[96:99], v[248:251]
    v_mfma_f32_16x16x32_bf16 v[252:255], v[84:87], a[100:103], v[252:255]
    s_waitcnt lgkmcnt(4)
    ds_read_b128 v[76:79], v13 offset:51456
    v_mfma_f32_16x16x32_bf16 v[252:255], v[80:83], v[196:199], v[252:255]
    v_mfma_f32_16x16x32_bf16 v[244:247], v[88:91], v[196:199], v[244:247]
    s_waitcnt lgkmcnt(4)
    ds_read_b128 v[80:83], v13 offset:53504
    v_mfma_f32_16x16x32_bf16 v[244:247], v[92:95], a[100:103], v[244:247]
    v_mfma_f32_16x16x32_bf16 v[240:243], v[92:95], a[96:99], v[240:243]
    s_waitcnt lgkmcnt(4)
    ds_read_b128 v[84:87], v13 offset:55552
    v_mfma_f32_16x16x32_bf16 v[240:243], v[88:91], v[192:195], v[240:243]
    v_mfma_f32_16x16x32_bf16 v[240:243], v[64:67], a[104:107], v[240:243]
    s_waitcnt lgkmcnt(4)
    ds_read_b128 v[88:91], v13 offset:53248
    v_mfma_f32_16x16x32_bf16 v[240:243], v[68:71], a[112:115], v[240:243]
    v_mfma_f32_16x16x32_bf16 v[244:247], v[68:71], a[116:119], v[244:247]
    s_waitcnt lgkmcnt(4)
    ds_read_b128 v[92:95], v13 offset:55296
    v_mfma_f32_16x16x32_bf16 v[244:247], v[64:67], a[108:111], v[244:247]
    v_mfma_f32_16x16x32_bf16 v[252:255], v[72:75], a[108:111], v[252:255]
    s_waitcnt lgkmcnt(4)
    ds_read_b128 v[64:67], v13 offset:57344
    v_mfma_f32_16x16x32_bf16 v[252:255], v[76:79], a[116:119], v[252:255]
    v_mfma_f32_16x16x32_bf16 v[248:251], v[76:79], a[112:115], v[248:251]
    s_waitcnt lgkmcnt(4)
    ds_read_b128 v[68:71], v13 offset:59392
    v_mfma_f32_16x16x32_bf16 v[248:251], v[72:75], a[104:107], v[248:251]
    v_mfma_f32_16x16x32_bf16 v[248:251], v[80:83], a[120:123], v[248:251]
    s_waitcnt lgkmcnt(4)
    ds_read_b128 v[72:75], v13 offset:57600
    v_mfma_f32_16x16x32_bf16 v[248:251], v[84:87], a[128:131], v[248:251]
    v_mfma_f32_16x16x32_bf16 v[252:255], v[84:87], a[132:135], v[252:255]
    s_waitcnt lgkmcnt(4)
    ds_read_b128 v[76:79], v13 offset:59648
    v_mfma_f32_16x16x32_bf16 v[252:255], v[80:83], a[124:127], v[252:255]
    v_mfma_f32_16x16x32_bf16 v[244:247], v[88:91], a[124:127], v[244:247]
    s_waitcnt lgkmcnt(4)
    ds_read_b128 v[80:83], v13 offset:61696
    v_mfma_f32_16x16x32_bf16 v[244:247], v[92:95], a[132:135], v[244:247]
    v_mfma_f32_16x16x32_bf16 v[240:243], v[92:95], a[128:131], v[240:243]
    s_waitcnt lgkmcnt(4)
    ds_read_b128 v[84:87], v13 offset:63744
    v_mfma_f32_16x16x32_bf16 v[240:243], v[88:91], a[120:123], v[240:243]
    v_mfma_f32_16x16x32_bf16 v[240:243], v[64:67], a[136:139], v[240:243]
    s_waitcnt lgkmcnt(4)
    ds_read_b128 v[88:91], v13 offset:61440
    v_mfma_f32_16x16x32_bf16 v[240:243], v[68:71], a[144:147], v[240:243]
    v_mfma_f32_16x16x32_bf16 v[244:247], v[68:71], a[148:151], v[244:247]
    s_waitcnt lgkmcnt(4)
    ds_read_b128 v[92:95], v13 offset:63488
    v_mfma_f32_16x16x32_bf16 v[244:247], v[64:67], a[140:143], v[244:247]
    v_mfma_f32_16x16x32_bf16 v[252:255], v[72:75], a[140:143], v[252:255]
    s_waitcnt lgkmcnt(4)
    v_mfma_f32_16x16x32_bf16 v[252:255], v[76:79], a[148:151], v[252:255]
    v_mfma_f32_16x16x32_bf16 v[248:251], v[76:79], a[144:147], v[248:251]
    s_waitcnt lgkmcnt(3)
    v_mfma_f32_16x16x32_bf16 v[248:251], v[72:75], a[136:139], v[248:251]
    v_mfma_f32_16x16x32_bf16 v[248:251], v[80:83], a[152:155], v[248:251]
    s_waitcnt lgkmcnt(2)
    v_mfma_f32_16x16x32_bf16 v[248:251], v[84:87], a[160:163], v[248:251]
    v_mfma_f32_16x16x32_bf16 v[252:255], v[84:87], a[164:167], v[252:255]
    s_waitcnt lgkmcnt(1)
    v_mfma_f32_16x16x32_bf16 v[252:255], v[80:83], a[156:159], v[252:255]
    v_mfma_f32_16x16x32_bf16 v[244:247], v[88:91], a[156:159], v[244:247]
    s_waitcnt lgkmcnt(0)
    v_mfma_f32_16x16x32_bf16 v[244:247], v[92:95], a[164:167], v[244:247]
    v_mfma_f32_16x16x32_bf16 v[240:243], v[92:95], a[160:163], v[240:243]
    v_mfma_f32_16x16x32_bf16 v[240:243], v[88:91], a[152:155], v[240:243]
    s_cmp_lg_u32 s6, 0
    s_cbranch_scc1 FB_ffb_kernel
FBACK_ffb_kernel:
    s_waitcnt vmcnt(0)
    v_mfma_f32_16x16x32_bf16 v[224:227], v[18:21], a[168:171], v[224:227]
    v_mfma_f32_16x16x32_bf16 v[232:235], v[16:19], a[168:171], v[232:235]
    v_mfma_f32_16x16x32_bf16 v[228:231], v[18:21], a[172:175], v[228:231]
    v_mfma_f32_16x16x32_bf16 v[236:239], v[16:19], a[172:175], v[236:239]
    v_mfma_f32_16x16x32_bf16 v[240:243], v[18:21], a[176:179], v[240:243]
    v_mfma_f32_16x16x32_bf16 v[248:251], v[16:19], a[176:179], v[248:251]
    v_mfma_f32_16x16x32_bf16 v[244:247], v[18:21], a[180:183], v[244:247]
    v_mfma_f32_16x16x32_bf16 v[252:255], v[16:19], a[180:183], v[252:255]
    v_mfma_f32_16x16x32_bf16 v[224:227], v[18:21], a[184:187], v[224:227]
    v_mfma_f32_16x16x32_bf16 v[232:235], v[16:19], a[184:187], v[232:235]
    v_mfma_f32_16x16x32_bf16 v[228:231], v[18:21], a[188:191], v[228:231]
    v_mfma_f32_16x16x32_bf16 v[236:239], v[16:19], a[188:191], v[236:239]
    v_mfma_f32_16x16x32_bf16 v[240:243], v[18:21], a[192:195], v[240:243]
    v_mfma_f32_16x16x32_bf16 v[248:251], v[16:19], a[192:195], v[248:251]
    v_mfma_f32_16x16x32_bf16 v[244:247], v[18:21], a[196:199], v[244:247]
    v_mfma_f32_16x16x32_bf16 v[252:255], v[16:19], a[196:199], v[252:255]
    v_mfma_f32_16x16x32_bf16 v[224:227], v[18:21], a[200:203], v[224:227]
    v_mfma_f32_16x16x32_bf16 v[232:235], v[16:19], a[200:203], v[232:235]
    v_mfma_f32_16x16x32_bf16 v[228:231], v[18:21], a[204:207], v[228:231]
    v_mfma_f32_16x16x32_bf16 v[236:239], v[16:19], a[204:207], v[236:239]
    v_mfma_f32_16x16x32_bf16 v[240:243], v[18:21], a[208:211], v[240:243]
    v_mfma_f32_16x16x32_bf16 v[248:251], v[16:19], a[208:211], v[248:251]
    v_mfma_f32_16x16x32_bf16 v[244:247], v[18:21], a[212:215], v[244:247]
    v_mfma_f32_16x16x32_bf16 v[252:255], v[16:19], a[212:215], v[252:255]
    s_nop 7
    v_cvt_pk_bf16_f32 v40, v224, v225
    v_cvt_pk_bf16_f32 v41, v226, v227
    v_cvt_pk_bf16_f32 v42, v232, v233
    v_cvt_pk_bf16_f32 v43, v234, v235
    buffer_store_dwordx4 v[40:43], v8, s[8:11], s32 offen offset:0 sc1
    v_cvt_pk_bf16_f32 v44, v228, v229
    v_cvt_pk_bf16_f32 v45, v230, v231
    v_cvt_pk_bf16_f32 v46, v236, v237
    v_cvt_pk_bf16_f32 v47, v238, v239
    buffer_store_dwordx4 v[44:47], v8, s[8:11], s33 offen offset:0 sc1
    v_cvt_pk_bf16_f32 v48, v240, v241
    v_cvt_pk_bf16_f32 v49, v242, v243
    v_cvt_pk_bf16_f32 v50, v248, v249
    v_cvt_pk_bf16_f32 v51, v250, v251
    buffer_store_dwordx4 v[48:51], v8, s[8:11], s32 offen offset:64 sc1
    v_cvt_pk_bf16_f32 v52, v244, v245
    v_cvt_pk_bf16_f32 v53, v246, v247
    v_cvt_pk_bf16_f32 v54, v252, v253
    v_cvt_pk_bf16_f32 v55, v254, v255
    buffer_store_dwordx4 v[52:55], v8, s[8:11], s33 offen offset:64 sc1
END_ffb_kernel:
    s_endpgm
FB_ffb_kernel:
    s_waitcnt vmcnt(0)
    v_cmp_gt_u32 vcc, v104, v62
    s_nop 2
    s_add_u32 s52, s52, 1
    s_cmp_gt_u32 s52, 200000
    s_cselect_b32 s28, 0, vcc_lo
    s_andn2_b32 s5, s6, s28
    s_bitcmp0_b32 s5, 2
    s_cbranch_scc1 U2_ffb_kernel
    buffer_load_dwordx4 a[200:203], v4, s[12:15], s53 offen offset:0 sc1
    buffer_load_dwordx4 a[204:207], v4, s[12:15], s53 offen offset:1024 sc1
    buffer_load_dwordx4 a[208:211], v4, s[12:15], s53 offen offset:2048 sc1
    buffer_load_dwordx4 a[212:215], v4, s[12:15], s53 offen offset:3072 sc1
U2_ffb_kernel:
    s_bitcmp0_b32 s5, 1
    s_cbranch_scc1 U1_ffb_kernel
    buffer_load_dwordx4 a[184:187], v4, s[12:15], s51 offen offset:0 sc1
    buffer_load_dwordx4 a[188:191], v4, s[12:15], s51 offen offset:1024 sc1
    buffer_load_dwordx4 a[192:195], v4, s[12:15], s51 offen offset:2048 sc1
    buffer_load_dwordx4 a[196:199], v4, s[12:15], s51 offen offset:3072 sc1
U1_ffb_kernel:
    s_bitcmp0_b32 s5, 0
    s_cbranch_scc1 U0_ffb_kernel
    buffer_load_dwordx4 a[168:171], v4, s[12:15], s50 offen offset:0 sc1
    buffer_load_dwordx4 a[172:175], v4, s[12:15], s50 offen offset:1024 sc1
    buffer_load_dwordx4 a[176:179], v4, s[12:15], s50 offen offset:2048 sc1
    buffer_load_dwordx4 a[180:183], v4, s[12:15], s50 offen offset:3072 sc1
U0_ffb_kernel:
    s_and_b32 s6, s6, s28
    s_cbranch_scc0 FBACK_ffb_kernel
    buffer_load_dword v62, v108, s[12:15], s26 offen sc1
    s_branch FB_ffb_kernel
SLOW0_ffb_kernel:
    s_add_u32 s52, s52, 1
    s_cmp_gt_u32 s52, 200000
    s_cbranch_scc1 BACK0_ffb_kernel
    buffer_load_dword v61, v58, s[12:15], s26 offen sc1
    s_waitcnt vmcnt(0)
    v_cmp_gt_u32 vcc, 1, v61
    s_nop 4
    s_cbranch_vccnz SLOW0_ffb_kernel
    s_branch BACK0_ffb_kernel
SLOW1_ffb_kernel:
    s_add_u32 s52, s52, 1
    s_cmp_gt_u32 s52, 200000
    s_cbranch_scc1 BACK1_ffb_kernel
    buffer_load_dword v62, v58, s[12:15], s26 offen sc1
    s_waitcnt vmcnt(0)
    v_cmp_gt_u32 vcc, 2, v62
    s_nop 4
    s_cbranch_vccnz SLOW1_ffb_kernel
    s_branch BACK1_ffb_kernel
SLOW2_ffb_kernel:
    s_add_u32 s52, s52, 1
    s_cmp_gt_u32 s52, 200000
    s_cbranch_scc1 BACK2_ffb_kernel
    buffer_load_dword v61, v58, s[12:15], s26 offen sc1
    s_waitcnt vmcnt(0)
    v_cmp_gt_u32 vcc, 3, v61
    s_nop 4
    s_cbranch_vccnz SLOW2_ffb_kernel
    s_branch BACK2_ffb_kernel
SLOW3_ffb_kernel:
    s_add_u32 s52, s52, 1
    s_cmp_gt_u32 s52, 200000
    s_cbranch_scc1 BACK3_ffb_kernel
    buffer_load_dword v62, v58, s[12:15], s26 offen sc1
    s_waitcnt vmcnt(0)
    v_cmp_gt_u32 vcc, 4, v62
    s_nop 4
    s_cbranch_vccnz SLOW3_ffb_kernel
    s_branch BACK3_ffb_kernel
SLOWX_ffb_kernel:
    s_add_u32 s52, s52, 1
    s_cmp_gt_u32 s52, 200000
    s_cbranch_scc1 BACKX_ffb_kernel
    buffer_load_dword v109, v15, s[12:15], s26 offen sc1
    s_waitcnt vmcnt(0)
    v_cmp_gt_u32 vcc, 3, v109
    s_nop 4
    s_cbranch_vccnz SLOWX_ffb_kernel
    s_branch BACKX_ffb_kernel
SLOW4_ffb_kernel:
    s_add_u32 s52, s52, 1
    s_cmp_gt_u32 s52, 200000
    s_cbranch_scc1 BACK4_ffb_kernel
    buffer_load_dword v61, v58, s[12:15], s26 offen sc1
    s_waitcnt vmcnt(0)
    v_cmp_gt_u32 vcc, 5, v61
    s_nop 4
    s_cbranch_vccnz SLOW4_ffb_kernel
    s_branch BACK4_ffb_kernel
SLOW5_ffb_kernel:
    s_add_u32 s52, s52, 1
    s_cmp_gt_u32 s52, 200000
    s_cbranch_scc1 BACK5_ffb_kernel
    buffer_load_dword v62, v58, s[12:15], s26 offen sc1
    s_waitcnt vmcnt(0)
    v_cmp_gt_u32 vcc, 6, v62
    s_nop 4
    s_cbranch_vccnz SLOW5_ffb_kernel
    s_branch BACK5_ffb_kernel
SLOW6_ffb_kernel:
    s_add_u32 s52, s52, 1
    s_cmp_gt_u32 s52, 200000
    s_cbranch_scc1 BACK6_ffb_kernel
    buffer_load_dword v61, v58, s[12:15], s26 offen sc1
    s_waitcnt vmcnt(0)
    v_cmp_gt_u32 vcc, 7, v61
    s_nop 4
    s_cbranch_vccnz SLOW6_ffb_kernel
    s_branch BACK6_ffb_kernel
LAST_ffb_kernel:

.section .rodata,"a"
.p2align 6
.amdhsa_kernel k1_kernel
  .amdhsa_next_free_vgpr 336
  .amdhsa_next_free_sgpr 96
  .amdhsa_accum_offset 256
  .amdhsa_group_segment_fixed_size 0
  .amdhsa_kernarg_size 72
  .amdhsa_user_sgpr_count 2
  .amdhsa_user_sgpr_kernarg_segment_ptr 1
  .amdhsa_system_sgpr_workgroup_id_x 1
.end_amdhsa_kernel

.p2align 6
.amdhsa_kernel k2_kernel
  .amdhsa_next_free_vgpr 256
  .amdhsa_next_free_sgpr 96
  .amdhsa_accum_offset 256
  .amdhsa_group_segment_fixed_size 0
  .amdhsa_kernarg_size 72
  .amdhsa_user_sgpr_count 2
  .amdhsa_user_sgpr_kernarg_segment_ptr 1
  .amdhsa_system_sgpr_workgroup_id_x 1
.end_amdhsa_kernel

.p2align 6
.amdhsa_kernel k2b_kernel
  .amdhsa_next_free_vgpr 256
  .amdhsa_next_free_sgpr 96
  .amdhsa_accum_offset 256
  .amdhsa_group_segment_fixed_size 0
  .amdhsa_kernarg_size 72
  .amdhsa_user_sgpr_count 2
  .amdhsa_user_sgpr_kernarg_segment_ptr 1
  .amdhsa_system_sgpr_workgroup_id_x 1
.end_amdhsa_kernel

.p2align 6
.amdhsa_kernel ff_kernel
  .amdhsa_next_free_vgpr 512
  .amdhsa_next_free_sgpr 102
  .amdhsa_accum_offset 256
  .amdhsa_group_segment_fixed_size 0
  .amdhsa_kernarg_size 72
  .amdhsa_user_sgpr_count 2
  .amdhsa_user_sgpr_kernarg_segment_ptr 1
  .amdhsa_system_sgpr_workgroup_id_x 1
.end_amdhsa_kernel

.p2align 6
.amdhsa_kernel ffb_kernel
  .amdhsa_next_free_vgpr 512
  .amdhsa_next_free_sgpr 102
  .amdhsa_accum_offset 256
  .amdhsa_group_segment_fixed_size 0
  .amdhsa_kernarg_size 72
  .amdhsa_user_sgpr_count 2
  .amdhsa_user_sgpr_kernarg_segment_ptr 1
  .amdhsa_system_sgpr_workgroup_id_x 1
.end_amdhsa_kernel
```
